```python
import torch

def _softmax(x, axis=-1):
    return torch.softmax(x, dim=axis)
def _gelu(x):
    return torch.nn.functional.gelu(x, approximate="tanh")
def _silu(x):
    return torch.nn.functional.silu(x)
def _sigmoid(x):
    return torch.sigmoid(x)
def _layernorm(x, axis=-1, eps=1e-5):
    m = x.mean(dim=axis, keepdim=True)
    v = x.var(dim=axis, keepdim=True, unbiased=False)
    return (x - m) / torch.sqrt(v + eps)
def _scatter_add(tgt, idx, src, axis=0):
    return tgt.clone().index_add_(axis, idx, src)
def _segment_sum(src, seg, n):
    out = torch.zeros((n,) + src.shape[1:], dtype=src.dtype)
    return out.index_add_(0, seg, src)
def _pad(x, pw):
    flat = tuple(v for pair in reversed(pw) for v in pair)
    return torch.nn.functional.pad(x, flat)

kernel_name = 'sequential_preLN__mha_block__glu_gated_reglu__prompt'

def setup_inputs():

    _w = (lambda a: (lambda t: t.to(torch.bfloat16) if t.is_floating_point() else t)(torch.as_tensor(a)))
    def _A_setup():
        B, S, D, H = 1, 2048, 1024, 32
        return {
            "x": _w((lambda *s: torch.randn(*s, dtype=torch.bfloat16) * 0.05)(B, S, D)),
            "wqkv": _w((lambda *s: torch.randn(*s, dtype=torch.bfloat16) * 0.05)(D, 3 * D)),
            "wo": _w((lambda *s: torch.randn(*s, dtype=torch.bfloat16) * 0.05)(D, D)),
        }
    _A_in = _A_setup()

    def _B_setup():
        B, S, D, F = 1, 2048, 1024, 3584
        return {
            "x": _w((lambda *s: torch.randn(*s, dtype=torch.bfloat16) * 0.05)(B, S, D)),
            "W_gate": _w((lambda *s: torch.randn(*s, dtype=torch.bfloat16) * 0.8)(D, F) * (2.0 / D) ** 0.5),
            "W_up": _w((lambda *s: torch.randn(*s, dtype=torch.bfloat16) * 0.8)(D, F) * (2.0 / D) ** 0.5),
            "W_down": _w((lambda *s: torch.randn(*s, dtype=torch.bfloat16) * 0.8)(F, D) * (1.0 / F) ** 0.5),
        }
    _B_in = _B_setup()

    return {
        "A_x": _A_in["x"],
        "A_wqkv": _A_in["wqkv"],
        "A_wo": _A_in["wo"],
        "B_x": _B_in["x"],
        "B_W_gate": _B_in["W_gate"],
        "B_W_up": _B_in["W_up"],
        "B_W_down": _B_in["W_down"],
    }

def reference(A_x, A_wqkv, A_wo, B_x, B_W_gate, B_W_up, B_W_down):
    def _A_ref(x, wqkv, wo):
        B, S, D = x.shape
        H = 32
        Dh = D // H
        qkv = (lambda x, *d: x.permute(*d))((x @ wqkv).reshape(B, S, 3, H, Dh), 2, 0, 3, 1, 4)
        q, k, v = qkv[0], qkv[1], qkv[2]
        scores = torch.einsum("bhqd,bhkd->bhqk", q, k) * (Dh ** -0.5)
        p = _softmax(scores, axis=-1)
        o = torch.einsum("bhqk,bhkd->bhqd", p, v)
        return (lambda x, *d: x.permute(*d))(o, 0, 2, 1, 3).reshape(B, S, D) @ wo

    def _B_ref(x, W_gate, W_up, W_down):
        gate = torch.einsum("bsd,df->bsf", x, W_gate)
        up = torch.einsum("bsd,df->bsf", x, W_up)
        gate = gate * (lambda x, dt: x.to(dt))(gate > 0, gate.dtype)
        h = gate * up
        return torch.einsum("bsf,fd->bsd", h, W_down)

    x = A_x
    h = x + _A_ref(_layernorm(x, axis=-1), A_wqkv, A_wo)
    h2 = h + _B_ref(_layernorm(h, axis=-1), B_W_gate, B_W_up, B_W_down)
    return h2
```

```asm
; @launch kernel=sequential_preLN__mha_block__glu_gated_reglu__prompt_kernel grid=(256,1,1) block=(256,1,1) lds=163840
.amdgcn_target "amdgcn-amd-amdhsa--gfx950"
.text
.globl sequential_preLN__mha_block__glu_gated_reglu__prompt_kernel
.p2align 8
.type sequential_preLN__mha_block__glu_gated_reglu__prompt_kernel,@function
sequential_preLN__mha_block__glu_gated_reglu__prompt_kernel:
    s_cmp_ge_u32 s2, 256
    s_cbranch_scc1 L_sequential_preLN__mha_block__glu_gated_reglu__prompt_kernel_end
    s_load_dwordx16 s[64:79], s[0:1], 0
    s_load_dwordx4 s[80:83], s[0:1], 64
    s_getpc_b64 s[20:21]
    v_lshrrev_b32 v2, 6, v0
    v_and_b32 v1, 63, v0
    v_lshl_add_u32 v7, v2, 4, v1
    v_lshlrev_b32 v7, 7, v7
    s_mov_b32 s22, 0x17078
    s_mov_b32 s23, 0x20000
    s_mov_b64 exec, 0xffff
    buffer_load_dword a252, v7, s[20:23], 0 offen
    s_mov_b64 exec, -1
    v_readfirstlane_b32 s3, v2
    v_lshlrev_b32 v4, 4, v1
    s_lshl_b32 s16, s2, 14
    s_nop 1
    s_lshl_b32 s17, s3, 12
    s_add_u32 s16, s16, s17
    s_mov_b32 s10, 4194304
    s_mov_b32 s11, 0x20000
    s_waitcnt lgkmcnt(0)
    s_mov_b32 s8, s64
    s_mov_b32 s9, s65
    buffer_load_dwordx4 v[136:139], v4, s[8:11], s16 offen offset:0
    buffer_load_dwordx4 v[140:143], v4, s[8:11], s16 offen offset:1024
    buffer_load_dwordx4 v[144:147], v4, s[8:11], s16 offen offset:2048
    buffer_load_dwordx4 v[148:151], v4, s[8:11], s16 offen offset:3072
    s_and_b32 s28, s2, 7
    s_lshr_b32 s29, s2, 3
    s_and_b32 s30, s28, 1
    s_lshl_b32 s30, s30, 3
    s_and_b32 s4, s29, 7
    s_add_u32 s30, s30, s4
    s_lshr_b32 s31, s28, 1
    s_lshl_b32 s31, s31, 2
    s_lshr_b32 s4, s29, 3
    s_add_u32 s31, s31, s4
    s_and_b32 s32, s28, 3
    s_lshl_b32 s32, s32, 2
    s_and_b32 s4, s29, 3
    s_add_u32 s32, s32, s4
    s_lshr_b32 s33, s28, 2
    s_lshl_b32 s33, s33, 3
    s_lshr_b32 s4, s29, 2
    s_add_u32 s33, s33, s4
    s_lshl_b32 s34, s28, 2
    s_lshr_b32 s4, s29, 3
    s_add_u32 s34, s34, s4
    s_and_b32 s35, s29, 7
    s_lshr_b32 s36, s3, 1
    s_and_b32 s37, s3, 1
    s_and_b32 s92, s29, 15
    s_lshr_b32 s93, s29, 4
    s_lshl_b32 s4, s28, 1
    s_add_u32 s93, s93, s4
    s_waitcnt lgkmcnt(0)
    s_add_u32 s84, s82, 0x2c00000
    s_addc_u32 s85, s83, 0
    s_mov_b32 s86, 0x100000
    s_mov_b32 s87, 0x20000
    s_load_dword s88, s[84:85], 0
    s_add_u32 s24, s82, 0x2a00000
    s_addc_u32 s25, s83, 0
    s_mov_b32 s26, 0x300000
    s_mov_b32 s27, 0x20000
    s_lshl_b32 s4, s2, 2
    s_add_u32 s4, s4, s3
    s_lshl_b32 s5, s4, 8
    v_lshl_add_u32 v2, v1, 7, s5
    s_lshl_b32 s5, s4, 5
    s_add_u32 s5, s5, 3080192
    v_writelane_b32 v2, s5, 2
    s_lshl_b32 s5, s28, 5
    s_add_u32 s5, s5, s29
    s_lshl_b32 s5, s5, 7
    s_add_u32 s5, s5, 2523136
    v_writelane_b32 v2, s5, 3
    s_lshl_b32 s5, s93, 7
    s_add_u32 s5, s5, 2109440
    v_writelane_b32 v2, s5, 4
    s_mov_b64 exec, 0x1f
    buffer_load_dword a244, v2, s[24:27], 0 offen sc1
    s_mov_b64 exec, -1
    v_lshrrev_b32 v2, 3, v1
    v_and_b32 v3, 7, v1
    v_xor_b32 v3, v3, v2
    v_lshlrev_b32 v20, 11, v2
    v_lshl_add_u32 v20, v3, 4, v20
    v_add_u32 v21, 16384, v20
    v_add_u32 v22, 32768, v20
    v_add_u32 v23, 49152, v20
    s_lshl_b32 s58, s92, 18
    s_lshl_b32 s19, s3, 16
    s_add_u32 s58, s58, s19
    s_lshl_b32 s19, s3, 12
    s_mul_i32 s61, s28, 2
    s_add_u32 s61, s61, s92
    s_and_b32 s61, s61, 15
    s_lshl_b32 s60, s61, 7
    s_add_u32 s16, s58, s60
    s_mov_b32 s12, s66
    s_mov_b32 s13, s67
    s_mov_b32 s14, 0x600000
    s_mov_b32 s15, 0x20000
    s_and_b32 s4, s3, 1
    s_lshl_b32 s4, s4, 2
    v_lshrrev_b32 v2, 3, v1
    v_mul_u32_u24 v4, 6144, v2
    v_bfe_u32 v2, v1, 4, 1
    v_lshlrev_b32 v2, 1, v2
    v_or_b32 v2, s4, v2
    v_and_b32 v3, 7, v1
    v_xor_b32 v2, v2, v3
    v_lshl_add_u32 v4, v2, 4, v4
    s_mul_i32 s5, s3, 49152
    v_add_u32 v4, s5, v4
    s_add_u32 s5, s93, 0
    s_and_b32 s5, s5, 15
    s_lshl_b32 s5, s5, 7
    s_add_u32 s5, s5, 0
    v_add_u32 v25, s5, v4
    v_add_u32 v28, 196608, v25
    s_add_u32 s5, s93, 0
    s_and_b32 s5, s5, 15
    s_lshl_b32 s5, s5, 7
    s_add_u32 s5, s5, 2048
    v_add_u32 v26, s5, v4
    v_add_u32 v29, 196608, v26
    s_add_u32 s5, s93, 0
    s_and_b32 s5, s5, 15
    s_lshl_b32 s5, s5, 7
    s_add_u32 s5, s5, 4096
    v_add_u32 v27, s5, v4
    v_add_u32 v30, 196608, v27
    s_mov_b32 s17, 0
    s_lshl_b32 s20, s3, 10
    s_add_u32 s20, s20, 16384
    s_mul_i32 s17, s61, 393216
    s_add_u32 m0, s19, 0
    s_nop 0
    buffer_load_dwordx4 v20, s[8:11], s16 offen lds
    s_add_u32 m0, s19, 1024
    s_nop 0
    buffer_load_dwordx4 v21, s[8:11], s16 offen lds
    s_add_u32 m0, s19, 2048
    s_nop 0
    buffer_load_dwordx4 v22, s[8:11], s16 offen lds
    s_add_u32 m0, s19, 3072
    s_nop 0
    buffer_load_dwordx4 v23, s[8:11], s16 offen lds
    v_and_b32 v2, 7, v1
    v_lshrrev_b32 v3, 4, v1
    v_xor_b32 v3, v3, v2
    v_lshlrev_b32 v16, 4, v3
    v_lshl_add_u32 v16, v2, 7, v16
    v_bfe_u32 v2, v1, 3, 1
    v_lshl_add_u32 v16, v2, 10, v16
    s_lshl_b32 s4, s36, 13
    v_add_u32 v16, s4, v16
    v_xor_b32 v18, 64, v16
    v_add_u32 v17, 81920, v16
    v_add_u32 v19, 81920, v18
    s_lshl_b32 s4, s37, 1
    s_add_u32 s4, s4, 0
    v_bfe_u32 v2, v1, 3, 2
    v_xor_b32 v2, s4, v2
    v_lshlrev_b32 v10, 5, v2
    v_and_b32 v2, 3, v1
    v_lshl_add_u32 v10, v2, 3, v10
    v_bfe_u32 v2, v1, 2, 2
    v_lshl_add_u32 v10, v2, 7, v10
    v_lshrrev_b32 v2, 4, v1
    v_lshl_add_u32 v10, v2, 10, v10
    v_add_u32 v10, 16384, v10
    s_lshl_b32 s4, s37, 1
    s_add_u32 s4, s4, 1
    v_bfe_u32 v2, v1, 3, 2
    v_xor_b32 v2, s4, v2
    v_lshlrev_b32 v12, 5, v2
    v_and_b32 v2, 3, v1
    v_lshl_add_u32 v12, v2, 3, v12
    v_bfe_u32 v2, v1, 2, 2
    v_lshl_add_u32 v12, v2, 7, v12
    v_lshrrev_b32 v2, 4, v1
    v_lshl_add_u32 v12, v2, 10, v12
    v_add_u32 v12, 16384, v12
    v_add_u32 v11, 81920, v10
    v_add_u32 v13, 81920, v12
    v_mov_b32 v32, 0
    v_mov_b32 v33, 0
    v_mov_b32 v34, 0
    v_mov_b32 v35, 0
    v_mov_b32 v36, 0
    v_mov_b32 v37, 0
    v_mov_b32 v38, 0
    v_mov_b32 v39, 0
    v_mov_b32 v40, 0
    v_mov_b32 v41, 0
    v_mov_b32 v42, 0
    v_mov_b32 v43, 0
    v_mov_b32 v44, 0
    v_mov_b32 v45, 0
    v_mov_b32 v46, 0
    v_mov_b32 v47, 0
    v_mov_b32 v48, 0
    v_mov_b32 v49, 0
    v_mov_b32 v50, 0
    v_mov_b32 v51, 0
    v_mov_b32 v52, 0
    v_mov_b32 v53, 0
    v_mov_b32 v54, 0
    v_mov_b32 v55, 0
    v_mov_b32 v56, 0
    v_mov_b32 v57, 0
    v_mov_b32 v58, 0
    v_mov_b32 v59, 0
    v_mov_b32 v60, 0
    v_mov_b32 v61, 0
    v_mov_b32 v62, 0
    v_mov_b32 v63, 0
    v_mov_b32 v64, 0
    v_mov_b32 v65, 0
    v_mov_b32 v66, 0
    v_mov_b32 v67, 0
    v_mov_b32 v68, 0
    v_mov_b32 v69, 0
    v_mov_b32 v70, 0
    v_mov_b32 v71, 0
    v_mov_b32 v72, 0
    v_mov_b32 v73, 0
    v_mov_b32 v74, 0
    v_mov_b32 v75, 0
    v_mov_b32 v76, 0
    v_mov_b32 v77, 0
    v_mov_b32 v78, 0
    v_mov_b32 v79, 0
    v_mov_b32 v80, 0
    v_mov_b32 v81, 0
    v_mov_b32 v82, 0
    v_mov_b32 v83, 0
    v_mov_b32 v84, 0
    v_mov_b32 v85, 0
    v_mov_b32 v86, 0
    v_mov_b32 v87, 0
    v_mov_b32 v88, 0
    v_mov_b32 v89, 0
    v_mov_b32 v90, 0
    v_mov_b32 v91, 0
    v_mov_b32 v92, 0
    v_mov_b32 v93, 0
    v_mov_b32 v94, 0
    v_mov_b32 v95, 0
    v_mov_b32 v96, 0
    v_mov_b32 v97, 0
    v_mov_b32 v98, 0
    v_mov_b32 v99, 0
    v_mov_b32 v100, 0
    v_mov_b32 v101, 0
    v_mov_b32 v102, 0
    v_mov_b32 v103, 0
    v_mov_b32 v104, 0
    v_mov_b32 v105, 0
    v_mov_b32 v106, 0
    v_mov_b32 v107, 0
    v_mov_b32 v108, 0
    v_mov_b32 v109, 0
    v_mov_b32 v110, 0
    v_mov_b32 v111, 0
    v_mov_b32 v112, 0
    v_mov_b32 v113, 0
    v_mov_b32 v114, 0
    v_mov_b32 v115, 0
    v_mov_b32 v116, 0
    v_mov_b32 v117, 0
    v_mov_b32 v118, 0
    v_mov_b32 v119, 0
    v_mov_b32 v120, 0
    v_mov_b32 v121, 0
    v_mov_b32 v122, 0
    v_mov_b32 v123, 0
    v_mov_b32 v124, 0
    v_mov_b32 v125, 0
    v_mov_b32 v126, 0
    v_mov_b32 v127, 0
    v_mov_b32 v184, 0x3f803f80
    v_mov_b32 v185, 0x3f803f80
    v_mov_b32 v186, 0x3f803f80
    v_mov_b32 v187, 0x3f803f80
    s_add_u32 s60, s60, 128
    s_and_b32 s60, s60, 0x7ff
    s_add_u32 s16, s58, s60
    s_add_u32 m0, s20, 0
    s_nop 0
    buffer_load_dwordx4 v25, s[12:15], s17 offen lds
    s_add_u32 m0, s20, 4096
    s_nop 0
    buffer_load_dwordx4 v26, s[12:15], s17 offen lds
    s_add_u32 m0, s20, 8192
    s_nop 0
    buffer_load_dwordx4 v27, s[12:15], s17 offen lds
    s_add_u32 m0, s20, 12288
    s_nop 0
    buffer_load_dwordx4 v28, s[12:15], s17 offen lds
    s_add_u32 m0, s20, 16384
    s_nop 0
    buffer_load_dwordx4 v29, s[12:15], s17 offen lds
    s_add_u32 m0, s20, 20480
    s_nop 0
    buffer_load_dwordx4 v30, s[12:15], s17 offen lds
    s_add_u32 s61, s61, 1
    s_and_b32 s61, s61, 15
    s_mul_i32 s17, s61, 393216
    s_getpc_b64 s[96:97]
    s_and_b32 s96, s96, 0xffffff80
    s_mov_b32 s98, 0x16d28
    s_mov_b32 s99, 0x20000
    s_lshl_b32 s4, s29, 2
    s_add_u32 s4, s4, s3
    s_lshl_b32 s4, s4, 10
    v_lshlrev_b32 v7, 7, v1
    s_mov_b64 exec, 0xff
    buffer_load_dword a251, v7, s[96:99], s4 offen
    s_mov_b64 exec, -1
    s_waitcnt lgkmcnt(0)
    s_mul_i32 s90, s88, 1664525
    s_add_u32 s90, s90, 1013904223
    s_and_b32 s88, s90, 0xfffffff0
    s_getreg_b32 s91, hwreg(HW_REG_XCC_ID, 0, 4)
    s_add_u32 s91, s91, s88
    s_cmp_lg_u32 s3, 0
    s_cbranch_scc1 L_fp_1
    s_lshl_b32 s4, s28, 5
    s_add_u32 s4, s4, s29
    s_lshl_b32 s4, s4, 7
    s_add_u32 s4, s4, 425984
    v_mov_b32 v2, s91
    v_mov_b32 v3, 0
    s_mov_b64 exec, 1
    buffer_store_dword v2, v3, s[84:87], s4 offen sc1
    s_mov_b64 exec, -1
L_fp_1:
    s_waitcnt vmcnt(12)
    v_lshlrev_b32 v152, 16, v136
    v_and_b32 v153, 0xffff0000, v136
    v_lshlrev_b32 v154, 16, v137
    v_and_b32 v155, 0xffff0000, v137
    v_lshlrev_b32 v156, 16, v138
    v_and_b32 v157, 0xffff0000, v138
    v_lshlrev_b32 v158, 16, v139
    v_and_b32 v159, 0xffff0000, v139
    v_lshlrev_b32 v160, 16, v140
    v_and_b32 v161, 0xffff0000, v140
    v_lshlrev_b32 v162, 16, v141
    v_and_b32 v163, 0xffff0000, v141
    v_lshlrev_b32 v164, 16, v142
    v_and_b32 v165, 0xffff0000, v142
    v_lshlrev_b32 v166, 16, v143
    v_and_b32 v167, 0xffff0000, v143
    v_lshlrev_b32 v168, 16, v144
    v_and_b32 v169, 0xffff0000, v144
    v_lshlrev_b32 v170, 16, v145
    v_and_b32 v171, 0xffff0000, v145
    v_lshlrev_b32 v172, 16, v146
    v_and_b32 v173, 0xffff0000, v146
    v_lshlrev_b32 v174, 16, v147
    v_and_b32 v175, 0xffff0000, v147
    v_lshlrev_b32 v176, 16, v148
    v_and_b32 v177, 0xffff0000, v148
    v_lshlrev_b32 v178, 16, v149
    v_and_b32 v179, 0xffff0000, v149
    v_lshlrev_b32 v180, 16, v150
    v_and_b32 v181, 0xffff0000, v150
    v_lshlrev_b32 v182, 16, v151
    v_and_b32 v183, 0xffff0000, v151
    v_pk_add_f32 v[136:137], v[152:153], v[154:155]
    v_pk_mul_f32 v[138:139], v[152:153], v[152:153]
    v_pk_fma_f32 v[138:139], v[154:155], v[154:155], v[138:139]
    v_pk_add_f32 v[136:137], v[136:137], v[156:157]
    v_pk_fma_f32 v[138:139], v[156:157], v[156:157], v[138:139]
    v_pk_add_f32 v[136:137], v[136:137], v[158:159]
    v_pk_fma_f32 v[138:139], v[158:159], v[158:159], v[138:139]
    v_pk_add_f32 v[136:137], v[136:137], v[160:161]
    v_pk_fma_f32 v[138:139], v[160:161], v[160:161], v[138:139]
    v_pk_add_f32 v[136:137], v[136:137], v[162:163]
    v_pk_fma_f32 v[138:139], v[162:163], v[162:163], v[138:139]
    v_pk_add_f32 v[136:137], v[136:137], v[164:165]
    v_pk_fma_f32 v[138:139], v[164:165], v[164:165], v[138:139]
    v_pk_add_f32 v[136:137], v[136:137], v[166:167]
    v_pk_fma_f32 v[138:139], v[166:167], v[166:167], v[138:139]
    v_add_f32 v136, v136, v137
    v_add_f32 v137, v138, v139
    v_pk_add_f32 v[140:141], v[168:169], v[170:171]
    v_pk_mul_f32 v[142:143], v[168:169], v[168:169]
    v_pk_fma_f32 v[142:143], v[170:171], v[170:171], v[142:143]
    v_pk_add_f32 v[140:141], v[140:141], v[172:173]
    v_pk_fma_f32 v[142:143], v[172:173], v[172:173], v[142:143]
    v_pk_add_f32 v[140:141], v[140:141], v[174:175]
    v_pk_fma_f32 v[142:143], v[174:175], v[174:175], v[142:143]
    v_pk_add_f32 v[140:141], v[140:141], v[176:177]
    v_pk_fma_f32 v[142:143], v[176:177], v[176:177], v[142:143]
    v_pk_add_f32 v[140:141], v[140:141], v[178:179]
    v_pk_fma_f32 v[142:143], v[178:179], v[178:179], v[142:143]
    v_pk_add_f32 v[140:141], v[140:141], v[180:181]
    v_pk_fma_f32 v[142:143], v[180:181], v[180:181], v[142:143]
    v_pk_add_f32 v[140:141], v[140:141], v[182:183]
    v_pk_fma_f32 v[142:143], v[182:183], v[182:183], v[142:143]
    v_add_f32 v140, v140, v141
    v_add_f32 v141, v142, v143
    s_nop 0
    v_permlane32_swap_b32 v136, v140
    v_permlane32_swap_b32 v137, v141
    v_pk_add_f32 v[136:137], v[136:137], v[140:141]
    v_mov_b32 v140, v136
    v_mov_b32 v141, v137
    s_nop 1
    v_permlane16_swap_b32 v136, v140
    v_permlane16_swap_b32 v137, v141
    v_pk_add_f32 v[136:137], v[136:137], v[140:141]
    s_nop 1
    v_add_f32_dpp v136, v136, v136 row_ror:8 row_mask:0xf bank_mask:0xf
    v_add_f32_dpp v137, v137, v137 row_ror:8 row_mask:0xf bank_mask:0xf
    s_nop 1
    v_add_f32_dpp v136, v136, v136 row_ror:4 row_mask:0xf bank_mask:0xf
    v_add_f32_dpp v137, v137, v137 row_ror:4 row_mask:0xf bank_mask:0xf
    s_nop 1
    v_add_f32_dpp v136, v136, v136 row_ror:2 row_mask:0xf bank_mask:0xf
    v_add_f32_dpp v137, v137, v137 row_ror:2 row_mask:0xf bank_mask:0xf
    s_nop 1
    v_add_f32_dpp v136, v136, v136 row_ror:1 row_mask:0xf bank_mask:0xf
    v_add_f32_dpp v137, v137, v137 row_ror:1 row_mask:0xf bank_mask:0xf
    v_mul_f32 v140, 0x3a800000, v136
    v_mul_f32 v138, v140, v140
    v_mov_b32 v139, 0x3a800000
    v_fma_f32 v137, v137, v139, -v138
    v_max_f32 v137, 0, v137
    v_add_f32 v137, 0x3727c5ac, v137
    v_rsq_f32 v136, v137
    v_mov_b32 v138, s88
    v_mov_b32 v139, s88
    v_mul_f32 v137, -v140, v136
    v_lshrrev_b32 v2, 1, v1
    s_lshl_b32 s4, s2, 2
    s_add_u32 s4, s4, s3
    s_lshl_b32 s4, s4, 5
    s_add_u32 s4, s4, 983040
    s_mov_b32 exec_lo, 1
    s_mov_b32 exec_hi, 1
    buffer_store_dwordx4 v[136:139], v2, s[84:87], s4 offen sc1
    s_mov_b64 exec, -1
    s_add_u32 m0, s19, 40960
    s_nop 0
    buffer_load_dwordx4 v20, s[8:11], s16 offen lds
    s_add_u32 m0, s19, 41984
    s_nop 0
    buffer_load_dwordx4 v21, s[8:11], s16 offen lds
    s_add_u32 m0, s19, 43008
    s_nop 0
    buffer_load_dwordx4 v22, s[8:11], s16 offen lds
    s_add_u32 m0, s19, 44032
    s_nop 0
    buffer_load_dwordx4 v23, s[8:11], s16 offen lds
    s_add_u32 s60, s60, 128
    s_and_b32 s60, s60, 0x7ff
    s_add_u32 s16, s58, s60
    s_add_u32 m0, s20, 40960
    s_nop 0
    buffer_load_dwordx4 v25, s[12:15], s17 offen lds
    s_add_u32 m0, s20, 45056
    s_nop 0
    buffer_load_dwordx4 v26, s[12:15], s17 offen lds
    s_add_u32 m0, s20, 49152
    s_nop 0
    buffer_load_dwordx4 v27, s[12:15], s17 offen lds
    s_add_u32 m0, s20, 53248
    s_nop 0
    buffer_load_dwordx4 v28, s[12:15], s17 offen lds
    s_add_u32 m0, s20, 57344
    s_nop 0
    buffer_load_dwordx4 v29, s[12:15], s17 offen lds
    s_add_u32 m0, s20, 61440
    s_nop 0
    buffer_load_dwordx4 v30, s[12:15], s17 offen lds
    s_add_u32 s61, s61, 1
    s_and_b32 s61, s61, 15
    s_mul_i32 s17, s61, 393216
    s_waitcnt vmcnt(12) lgkmcnt(0)
    s_barrier
    ds_read_b128 a[0:3], v16 offset:0
    ds_read_b128 a[4:7], v16 offset:2048
    ds_read_b128 a[8:11], v16 offset:4096
    ds_read_b128 a[12:15], v16 offset:6144
    ds_read_b64_tr_b16 a[16:17], v10 offset:0
    ds_read_b64_tr_b16 a[18:19], v10 offset:512
    ds_read_b64_tr_b16 a[20:21], v12 offset:0
    ds_read_b64_tr_b16 a[22:23], v12 offset:512
    ds_read_b64_tr_b16 a[24:25], v10 offset:4096
    ds_read_b64_tr_b16 a[26:27], v10 offset:4608
    ds_read_b64_tr_b16 a[28:29], v12 offset:4096
    ds_read_b64_tr_b16 a[30:31], v12 offset:4608
    ds_read_b64_tr_b16 a[32:33], v10 offset:8192
    ds_read_b64_tr_b16 a[34:35], v10 offset:8704
    ds_read_b64_tr_b16 a[36:37], v12 offset:8192
    ds_read_b64_tr_b16 a[38:39], v12 offset:8704
    s_waitcnt lgkmcnt(0)
    v_mfma_f32_16x16x32_bf16 v[32:35], a[16:19], a[0:3], v[32:35]
    ds_read_b128 a[40:43], v18 offset:0
    s_add_u32 m0, s19, 81920
    s_nop 0
    buffer_load_dwordx4 v20, s[8:11], s16 offen lds
    v_mfma_f32_16x16x32_bf16 v[56:59], a[16:19], a[4:7], v[56:59]
    ds_read_b128 a[44:47], v18 offset:2048
    s_add_u32 m0, s19, 82944
    v_mfma_f32_16x16x32_bf16 v[80:83], a[16:19], a[8:11], v[80:83]
    ds_read_b128 a[48:51], v18 offset:4096
    buffer_load_dwordx4 v21, s[8:11], s16 offen lds
    v_mfma_f32_16x16x32_bf16 v[104:107], a[16:19], a[12:15], v[104:107]
    s_add_u32 m0, s19, 83968
    v_mfma_f32_16x16x32_bf16 v[36:39], a[20:23], a[0:3], v[36:39]
    ds_read_b128 a[52:55], v18 offset:6144
    buffer_load_dwordx4 v22, s[8:11], s16 offen lds
    v_mfma_f32_16x16x32_bf16 v[60:63], a[20:23], a[4:7], v[60:63]
    ds_read_b64_tr_b16 a[56:57], v10 offset:12288
    s_add_u32 m0, s19, 84992
    v_mfma_f32_16x16x32_bf16 v[84:87], a[20:23], a[8:11], v[84:87]
    ds_read_b64_tr_b16 a[58:59], v10 offset:12800
    buffer_load_dwordx4 v23, s[8:11], s16 offen lds
    v_mfma_f32_16x16x32_bf16 v[108:111], a[20:23], a[12:15], v[108:111]
    v_mfma_f32_16x16x32_bf16 v[40:43], a[24:27], a[0:3], v[40:43]
    ds_read_b64_tr_b16 a[60:61], v12 offset:12288
    s_add_u32 s60, s60, 128
    v_mfma_f32_16x16x32_bf16 v[64:67], a[24:27], a[4:7], v[64:67]
    ds_read_b64_tr_b16 a[62:63], v12 offset:12800
    v_mfma_f32_16x16x32_bf16 v[88:91], a[24:27], a[8:11], v[88:91]
    s_and_b32 s60, s60, 0x7ff
    v_mfma_f32_16x16x32_bf16 v[112:115], a[24:27], a[12:15], v[112:115]
    ds_read_b64_tr_b16 a[64:65], v10 offset:16384
    v_mfma_f32_16x16x32_bf16 v[44:47], a[28:31], a[0:3], v[44:47]
    ds_read_b64_tr_b16 a[66:67], v10 offset:16896
    s_add_u32 s16, s58, s60
    v_mfma_f32_16x16x32_bf16 v[68:71], a[28:31], a[4:7], v[68:71]
    ds_read_b64_tr_b16 a[68:69], v12 offset:16384
    s_add_u32 m0, s20, 81920
    v_mfma_f32_16x16x32_bf16 v[92:95], a[28:31], a[8:11], v[92:95]
    buffer_load_dwordx4 v25, s[12:15], s17 offen lds
    s_add_u32 m0, s20, 86016
    v_mfma_f32_16x16x32_bf16 v[116:119], a[28:31], a[12:15], v[116:119]
    ds_read_b64_tr_b16 a[70:71], v12 offset:16896
    buffer_load_dwordx4 v26, s[12:15], s17 offen lds
    v_mfma_f32_16x16x32_bf16 v[48:51], a[0:3], a[32:35], v[48:51]
    ds_read_b64_tr_b16 a[72:73], v10 offset:20480
    s_add_u32 m0, s20, 90112
    v_mfma_f32_16x16x32_bf16 v[72:75], a[4:7], a[32:35], v[72:75]
    ds_read_b64_tr_b16 a[74:75], v10 offset:20992
    buffer_load_dwordx4 v27, s[12:15], s17 offen lds
    v_mfma_f32_16x16x32_bf16 v[96:99], a[8:11], a[32:35], v[96:99]
    s_add_u32 m0, s20, 94208
    v_mfma_f32_16x16x32_bf16 v[120:123], a[12:15], a[32:35], v[120:123]
    ds_read_b64_tr_b16 a[76:77], v12 offset:20480
    buffer_load_dwordx4 v28, s[12:15], s17 offen lds
    v_mfma_f32_16x16x32_bf16 v[52:55], a[0:3], a[36:39], v[52:55]
    ds_read_b64_tr_b16 a[78:79], v12 offset:20992
    s_add_u32 m0, s20, 98304
    v_mfma_f32_16x16x32_bf16 v[76:79], a[4:7], a[36:39], v[76:79]
    buffer_load_dwordx4 v29, s[12:15], s17 offen lds
    v_mfma_f32_16x16x32_bf16 v[100:103], a[8:11], a[36:39], v[100:103]
    s_add_u32 m0, s20, 102400
    v_mfma_f32_16x16x32_bf16 v[124:127], a[12:15], a[36:39], v[124:127]
    buffer_load_dwordx4 v30, s[12:15], s17 offen lds
    v_mfma_f32_16x16x32_bf16 v[188:191], v[184:187], a[16:19], 0
    v_mfma_f32_16x16x32_bf16 v[192:195], v[184:187], a[20:23], 0
    s_add_u32 s61, s61, 1
    v_mfma_f32_16x16x32_bf16 v[196:199], v[184:187], a[24:27], 0
    v_mfma_f32_16x16x32_bf16 v[200:203], v[184:187], a[28:31], 0
    s_and_b32 s61, s61, 15
    v_mfma_f32_16x16x32_bf16 v[204:207], v[184:187], a[32:35], 0
    v_mfma_f32_16x16x32_bf16 v[208:211], v[184:187], a[36:39], 0
    s_mul_i32 s17, s61, 393216
    s_waitcnt vmcnt(10) lgkmcnt(0)
    s_barrier
    v_mfma_f32_16x16x32_bf16 v[32:35], a[56:59], a[40:43], v[32:35]
    ds_read_b128 a[0:3], v16 offset:40960
    s_add_u32 m0, s19, 122880
    s_nop 0
    buffer_load_dwordx4 v20, s[8:11], s16 offen lds
    v_mfma_f32_16x16x32_bf16 v[56:59], a[56:59], a[44:47], v[56:59]
    ds_read_b128 a[4:7], v16 offset:43008
    s_add_u32 m0, s19, 123904
    v_mfma_f32_16x16x32_bf16 v[80:83], a[56:59], a[48:51], v[80:83]
    ds_read_b128 a[8:11], v16 offset:45056
    buffer_load_dwordx4 v21, s[8:11], s16 offen lds
    v_mfma_f32_16x16x32_bf16 v[104:107], a[56:59], a[52:55], v[104:107]
    s_add_u32 m0, s19, 124928
    v_mfma_f32_16x16x32_bf16 v[36:39], a[60:63], a[40:43], v[36:39]
    ds_read_b128 a[12:15], v16 offset:47104
    buffer_load_dwordx4 v22, s[8:11], s16 offen lds
    v_mfma_f32_16x16x32_bf16 v[60:63], a[60:63], a[44:47], v[60:63]
    ds_read_b64_tr_b16 a[16:17], v10 offset:40960
    s_add_u32 m0, s19, 125952
    v_mfma_f32_16x16x32_bf16 v[84:87], a[60:63], a[48:51], v[84:87]
    ds_read_b64_tr_b16 a[18:19], v10 offset:41472
    buffer_load_dwordx4 v23, s[8:11], s16 offen lds
    v_mfma_f32_16x16x32_bf16 v[108:111], a[60:63], a[52:55], v[108:111]
    v_mfma_f32_16x16x32_bf16 v[40:43], a[64:67], a[40:43], v[40:43]
    ds_read_b64_tr_b16 a[20:21], v12 offset:40960
    s_add_u32 s60, s60, 128
    v_mfma_f32_16x16x32_bf16 v[64:67], a[64:67], a[44:47], v[64:67]
    ds_read_b64_tr_b16 a[22:23], v12 offset:41472
    v_mfma_f32_16x16x32_bf16 v[88:91], a[64:67], a[48:51], v[88:91]
    s_and_b32 s60, s60, 0x7ff
    v_mfma_f32_16x16x32_bf16 v[112:115], a[64:67], a[52:55], v[112:115]
    ds_read_b64_tr_b16 a[24:25], v10 offset:45056
    v_mfma_f32_16x16x32_bf16 v[44:47], a[68:71], a[40:43], v[44:47]
    ds_read_b64_tr_b16 a[26:27], v10 offset:45568
    s_add_u32 s16, s58, s60
    v_mfma_f32_16x16x32_bf16 v[68:71], a[68:71], a[44:47], v[68:71]
    ds_read_b64_tr_b16 a[28:29], v12 offset:45056
    s_add_u32 m0, s20, 122880
    v_mfma_f32_16x16x32_bf16 v[92:95], a[68:71], a[48:51], v[92:95]
    buffer_load_dwordx4 v25, s[12:15], s17 offen lds
    s_add_u32 m0, s20, 126976
    v_mfma_f32_16x16x32_bf16 v[116:119], a[68:71], a[52:55], v[116:119]
    ds_read_b64_tr_b16 a[30:31], v12 offset:45568
    buffer_load_dwordx4 v26, s[12:15], s17 offen lds
    v_mfma_f32_16x16x32_bf16 v[48:51], a[40:43], a[72:75], v[48:51]
    ds_read_b64_tr_b16 a[32:33], v10 offset:49152
    s_add_u32 m0, s20, 131072
    v_mfma_f32_16x16x32_bf16 v[72:75], a[44:47], a[72:75], v[72:75]
    ds_read_b64_tr_b16 a[34:35], v10 offset:49664
    buffer_load_dwordx4 v27, s[12:15], s17 offen lds
    v_mfma_f32_16x16x32_bf16 v[96:99], a[48:51], a[72:75], v[96:99]
    s_add_u32 m0, s20, 135168
    v_mfma_f32_16x16x32_bf16 v[120:123], a[52:55], a[72:75], v[120:123]
    ds_read_b64_tr_b16 a[36:37], v12 offset:49152
    buffer_load_dwordx4 v28, s[12:15], s17 offen lds
    v_mfma_f32_16x16x32_bf16 v[52:55], a[40:43], a[76:79], v[52:55]
    ds_read_b64_tr_b16 a[38:39], v12 offset:49664
    s_add_u32 m0, s20, 139264
    v_mfma_f32_16x16x32_bf16 v[76:79], a[44:47], a[76:79], v[76:79]
    buffer_load_dwordx4 v29, s[12:15], s17 offen lds
    v_mfma_f32_16x16x32_bf16 v[100:103], a[48:51], a[76:79], v[100:103]
    s_add_u32 m0, s20, 143360
    v_mfma_f32_16x16x32_bf16 v[124:127], a[52:55], a[76:79], v[124:127]
    buffer_load_dwordx4 v30, s[12:15], s17 offen lds
    v_mfma_f32_16x16x32_bf16 v[188:191], v[184:187], a[56:59], v[188:191]
    v_mfma_f32_16x16x32_bf16 v[192:195], v[184:187], a[60:63], v[192:195]
    s_add_u32 s61, s61, 1
    v_mfma_f32_16x16x32_bf16 v[196:199], v[184:187], a[64:67], v[196:199]
    v_mfma_f32_16x16x32_bf16 v[200:203], v[184:187], a[68:71], v[200:203]
    s_and_b32 s61, s61, 15
    v_mfma_f32_16x16x32_bf16 v[204:207], v[184:187], a[72:75], v[204:207]
    v_mfma_f32_16x16x32_bf16 v[208:211], v[184:187], a[76:79], v[208:211]
    s_mul_i32 s17, s61, 393216
    s_waitcnt lgkmcnt(0)
    v_mfma_f32_16x16x32_bf16 v[32:35], a[16:19], a[0:3], v[32:35]
    ds_read_b128 a[40:43], v18 offset:40960
    s_add_u32 m0, s19, 0
    s_nop 0
    buffer_load_dwordx4 v20, s[8:11], s16 offen lds
    v_mfma_f32_16x16x32_bf16 v[56:59], a[16:19], a[4:7], v[56:59]
    ds_read_b128 a[44:47], v18 offset:43008
    s_add_u32 m0, s19, 1024
    v_mfma_f32_16x16x32_bf16 v[80:83], a[16:19], a[8:11], v[80:83]
    ds_read_b128 a[48:51], v18 offset:45056
    buffer_load_dwordx4 v21, s[8:11], s16 offen lds
    s_add_u32 m0, s19, 2048
    v_mfma_f32_16x16x32_bf16 v[104:107], a[16:19], a[12:15], v[104:107]
    ds_read_b128 a[52:55], v18 offset:47104
    buffer_load_dwordx4 v22, s[8:11], s16 offen lds
    v_mfma_f32_16x16x32_bf16 v[36:39], a[20:23], a[0:3], v[36:39]
    ds_read_b64_tr_b16 a[56:57], v10 offset:53248
    s_add_u32 m0, s19, 3072
    v_mfma_f32_16x16x32_bf16 v[60:63], a[20:23], a[4:7], v[60:63]
    ds_read_b64_tr_b16 a[58:59], v10 offset:53760
    buffer_load_dwordx4 v23, s[8:11], s16 offen lds
    v_mfma_f32_16x16x32_bf16 v[84:87], a[20:23], a[8:11], v[84:87]
    ds_read_b64_tr_b16 a[60:61], v12 offset:53248
    s_add_u32 s60, s60, 128
    v_mfma_f32_16x16x32_bf16 v[108:111], a[20:23], a[12:15], v[108:111]
    ds_read_b64_tr_b16 a[62:63], v12 offset:53760
    v_mfma_f32_16x16x32_bf16 v[40:43], a[24:27], a[0:3], v[40:43]
    s_and_b32 s60, s60, 0x7ff
    v_mfma_f32_16x16x32_bf16 v[64:67], a[24:27], a[4:7], v[64:67]
    ds_read_b64_tr_b16 a[64:65], v10 offset:57344
    s_add_u32 s16, s58, s60
    v_mfma_f32_16x16x32_bf16 v[88:91], a[24:27], a[8:11], v[88:91]
    ds_read_b64_tr_b16 a[66:67], v10 offset:57856
    s_add_u32 m0, s20, 0
    v_mfma_f32_16x16x32_bf16 v[112:115], a[24:27], a[12:15], v[112:115]
    ds_read_b64_tr_b16 a[68:69], v12 offset:57344
    buffer_load_dwordx4 v25, s[12:15], s17 offen lds
    s_add_u32 m0, s20, 4096
    v_mfma_f32_16x16x32_bf16 v[44:47], a[28:31], a[0:3], v[44:47]
    ds_read_b64_tr_b16 a[70:71], v12 offset:57856
    buffer_load_dwordx4 v26, s[12:15], s17 offen lds
    v_mfma_f32_16x16x32_bf16 v[68:71], a[28:31], a[4:7], v[68:71]
    ds_read_b64_tr_b16 a[72:73], v10 offset:61440
    s_add_u32 m0, s20, 8192
    v_mfma_f32_16x16x32_bf16 v[92:95], a[28:31], a[8:11], v[92:95]
    ds_read_b64_tr_b16 a[74:75], v10 offset:61952
    buffer_load_dwordx4 v27, s[12:15], s17 offen lds
    s_add_u32 m0, s20, 12288
    v_mfma_f32_16x16x32_bf16 v[116:119], a[28:31], a[12:15], v[116:119]
    ds_read_b64_tr_b16 a[76:77], v12 offset:61440
    buffer_load_dwordx4 v28, s[12:15], s17 offen lds
    v_mfma_f32_16x16x32_bf16 v[48:51], a[0:3], a[32:35], v[48:51]
    ds_read_b64_tr_b16 a[78:79], v12 offset:61952
    s_add_u32 m0, s20, 16384
    v_mfma_f32_16x16x32_bf16 v[72:75], a[4:7], a[32:35], v[72:75]
    buffer_load_dwordx4 v29, s[12:15], s17 offen lds
    s_add_u32 m0, s20, 20480
    v_mfma_f32_16x16x32_bf16 v[96:99], a[8:11], a[32:35], v[96:99]
    buffer_load_dwordx4 v30, s[12:15], s17 offen lds
    v_mfma_f32_16x16x32_bf16 v[120:123], a[12:15], a[32:35], v[120:123]
    v_mfma_f32_16x16x32_bf16 v[52:55], a[0:3], a[36:39], v[52:55]
    s_add_u32 s61, s61, 1
    v_mfma_f32_16x16x32_bf16 v[76:79], a[4:7], a[36:39], v[76:79]
    s_and_b32 s61, s61, 15
    v_mfma_f32_16x16x32_bf16 v[100:103], a[8:11], a[36:39], v[100:103]
    v_mfma_f32_16x16x32_bf16 v[124:127], a[12:15], a[36:39], v[124:127]
    s_mul_i32 s17, s61, 393216
    s_waitcnt vmcnt(20) lgkmcnt(0)
    s_barrier
    v_mfma_f32_16x16x32_bf16 v[32:35], a[56:59], a[40:43], v[32:35]
    ds_read_b128 a[0:3], v17 offset:0
    s_add_u32 m0, s19, 40960
    v_mfma_f32_16x16x32_bf16 v[56:59], a[56:59], a[44:47], v[56:59]
    ds_read_b128 a[4:7], v17 offset:2048
    buffer_load_dwordx4 v20, s[8:11], s16 offen lds
    v_mfma_f32_16x16x32_bf16 v[80:83], a[56:59], a[48:51], v[80:83]
    ds_read_b128 a[8:11], v17 offset:4096
    s_add_u32 m0, s19, 41984
    v_mfma_f32_16x16x32_bf16 v[104:107], a[56:59], a[52:55], v[104:107]
    ds_read_b128 a[12:15], v17 offset:6144
    buffer_load_dwordx4 v21, s[8:11], s16 offen lds
    v_mfma_f32_16x16x32_bf16 v[36:39], a[60:63], a[40:43], v[36:39]
    ds_read_b64_tr_b16 a[16:17], v11 offset:0
    s_add_u32 m0, s19, 43008
    v_mfma_f32_16x16x32_bf16 v[60:63], a[60:63], a[44:47], v[60:63]
    ds_read_b64_tr_b16 a[18:19], v11 offset:512
    buffer_load_dwordx4 v22, s[8:11], s16 offen lds
    v_mfma_f32_16x16x32_bf16 v[84:87], a[60:63], a[48:51], v[84:87]
    ds_read_b64_tr_b16 a[20:21], v13 offset:0
    s_add_u32 m0, s19, 44032
    v_mfma_f32_16x16x32_bf16 v[108:111], a[60:63], a[52:55], v[108:111]
    ds_read_b64_tr_b16 a[22:23], v13 offset:512
    buffer_load_dwordx4 v23, s[8:11], s16 offen lds
    v_mfma_f32_16x16x32_bf16 v[40:43], a[64:67], a[40:43], v[40:43]
    v_mfma_f32_16x16x32_bf16 v[64:67], a[64:67], a[44:47], v[64:67]
    ds_read_b64_tr_b16 a[24:25], v11 offset:4096
    s_add_u32 s60, s60, 128
    v_mfma_f32_16x16x32_bf16 v[88:91], a[64:67], a[48:51], v[88:91]
    ds_read_b64_tr_b16 a[26:27], v11 offset:4608
    v_mfma_f32_16x16x32_bf16 v[112:115], a[64:67], a[52:55], v[112:115]
    ds_read_b64_tr_b16 a[28:29], v13 offset:4096
    s_and_b32 s60, s60, 0x7ff
    v_mfma_f32_16x16x32_bf16 v[44:47], a[68:71], a[40:43], v[44:47]
    ds_read_b64_tr_b16 a[30:31], v13 offset:4608
    v_mfma_f32_16x16x32_bf16 v[68:71], a[68:71], a[44:47], v[68:71]
    ds_read_b64_tr_b16 a[32:33], v11 offset:8192
    s_add_u32 s16, s58, s60
    v_mfma_f32_16x16x32_bf16 v[92:95], a[68:71], a[48:51], v[92:95]
    ds_read_b64_tr_b16 a[34:35], v11 offset:8704
    s_add_u32 m0, s20, 40960
    v_mfma_f32_16x16x32_bf16 v[116:119], a[68:71], a[52:55], v[116:119]
    ds_read_b64_tr_b16 a[36:37], v13 offset:8192
    buffer_load_dwordx4 v25, s[12:15], s17 offen lds
    v_mfma_f32_16x16x32_bf16 v[48:51], a[40:43], a[72:75], v[48:51]
    ds_read_b64_tr_b16 a[38:39], v13 offset:8704
    s_add_u32 m0, s20, 45056
    v_mfma_f32_16x16x32_bf16 v[72:75], a[44:47], a[72:75], v[72:75]
    buffer_load_dwordx4 v26, s[12:15], s17 offen lds
    v_mfma_f32_16x16x32_bf16 v[96:99], a[48:51], a[72:75], v[96:99]
    s_add_u32 m0, s20, 49152
    v_mfma_f32_16x16x32_bf16 v[120:123], a[52:55], a[72:75], v[120:123]
    buffer_load_dwordx4 v27, s[12:15], s17 offen lds
    v_mfma_f32_16x16x32_bf16 v[52:55], a[40:43], a[76:79], v[52:55]
    s_add_u32 m0, s20, 53248
    v_mfma_f32_16x16x32_bf16 v[76:79], a[44:47], a[76:79], v[76:79]
    buffer_load_dwordx4 v28, s[12:15], s17 offen lds
    v_mfma_f32_16x16x32_bf16 v[100:103], a[48:51], a[76:79], v[100:103]
    s_add_u32 m0, s20, 57344
    v_mfma_f32_16x16x32_bf16 v[124:127], a[52:55], a[76:79], v[124:127]
    buffer_load_dwordx4 v29, s[12:15], s17 offen lds
    s_waitcnt lgkmcnt(0)
    v_mfma_f32_16x16x32_bf16 v[32:35], a[16:19], a[0:3], v[32:35]
    ds_read_b128 a[40:43], v19 offset:0
    s_add_u32 m0, s20, 61440
    v_mfma_f32_16x16x32_bf16 v[56:59], a[16:19], a[4:7], v[56:59]
    ds_read_b128 a[44:47], v19 offset:2048
    buffer_load_dwordx4 v30, s[12:15], s17 offen lds
    v_mfma_f32_16x16x32_bf16 v[80:83], a[16:19], a[8:11], v[80:83]
    ds_read_b128 a[48:51], v19 offset:4096
    v_mfma_f32_16x16x32_bf16 v[104:107], a[16:19], a[12:15], v[104:107]
    ds_read_b128 a[52:55], v19 offset:6144
    s_add_u32 s61, s61, 1
    v_mfma_f32_16x16x32_bf16 v[36:39], a[20:23], a[0:3], v[36:39]
    ds_read_b64_tr_b16 a[56:57], v11 offset:12288
    v_mfma_f32_16x16x32_bf16 v[60:63], a[20:23], a[4:7], v[60:63]
    ds_read_b64_tr_b16 a[58:59], v11 offset:12800
    s_and_b32 s61, s61, 15
    v_mfma_f32_16x16x32_bf16 v[84:87], a[20:23], a[8:11], v[84:87]
    ds_read_b64_tr_b16 a[60:61], v13 offset:12288
    v_mfma_f32_16x16x32_bf16 v[108:111], a[20:23], a[12:15], v[108:111]
    ds_read_b64_tr_b16 a[62:63], v13 offset:12800
    s_mul_i32 s17, s61, 393216
    v_mfma_f32_16x16x32_bf16 v[40:43], a[24:27], a[0:3], v[40:43]
    v_mfma_f32_16x16x32_bf16 v[64:67], a[24:27], a[4:7], v[64:67]
    ds_read_b64_tr_b16 a[64:65], v11 offset:16384
    s_add_u32 s52, s82, 0x2a00000
    s_addc_u32 s53, s83, 0
    s_mov_b32 s54, 0x40000
    s_mov_b32 s55, 0x20000
    s_cmp_eq_u32 s36, 0
    s_cselect_b32 s54, s54, 0
    s_lshl_b32 s56, s93, 1
    s_add_u32 s56, s56, s37
    s_lshl_b32 s57, s56, 13
    s_lshl_b32 s4, s92, 2
    s_add_u32 s62, s57, s4
    s_add_u32 s63, s62, 4096
    v_lshlrev_b32 v3, 6, v1
    v_mfma_f32_16x16x32_bf16 v[88:91], a[24:27], a[8:11], v[88:91]
    ds_read_b64_tr_b16 a[66:67], v11 offset:16896
    v_mfma_f32_16x16x32_bf16 v[112:115], a[24:27], a[12:15], v[112:115]
    ds_read_b64_tr_b16 a[68:69], v13 offset:16384
    v_mfma_f32_16x16x32_bf16 v[44:47], a[28:31], a[0:3], v[44:47]
    ds_read_b64_tr_b16 a[70:71], v13 offset:16896
    s_mov_b64 exec, 0xffff
    buffer_store_dword v188, v3, s[52:55], s62 offen offset:0 sc1
    s_mov_b64 exec, -1
    v_mfma_f32_16x16x32_bf16 v[68:71], a[28:31], a[4:7], v[68:71]
    ds_read_b64_tr_b16 a[72:73], v11 offset:20480
    v_mfma_f32_16x16x32_bf16 v[92:95], a[28:31], a[8:11], v[92:95]
    ds_read_b64_tr_b16 a[74:75], v11 offset:20992
    s_mov_b64 exec, 0xffff
    buffer_store_dword v192, v3, s[52:55], s62 offen offset:1024 sc1
    s_mov_b64 exec, -1
    v_mfma_f32_16x16x32_bf16 v[116:119], a[28:31], a[12:15], v[116:119]
    ds_read_b64_tr_b16 a[76:77], v13 offset:20480
    v_mfma_f32_16x16x32_bf16 v[48:51], a[0:3], a[32:35], v[48:51]
    ds_read_b64_tr_b16 a[78:79], v13 offset:20992
    s_mov_b64 exec, 0xffff
    buffer_store_dword v196, v3, s[52:55], s62 offen offset:2048 sc1
    s_mov_b64 exec, -1
    v_mfma_f32_16x16x32_bf16 v[72:75], a[4:7], a[32:35], v[72:75]
    v_mfma_f32_16x16x32_bf16 v[96:99], a[8:11], a[32:35], v[96:99]
    s_mov_b64 exec, 0xffff
    buffer_store_dword v200, v3, s[52:55], s62 offen offset:3072 sc1
    s_mov_b64 exec, -1
    v_mfma_f32_16x16x32_bf16 v[120:123], a[12:15], a[32:35], v[120:123]
    v_mfma_f32_16x16x32_bf16 v[52:55], a[0:3], a[36:39], v[52:55]
    s_mov_b64 exec, 0xffff
    buffer_store_dword v204, v3, s[52:55], s63 offen offset:0 sc1
    s_mov_b64 exec, -1
    v_mfma_f32_16x16x32_bf16 v[76:79], a[4:7], a[36:39], v[76:79]
    v_mfma_f32_16x16x32_bf16 v[100:103], a[8:11], a[36:39], v[100:103]
    s_mov_b64 exec, 0xffff
    buffer_store_dword v208, v3, s[52:55], s63 offen offset:1024 sc1
    s_mov_b64 exec, -1
    v_mfma_f32_16x16x32_bf16 v[124:127], a[12:15], a[36:39], v[124:127]
    s_waitcnt vmcnt(26) lgkmcnt(0)
    s_barrier
    v_mfma_f32_16x16x32_bf16 v[32:35], a[56:59], a[40:43], v[32:35]
    ds_read_b128 a[0:3], v17 offset:40960
    s_add_u32 m0, s19, 81920
    v_mfma_f32_16x16x32_bf16 v[56:59], a[56:59], a[44:47], v[56:59]
    ds_read_b128 a[4:7], v17 offset:43008
    buffer_load_dwordx4 v20, s[8:11], s16 offen lds
    v_mfma_f32_16x16x32_bf16 v[80:83], a[56:59], a[48:51], v[80:83]
    ds_read_b128 a[8:11], v17 offset:45056
    v_mfma_f32_16x16x32_bf16 v[104:107], a[56:59], a[52:55], v[104:107]
    ds_read_b128 a[12:15], v17 offset:47104
    s_add_u32 m0, s19, 82944
    v_mfma_f32_16x16x32_bf16 v[36:39], a[60:63], a[40:43], v[36:39]
    ds_read_b64_tr_b16 a[16:17], v11 offset:40960
    buffer_load_dwordx4 v21, s[8:11], s16 offen lds
    v_mfma_f32_16x16x32_bf16 v[60:63], a[60:63], a[44:47], v[60:63]
    ds_read_b64_tr_b16 a[18:19], v11 offset:41472
    v_mfma_f32_16x16x32_bf16 v[84:87], a[60:63], a[48:51], v[84:87]
    ds_read_b64_tr_b16 a[20:21], v13 offset:40960
    s_add_u32 m0, s19, 83968
    v_mfma_f32_16x16x32_bf16 v[108:111], a[60:63], a[52:55], v[108:111]
    ds_read_b64_tr_b16 a[22:23], v13 offset:41472
    buffer_load_dwordx4 v22, s[8:11], s16 offen lds
    v_mfma_f32_16x16x32_bf16 v[40:43], a[64:67], a[40:43], v[40:43]
    v_mfma_f32_16x16x32_bf16 v[64:67], a[64:67], a[44:47], v[64:67]
    ds_read_b64_tr_b16 a[24:25], v11 offset:45056
    s_add_u32 m0, s19, 84992
    v_mfma_f32_16x16x32_bf16 v[88:91], a[64:67], a[48:51], v[88:91]
    ds_read_b64_tr_b16 a[26:27], v11 offset:45568
    buffer_load_dwordx4 v23, s[8:11], s16 offen lds
    v_mfma_f32_16x16x32_bf16 v[112:115], a[64:67], a[52:55], v[112:115]
    ds_read_b64_tr_b16 a[28:29], v13 offset:45056
    v_mfma_f32_16x16x32_bf16 v[44:47], a[68:71], a[40:43], v[44:47]
    ds_read_b64_tr_b16 a[30:31], v13 offset:45568
    v_mfma_f32_16x16x32_bf16 v[68:71], a[68:71], a[44:47], v[68:71]
    ds_read_b64_tr_b16 a[32:33], v11 offset:49152
    s_add_u32 s60, s60, 128
    v_mfma_f32_16x16x32_bf16 v[92:95], a[68:71], a[48:51], v[92:95]
    ds_read_b64_tr_b16 a[34:35], v11 offset:49664
    v_mfma_f32_16x16x32_bf16 v[116:119], a[68:71], a[52:55], v[116:119]
    ds_read_b64_tr_b16 a[36:37], v13 offset:49152
    v_mfma_f32_16x16x32_bf16 v[48:51], a[40:43], a[72:75], v[48:51]
    ds_read_b64_tr_b16 a[38:39], v13 offset:49664
    s_and_b32 s60, s60, 0x7ff
    v_mfma_f32_16x16x32_bf16 v[72:75], a[44:47], a[72:75], v[72:75]
    v_mfma_f32_16x16x32_bf16 v[96:99], a[48:51], a[72:75], v[96:99]
    v_mfma_f32_16x16x32_bf16 v[120:123], a[52:55], a[72:75], v[120:123]
    s_add_u32 s16, s58, s60
    v_mfma_f32_16x16x32_bf16 v[52:55], a[40:43], a[76:79], v[52:55]
    v_mfma_f32_16x16x32_bf16 v[76:79], a[44:47], a[76:79], v[76:79]
    s_add_u32 m0, s20, 81920
    v_mfma_f32_16x16x32_bf16 v[100:103], a[48:51], a[76:79], v[100:103]
    buffer_load_dwordx4 v25, s[12:15], s17 offen lds
    v_mfma_f32_16x16x32_bf16 v[124:127], a[52:55], a[76:79], v[124:127]
    s_waitcnt lgkmcnt(0)
    v_mfma_f32_16x16x32_bf16 v[32:35], a[16:19], a[0:3], v[32:35]
    ds_read_b128 a[40:43], v19 offset:40960
    s_add_u32 m0, s20, 86016
    v_mfma_f32_16x16x32_bf16 v[56:59], a[16:19], a[4:7], v[56:59]
    ds_read_b128 a[44:47], v19 offset:43008
    buffer_load_dwordx4 v26, s[12:15], s17 offen lds
    v_mfma_f32_16x16x32_bf16 v[80:83], a[16:19], a[8:11], v[80:83]
    ds_read_b128 a[48:51], v19 offset:45056
    v_mfma_f32_16x16x32_bf16 v[104:107], a[16:19], a[12:15], v[104:107]
    ds_read_b128 a[52:55], v19 offset:47104
    s_add_u32 m0, s20, 90112
    v_mfma_f32_16x16x32_bf16 v[36:39], a[20:23], a[0:3], v[36:39]
    ds_read_b64_tr_b16 a[56:57], v11 offset:53248
    buffer_load_dwordx4 v27, s[12:15], s17 offen lds
    v_mfma_f32_16x16x32_bf16 v[60:63], a[20:23], a[4:7], v[60:63]
    ds_read_b64_tr_b16 a[58:59], v11 offset:53760
    v_mfma_f32_16x16x32_bf16 v[84:87], a[20:23], a[8:11], v[84:87]
    ds_read_b64_tr_b16 a[60:61], v13 offset:53248
    s_add_u32 m0, s20, 94208
    v_mfma_f32_16x16x32_bf16 v[108:111], a[20:23], a[12:15], v[108:111]
    ds_read_b64_tr_b16 a[62:63], v13 offset:53760
    buffer_load_dwordx4 v28, s[12:15], s17 offen lds
    v_mfma_f32_16x16x32_bf16 v[40:43], a[24:27], a[0:3], v[40:43]
    v_mfma_f32_16x16x32_bf16 v[64:67], a[24:27], a[4:7], v[64:67]
    ds_read_b64_tr_b16 a[64:65], v11 offset:57344
    s_add_u32 m0, s20, 98304
    v_mfma_f32_16x16x32_bf16 v[88:91], a[24:27], a[8:11], v[88:91]
    ds_read_b64_tr_b16 a[66:67], v11 offset:57856
    buffer_load_dwordx4 v29, s[12:15], s17 offen lds
    v_mfma_f32_16x16x32_bf16 v[112:115], a[24:27], a[12:15], v[112:115]
    ds_read_b64_tr_b16 a[68:69], v13 offset:57344
    v_mfma_f32_16x16x32_bf16 v[44:47], a[28:31], a[0:3], v[44:47]
    ds_read_b64_tr_b16 a[70:71], v13 offset:57856
    s_add_u32 m0, s20, 102400
    v_mfma_f32_16x16x32_bf16 v[68:71], a[28:31], a[4:7], v[68:71]
    ds_read_b64_tr_b16 a[72:73], v11 offset:61440
    buffer_load_dwordx4 v30, s[12:15], s17 offen lds
    v_mfma_f32_16x16x32_bf16 v[92:95], a[28:31], a[8:11], v[92:95]
    ds_read_b64_tr_b16 a[74:75], v11 offset:61952
    v_mfma_f32_16x16x32_bf16 v[116:119], a[28:31], a[12:15], v[116:119]
    ds_read_b64_tr_b16 a[76:77], v13 offset:61440
    v_mfma_f32_16x16x32_bf16 v[48:51], a[0:3], a[32:35], v[48:51]
    ds_read_b64_tr_b16 a[78:79], v13 offset:61952
    s_add_u32 s61, s61, 1
    v_mfma_f32_16x16x32_bf16 v[72:75], a[4:7], a[32:35], v[72:75]
    v_mfma_f32_16x16x32_bf16 v[96:99], a[8:11], a[32:35], v[96:99]
    v_mfma_f32_16x16x32_bf16 v[120:123], a[12:15], a[32:35], v[120:123]
    s_and_b32 s61, s61, 15
    v_mfma_f32_16x16x32_bf16 v[52:55], a[0:3], a[36:39], v[52:55]
    v_mfma_f32_16x16x32_bf16 v[76:79], a[4:7], a[36:39], v[76:79]
    v_mfma_f32_16x16x32_bf16 v[100:103], a[8:11], a[36:39], v[100:103]
    s_mul_i32 s17, s61, 393216
    v_mfma_f32_16x16x32_bf16 v[124:127], a[12:15], a[36:39], v[124:127]
    s_waitcnt vmcnt(26) lgkmcnt(0)
    s_barrier
    v_mfma_f32_16x16x32_bf16 v[32:35], a[56:59], a[40:43], v[32:35]
    ds_read_b128 a[0:3], v16 offset:0
    s_add_u32 m0, s19, 122880
    v_mfma_f32_16x16x32_bf16 v[56:59], a[56:59], a[44:47], v[56:59]
    ds_read_b128 a[4:7], v16 offset:2048
    buffer_load_dwordx4 v20, s[8:11], s16 offen lds
    v_mfma_f32_16x16x32_bf16 v[80:83], a[56:59], a[48:51], v[80:83]
    ds_read_b128 a[8:11], v16 offset:4096
    v_mfma_f32_16x16x32_bf16 v[104:107], a[56:59], a[52:55], v[104:107]
    ds_read_b128 a[12:15], v16 offset:6144
    s_add_u32 m0, s19, 123904
    v_mfma_f32_16x16x32_bf16 v[36:39], a[60:63], a[40:43], v[36:39]
    ds_read_b64_tr_b16 a[16:17], v10 offset:0
    buffer_load_dwordx4 v21, s[8:11], s16 offen lds
    v_mfma_f32_16x16x32_bf16 v[60:63], a[60:63], a[44:47], v[60:63]
    ds_read_b64_tr_b16 a[18:19], v10 offset:512
    v_mfma_f32_16x16x32_bf16 v[84:87], a[60:63], a[48:51], v[84:87]
    ds_read_b64_tr_b16 a[20:21], v12 offset:0
    s_add_u32 m0, s19, 124928
    v_mfma_f32_16x16x32_bf16 v[108:111], a[60:63], a[52:55], v[108:111]
    ds_read_b64_tr_b16 a[22:23], v12 offset:512
    buffer_load_dwordx4 v22, s[8:11], s16 offen lds
    v_mfma_f32_16x16x32_bf16 v[40:43], a[64:67], a[40:43], v[40:43]
    v_mfma_f32_16x16x32_bf16 v[64:67], a[64:67], a[44:47], v[64:67]
    ds_read_b64_tr_b16 a[24:25], v10 offset:4096
    s_add_u32 m0, s19, 125952
    v_mfma_f32_16x16x32_bf16 v[88:91], a[64:67], a[48:51], v[88:91]
    ds_read_b64_tr_b16 a[26:27], v10 offset:4608
    buffer_load_dwordx4 v23, s[8:11], s16 offen lds
    v_mfma_f32_16x16x32_bf16 v[112:115], a[64:67], a[52:55], v[112:115]
    ds_read_b64_tr_b16 a[28:29], v12 offset:4096
    v_mfma_f32_16x16x32_bf16 v[44:47], a[68:71], a[40:43], v[44:47]
    ds_read_b64_tr_b16 a[30:31], v12 offset:4608
    v_mfma_f32_16x16x32_bf16 v[68:71], a[68:71], a[44:47], v[68:71]
    ds_read_b64_tr_b16 a[32:33], v10 offset:8192
    s_add_u32 s60, s60, 128
    v_mfma_f32_16x16x32_bf16 v[92:95], a[68:71], a[48:51], v[92:95]
    ds_read_b64_tr_b16 a[34:35], v10 offset:8704
    v_mfma_f32_16x16x32_bf16 v[116:119], a[68:71], a[52:55], v[116:119]
    ds_read_b64_tr_b16 a[36:37], v12 offset:8192
    v_mfma_f32_16x16x32_bf16 v[48:51], a[40:43], a[72:75], v[48:51]
    ds_read_b64_tr_b16 a[38:39], v12 offset:8704
    s_and_b32 s60, s60, 0x7ff
    v_mfma_f32_16x16x32_bf16 v[72:75], a[44:47], a[72:75], v[72:75]
    v_mfma_f32_16x16x32_bf16 v[96:99], a[48:51], a[72:75], v[96:99]
    v_mfma_f32_16x16x32_bf16 v[120:123], a[52:55], a[72:75], v[120:123]
    s_add_u32 s16, s58, s60
    v_mfma_f32_16x16x32_bf16 v[52:55], a[40:43], a[76:79], v[52:55]
    v_mfma_f32_16x16x32_bf16 v[76:79], a[44:47], a[76:79], v[76:79]
    s_add_u32 m0, s20, 122880
    v_mfma_f32_16x16x32_bf16 v[100:103], a[48:51], a[76:79], v[100:103]
    buffer_load_dwordx4 v25, s[12:15], s17 offen lds
    v_mfma_f32_16x16x32_bf16 v[124:127], a[52:55], a[76:79], v[124:127]
    s_waitcnt lgkmcnt(0)
    v_mfma_f32_16x16x32_bf16 v[32:35], a[16:19], a[0:3], v[32:35]
    ds_read_b128 a[40:43], v18 offset:0
    s_add_u32 m0, s20, 126976
    v_mfma_f32_16x16x32_bf16 v[56:59], a[16:19], a[4:7], v[56:59]
    ds_read_b128 a[44:47], v18 offset:2048
    buffer_load_dwordx4 v26, s[12:15], s17 offen lds
    v_mfma_f32_16x16x32_bf16 v[80:83], a[16:19], a[8:11], v[80:83]
    ds_read_b128 a[48:51], v18 offset:4096
    v_mfma_f32_16x16x32_bf16 v[104:107], a[16:19], a[12:15], v[104:107]
    ds_read_b128 a[52:55], v18 offset:6144
    s_add_u32 m0, s20, 131072
    v_mfma_f32_16x16x32_bf16 v[36:39], a[20:23], a[0:3], v[36:39]
    ds_read_b64_tr_b16 a[56:57], v10 offset:12288
    buffer_load_dwordx4 v27, s[12:15], s17 offen lds
    v_mfma_f32_16x16x32_bf16 v[60:63], a[20:23], a[4:7], v[60:63]
    ds_read_b64_tr_b16 a[58:59], v10 offset:12800
    v_mfma_f32_16x16x32_bf16 v[84:87], a[20:23], a[8:11], v[84:87]
    ds_read_b64_tr_b16 a[60:61], v12 offset:12288
    s_add_u32 m0, s20, 135168
    v_mfma_f32_16x16x32_bf16 v[108:111], a[20:23], a[12:15], v[108:111]
    ds_read_b64_tr_b16 a[62:63], v12 offset:12800
    buffer_load_dwordx4 v28, s[12:15], s17 offen lds
    v_mfma_f32_16x16x32_bf16 v[40:43], a[24:27], a[0:3], v[40:43]
    v_mfma_f32_16x16x32_bf16 v[64:67], a[24:27], a[4:7], v[64:67]
    ds_read_b64_tr_b16 a[64:65], v10 offset:16384
    s_add_u32 m0, s20, 139264
    v_mfma_f32_16x16x32_bf16 v[88:91], a[24:27], a[8:11], v[88:91]
    ds_read_b64_tr_b16 a[66:67], v10 offset:16896
    buffer_load_dwordx4 v29, s[12:15], s17 offen lds
    v_mfma_f32_16x16x32_bf16 v[112:115], a[24:27], a[12:15], v[112:115]
    ds_read_b64_tr_b16 a[68:69], v12 offset:16384
    v_mfma_f32_16x16x32_bf16 v[44:47], a[28:31], a[0:3], v[44:47]
    ds_read_b64_tr_b16 a[70:71], v12 offset:16896
    s_add_u32 m0, s20, 143360
    v_mfma_f32_16x16x32_bf16 v[68:71], a[28:31], a[4:7], v[68:71]
    ds_read_b64_tr_b16 a[72:73], v10 offset:20480
    buffer_load_dwordx4 v30, s[12:15], s17 offen lds
    v_mfma_f32_16x16x32_bf16 v[92:95], a[28:31], a[8:11], v[92:95]
    ds_read_b64_tr_b16 a[74:75], v10 offset:20992
    v_mfma_f32_16x16x32_bf16 v[116:119], a[28:31], a[12:15], v[116:119]
    ds_read_b64_tr_b16 a[76:77], v12 offset:20480
    v_mfma_f32_16x16x32_bf16 v[48:51], a[0:3], a[32:35], v[48:51]
    ds_read_b64_tr_b16 a[78:79], v12 offset:20992
    s_add_u32 s61, s61, 1
    v_mfma_f32_16x16x32_bf16 v[72:75], a[4:7], a[32:35], v[72:75]
    v_mfma_f32_16x16x32_bf16 v[96:99], a[8:11], a[32:35], v[96:99]
    v_mfma_f32_16x16x32_bf16 v[120:123], a[12:15], a[32:35], v[120:123]
    s_and_b32 s61, s61, 15
    v_mfma_f32_16x16x32_bf16 v[52:55], a[0:3], a[36:39], v[52:55]
    v_mfma_f32_16x16x32_bf16 v[76:79], a[4:7], a[36:39], v[76:79]
    v_mfma_f32_16x16x32_bf16 v[100:103], a[8:11], a[36:39], v[100:103]
    s_mul_i32 s17, s61, 393216
    v_mfma_f32_16x16x32_bf16 v[124:127], a[12:15], a[36:39], v[124:127]
    s_waitcnt vmcnt(26) lgkmcnt(0)
    s_barrier
    v_mfma_f32_16x16x32_bf16 v[32:35], a[56:59], a[40:43], v[32:35]
    ds_read_b128 a[0:3], v16 offset:40960
    s_add_u32 m0, s19, 0
    v_mfma_f32_16x16x32_bf16 v[56:59], a[56:59], a[44:47], v[56:59]
    ds_read_b128 a[4:7], v16 offset:43008
    buffer_load_dwordx4 v20, s[8:11], s16 offen lds
    v_mfma_f32_16x16x32_bf16 v[80:83], a[56:59], a[48:51], v[80:83]
    ds_read_b128 a[8:11], v16 offset:45056
    v_mfma_f32_16x16x32_bf16 v[104:107], a[56:59], a[52:55], v[104:107]
    ds_read_b128 a[12:15], v16 offset:47104
    s_add_u32 m0, s19, 1024
    v_mfma_f32_16x16x32_bf16 v[36:39], a[60:63], a[40:43], v[36:39]
    ds_read_b64_tr_b16 a[16:17], v10 offset:40960
    buffer_load_dwordx4 v21, s[8:11], s16 offen lds
    v_mfma_f32_16x16x32_bf16 v[60:63], a[60:63], a[44:47], v[60:63]
    ds_read_b64_tr_b16 a[18:19], v10 offset:41472
    v_mfma_f32_16x16x32_bf16 v[84:87], a[60:63], a[48:51], v[84:87]
    ds_read_b64_tr_b16 a[20:21], v12 offset:40960
    s_add_u32 m0, s19, 2048
    v_mfma_f32_16x16x32_bf16 v[108:111], a[60:63], a[52:55], v[108:111]
    ds_read_b64_tr_b16 a[22:23], v12 offset:41472
    buffer_load_dwordx4 v22, s[8:11], s16 offen lds
    v_mfma_f32_16x16x32_bf16 v[40:43], a[64:67], a[40:43], v[40:43]
    v_mfma_f32_16x16x32_bf16 v[64:67], a[64:67], a[44:47], v[64:67]
    ds_read_b64_tr_b16 a[24:25], v10 offset:45056
    s_add_u32 m0, s19, 3072
    v_mfma_f32_16x16x32_bf16 v[88:91], a[64:67], a[48:51], v[88:91]
    ds_read_b64_tr_b16 a[26:27], v10 offset:45568
    buffer_load_dwordx4 v23, s[8:11], s16 offen lds
    v_mfma_f32_16x16x32_bf16 v[112:115], a[64:67], a[52:55], v[112:115]
    ds_read_b64_tr_b16 a[28:29], v12 offset:45056
    v_mfma_f32_16x16x32_bf16 v[44:47], a[68:71], a[40:43], v[44:47]
    ds_read_b64_tr_b16 a[30:31], v12 offset:45568
    v_mfma_f32_16x16x32_bf16 v[68:71], a[68:71], a[44:47], v[68:71]
    ds_read_b64_tr_b16 a[32:33], v10 offset:49152
    s_add_u32 s60, s60, 128
    v_mfma_f32_16x16x32_bf16 v[92:95], a[68:71], a[48:51], v[92:95]
    ds_read_b64_tr_b16 a[34:35], v10 offset:49664
    v_mfma_f32_16x16x32_bf16 v[116:119], a[68:71], a[52:55], v[116:119]
    ds_read_b64_tr_b16 a[36:37], v12 offset:49152
    v_mfma_f32_16x16x32_bf16 v[48:51], a[40:43], a[72:75], v[48:51]
    ds_read_b64_tr_b16 a[38:39], v12 offset:49664
    s_and_b32 s60, s60, 0x7ff
    v_mfma_f32_16x16x32_bf16 v[72:75], a[44:47], a[72:75], v[72:75]
    v_mfma_f32_16x16x32_bf16 v[96:99], a[48:51], a[72:75], v[96:99]
    v_mfma_f32_16x16x32_bf16 v[120:123], a[52:55], a[72:75], v[120:123]
    s_add_u32 s16, s58, s60
    v_mfma_f32_16x16x32_bf16 v[52:55], a[40:43], a[76:79], v[52:55]
    v_mfma_f32_16x16x32_bf16 v[76:79], a[44:47], a[76:79], v[76:79]
    s_add_u32 m0, s20, 0
    v_mfma_f32_16x16x32_bf16 v[100:103], a[48:51], a[76:79], v[100:103]
    buffer_load_dwordx4 v25, s[12:15], s17 offen lds
    v_mfma_f32_16x16x32_bf16 v[124:127], a[52:55], a[76:79], v[124:127]
    s_waitcnt lgkmcnt(0)
    v_mfma_f32_16x16x32_bf16 v[32:35], a[16:19], a[0:3], v[32:35]
    ds_read_b128 a[40:43], v18 offset:40960
    s_add_u32 m0, s20, 4096
    v_mfma_f32_16x16x32_bf16 v[56:59], a[16:19], a[4:7], v[56:59]
    ds_read_b128 a[44:47], v18 offset:43008
    buffer_load_dwordx4 v26, s[12:15], s17 offen lds
    v_mfma_f32_16x16x32_bf16 v[80:83], a[16:19], a[8:11], v[80:83]
    ds_read_b128 a[48:51], v18 offset:45056
    v_mfma_f32_16x16x32_bf16 v[104:107], a[16:19], a[12:15], v[104:107]
    ds_read_b128 a[52:55], v18 offset:47104
    s_add_u32 m0, s20, 8192
    v_mfma_f32_16x16x32_bf16 v[36:39], a[20:23], a[0:3], v[36:39]
    ds_read_b64_tr_b16 a[56:57], v10 offset:53248
    buffer_load_dwordx4 v27, s[12:15], s17 offen lds
    v_mfma_f32_16x16x32_bf16 v[60:63], a[20:23], a[4:7], v[60:63]
    ds_read_b64_tr_b16 a[58:59], v10 offset:53760
    v_mfma_f32_16x16x32_bf16 v[84:87], a[20:23], a[8:11], v[84:87]
    ds_read_b64_tr_b16 a[60:61], v12 offset:53248
    s_add_u32 m0, s20, 12288
    v_mfma_f32_16x16x32_bf16 v[108:111], a[20:23], a[12:15], v[108:111]
    ds_read_b64_tr_b16 a[62:63], v12 offset:53760
    buffer_load_dwordx4 v28, s[12:15], s17 offen lds
    v_mfma_f32_16x16x32_bf16 v[40:43], a[24:27], a[0:3], v[40:43]
    v_mfma_f32_16x16x32_bf16 v[64:67], a[24:27], a[4:7], v[64:67]
    ds_read_b64_tr_b16 a[64:65], v10 offset:57344
    s_add_u32 m0, s20, 16384
    v_mfma_f32_16x16x32_bf16 v[88:91], a[24:27], a[8:11], v[88:91]
    ds_read_b64_tr_b16 a[66:67], v10 offset:57856
    buffer_load_dwordx4 v29, s[12:15], s17 offen lds
    v_mfma_f32_16x16x32_bf16 v[112:115], a[24:27], a[12:15], v[112:115]
    ds_read_b64_tr_b16 a[68:69], v12 offset:57344
    v_mfma_f32_16x16x32_bf16 v[44:47], a[28:31], a[0:3], v[44:47]
    ds_read_b64_tr_b16 a[70:71], v12 offset:57856
    s_add_u32 m0, s20, 20480
    v_mfma_f32_16x16x32_bf16 v[68:71], a[28:31], a[4:7], v[68:71]
    ds_read_b64_tr_b16 a[72:73], v10 offset:61440
    buffer_load_dwordx4 v30, s[12:15], s17 offen lds
    v_mfma_f32_16x16x32_bf16 v[92:95], a[28:31], a[8:11], v[92:95]
    ds_read_b64_tr_b16 a[74:75], v10 offset:61952
    v_mfma_f32_16x16x32_bf16 v[116:119], a[28:31], a[12:15], v[116:119]
    ds_read_b64_tr_b16 a[76:77], v12 offset:61440
    v_mfma_f32_16x16x32_bf16 v[48:51], a[0:3], a[32:35], v[48:51]
    ds_read_b64_tr_b16 a[78:79], v12 offset:61952
    s_add_u32 s61, s61, 1
    v_mfma_f32_16x16x32_bf16 v[72:75], a[4:7], a[32:35], v[72:75]
    v_mfma_f32_16x16x32_bf16 v[96:99], a[8:11], a[32:35], v[96:99]
    v_mfma_f32_16x16x32_bf16 v[120:123], a[12:15], a[32:35], v[120:123]
    s_and_b32 s61, s61, 15
    v_mfma_f32_16x16x32_bf16 v[52:55], a[0:3], a[36:39], v[52:55]
    v_mfma_f32_16x16x32_bf16 v[76:79], a[4:7], a[36:39], v[76:79]
    v_mfma_f32_16x16x32_bf16 v[100:103], a[8:11], a[36:39], v[100:103]
    s_mul_i32 s17, s61, 393216
    v_mfma_f32_16x16x32_bf16 v[124:127], a[12:15], a[36:39], v[124:127]
    s_waitcnt vmcnt(20) lgkmcnt(0)
    s_cmp_lg_u32 s36, 0
    s_cbranch_scc1 L_f7_2
    s_lshl_b32 s4, s56, 4
    s_add_u32 s4, s4, s92
    s_lshl_b32 s4, s4, 2
    s_add_u32 s4, s4, 12288
    v_mov_b32 v2, s88
    v_mov_b32 v3, 0
    s_mov_b64 exec, 1
    buffer_store_dword v2, v3, s[84:87], s4 offen sc1
    s_mov_b64 exec, -1
L_f7_2:
    s_barrier
    v_mfma_f32_16x16x32_bf16 v[32:35], a[56:59], a[40:43], v[32:35]
    ds_read_b128 a[0:3], v17 offset:0
    s_add_u32 m0, s19, 40960
    v_mfma_f32_16x16x32_bf16 v[56:59], a[56:59], a[44:47], v[56:59]
    ds_read_b128 a[4:7], v17 offset:2048
    buffer_load_dwordx4 v20, s[8:11], s16 offen lds
    v_mfma_f32_16x16x32_bf16 v[80:83], a[56:59], a[48:51], v[80:83]
    ds_read_b128 a[8:11], v17 offset:4096
    v_mfma_f32_16x16x32_bf16 v[104:107], a[56:59], a[52:55], v[104:107]
    ds_read_b128 a[12:15], v17 offset:6144
    s_add_u32 m0, s19, 41984
    v_mfma_f32_16x16x32_bf16 v[36:39], a[60:63], a[40:43], v[36:39]
    ds_read_b64_tr_b16 a[16:17], v11 offset:0
    buffer_load_dwordx4 v21, s[8:11], s16 offen lds
    v_mfma_f32_16x16x32_bf16 v[60:63], a[60:63], a[44:47], v[60:63]
    ds_read_b64_tr_b16 a[18:19], v11 offset:512
    v_mfma_f32_16x16x32_bf16 v[84:87], a[60:63], a[48:51], v[84:87]
    ds_read_b64_tr_b16 a[20:21], v13 offset:0
    s_add_u32 m0, s19, 43008
    v_mfma_f32_16x16x32_bf16 v[108:111], a[60:63], a[52:55], v[108:111]
    ds_read_b64_tr_b16 a[22:23], v13 offset:512
    buffer_load_dwordx4 v22, s[8:11], s16 offen lds
    v_mfma_f32_16x16x32_bf16 v[40:43], a[64:67], a[40:43], v[40:43]
    v_mfma_f32_16x16x32_bf16 v[64:67], a[64:67], a[44:47], v[64:67]
    ds_read_b64_tr_b16 a[24:25], v11 offset:4096
    s_add_u32 m0, s19, 44032
    v_mfma_f32_16x16x32_bf16 v[88:91], a[64:67], a[48:51], v[88:91]
    ds_read_b64_tr_b16 a[26:27], v11 offset:4608
    buffer_load_dwordx4 v23, s[8:11], s16 offen lds
    v_mfma_f32_16x16x32_bf16 v[112:115], a[64:67], a[52:55], v[112:115]
    ds_read_b64_tr_b16 a[28:29], v13 offset:4096
    v_mfma_f32_16x16x32_bf16 v[44:47], a[68:71], a[40:43], v[44:47]
    ds_read_b64_tr_b16 a[30:31], v13 offset:4608
    v_mfma_f32_16x16x32_bf16 v[68:71], a[68:71], a[44:47], v[68:71]
    ds_read_b64_tr_b16 a[32:33], v11 offset:8192
    s_add_u32 s60, s60, 128
    v_mfma_f32_16x16x32_bf16 v[92:95], a[68:71], a[48:51], v[92:95]
    ds_read_b64_tr_b16 a[34:35], v11 offset:8704
    v_mfma_f32_16x16x32_bf16 v[116:119], a[68:71], a[52:55], v[116:119]
    ds_read_b64_tr_b16 a[36:37], v13 offset:8192
    v_mfma_f32_16x16x32_bf16 v[48:51], a[40:43], a[72:75], v[48:51]
    ds_read_b64_tr_b16 a[38:39], v13 offset:8704
    s_and_b32 s60, s60, 0x7ff
    v_mfma_f32_16x16x32_bf16 v[72:75], a[44:47], a[72:75], v[72:75]
    v_mfma_f32_16x16x32_bf16 v[96:99], a[48:51], a[72:75], v[96:99]
    v_mfma_f32_16x16x32_bf16 v[120:123], a[52:55], a[72:75], v[120:123]
    s_add_u32 s16, s58, s60
    v_mfma_f32_16x16x32_bf16 v[52:55], a[40:43], a[76:79], v[52:55]
    v_mfma_f32_16x16x32_bf16 v[76:79], a[44:47], a[76:79], v[76:79]
    s_add_u32 m0, s20, 40960
    v_mfma_f32_16x16x32_bf16 v[100:103], a[48:51], a[76:79], v[100:103]
    buffer_load_dwordx4 v25, s[12:15], s17 offen lds
    v_mfma_f32_16x16x32_bf16 v[124:127], a[52:55], a[76:79], v[124:127]
    s_waitcnt lgkmcnt(0)
    v_mfma_f32_16x16x32_bf16 v[32:35], a[16:19], a[0:3], v[32:35]
    ds_read_b128 a[40:43], v19 offset:0
    s_add_u32 m0, s20, 45056
    v_mfma_f32_16x16x32_bf16 v[56:59], a[16:19], a[4:7], v[56:59]
    ds_read_b128 a[44:47], v19 offset:2048
    buffer_load_dwordx4 v26, s[12:15], s17 offen lds
    v_mfma_f32_16x16x32_bf16 v[80:83], a[16:19], a[8:11], v[80:83]
    ds_read_b128 a[48:51], v19 offset:4096
    v_mfma_f32_16x16x32_bf16 v[104:107], a[16:19], a[12:15], v[104:107]
    ds_read_b128 a[52:55], v19 offset:6144
    s_add_u32 m0, s20, 49152
    v_mfma_f32_16x16x32_bf16 v[36:39], a[20:23], a[0:3], v[36:39]
    ds_read_b64_tr_b16 a[56:57], v11 offset:12288
    buffer_load_dwordx4 v27, s[12:15], s17 offen lds
    v_mfma_f32_16x16x32_bf16 v[60:63], a[20:23], a[4:7], v[60:63]
    ds_read_b64_tr_b16 a[58:59], v11 offset:12800
    v_mfma_f32_16x16x32_bf16 v[84:87], a[20:23], a[8:11], v[84:87]
    ds_read_b64_tr_b16 a[60:61], v13 offset:12288
    s_add_u32 m0, s20, 53248
    v_mfma_f32_16x16x32_bf16 v[108:111], a[20:23], a[12:15], v[108:111]
    ds_read_b64_tr_b16 a[62:63], v13 offset:12800
    buffer_load_dwordx4 v28, s[12:15], s17 offen lds
    v_mfma_f32_16x16x32_bf16 v[40:43], a[24:27], a[0:3], v[40:43]
    v_mfma_f32_16x16x32_bf16 v[64:67], a[24:27], a[4:7], v[64:67]
    ds_read_b64_tr_b16 a[64:65], v11 offset:16384
    s_add_u32 m0, s20, 57344
    v_mfma_f32_16x16x32_bf16 v[88:91], a[24:27], a[8:11], v[88:91]
    ds_read_b64_tr_b16 a[66:67], v11 offset:16896
    buffer_load_dwordx4 v29, s[12:15], s17 offen lds
    v_mfma_f32_16x16x32_bf16 v[112:115], a[24:27], a[12:15], v[112:115]
    ds_read_b64_tr_b16 a[68:69], v13 offset:16384
    v_mfma_f32_16x16x32_bf16 v[44:47], a[28:31], a[0:3], v[44:47]
    ds_read_b64_tr_b16 a[70:71], v13 offset:16896
    s_add_u32 m0, s20, 61440
    v_mfma_f32_16x16x32_bf16 v[68:71], a[28:31], a[4:7], v[68:71]
    ds_read_b64_tr_b16 a[72:73], v11 offset:20480
    buffer_load_dwordx4 v30, s[12:15], s17 offen lds
    v_mfma_f32_16x16x32_bf16 v[92:95], a[28:31], a[8:11], v[92:95]
    ds_read_b64_tr_b16 a[74:75], v11 offset:20992
    v_mfma_f32_16x16x32_bf16 v[116:119], a[28:31], a[12:15], v[116:119]
    ds_read_b64_tr_b16 a[76:77], v13 offset:20480
    v_mfma_f32_16x16x32_bf16 v[48:51], a[0:3], a[32:35], v[48:51]
    ds_read_b64_tr_b16 a[78:79], v13 offset:20992
    s_add_u32 s61, s61, 1
    v_mfma_f32_16x16x32_bf16 v[72:75], a[4:7], a[32:35], v[72:75]
    v_mfma_f32_16x16x32_bf16 v[96:99], a[8:11], a[32:35], v[96:99]
    v_mfma_f32_16x16x32_bf16 v[120:123], a[12:15], a[32:35], v[120:123]
    s_and_b32 s61, s61, 15
    v_mfma_f32_16x16x32_bf16 v[52:55], a[0:3], a[36:39], v[52:55]
    v_mfma_f32_16x16x32_bf16 v[76:79], a[4:7], a[36:39], v[76:79]
    v_mfma_f32_16x16x32_bf16 v[100:103], a[8:11], a[36:39], v[100:103]
    s_mul_i32 s17, s61, 393216
    v_mfma_f32_16x16x32_bf16 v[124:127], a[12:15], a[36:39], v[124:127]
    s_waitcnt vmcnt(20) lgkmcnt(0)
    s_barrier
    v_mfma_f32_16x16x32_bf16 v[32:35], a[56:59], a[40:43], v[32:35]
    ds_read_b128 a[0:3], v17 offset:40960
    s_add_u32 m0, s19, 81920
    v_mfma_f32_16x16x32_bf16 v[56:59], a[56:59], a[44:47], v[56:59]
    ds_read_b128 a[4:7], v17 offset:43008
    buffer_load_dwordx4 v20, s[8:11], s16 offen lds
    v_mfma_f32_16x16x32_bf16 v[80:83], a[56:59], a[48:51], v[80:83]
    ds_read_b128 a[8:11], v17 offset:45056
    v_mfma_f32_16x16x32_bf16 v[104:107], a[56:59], a[52:55], v[104:107]
    ds_read_b128 a[12:15], v17 offset:47104
    s_add_u32 m0, s19, 82944
    v_mfma_f32_16x16x32_bf16 v[36:39], a[60:63], a[40:43], v[36:39]
    ds_read_b64_tr_b16 a[16:17], v11 offset:40960
    buffer_load_dwordx4 v21, s[8:11], s16 offen lds
    v_mfma_f32_16x16x32_bf16 v[60:63], a[60:63], a[44:47], v[60:63]
    ds_read_b64_tr_b16 a[18:19], v11 offset:41472
    v_mfma_f32_16x16x32_bf16 v[84:87], a[60:63], a[48:51], v[84:87]
    ds_read_b64_tr_b16 a[20:21], v13 offset:40960
    s_add_u32 m0, s19, 83968
    v_mfma_f32_16x16x32_bf16 v[108:111], a[60:63], a[52:55], v[108:111]
    ds_read_b64_tr_b16 a[22:23], v13 offset:41472
    buffer_load_dwordx4 v22, s[8:11], s16 offen lds
    v_mfma_f32_16x16x32_bf16 v[40:43], a[64:67], a[40:43], v[40:43]
    v_mfma_f32_16x16x32_bf16 v[64:67], a[64:67], a[44:47], v[64:67]
    ds_read_b64_tr_b16 a[24:25], v11 offset:45056
    s_add_u32 m0, s19, 84992
    v_mfma_f32_16x16x32_bf16 v[88:91], a[64:67], a[48:51], v[88:91]
    ds_read_b64_tr_b16 a[26:27], v11 offset:45568
    buffer_load_dwordx4 v23, s[8:11], s16 offen lds
    v_mfma_f32_16x16x32_bf16 v[112:115], a[64:67], a[52:55], v[112:115]
    ds_read_b64_tr_b16 a[28:29], v13 offset:45056
    v_mfma_f32_16x16x32_bf16 v[44:47], a[68:71], a[40:43], v[44:47]
    ds_read_b64_tr_b16 a[30:31], v13 offset:45568
    v_mfma_f32_16x16x32_bf16 v[68:71], a[68:71], a[44:47], v[68:71]
    ds_read_b64_tr_b16 a[32:33], v11 offset:49152
    s_add_u32 s60, s60, 128
    v_mfma_f32_16x16x32_bf16 v[92:95], a[68:71], a[48:51], v[92:95]
    ds_read_b64_tr_b16 a[34:35], v11 offset:49664
    v_mfma_f32_16x16x32_bf16 v[116:119], a[68:71], a[52:55], v[116:119]
    ds_read_b64_tr_b16 a[36:37], v13 offset:49152
    v_mfma_f32_16x16x32_bf16 v[48:51], a[40:43], a[72:75], v[48:51]
    ds_read_b64_tr_b16 a[38:39], v13 offset:49664
    s_and_b32 s60, s60, 0x7ff
    v_mfma_f32_16x16x32_bf16 v[72:75], a[44:47], a[72:75], v[72:75]
    v_mfma_f32_16x16x32_bf16 v[96:99], a[48:51], a[72:75], v[96:99]
    v_mfma_f32_16x16x32_bf16 v[120:123], a[52:55], a[72:75], v[120:123]
    s_add_u32 s16, s58, s60
    v_mfma_f32_16x16x32_bf16 v[52:55], a[40:43], a[76:79], v[52:55]
    v_mfma_f32_16x16x32_bf16 v[76:79], a[44:47], a[76:79], v[76:79]
    s_add_u32 m0, s20, 81920
    v_mfma_f32_16x16x32_bf16 v[100:103], a[48:51], a[76:79], v[100:103]
    buffer_load_dwordx4 v25, s[12:15], s17 offen lds
    v_mfma_f32_16x16x32_bf16 v[124:127], a[52:55], a[76:79], v[124:127]
    s_waitcnt lgkmcnt(0)
    v_mfma_f32_16x16x32_bf16 v[32:35], a[16:19], a[0:3], v[32:35]
    ds_read_b128 a[40:43], v19 offset:40960
    s_add_u32 m0, s20, 86016
    v_mfma_f32_16x16x32_bf16 v[56:59], a[16:19], a[4:7], v[56:59]
    ds_read_b128 a[44:47], v19 offset:43008
    buffer_load_dwordx4 v26, s[12:15], s17 offen lds
    v_mfma_f32_16x16x32_bf16 v[80:83], a[16:19], a[8:11], v[80:83]
    ds_read_b128 a[48:51], v19 offset:45056
    v_mfma_f32_16x16x32_bf16 v[104:107], a[16:19], a[12:15], v[104:107]
    ds_read_b128 a[52:55], v19 offset:47104
    s_add_u32 m0, s20, 90112
    v_mfma_f32_16x16x32_bf16 v[36:39], a[20:23], a[0:3], v[36:39]
    ds_read_b64_tr_b16 a[56:57], v11 offset:53248
    buffer_load_dwordx4 v27, s[12:15], s17 offen lds
    v_mfma_f32_16x16x32_bf16 v[60:63], a[20:23], a[4:7], v[60:63]
    ds_read_b64_tr_b16 a[58:59], v11 offset:53760
    v_mfma_f32_16x16x32_bf16 v[84:87], a[20:23], a[8:11], v[84:87]
    ds_read_b64_tr_b16 a[60:61], v13 offset:53248
    s_add_u32 m0, s20, 94208
    v_mfma_f32_16x16x32_bf16 v[108:111], a[20:23], a[12:15], v[108:111]
    ds_read_b64_tr_b16 a[62:63], v13 offset:53760
    buffer_load_dwordx4 v28, s[12:15], s17 offen lds
    v_mfma_f32_16x16x32_bf16 v[40:43], a[24:27], a[0:3], v[40:43]
    v_mfma_f32_16x16x32_bf16 v[64:67], a[24:27], a[4:7], v[64:67]
    ds_read_b64_tr_b16 a[64:65], v11 offset:57344
    s_add_u32 m0, s20, 98304
    v_mfma_f32_16x16x32_bf16 v[88:91], a[24:27], a[8:11], v[88:91]
    ds_read_b64_tr_b16 a[66:67], v11 offset:57856
    buffer_load_dwordx4 v29, s[12:15], s17 offen lds
    v_mfma_f32_16x16x32_bf16 v[112:115], a[24:27], a[12:15], v[112:115]
    ds_read_b64_tr_b16 a[68:69], v13 offset:57344
    v_mfma_f32_16x16x32_bf16 v[44:47], a[28:31], a[0:3], v[44:47]
    ds_read_b64_tr_b16 a[70:71], v13 offset:57856
    s_add_u32 m0, s20, 102400
    v_mfma_f32_16x16x32_bf16 v[68:71], a[28:31], a[4:7], v[68:71]
    ds_read_b64_tr_b16 a[72:73], v11 offset:61440
    buffer_load_dwordx4 v30, s[12:15], s17 offen lds
    v_mfma_f32_16x16x32_bf16 v[92:95], a[28:31], a[8:11], v[92:95]
    ds_read_b64_tr_b16 a[74:75], v11 offset:61952
    v_mfma_f32_16x16x32_bf16 v[116:119], a[28:31], a[12:15], v[116:119]
    ds_read_b64_tr_b16 a[76:77], v13 offset:61440
    v_mfma_f32_16x16x32_bf16 v[48:51], a[0:3], a[32:35], v[48:51]
    ds_read_b64_tr_b16 a[78:79], v13 offset:61952
    s_add_u32 s61, s61, 1
    v_mfma_f32_16x16x32_bf16 v[72:75], a[4:7], a[32:35], v[72:75]
    v_mfma_f32_16x16x32_bf16 v[96:99], a[8:11], a[32:35], v[96:99]
    v_mfma_f32_16x16x32_bf16 v[120:123], a[12:15], a[32:35], v[120:123]
    s_and_b32 s61, s61, 15
    v_mfma_f32_16x16x32_bf16 v[52:55], a[0:3], a[36:39], v[52:55]
    v_mfma_f32_16x16x32_bf16 v[76:79], a[4:7], a[36:39], v[76:79]
    v_mfma_f32_16x16x32_bf16 v[100:103], a[8:11], a[36:39], v[100:103]
    s_mul_i32 s17, s61, 393216
    v_mfma_f32_16x16x32_bf16 v[124:127], a[12:15], a[36:39], v[124:127]
    s_waitcnt vmcnt(20) lgkmcnt(0)
    s_barrier
    v_mfma_f32_16x16x32_bf16 v[32:35], a[56:59], a[40:43], v[32:35]
    ds_read_b128 a[0:3], v16 offset:0
    s_add_u32 m0, s19, 122880
    v_mfma_f32_16x16x32_bf16 v[56:59], a[56:59], a[44:47], v[56:59]
    ds_read_b128 a[4:7], v16 offset:2048
    buffer_load_dwordx4 v20, s[8:11], s16 offen lds
    v_mfma_f32_16x16x32_bf16 v[80:83], a[56:59], a[48:51], v[80:83]
    ds_read_b128 a[8:11], v16 offset:4096
    v_mfma_f32_16x16x32_bf16 v[104:107], a[56:59], a[52:55], v[104:107]
    ds_read_b128 a[12:15], v16 offset:6144
    s_add_u32 m0, s19, 123904
    v_mfma_f32_16x16x32_bf16 v[36:39], a[60:63], a[40:43], v[36:39]
    ds_read_b64_tr_b16 a[16:17], v10 offset:0
    buffer_load_dwordx4 v21, s[8:11], s16 offen lds
    v_mfma_f32_16x16x32_bf16 v[60:63], a[60:63], a[44:47], v[60:63]
    ds_read_b64_tr_b16 a[18:19], v10 offset:512
    v_mfma_f32_16x16x32_bf16 v[84:87], a[60:63], a[48:51], v[84:87]
    ds_read_b64_tr_b16 a[20:21], v12 offset:0
    s_add_u32 m0, s19, 124928
    v_mfma_f32_16x16x32_bf16 v[108:111], a[60:63], a[52:55], v[108:111]
    ds_read_b64_tr_b16 a[22:23], v12 offset:512
    buffer_load_dwordx4 v22, s[8:11], s16 offen lds
    v_mfma_f32_16x16x32_bf16 v[40:43], a[64:67], a[40:43], v[40:43]
    v_mfma_f32_16x16x32_bf16 v[64:67], a[64:67], a[44:47], v[64:67]
    ds_read_b64_tr_b16 a[24:25], v10 offset:4096
    s_add_u32 m0, s19, 125952
    v_mfma_f32_16x16x32_bf16 v[88:91], a[64:67], a[48:51], v[88:91]
    ds_read_b64_tr_b16 a[26:27], v10 offset:4608
    buffer_load_dwordx4 v23, s[8:11], s16 offen lds
    v_mfma_f32_16x16x32_bf16 v[112:115], a[64:67], a[52:55], v[112:115]
    ds_read_b64_tr_b16 a[28:29], v12 offset:4096
    v_mfma_f32_16x16x32_bf16 v[44:47], a[68:71], a[40:43], v[44:47]
    ds_read_b64_tr_b16 a[30:31], v12 offset:4608
    v_mfma_f32_16x16x32_bf16 v[68:71], a[68:71], a[44:47], v[68:71]
    ds_read_b64_tr_b16 a[32:33], v10 offset:8192
    s_add_u32 s60, s60, 128
    v_mfma_f32_16x16x32_bf16 v[92:95], a[68:71], a[48:51], v[92:95]
    ds_read_b64_tr_b16 a[34:35], v10 offset:8704
    v_mfma_f32_16x16x32_bf16 v[116:119], a[68:71], a[52:55], v[116:119]
    ds_read_b64_tr_b16 a[36:37], v12 offset:8192
    v_mfma_f32_16x16x32_bf16 v[48:51], a[40:43], a[72:75], v[48:51]
    ds_read_b64_tr_b16 a[38:39], v12 offset:8704
    s_and_b32 s60, s60, 0x7ff
    v_mfma_f32_16x16x32_bf16 v[72:75], a[44:47], a[72:75], v[72:75]
    v_mfma_f32_16x16x32_bf16 v[96:99], a[48:51], a[72:75], v[96:99]
    v_mfma_f32_16x16x32_bf16 v[120:123], a[52:55], a[72:75], v[120:123]
    s_add_u32 s16, s58, s60
    v_mfma_f32_16x16x32_bf16 v[52:55], a[40:43], a[76:79], v[52:55]
    v_mfma_f32_16x16x32_bf16 v[76:79], a[44:47], a[76:79], v[76:79]
    s_add_u32 m0, s20, 122880
    v_mfma_f32_16x16x32_bf16 v[100:103], a[48:51], a[76:79], v[100:103]
    buffer_load_dwordx4 v25, s[12:15], s17 offen lds
    v_mfma_f32_16x16x32_bf16 v[124:127], a[52:55], a[76:79], v[124:127]
    s_waitcnt lgkmcnt(0)
    v_mfma_f32_16x16x32_bf16 v[32:35], a[16:19], a[0:3], v[32:35]
    ds_read_b128 a[40:43], v18 offset:0
    s_add_u32 m0, s20, 126976
    v_mfma_f32_16x16x32_bf16 v[56:59], a[16:19], a[4:7], v[56:59]
    ds_read_b128 a[44:47], v18 offset:2048
    buffer_load_dwordx4 v26, s[12:15], s17 offen lds
    v_mfma_f32_16x16x32_bf16 v[80:83], a[16:19], a[8:11], v[80:83]
    ds_read_b128 a[48:51], v18 offset:4096
    v_mfma_f32_16x16x32_bf16 v[104:107], a[16:19], a[12:15], v[104:107]
    ds_read_b128 a[52:55], v18 offset:6144
    s_add_u32 m0, s20, 131072
    v_mfma_f32_16x16x32_bf16 v[36:39], a[20:23], a[0:3], v[36:39]
    ds_read_b64_tr_b16 a[56:57], v10 offset:12288
    buffer_load_dwordx4 v27, s[12:15], s17 offen lds
    v_mfma_f32_16x16x32_bf16 v[60:63], a[20:23], a[4:7], v[60:63]
    ds_read_b64_tr_b16 a[58:59], v10 offset:12800
    v_mfma_f32_16x16x32_bf16 v[84:87], a[20:23], a[8:11], v[84:87]
    ds_read_b64_tr_b16 a[60:61], v12 offset:12288
    s_add_u32 m0, s20, 135168
    v_mfma_f32_16x16x32_bf16 v[108:111], a[20:23], a[12:15], v[108:111]
    ds_read_b64_tr_b16 a[62:63], v12 offset:12800
    buffer_load_dwordx4 v28, s[12:15], s17 offen lds
    v_mfma_f32_16x16x32_bf16 v[40:43], a[24:27], a[0:3], v[40:43]
    v_mfma_f32_16x16x32_bf16 v[64:67], a[24:27], a[4:7], v[64:67]
    ds_read_b64_tr_b16 a[64:65], v10 offset:16384
    s_add_u32 m0, s20, 139264
    v_mfma_f32_16x16x32_bf16 v[88:91], a[24:27], a[8:11], v[88:91]
    ds_read_b64_tr_b16 a[66:67], v10 offset:16896
    buffer_load_dwordx4 v29, s[12:15], s17 offen lds
    v_mfma_f32_16x16x32_bf16 v[112:115], a[24:27], a[12:15], v[112:115]
    ds_read_b64_tr_b16 a[68:69], v12 offset:16384
    v_mfma_f32_16x16x32_bf16 v[44:47], a[28:31], a[0:3], v[44:47]
    ds_read_b64_tr_b16 a[70:71], v12 offset:16896
    s_add_u32 m0, s20, 143360
    v_mfma_f32_16x16x32_bf16 v[68:71], a[28:31], a[4:7], v[68:71]
    ds_read_b64_tr_b16 a[72:73], v10 offset:20480
    buffer_load_dwordx4 v30, s[12:15], s17 offen lds
    v_mfma_f32_16x16x32_bf16 v[92:95], a[28:31], a[8:11], v[92:95]
    ds_read_b64_tr_b16 a[74:75], v10 offset:20992
    v_mfma_f32_16x16x32_bf16 v[116:119], a[28:31], a[12:15], v[116:119]
    ds_read_b64_tr_b16 a[76:77], v12 offset:20480
    v_mfma_f32_16x16x32_bf16 v[48:51], a[0:3], a[32:35], v[48:51]
    ds_read_b64_tr_b16 a[78:79], v12 offset:20992
    s_add_u32 s61, s61, 1
    v_mfma_f32_16x16x32_bf16 v[72:75], a[4:7], a[32:35], v[72:75]
    v_mfma_f32_16x16x32_bf16 v[96:99], a[8:11], a[32:35], v[96:99]
    v_mfma_f32_16x16x32_bf16 v[120:123], a[12:15], a[32:35], v[120:123]
    s_and_b32 s61, s61, 15
    v_mfma_f32_16x16x32_bf16 v[52:55], a[0:3], a[36:39], v[52:55]
    v_mfma_f32_16x16x32_bf16 v[76:79], a[4:7], a[36:39], v[76:79]
    v_mfma_f32_16x16x32_bf16 v[100:103], a[8:11], a[36:39], v[100:103]
    s_mul_i32 s17, s61, 393216
    v_mfma_f32_16x16x32_bf16 v[124:127], a[12:15], a[36:39], v[124:127]
    s_waitcnt vmcnt(20) lgkmcnt(0)
    s_barrier
    v_mfma_f32_16x16x32_bf16 v[32:35], a[56:59], a[40:43], v[32:35]
    ds_read_b128 a[0:3], v16 offset:40960
    s_add_u32 m0, s19, 0
    v_mfma_f32_16x16x32_bf16 v[56:59], a[56:59], a[44:47], v[56:59]
    ds_read_b128 a[4:7], v16 offset:43008
    buffer_load_dwordx4 v20, s[8:11], s16 offen lds
    v_mfma_f32_16x16x32_bf16 v[80:83], a[56:59], a[48:51], v[80:83]
    ds_read_b128 a[8:11], v16 offset:45056
    s_add_u32 m0, s19, 1024
    v_mfma_f32_16x16x32_bf16 v[104:107], a[56:59], a[52:55], v[104:107]
    ds_read_b128 a[12:15], v16 offset:47104
    buffer_load_dwordx4 v21, s[8:11], s16 offen lds
    v_mfma_f32_16x16x32_bf16 v[36:39], a[60:63], a[40:43], v[36:39]
    ds_read_b64_tr_b16 a[16:17], v10 offset:40960
    v_mfma_f32_16x16x32_bf16 v[60:63], a[60:63], a[44:47], v[60:63]
    ds_read_b64_tr_b16 a[18:19], v10 offset:41472
    s_add_u32 m0, s19, 2048
    v_mfma_f32_16x16x32_bf16 v[84:87], a[60:63], a[48:51], v[84:87]
    ds_read_b64_tr_b16 a[20:21], v12 offset:40960
    buffer_load_dwordx4 v22, s[8:11], s16 offen lds
    v_mfma_f32_16x16x32_bf16 v[108:111], a[60:63], a[52:55], v[108:111]
    ds_read_b64_tr_b16 a[22:23], v12 offset:41472
    s_add_u32 m0, s19, 3072
    v_mfma_f32_16x16x32_bf16 v[40:43], a[64:67], a[40:43], v[40:43]
    buffer_load_dwordx4 v23, s[8:11], s16 offen lds
    v_mfma_f32_16x16x32_bf16 v[64:67], a[64:67], a[44:47], v[64:67]
    ds_read_b64_tr_b16 a[24:25], v10 offset:45056
    v_mfma_f32_16x16x32_bf16 v[88:91], a[64:67], a[48:51], v[88:91]
    ds_read_b64_tr_b16 a[26:27], v10 offset:45568
    s_add_u32 s60, s60, 128
    v_mfma_f32_16x16x32_bf16 v[112:115], a[64:67], a[52:55], v[112:115]
    ds_read_b64_tr_b16 a[28:29], v12 offset:45056
    v_mfma_f32_16x16x32_bf16 v[44:47], a[68:71], a[40:43], v[44:47]
    ds_read_b64_tr_b16 a[30:31], v12 offset:45568
    v_mfma_f32_16x16x32_bf16 v[68:71], a[68:71], a[44:47], v[68:71]
    ds_read_b64_tr_b16 a[32:33], v10 offset:49152
    s_and_b32 s60, s60, 0x7ff
    v_mfma_f32_16x16x32_bf16 v[92:95], a[68:71], a[48:51], v[92:95]
    ds_read_b64_tr_b16 a[34:35], v10 offset:49664
    v_mfma_f32_16x16x32_bf16 v[116:119], a[68:71], a[52:55], v[116:119]
    ds_read_b64_tr_b16 a[36:37], v12 offset:49152
    s_add_u32 s16, s58, s60
    v_mfma_f32_16x16x32_bf16 v[48:51], a[40:43], a[72:75], v[48:51]
    ds_read_b64_tr_b16 a[38:39], v12 offset:49664
    v_mfma_f32_16x16x32_bf16 v[72:75], a[44:47], a[72:75], v[72:75]
    s_add_u32 m0, s20, 0
    v_mfma_f32_16x16x32_bf16 v[96:99], a[48:51], a[72:75], v[96:99]
    buffer_load_dwordx4 v25, s[12:15], s17 offen lds
    v_mfma_f32_16x16x32_bf16 v[120:123], a[52:55], a[72:75], v[120:123]
    s_add_u32 m0, s20, 4096
    v_mfma_f32_16x16x32_bf16 v[52:55], a[40:43], a[76:79], v[52:55]
    buffer_load_dwordx4 v26, s[12:15], s17 offen lds
    v_mfma_f32_16x16x32_bf16 v[76:79], a[44:47], a[76:79], v[76:79]
    s_add_u32 m0, s20, 8192
    v_mfma_f32_16x16x32_bf16 v[100:103], a[48:51], a[76:79], v[100:103]
    buffer_load_dwordx4 v27, s[12:15], s17 offen lds
    v_mfma_f32_16x16x32_bf16 v[124:127], a[52:55], a[76:79], v[124:127]
    s_waitcnt lgkmcnt(0)
    v_mfma_f32_16x16x32_bf16 v[32:35], a[16:19], a[0:3], v[32:35]
    ds_read_b128 a[40:43], v18 offset:40960
    s_add_u32 m0, s20, 12288
    v_mfma_f32_16x16x32_bf16 v[56:59], a[16:19], a[4:7], v[56:59]
    ds_read_b128 a[44:47], v18 offset:43008
    buffer_load_dwordx4 v28, s[12:15], s17 offen lds
    v_mfma_f32_16x16x32_bf16 v[80:83], a[16:19], a[8:11], v[80:83]
    ds_read_b128 a[48:51], v18 offset:45056
    v_mfma_f32_16x16x32_bf16 v[104:107], a[16:19], a[12:15], v[104:107]
    ds_read_b128 a[52:55], v18 offset:47104
    s_add_u32 m0, s20, 16384
    v_mfma_f32_16x16x32_bf16 v[36:39], a[20:23], a[0:3], v[36:39]
    ds_read_b64_tr_b16 a[56:57], v10 offset:53248
    buffer_load_dwordx4 v29, s[12:15], s17 offen lds
    v_mfma_f32_16x16x32_bf16 v[60:63], a[20:23], a[4:7], v[60:63]
    ds_read_b64_tr_b16 a[58:59], v10 offset:53760
    s_add_u32 m0, s20, 20480
    v_mfma_f32_16x16x32_bf16 v[84:87], a[20:23], a[8:11], v[84:87]
    ds_read_b64_tr_b16 a[60:61], v12 offset:53248
    buffer_load_dwordx4 v30, s[12:15], s17 offen lds
    v_mfma_f32_16x16x32_bf16 v[108:111], a[20:23], a[12:15], v[108:111]
    ds_read_b64_tr_b16 a[62:63], v12 offset:53760
    v_mfma_f32_16x16x32_bf16 v[40:43], a[24:27], a[0:3], v[40:43]
    v_mfma_f32_16x16x32_bf16 v[64:67], a[24:27], a[4:7], v[64:67]
    ds_read_b64_tr_b16 a[64:65], v10 offset:57344
    s_add_u32 s61, s61, 1
    v_mfma_f32_16x16x32_bf16 v[88:91], a[24:27], a[8:11], v[88:91]
    ds_read_b64_tr_b16 a[66:67], v10 offset:57856
    v_mfma_f32_16x16x32_bf16 v[112:115], a[24:27], a[12:15], v[112:115]
    ds_read_b64_tr_b16 a[68:69], v12 offset:57344
    v_mfma_f32_16x16x32_bf16 v[44:47], a[28:31], a[0:3], v[44:47]
    ds_read_b64_tr_b16 a[70:71], v12 offset:57856
    s_and_b32 s61, s61, 15
    v_mfma_f32_16x16x32_bf16 v[68:71], a[28:31], a[4:7], v[68:71]
    ds_read_b64_tr_b16 a[72:73], v10 offset:61440
    v_mfma_f32_16x16x32_bf16 v[92:95], a[28:31], a[8:11], v[92:95]
    ds_read_b64_tr_b16 a[74:75], v10 offset:61952
    s_mul_i32 s17, s61, 393216
    v_mfma_f32_16x16x32_bf16 v[116:119], a[28:31], a[12:15], v[116:119]
    ds_read_b64_tr_b16 a[76:77], v12 offset:61440
    v_mfma_f32_16x16x32_bf16 v[48:51], a[0:3], a[32:35], v[48:51]
    ds_read_b64_tr_b16 a[78:79], v12 offset:61952
    v_mfma_f32_16x16x32_bf16 v[72:75], a[4:7], a[32:35], v[72:75]
    s_lshl_b32 s62, s56, 6
    s_add_u32 s62, s62, 12288
    s_lshl_b32 s63, s92, 1
    s_add_u32 s63, s63, s36
    s_lshl_b32 s63, s63, 10
    s_add_u32 s63, s63, 983040
    v_and_b32 v134, 15, v1
    v_lshlrev_b32 v134, 2, v134
    v_lshlrev_b32 v135, 4, v1
    s_mov_b32 s54, 262144
    buffer_load_dword v133, v134, s[84:87], s62 offen sc1
    v_mfma_f32_16x16x32_bf16 v[96:99], a[8:11], a[32:35], v[96:99]
    v_mfma_f32_16x16x32_bf16 v[120:123], a[12:15], a[32:35], v[120:123]
    v_mfma_f32_16x16x32_bf16 v[52:55], a[0:3], a[36:39], v[52:55]
    buffer_load_dwordx4 v[212:215], v135, s[84:87], s63 offen sc1
    v_mfma_f32_16x16x32_bf16 v[76:79], a[4:7], a[36:39], v[76:79]
    v_mfma_f32_16x16x32_bf16 v[100:103], a[8:11], a[36:39], v[100:103]
    s_lshr_b32 s4, s34, 1
    s_lshl_b32 s4, s4, 6
    s_add_u32 s4, s4, 3072
    v_mov_b32 v2, 0
    s_mov_b64 exec, 1
    buffer_load_dword a245, v2, s[84:87], s4 offen sc1
    s_mov_b64 exec, -1
    v_mfma_f32_16x16x32_bf16 v[124:127], a[12:15], a[36:39], v[124:127]
    s_waitcnt vmcnt(23) lgkmcnt(0)
    s_barrier
    v_mfma_f32_16x16x32_bf16 v[32:35], a[56:59], a[40:43], v[32:35]
    ds_read_b128 a[0:3], v17 offset:0
    s_add_u32 m0, s19, 40960
    v_mfma_f32_16x16x32_bf16 v[56:59], a[56:59], a[44:47], v[56:59]
    ds_read_b128 a[4:7], v17 offset:2048
    buffer_load_dwordx4 v20, s[8:11], s16 offen lds
    v_mfma_f32_16x16x32_bf16 v[80:83], a[56:59], a[48:51], v[80:83]
    ds_read_b128 a[8:11], v17 offset:4096
    v_mfma_f32_16x16x32_bf16 v[104:107], a[56:59], a[52:55], v[104:107]
    ds_read_b128 a[12:15], v17 offset:6144
    s_add_u32 m0, s19, 41984
    v_mfma_f32_16x16x32_bf16 v[36:39], a[60:63], a[40:43], v[36:39]
    ds_read_b64_tr_b16 a[16:17], v11 offset:0
    buffer_load_dwordx4 v21, s[8:11], s16 offen lds
    v_mfma_f32_16x16x32_bf16 v[60:63], a[60:63], a[44:47], v[60:63]
    ds_read_b64_tr_b16 a[18:19], v11 offset:512
    v_mfma_f32_16x16x32_bf16 v[84:87], a[60:63], a[48:51], v[84:87]
    ds_read_b64_tr_b16 a[20:21], v13 offset:0
    s_add_u32 m0, s19, 43008
    v_mfma_f32_16x16x32_bf16 v[108:111], a[60:63], a[52:55], v[108:111]
    ds_read_b64_tr_b16 a[22:23], v13 offset:512
    buffer_load_dwordx4 v22, s[8:11], s16 offen lds
    v_mfma_f32_16x16x32_bf16 v[40:43], a[64:67], a[40:43], v[40:43]
    v_mfma_f32_16x16x32_bf16 v[64:67], a[64:67], a[44:47], v[64:67]
    ds_read_b64_tr_b16 a[24:25], v11 offset:4096
    s_add_u32 m0, s19, 44032
    v_mfma_f32_16x16x32_bf16 v[88:91], a[64:67], a[48:51], v[88:91]
    ds_read_b64_tr_b16 a[26:27], v11 offset:4608
    buffer_load_dwordx4 v23, s[8:11], s16 offen lds
    v_mfma_f32_16x16x32_bf16 v[112:115], a[64:67], a[52:55], v[112:115]
    ds_read_b64_tr_b16 a[28:29], v13 offset:4096
    v_mfma_f32_16x16x32_bf16 v[44:47], a[68:71], a[40:43], v[44:47]
    ds_read_b64_tr_b16 a[30:31], v13 offset:4608
    v_mfma_f32_16x16x32_bf16 v[68:71], a[68:71], a[44:47], v[68:71]
    ds_read_b64_tr_b16 a[32:33], v11 offset:8192
    s_add_u32 s60, s60, 128
    v_mfma_f32_16x16x32_bf16 v[92:95], a[68:71], a[48:51], v[92:95]
    ds_read_b64_tr_b16 a[34:35], v11 offset:8704
    v_mfma_f32_16x16x32_bf16 v[116:119], a[68:71], a[52:55], v[116:119]
    ds_read_b64_tr_b16 a[36:37], v13 offset:8192
    v_mfma_f32_16x16x32_bf16 v[48:51], a[40:43], a[72:75], v[48:51]
    ds_read_b64_tr_b16 a[38:39], v13 offset:8704
    s_and_b32 s60, s60, 0x7ff
    v_mfma_f32_16x16x32_bf16 v[72:75], a[44:47], a[72:75], v[72:75]
    v_mfma_f32_16x16x32_bf16 v[96:99], a[48:51], a[72:75], v[96:99]
    v_mfma_f32_16x16x32_bf16 v[120:123], a[52:55], a[72:75], v[120:123]
    s_add_u32 s16, s58, s60
    v_mfma_f32_16x16x32_bf16 v[52:55], a[40:43], a[76:79], v[52:55]
    v_mfma_f32_16x16x32_bf16 v[76:79], a[44:47], a[76:79], v[76:79]
    s_add_u32 m0, s20, 40960
    v_mfma_f32_16x16x32_bf16 v[100:103], a[48:51], a[76:79], v[100:103]
    buffer_load_dwordx4 v25, s[12:15], s17 offen lds
    v_mfma_f32_16x16x32_bf16 v[124:127], a[52:55], a[76:79], v[124:127]
    s_waitcnt lgkmcnt(0)
    v_mfma_f32_16x16x32_bf16 v[32:35], a[16:19], a[0:3], v[32:35]
    ds_read_b128 a[40:43], v19 offset:0
    s_add_u32 m0, s20, 45056
    v_mfma_f32_16x16x32_bf16 v[56:59], a[16:19], a[4:7], v[56:59]
    ds_read_b128 a[44:47], v19 offset:2048
    buffer_load_dwordx4 v26, s[12:15], s17 offen lds
    v_mfma_f32_16x16x32_bf16 v[80:83], a[16:19], a[8:11], v[80:83]
    ds_read_b128 a[48:51], v19 offset:4096
    v_mfma_f32_16x16x32_bf16 v[104:107], a[16:19], a[12:15], v[104:107]
    ds_read_b128 a[52:55], v19 offset:6144
    s_add_u32 m0, s20, 49152
    v_mfma_f32_16x16x32_bf16 v[36:39], a[20:23], a[0:3], v[36:39]
    ds_read_b64_tr_b16 a[56:57], v11 offset:12288
    buffer_load_dwordx4 v27, s[12:15], s17 offen lds
    v_mfma_f32_16x16x32_bf16 v[60:63], a[20:23], a[4:7], v[60:63]
    ds_read_b64_tr_b16 a[58:59], v11 offset:12800
    v_mfma_f32_16x16x32_bf16 v[84:87], a[20:23], a[8:11], v[84:87]
    ds_read_b64_tr_b16 a[60:61], v13 offset:12288
    s_add_u32 m0, s20, 53248
    v_mfma_f32_16x16x32_bf16 v[108:111], a[20:23], a[12:15], v[108:111]
    ds_read_b64_tr_b16 a[62:63], v13 offset:12800
    buffer_load_dwordx4 v28, s[12:15], s17 offen lds
    v_mfma_f32_16x16x32_bf16 v[40:43], a[24:27], a[0:3], v[40:43]
    v_mfma_f32_16x16x32_bf16 v[64:67], a[24:27], a[4:7], v[64:67]
    ds_read_b64_tr_b16 a[64:65], v11 offset:16384
    s_add_u32 m0, s20, 57344
    v_mfma_f32_16x16x32_bf16 v[88:91], a[24:27], a[8:11], v[88:91]
    ds_read_b64_tr_b16 a[66:67], v11 offset:16896
    buffer_load_dwordx4 v29, s[12:15], s17 offen lds
    v_mfma_f32_16x16x32_bf16 v[112:115], a[24:27], a[12:15], v[112:115]
    ds_read_b64_tr_b16 a[68:69], v13 offset:16384
    v_mfma_f32_16x16x32_bf16 v[44:47], a[28:31], a[0:3], v[44:47]
    ds_read_b64_tr_b16 a[70:71], v13 offset:16896
    s_add_u32 m0, s20, 61440
    v_mfma_f32_16x16x32_bf16 v[68:71], a[28:31], a[4:7], v[68:71]
    ds_read_b64_tr_b16 a[72:73], v11 offset:20480
    buffer_load_dwordx4 v30, s[12:15], s17 offen lds
    v_mfma_f32_16x16x32_bf16 v[92:95], a[28:31], a[8:11], v[92:95]
    ds_read_b64_tr_b16 a[74:75], v11 offset:20992
    v_mfma_f32_16x16x32_bf16 v[116:119], a[28:31], a[12:15], v[116:119]
    ds_read_b64_tr_b16 a[76:77], v13 offset:20480
    v_mfma_f32_16x16x32_bf16 v[48:51], a[0:3], a[32:35], v[48:51]
    ds_read_b64_tr_b16 a[78:79], v13 offset:20992
    s_add_u32 s61, s61, 1
    v_mfma_f32_16x16x32_bf16 v[72:75], a[4:7], a[32:35], v[72:75]
    v_mfma_f32_16x16x32_bf16 v[96:99], a[8:11], a[32:35], v[96:99]
    v_mfma_f32_16x16x32_bf16 v[120:123], a[12:15], a[32:35], v[120:123]
    s_and_b32 s61, s61, 15
    v_mfma_f32_16x16x32_bf16 v[52:55], a[0:3], a[36:39], v[52:55]
    v_mfma_f32_16x16x32_bf16 v[76:79], a[4:7], a[36:39], v[76:79]
    v_mfma_f32_16x16x32_bf16 v[100:103], a[8:11], a[36:39], v[100:103]
    s_mul_i32 s17, s61, 393216
    v_mfma_f32_16x16x32_bf16 v[124:127], a[12:15], a[36:39], v[124:127]
    s_waitcnt vmcnt(23) lgkmcnt(0)
    s_waitcnt vmcnt(11)
    v_xor_b32 v2, s88, v133
    v_xor_b32 v3, s88, v214
    v_or_b32 v2, v2, v3
    v_cmp_ne_u32 vcc, 0, v2
    s_nop 4
    s_cbranch_vccz L_ck_3
    s_mov_b32 s4, 0x20000
L_spin_4:
    buffer_load_dword v133, v134, s[84:87], s62 offen sc1
    buffer_load_dwordx4 v[212:215], v135, s[84:87], s63 offen sc1
    s_waitcnt vmcnt(0)
    v_xor_b32 v2, s88, v133
    v_xor_b32 v3, s88, v214
    v_or_b32 v2, v2, v3
    v_cmp_ne_u32 vcc, 0, v2
    s_sub_u32 s4, s4, 1
    s_nop 3
    s_cbranch_vccz L_spin_4_ok
    s_cmp_eq_u32 s4, 0
    s_cbranch_scc0 L_spin_4
L_spin_4_ok:
L_ck_3:
    s_barrier
    v_mfma_f32_16x16x32_bf16 v[32:35], a[56:59], a[40:43], v[32:35]
    ds_read_b128 a[0:3], v17 offset:40960
    s_add_u32 m0, s19, 81920
    v_mfma_f32_16x16x32_bf16 v[56:59], a[56:59], a[44:47], v[56:59]
    ds_read_b128 a[4:7], v17 offset:43008
    buffer_load_dwordx4 v20, s[8:11], s16 offen lds
    v_mfma_f32_16x16x32_bf16 v[80:83], a[56:59], a[48:51], v[80:83]
    ds_read_b128 a[8:11], v17 offset:45056
    s_add_u32 m0, s19, 82944
    v_mfma_f32_16x16x32_bf16 v[104:107], a[56:59], a[52:55], v[104:107]
    ds_read_b128 a[12:15], v17 offset:47104
    buffer_load_dwordx4 v21, s[8:11], s16 offen lds
    v_mfma_f32_16x16x32_bf16 v[36:39], a[60:63], a[40:43], v[36:39]
    ds_read_b64_tr_b16 a[16:17], v11 offset:40960
    s_add_u32 m0, s19, 83968
    v_mfma_f32_16x16x32_bf16 v[60:63], a[60:63], a[44:47], v[60:63]
    ds_read_b64_tr_b16 a[18:19], v11 offset:41472
    buffer_load_dwordx4 v22, s[8:11], s16 offen lds
    v_mfma_f32_16x16x32_bf16 v[84:87], a[60:63], a[48:51], v[84:87]
    ds_read_b64_tr_b16 a[20:21], v13 offset:40960
    s_add_u32 m0, s19, 84992
    v_mfma_f32_16x16x32_bf16 v[108:111], a[60:63], a[52:55], v[108:111]
    ds_read_b64_tr_b16 a[22:23], v13 offset:41472
    buffer_load_dwordx4 v23, s[8:11], s16 offen lds
    v_mfma_f32_16x16x32_bf16 v[40:43], a[64:67], a[40:43], v[40:43]
    v_mfma_f32_16x16x32_bf16 v[64:67], a[64:67], a[44:47], v[64:67]
    ds_read_b64_tr_b16 a[24:25], v11 offset:45056
    s_add_u32 s60, s60, 128
    v_mfma_f32_16x16x32_bf16 v[88:91], a[64:67], a[48:51], v[88:91]
    ds_read_b64_tr_b16 a[26:27], v11 offset:45568
    v_mfma_f32_16x16x32_bf16 v[112:115], a[64:67], a[52:55], v[112:115]
    ds_read_b64_tr_b16 a[28:29], v13 offset:45056
    s_and_b32 s60, s60, 0x7ff
    v_mfma_f32_16x16x32_bf16 v[44:47], a[68:71], a[40:43], v[44:47]
    ds_read_b64_tr_b16 a[30:31], v13 offset:45568
    v_mfma_f32_16x16x32_bf16 v[68:71], a[68:71], a[44:47], v[68:71]
    ds_read_b64_tr_b16 a[32:33], v11 offset:49152
    s_add_u32 s16, s58, s60
    v_mfma_f32_16x16x32_bf16 v[92:95], a[68:71], a[48:51], v[92:95]
    ds_read_b64_tr_b16 a[34:35], v11 offset:49664
    s_add_u32 m0, s20, 81920
    v_mfma_f32_16x16x32_bf16 v[116:119], a[68:71], a[52:55], v[116:119]
    ds_read_b64_tr_b16 a[36:37], v13 offset:49152
    buffer_load_dwordx4 v25, s[12:15], s17 offen lds
    v_mfma_f32_16x16x32_bf16 v[48:51], a[40:43], a[72:75], v[48:51]
    ds_read_b64_tr_b16 a[38:39], v13 offset:49664
    s_add_u32 m0, s20, 86016
    v_mfma_f32_16x16x32_bf16 v[72:75], a[44:47], a[72:75], v[72:75]
    buffer_load_dwordx4 v26, s[12:15], s17 offen lds
    v_mfma_f32_16x16x32_bf16 v[96:99], a[48:51], a[72:75], v[96:99]
    s_add_u32 m0, s20, 90112
    v_mfma_f32_16x16x32_bf16 v[120:123], a[52:55], a[72:75], v[120:123]
    buffer_load_dwordx4 v27, s[12:15], s17 offen lds
    v_mfma_f32_16x16x32_bf16 v[52:55], a[40:43], a[76:79], v[52:55]
    s_add_u32 m0, s20, 94208
    v_mfma_f32_16x16x32_bf16 v[76:79], a[44:47], a[76:79], v[76:79]
    buffer_load_dwordx4 v28, s[12:15], s17 offen lds
    v_mfma_f32_16x16x32_bf16 v[100:103], a[48:51], a[76:79], v[100:103]
    s_add_u32 m0, s20, 98304
    v_mfma_f32_16x16x32_bf16 v[124:127], a[52:55], a[76:79], v[124:127]
    buffer_load_dwordx4 v29, s[12:15], s17 offen lds
    s_waitcnt lgkmcnt(0)
    v_mfma_f32_16x16x32_bf16 v[32:35], a[16:19], a[0:3], v[32:35]
    ds_read_b128 a[40:43], v19 offset:40960
    s_add_u32 m0, s20, 102400
    v_mfma_f32_16x16x32_bf16 v[56:59], a[16:19], a[4:7], v[56:59]
    ds_read_b128 a[44:47], v19 offset:43008
    buffer_load_dwordx4 v30, s[12:15], s17 offen lds
    v_mfma_f32_16x16x32_bf16 v[80:83], a[16:19], a[8:11], v[80:83]
    ds_read_b128 a[48:51], v19 offset:45056
    v_mfma_f32_16x16x32_bf16 v[104:107], a[16:19], a[12:15], v[104:107]
    ds_read_b128 a[52:55], v19 offset:47104
    s_add_u32 s61, s61, 1
    v_mfma_f32_16x16x32_bf16 v[36:39], a[20:23], a[0:3], v[36:39]
    ds_read_b64_tr_b16 a[56:57], v11 offset:53248
    v_mfma_f32_16x16x32_bf16 v[60:63], a[20:23], a[4:7], v[60:63]
    ds_read_b64_tr_b16 a[58:59], v11 offset:53760
    s_and_b32 s61, s61, 15
    v_mfma_f32_16x16x32_bf16 v[84:87], a[20:23], a[8:11], v[84:87]
    ds_read_b64_tr_b16 a[60:61], v13 offset:53248
    v_mfma_f32_16x16x32_bf16 v[108:111], a[20:23], a[12:15], v[108:111]
    ds_read_b64_tr_b16 a[62:63], v13 offset:53760
    s_mul_i32 s17, s61, 393216
    v_mfma_f32_16x16x32_bf16 v[40:43], a[24:27], a[0:3], v[40:43]
    v_mfma_f32_16x16x32_bf16 v[64:67], a[24:27], a[4:7], v[64:67]
    ds_read_b64_tr_b16 a[64:65], v11 offset:57344
    v_and_b32 v2, 15, v1
    v_lshlrev_b32 v2, 6, v2
    v_and_b32 v3, 48, v1
    v_add_u32 v134, v2, v3
    s_add_u32 s4, s57, 4096
    v_mfma_f32_16x16x32_bf16 v[88:91], a[24:27], a[8:11], v[88:91]
    ds_read_b64_tr_b16 a[66:67], v11 offset:57856
    v_mfma_f32_16x16x32_bf16 v[112:115], a[24:27], a[12:15], v[112:115]
    ds_read_b64_tr_b16 a[68:69], v13 offset:57344
    v_mfma_f32_16x16x32_bf16 v[44:47], a[28:31], a[0:3], v[44:47]
    ds_read_b64_tr_b16 a[70:71], v13 offset:57856
    buffer_load_dwordx4 v[188:191], v134, s[52:55], s57 offen offset:0 sc1
    v_mfma_f32_16x16x32_bf16 v[68:71], a[28:31], a[4:7], v[68:71]
    ds_read_b64_tr_b16 a[72:73], v11 offset:61440
    v_mfma_f32_16x16x32_bf16 v[92:95], a[28:31], a[8:11], v[92:95]
    ds_read_b64_tr_b16 a[74:75], v11 offset:61952
    buffer_load_dwordx4 v[192:195], v134, s[52:55], s57 offen offset:1024 sc1
    v_mfma_f32_16x16x32_bf16 v[116:119], a[28:31], a[12:15], v[116:119]
    ds_read_b64_tr_b16 a[76:77], v13 offset:61440
    v_mfma_f32_16x16x32_bf16 v[48:51], a[0:3], a[32:35], v[48:51]
    ds_read_b64_tr_b16 a[78:79], v13 offset:61952
    buffer_load_dwordx4 v[196:199], v134, s[52:55], s57 offen offset:2048 sc1
    v_mfma_f32_16x16x32_bf16 v[72:75], a[4:7], a[32:35], v[72:75]
    v_mfma_f32_16x16x32_bf16 v[96:99], a[8:11], a[32:35], v[96:99]
    buffer_load_dwordx4 v[200:203], v134, s[52:55], s57 offen offset:3072 sc1
    v_mfma_f32_16x16x32_bf16 v[120:123], a[12:15], a[32:35], v[120:123]
    v_mfma_f32_16x16x32_bf16 v[52:55], a[0:3], a[36:39], v[52:55]
    buffer_load_dwordx4 v[204:207], v134, s[52:55], s4 offen offset:0 sc1
    v_mfma_f32_16x16x32_bf16 v[76:79], a[4:7], a[36:39], v[76:79]
    v_mfma_f32_16x16x32_bf16 v[100:103], a[8:11], a[36:39], v[100:103]
    buffer_load_dwordx4 v[208:211], v134, s[52:55], s4 offen offset:1024 sc1
    v_mfma_f32_16x16x32_bf16 v[124:127], a[12:15], a[36:39], v[124:127]
    s_waitcnt vmcnt(29) lgkmcnt(0)
    s_barrier
    v_mfma_f32_16x16x32_bf16 v[32:35], a[56:59], a[40:43], v[32:35]
    ds_read_b128 a[0:3], v16 offset:0
    s_add_u32 m0, s19, 122880
    v_mfma_f32_16x16x32_bf16 v[56:59], a[56:59], a[44:47], v[56:59]
    ds_read_b128 a[4:7], v16 offset:2048
    buffer_load_dwordx4 v20, s[8:11], s16 offen lds
    v_mfma_f32_16x16x32_bf16 v[80:83], a[56:59], a[48:51], v[80:83]
    ds_read_b128 a[8:11], v16 offset:4096
    v_mfma_f32_16x16x32_bf16 v[104:107], a[56:59], a[52:55], v[104:107]
    ds_read_b128 a[12:15], v16 offset:6144
    s_add_u32 m0, s19, 123904
    v_mfma_f32_16x16x32_bf16 v[36:39], a[60:63], a[40:43], v[36:39]
    ds_read_b64_tr_b16 a[16:17], v10 offset:0
    buffer_load_dwordx4 v21, s[8:11], s16 offen lds
    v_mfma_f32_16x16x32_bf16 v[60:63], a[60:63], a[44:47], v[60:63]
    ds_read_b64_tr_b16 a[18:19], v10 offset:512
    s_add_u32 m0, s19, 124928
    v_mfma_f32_16x16x32_bf16 v[84:87], a[60:63], a[48:51], v[84:87]
    ds_read_b64_tr_b16 a[20:21], v12 offset:0
    buffer_load_dwordx4 v22, s[8:11], s16 offen lds
    v_mfma_f32_16x16x32_bf16 v[108:111], a[60:63], a[52:55], v[108:111]
    ds_read_b64_tr_b16 a[22:23], v12 offset:512
    v_mfma_f32_16x16x32_bf16 v[40:43], a[64:67], a[40:43], v[40:43]
    s_add_u32 m0, s19, 125952
    v_mfma_f32_16x16x32_bf16 v[64:67], a[64:67], a[44:47], v[64:67]
    ds_read_b64_tr_b16 a[24:25], v10 offset:4096
    buffer_load_dwordx4 v23, s[8:11], s16 offen lds
    v_mfma_f32_16x16x32_bf16 v[88:91], a[64:67], a[48:51], v[88:91]
    ds_read_b64_tr_b16 a[26:27], v10 offset:4608
    v_mfma_f32_16x16x32_bf16 v[112:115], a[64:67], a[52:55], v[112:115]
    ds_read_b64_tr_b16 a[28:29], v12 offset:4096
    v_mfma_f32_16x16x32_bf16 v[44:47], a[68:71], a[40:43], v[44:47]
    ds_read_b64_tr_b16 a[30:31], v12 offset:4608
    s_add_u32 s60, s60, 128
    v_mfma_f32_16x16x32_bf16 v[68:71], a[68:71], a[44:47], v[68:71]
    ds_read_b64_tr_b16 a[32:33], v10 offset:8192
    v_mfma_f32_16x16x32_bf16 v[92:95], a[68:71], a[48:51], v[92:95]
    ds_read_b64_tr_b16 a[34:35], v10 offset:8704
    s_and_b32 s60, s60, 0x7ff
    v_mfma_f32_16x16x32_bf16 v[116:119], a[68:71], a[52:55], v[116:119]
    ds_read_b64_tr_b16 a[36:37], v12 offset:8192
    v_mfma_f32_16x16x32_bf16 v[48:51], a[40:43], a[72:75], v[48:51]
    ds_read_b64_tr_b16 a[38:39], v12 offset:8704
    v_mfma_f32_16x16x32_bf16 v[72:75], a[44:47], a[72:75], v[72:75]
    s_add_u32 s16, s58, s60
    v_mfma_f32_16x16x32_bf16 v[96:99], a[48:51], a[72:75], v[96:99]
    v_mfma_f32_16x16x32_bf16 v[120:123], a[52:55], a[72:75], v[120:123]
    s_add_u32 m0, s20, 122880
    v_mfma_f32_16x16x32_bf16 v[52:55], a[40:43], a[76:79], v[52:55]
    buffer_load_dwordx4 v25, s[12:15], s17 offen lds
    v_mfma_f32_16x16x32_bf16 v[76:79], a[44:47], a[76:79], v[76:79]
    s_add_u32 m0, s20, 126976
    v_mfma_f32_16x16x32_bf16 v[100:103], a[48:51], a[76:79], v[100:103]
    buffer_load_dwordx4 v26, s[12:15], s17 offen lds
    v_mfma_f32_16x16x32_bf16 v[124:127], a[52:55], a[76:79], v[124:127]
    s_waitcnt lgkmcnt(0)
    v_mfma_f32_16x16x32_bf16 v[32:35], a[16:19], a[0:3], v[32:35]
    ds_read_b128 a[40:43], v18 offset:0
    s_add_u32 m0, s20, 131072
    v_mfma_f32_16x16x32_bf16 v[56:59], a[16:19], a[4:7], v[56:59]
    ds_read_b128 a[44:47], v18 offset:2048
    buffer_load_dwordx4 v27, s[12:15], s17 offen lds
    v_mfma_f32_16x16x32_bf16 v[80:83], a[16:19], a[8:11], v[80:83]
    ds_read_b128 a[48:51], v18 offset:4096
    v_mfma_f32_16x16x32_bf16 v[104:107], a[16:19], a[12:15], v[104:107]
    ds_read_b128 a[52:55], v18 offset:6144
    s_add_u32 m0, s20, 135168
    v_mfma_f32_16x16x32_bf16 v[36:39], a[20:23], a[0:3], v[36:39]
    ds_read_b64_tr_b16 a[56:57], v10 offset:12288
    buffer_load_dwordx4 v28, s[12:15], s17 offen lds
    v_mfma_f32_16x16x32_bf16 v[60:63], a[20:23], a[4:7], v[60:63]
    ds_read_b64_tr_b16 a[58:59], v10 offset:12800
    v_mfma_f32_16x16x32_bf16 v[84:87], a[20:23], a[8:11], v[84:87]
    ds_read_b64_tr_b16 a[60:61], v12 offset:12288
    s_add_u32 m0, s20, 139264
    v_mfma_f32_16x16x32_bf16 v[108:111], a[20:23], a[12:15], v[108:111]
    ds_read_b64_tr_b16 a[62:63], v12 offset:12800
    buffer_load_dwordx4 v29, s[12:15], s17 offen lds
    v_mfma_f32_16x16x32_bf16 v[40:43], a[24:27], a[0:3], v[40:43]
    v_mfma_f32_16x16x32_bf16 v[64:67], a[24:27], a[4:7], v[64:67]
    ds_read_b64_tr_b16 a[64:65], v10 offset:16384
    s_add_u32 m0, s20, 143360
    v_mfma_f32_16x16x32_bf16 v[88:91], a[24:27], a[8:11], v[88:91]
    ds_read_b64_tr_b16 a[66:67], v10 offset:16896
    buffer_load_dwordx4 v30, s[12:15], s17 offen lds
    v_mfma_f32_16x16x32_bf16 v[112:115], a[24:27], a[12:15], v[112:115]
    ds_read_b64_tr_b16 a[68:69], v12 offset:16384
    v_mfma_f32_16x16x32_bf16 v[44:47], a[28:31], a[0:3], v[44:47]
    ds_read_b64_tr_b16 a[70:71], v12 offset:16896
    v_mfma_f32_16x16x32_bf16 v[68:71], a[28:31], a[4:7], v[68:71]
    ds_read_b64_tr_b16 a[72:73], v10 offset:20480
    s_add_u32 s61, s61, 1
    v_mfma_f32_16x16x32_bf16 v[92:95], a[28:31], a[8:11], v[92:95]
    ds_read_b64_tr_b16 a[74:75], v10 offset:20992
    v_mfma_f32_16x16x32_bf16 v[116:119], a[28:31], a[12:15], v[116:119]
    ds_read_b64_tr_b16 a[76:77], v12 offset:20480
    v_mfma_f32_16x16x32_bf16 v[48:51], a[0:3], a[32:35], v[48:51]
    ds_read_b64_tr_b16 a[78:79], v12 offset:20992
    s_and_b32 s61, s61, 15
    v_mfma_f32_16x16x32_bf16 v[72:75], a[4:7], a[32:35], v[72:75]
    v_mfma_f32_16x16x32_bf16 v[96:99], a[8:11], a[32:35], v[96:99]
    v_mfma_f32_16x16x32_bf16 v[120:123], a[12:15], a[32:35], v[120:123]
    s_mul_i32 s17, s61, 393216
    v_mfma_f32_16x16x32_bf16 v[52:55], a[0:3], a[36:39], v[52:55]
    v_mfma_f32_16x16x32_bf16 v[76:79], a[4:7], a[36:39], v[76:79]
    v_mfma_f32_16x16x32_bf16 v[100:103], a[8:11], a[36:39], v[100:103]
    s_lshl_b32 s4, s28, 12
    s_add_u32 s4, s4, 425984
    v_and_b32 v131, 31, v1
    v_lshl_add_u32 v131, v131, 7, s4
    buffer_load_dword v130, v131, s[84:87], 0 offen sc1
    v_mfma_f32_16x16x32_bf16 v[124:127], a[12:15], a[36:39], v[124:127]
    s_waitcnt vmcnt(27) lgkmcnt(0)
    s_barrier
    v_mfma_f32_16x16x32_bf16 v[32:35], a[56:59], a[40:43], v[32:35]
    ds_read_b128 a[0:3], v16 offset:40960
    v_mfma_f32_16x16x32_bf16 v[56:59], a[56:59], a[44:47], v[56:59]
    ds_read_b128 a[4:7], v16 offset:43008
    v_mfma_f32_16x16x32_bf16 v[80:83], a[56:59], a[48:51], v[80:83]
    ds_read_b128 a[8:11], v16 offset:45056
    v_mfma_f32_16x16x32_bf16 v[104:107], a[56:59], a[52:55], v[104:107]
    ds_read_b128 a[12:15], v16 offset:47104
    v_mfma_f32_16x16x32_bf16 v[36:39], a[60:63], a[40:43], v[36:39]
    ds_read_b64_tr_b16 a[16:17], v10 offset:40960
    v_mfma_f32_16x16x32_bf16 v[60:63], a[60:63], a[44:47], v[60:63]
    ds_read_b64_tr_b16 a[18:19], v10 offset:41472
    v_mfma_f32_16x16x32_bf16 v[84:87], a[60:63], a[48:51], v[84:87]
    ds_read_b64_tr_b16 a[20:21], v12 offset:40960
    s_lshl_b32 s4, s3, 9
    v_lshl_add_u32 v133, v1, 2, s4
    ds_write_b32 v133, v212
    ds_write_b32 v133, v213 offset:256
    v_mfma_f32_16x16x32_bf16 v[108:111], a[60:63], a[52:55], v[108:111]
    ds_read_b64_tr_b16 a[22:23], v12 offset:41472
    v_mfma_f32_16x16x32_bf16 v[40:43], a[64:67], a[40:43], v[40:43]
    v_mfma_f32_16x16x32_bf16 v[64:67], a[64:67], a[44:47], v[64:67]
    ds_read_b64_tr_b16 a[24:25], v10 offset:45056
    v_mfma_f32_16x16x32_bf16 v[88:91], a[64:67], a[48:51], v[88:91]
    ds_read_b64_tr_b16 a[26:27], v10 offset:45568
    v_mfma_f32_16x16x32_bf16 v[112:115], a[64:67], a[52:55], v[112:115]
    ds_read_b64_tr_b16 a[28:29], v12 offset:45056
    v_mfma_f32_16x16x32_bf16 v[44:47], a[68:71], a[40:43], v[44:47]
    ds_read_b64_tr_b16 a[30:31], v12 offset:45568
    v_mfma_f32_16x16x32_bf16 v[68:71], a[68:71], a[44:47], v[68:71]
    ds_read_b64_tr_b16 a[32:33], v10 offset:49152
    v_mfma_f32_16x16x32_bf16 v[92:95], a[68:71], a[48:51], v[92:95]
    ds_read_b64_tr_b16 a[34:35], v10 offset:49664
    v_mfma_f32_16x16x32_bf16 v[116:119], a[68:71], a[52:55], v[116:119]
    ds_read_b64_tr_b16 a[36:37], v12 offset:49152
    v_mfma_f32_16x16x32_bf16 v[48:51], a[40:43], a[72:75], v[48:51]
    ds_read_b64_tr_b16 a[38:39], v12 offset:49664
    v_mfma_f32_16x16x32_bf16 v[72:75], a[44:47], a[72:75], v[72:75]
    v_mfma_f32_16x16x32_bf16 v[96:99], a[48:51], a[72:75], v[96:99]
    v_and_b32 v2, 15, v1
    v_lshl_add_u32 v133, v2, 2, s4
    v_and_b32 v2, 48, v1
    v_add_u32 v135, s4, v2
    v_mfma_f32_16x16x32_bf16 v[120:123], a[52:55], a[72:75], v[120:123]
    v_mfma_f32_16x16x32_bf16 v[52:55], a[40:43], a[76:79], v[52:55]
    v_mfma_f32_16x16x32_bf16 v[76:79], a[44:47], a[76:79], v[76:79]
    v_mfma_f32_16x16x32_bf16 v[100:103], a[48:51], a[76:79], v[100:103]
    v_mfma_f32_16x16x32_bf16 v[124:127], a[52:55], a[76:79], v[124:127]
    s_waitcnt lgkmcnt(0)
    v_mfma_f32_16x16x32_bf16 v[32:35], a[16:19], a[0:3], v[32:35]
    ds_read_b128 a[40:43], v18 offset:40960
    v_mfma_f32_16x16x32_bf16 v[56:59], a[16:19], a[4:7], v[56:59]
    ds_read_b128 a[44:47], v18 offset:43008
    v_mfma_f32_16x16x32_bf16 v[80:83], a[16:19], a[8:11], v[80:83]
    ds_read_b128 a[48:51], v18 offset:45056
    v_mfma_f32_16x16x32_bf16 v[104:107], a[16:19], a[12:15], v[104:107]
    ds_read_b128 a[52:55], v18 offset:47104
    v_mfma_f32_16x16x32_bf16 v[36:39], a[20:23], a[0:3], v[36:39]
    ds_read_b64_tr_b16 a[56:57], v10 offset:53248
    v_mfma_f32_16x16x32_bf16 v[60:63], a[20:23], a[4:7], v[60:63]
    ds_read_b64_tr_b16 a[58:59], v10 offset:53760
    v_mfma_f32_16x16x32_bf16 v[84:87], a[20:23], a[8:11], v[84:87]
    ds_read_b64_tr_b16 a[60:61], v12 offset:53248
    v_mfma_f32_16x16x32_bf16 v[108:111], a[20:23], a[12:15], v[108:111]
    ds_read_b64_tr_b16 a[62:63], v12 offset:53760
    v_mfma_f32_16x16x32_bf16 v[40:43], a[24:27], a[0:3], v[40:43]
    v_mfma_f32_16x16x32_bf16 v[64:67], a[24:27], a[4:7], v[64:67]
    ds_read_b64_tr_b16 a[64:65], v10 offset:57344
    v_mfma_f32_16x16x32_bf16 v[88:91], a[24:27], a[8:11], v[88:91]
    ds_read_b64_tr_b16 a[66:67], v10 offset:57856
    v_mfma_f32_16x16x32_bf16 v[112:115], a[24:27], a[12:15], v[112:115]
    ds_read_b64_tr_b16 a[68:69], v12 offset:57344
    v_mfma_f32_16x16x32_bf16 v[44:47], a[28:31], a[0:3], v[44:47]
    ds_read_b64_tr_b16 a[70:71], v12 offset:57856
    s_getpc_b64 s[96:97]
    s_and_b32 s96, s96, 0xffffff80
    s_mov_b32 s98, 0x13934
    s_mov_b32 s99, 0x20000
    s_lshl_b32 s100, s29, 2
    s_add_u32 s100, s100, s3
    s_lshl_b32 s100, s100, 8
    v_lshlrev_b32 v132, 7, v1
    s_mov_b64 exec, 3
    buffer_load_dword a255, v132, s[96:99], s100 offen
    s_mov_b64 exec, -1
    v_mfma_f32_16x16x32_bf16 v[68:71], a[28:31], a[4:7], v[68:71]
    ds_read_b64_tr_b16 a[72:73], v10 offset:61440
    v_mfma_f32_16x16x32_bf16 v[92:95], a[28:31], a[8:11], v[92:95]
    ds_read_b64_tr_b16 a[74:75], v10 offset:61952
    v_mfma_f32_16x16x32_bf16 v[116:119], a[28:31], a[12:15], v[116:119]
    ds_read_b64_tr_b16 a[76:77], v12 offset:61440
    v_mfma_f32_16x16x32_bf16 v[48:51], a[0:3], a[32:35], v[48:51]
    ds_read_b64_tr_b16 a[78:79], v12 offset:61952
    v_mfma_f32_16x16x32_bf16 v[72:75], a[4:7], a[32:35], v[72:75]
    v_mfma_f32_16x16x32_bf16 v[96:99], a[8:11], a[32:35], v[96:99]
    v_mfma_f32_16x16x32_bf16 v[120:123], a[12:15], a[32:35], v[120:123]
    v_mfma_f32_16x16x32_bf16 v[52:55], a[0:3], a[36:39], v[52:55]
    v_mfma_f32_16x16x32_bf16 v[76:79], a[4:7], a[36:39], v[76:79]
    v_mfma_f32_16x16x32_bf16 v[100:103], a[8:11], a[36:39], v[100:103]
    v_mfma_f32_16x16x32_bf16 v[124:127], a[12:15], a[36:39], v[124:127]
    s_waitcnt vmcnt(18) lgkmcnt(0)
    s_barrier
    v_mfma_f32_16x16x32_bf16 v[32:35], a[56:59], a[40:43], v[32:35]
    ds_read_b128 a[0:3], v17 offset:0
    ds_read_b32 v216, v133 offset:0
    v_mfma_f32_16x16x32_bf16 v[56:59], a[56:59], a[44:47], v[56:59]
    ds_read_b128 a[4:7], v17 offset:2048
    ds_read_b32 v217, v133 offset:64
    v_mfma_f32_16x16x32_bf16 v[80:83], a[56:59], a[48:51], v[80:83]
    ds_read_b128 a[8:11], v17 offset:4096
    ds_read_b32 v218, v133 offset:128
    v_mfma_f32_16x16x32_bf16 v[104:107], a[56:59], a[52:55], v[104:107]
    ds_read_b128 a[12:15], v17 offset:6144
    v_mfma_f32_16x16x32_bf16 v[36:39], a[60:63], a[40:43], v[36:39]
    ds_read_b64_tr_b16 a[16:17], v11 offset:0
    ds_read_b32 v219, v133 offset:192
    v_mfma_f32_16x16x32_bf16 v[60:63], a[60:63], a[44:47], v[60:63]
    ds_read_b64_tr_b16 a[18:19], v11 offset:512
    ds_read_b32 v220, v133 offset:256
    v_mfma_f32_16x16x32_bf16 v[84:87], a[60:63], a[48:51], v[84:87]
    ds_read_b64_tr_b16 a[20:21], v13 offset:0
    ds_read_b32 v221, v133 offset:320
    v_mfma_f32_16x16x32_bf16 v[108:111], a[60:63], a[52:55], v[108:111]
    ds_read_b64_tr_b16 a[22:23], v13 offset:512
    ds_read_b32 v222, v133 offset:384
    v_mfma_f32_16x16x32_bf16 v[40:43], a[64:67], a[40:43], v[40:43]
    ds_read_b32 v223, v133 offset:448
    v_mfma_f32_16x16x32_bf16 v[64:67], a[64:67], a[44:47], v[64:67]
    ds_read_b64_tr_b16 a[24:25], v11 offset:4096
    ds_read_b128 v[224:227], v135 offset:0
    v_mfma_f32_16x16x32_bf16 v[88:91], a[64:67], a[48:51], v[88:91]
    ds_read_b64_tr_b16 a[26:27], v11 offset:4608
    ds_read_b128 v[228:231], v135 offset:64
    v_mfma_f32_16x16x32_bf16 v[112:115], a[64:67], a[52:55], v[112:115]
    ds_read_b64_tr_b16 a[28:29], v13 offset:4096
    v_mfma_f32_16x16x32_bf16 v[44:47], a[68:71], a[40:43], v[44:47]
    ds_read_b64_tr_b16 a[30:31], v13 offset:4608
    ds_read_b128 v[232:235], v135 offset:128
    v_mfma_f32_16x16x32_bf16 v[68:71], a[68:71], a[44:47], v[68:71]
    ds_read_b64_tr_b16 a[32:33], v11 offset:8192
    ds_read_b128 v[236:239], v135 offset:192
    v_mfma_f32_16x16x32_bf16 v[92:95], a[68:71], a[48:51], v[92:95]
    ds_read_b64_tr_b16 a[34:35], v11 offset:8704
    ds_read_b128 v[240:243], v135 offset:256
    v_mfma_f32_16x16x32_bf16 v[116:119], a[68:71], a[52:55], v[116:119]
    ds_read_b64_tr_b16 a[36:37], v13 offset:8192
    ds_read_b128 v[244:247], v135 offset:320
    v_mfma_f32_16x16x32_bf16 v[48:51], a[40:43], a[72:75], v[48:51]
    ds_read_b64_tr_b16 a[38:39], v13 offset:8704
    ds_read_b128 v[248:251], v135 offset:384
    v_mfma_f32_16x16x32_bf16 v[72:75], a[44:47], a[72:75], v[72:75]
    ds_read_b128 v[252:255], v135 offset:448
    v_mfma_f32_16x16x32_bf16 v[96:99], a[48:51], a[72:75], v[96:99]
    s_waitcnt vmcnt(12)
    v_mfma_f32_16x16x32_bf16 v[120:123], a[52:55], a[72:75], v[120:123]
    v_mfma_f32_16x16x32_bf16 v[52:55], a[40:43], a[76:79], v[52:55]
    v_mov_b32 v184, 1.0
    v_mfma_f32_16x16x32_bf16 v[76:79], a[44:47], a[76:79], v[76:79]
    v_add_f32 v188, v188, v189
    v_mfma_f32_16x16x32_bf16 v[100:103], a[48:51], a[76:79], v[100:103]
    v_add_f32 v192, v192, v193
    v_mfma_f32_16x16x32_bf16 v[124:127], a[52:55], a[76:79], v[124:127]
    v_add_f32 v196, v196, v197
    s_waitcnt lgkmcnt(0)
    v_mfma_f32_16x16x32_bf16 v[32:35], a[16:19], a[0:3], v[32:35]
    ds_read_b128 a[40:43], v19 offset:0
    v_add_f32 v200, v200, v201
    v_mfma_f32_16x16x32_bf16 v[56:59], a[16:19], a[4:7], v[56:59]
    ds_read_b128 a[44:47], v19 offset:2048
    v_add_f32 v204, v204, v205
    v_mfma_f32_16x16x32_bf16 v[80:83], a[16:19], a[8:11], v[80:83]
    ds_read_b128 a[48:51], v19 offset:4096
    v_add_f32 v208, v208, v209
    v_mfma_f32_16x16x32_bf16 v[104:107], a[16:19], a[12:15], v[104:107]
    ds_read_b128 a[52:55], v19 offset:6144
    v_mfma_f32_16x16x32_bf16 v[36:39], a[20:23], a[0:3], v[36:39]
    ds_read_b64_tr_b16 a[56:57], v11 offset:12288
    v_add_f32 v190, v190, v191
    v_mfma_f32_16x16x32_bf16 v[60:63], a[20:23], a[4:7], v[60:63]
    ds_read_b64_tr_b16 a[58:59], v11 offset:12800
    v_add_f32 v194, v194, v195
    v_mfma_f32_16x16x32_bf16 v[84:87], a[20:23], a[8:11], v[84:87]
    ds_read_b64_tr_b16 a[60:61], v13 offset:12288
    v_add_f32 v198, v198, v199
    v_mfma_f32_16x16x32_bf16 v[108:111], a[20:23], a[12:15], v[108:111]
    ds_read_b64_tr_b16 a[62:63], v13 offset:12800
    v_add_f32 v202, v202, v203
    v_mfma_f32_16x16x32_bf16 v[40:43], a[24:27], a[0:3], v[40:43]
    v_add_f32 v206, v206, v207
    v_mfma_f32_16x16x32_bf16 v[64:67], a[24:27], a[4:7], v[64:67]
    ds_read_b64_tr_b16 a[64:65], v11 offset:16384
    v_add_f32 v210, v210, v211
    v_mfma_f32_16x16x32_bf16 v[88:91], a[24:27], a[8:11], v[88:91]
    ds_read_b64_tr_b16 a[66:67], v11 offset:16896
    v_add_f32 v160, v188, v190
    v_mfma_f32_16x16x32_bf16 v[112:115], a[24:27], a[12:15], v[112:115]
    ds_read_b64_tr_b16 a[68:69], v13 offset:16384
    v_mfma_f32_16x16x32_bf16 v[44:47], a[28:31], a[0:3], v[44:47]
    ds_read_b64_tr_b16 a[70:71], v13 offset:16896
    v_add_f32 v161, v192, v194
    v_mfma_f32_16x16x32_bf16 v[68:71], a[28:31], a[4:7], v[68:71]
    ds_read_b64_tr_b16 a[72:73], v11 offset:20480
    v_add_f32 v162, v196, v198
    v_mfma_f32_16x16x32_bf16 v[92:95], a[28:31], a[8:11], v[92:95]
    ds_read_b64_tr_b16 a[74:75], v11 offset:20992
    v_add_f32 v163, v200, v202
    v_mfma_f32_16x16x32_bf16 v[116:119], a[28:31], a[12:15], v[116:119]
    ds_read_b64_tr_b16 a[76:77], v13 offset:20480
    v_add_f32 v164, v204, v206
    v_mfma_f32_16x16x32_bf16 v[48:51], a[0:3], a[32:35], v[48:51]
    ds_read_b64_tr_b16 a[78:79], v13 offset:20992
    v_add_f32 v165, v208, v210
    v_mfma_f32_16x16x32_bf16 v[72:75], a[4:7], a[32:35], v[72:75]
    v_mfma_f32_16x16x4_f32 v[188:191], v160, v184, 0
    v_mfma_f32_16x16x32_bf16 v[96:99], a[8:11], a[32:35], v[96:99]
    v_mfma_f32_16x16x4_f32 v[192:195], v161, v184, 0
    v_mfma_f32_16x16x32_bf16 v[120:123], a[12:15], a[32:35], v[120:123]
    v_mfma_f32_16x16x32_bf16 v[52:55], a[0:3], a[36:39], v[52:55]
    v_mfma_f32_16x16x4_f32 v[196:199], v162, v184, 0
    v_mfma_f32_16x16x32_bf16 v[76:79], a[4:7], a[36:39], v[76:79]
    v_mfma_f32_16x16x4_f32 v[200:203], v163, v184, 0
    v_mfma_f32_16x16x32_bf16 v[100:103], a[8:11], a[36:39], v[100:103]
    v_mfma_f32_16x16x4_f32 v[204:207], v184, v164, 0
    v_mfma_f32_16x16x32_bf16 v[124:127], a[12:15], a[36:39], v[124:127]
    v_mfma_f32_16x16x4_f32 v[208:211], v184, v165, 0
    s_waitcnt vmcnt(2) lgkmcnt(0)
    s_barrier
    v_mfma_f32_16x16x32_bf16 v[32:35], a[56:59], a[40:43], v[32:35]
    ds_read_b128 a[0:3], v17 offset:40960
    s_add_u32 s44, s82, 0x400000
    s_addc_u32 s45, s83, 0
    v_mfma_f32_16x16x32_bf16 v[56:59], a[56:59], a[44:47], v[56:59]
    ds_read_b128 a[4:7], v17 offset:43008
    v_mfma_f32_16x16x32_bf16 v[80:83], a[56:59], a[48:51], v[80:83]
    ds_read_b128 a[8:11], v17 offset:45056
    s_mov_b32 s46, 0x400000
    v_mfma_f32_16x16x32_bf16 v[104:107], a[56:59], a[52:55], v[104:107]
    ds_read_b128 a[12:15], v17 offset:47104
    s_mov_b32 s47, 0x20000
    v_mfma_f32_16x16x32_bf16 v[36:39], a[60:63], a[40:43], v[36:39]
    ds_read_b64_tr_b16 a[16:17], v11 offset:40960
    s_add_u32 s48, s82, 0x800000
    s_addc_u32 s49, s83, 0
    v_mfma_f32_16x16x32_bf16 v[60:63], a[60:63], a[44:47], v[60:63]
    ds_read_b64_tr_b16 a[18:19], v11 offset:41472
    v_mfma_f32_16x16x32_bf16 v[84:87], a[60:63], a[48:51], v[84:87]
    ds_read_b64_tr_b16 a[20:21], v13 offset:40960
    s_mov_b32 s50, 0x800000
    v_mfma_f32_16x16x32_bf16 v[108:111], a[60:63], a[52:55], v[108:111]
    ds_read_b64_tr_b16 a[22:23], v13 offset:41472
    s_mov_b32 s51, 0x20000
    v_mfma_f32_16x16x32_bf16 v[40:43], a[64:67], a[40:43], v[40:43]
    v_mfma_f32_16x16x32_bf16 v[64:67], a[64:67], a[44:47], v[64:67]
    ds_read_b64_tr_b16 a[24:25], v11 offset:45056
    v_lshrrev_b32 v2, 5, v1
    v_mfma_f32_16x16x32_bf16 v[88:91], a[64:67], a[48:51], v[88:91]
    ds_read_b64_tr_b16 a[26:27], v11 offset:45568
    v_lshlrev_b32 v2, 10, v2
    v_mfma_f32_16x16x32_bf16 v[112:115], a[64:67], a[52:55], v[112:115]
    ds_read_b64_tr_b16 a[28:29], v13 offset:45056
    v_mfma_f32_16x16x32_bf16 v[44:47], a[68:71], a[40:43], v[44:47]
    ds_read_b64_tr_b16 a[30:31], v13 offset:45568
    v_bfe_u32 v3, v1, 4, 1
    v_mfma_f32_16x16x32_bf16 v[68:71], a[68:71], a[44:47], v[68:71]
    ds_read_b64_tr_b16 a[32:33], v11 offset:49152
    v_lshl_add_u32 v2, v3, 9, v2
    v_mfma_f32_16x16x32_bf16 v[92:95], a[68:71], a[48:51], v[92:95]
    ds_read_b64_tr_b16 a[34:35], v11 offset:49664
    v_and_b32 v3, 15, v1
    v_mfma_f32_16x16x32_bf16 v[116:119], a[68:71], a[52:55], v[116:119]
    ds_read_b64_tr_b16 a[36:37], v13 offset:49152
    v_mfma_f32_16x16x32_bf16 v[48:51], a[40:43], a[72:75], v[48:51]
    ds_read_b64_tr_b16 a[38:39], v13 offset:49664
    v_lshl_add_u32 v4, v3, 4, v2
    v_mfma_f32_16x16x32_bf16 v[72:75], a[44:47], a[72:75], v[72:75]
    v_and_b32 v3, 7, v1
    v_mfma_f32_16x16x32_bf16 v[96:99], a[48:51], a[72:75], v[96:99]
    v_mfma_f32_16x16x32_bf16 v[120:123], a[52:55], a[72:75], v[120:123]
    v_lshl_add_u32 v5, v3, 4, v2
    v_mfma_f32_16x16x32_bf16 v[52:55], a[40:43], a[76:79], v[52:55]
    v_bfe_u32 v3, v1, 3, 1
    v_mfma_f32_16x16x32_bf16 v[76:79], a[44:47], a[76:79], v[76:79]
    v_lshl_add_u32 v5, v3, 8, v5
    v_mfma_f32_16x16x32_bf16 v[100:103], a[48:51], a[76:79], v[100:103]
    v_mfma_f32_16x16x32_bf16 v[124:127], a[52:55], a[76:79], v[124:127]
    s_lshl_b32 s4, s92, 2
    s_waitcnt lgkmcnt(0)
    v_mfma_f32_16x16x32_bf16 v[32:35], a[16:19], a[0:3], v[32:35]
    ds_read_b128 a[40:43], v19 offset:40960
    s_lshl_b32 s5, s36, 1
    v_mfma_f32_16x16x32_bf16 v[56:59], a[16:19], a[4:7], v[56:59]
    ds_read_b128 a[44:47], v19 offset:43008
    v_mfma_f32_16x16x32_bf16 v[80:83], a[16:19], a[8:11], v[80:83]
    ds_read_b128 a[48:51], v19 offset:45056
    s_add_u32 s4, s4, s5
    v_mfma_f32_16x16x32_bf16 v[104:107], a[16:19], a[12:15], v[104:107]
    ds_read_b128 a[52:55], v19 offset:47104
    s_lshl_b32 s4, s4, 11
    v_mfma_f32_16x16x32_bf16 v[36:39], a[20:23], a[0:3], v[36:39]
    ds_read_b64_tr_b16 a[56:57], v11 offset:53248
    v_mfma_f32_16x16x32_bf16 v[60:63], a[20:23], a[4:7], v[60:63]
    ds_read_b64_tr_b16 a[58:59], v11 offset:53760
    s_lshl_b32 s38, s56, 17
    v_mfma_f32_16x16x32_bf16 v[84:87], a[20:23], a[8:11], v[84:87]
    ds_read_b64_tr_b16 a[60:61], v13 offset:53248
    s_add_u32 s38, s38, s4
    v_mfma_f32_16x16x32_bf16 v[108:111], a[20:23], a[12:15], v[108:111]
    ds_read_b64_tr_b16 a[62:63], v13 offset:53760
    v_mfma_f32_16x16x32_bf16 v[40:43], a[24:27], a[0:3], v[40:43]
    s_lshl_b32 s40, s38, 1
    v_mfma_f32_16x16x32_bf16 v[64:67], a[24:27], a[4:7], v[64:67]
    ds_read_b64_tr_b16 a[64:65], v11 offset:57344
    s_add_u32 s41, s40, 4096
    v_mfma_f32_16x16x32_bf16 v[88:91], a[24:27], a[8:11], v[88:91]
    ds_read_b64_tr_b16 a[66:67], v11 offset:57856
    v_mfma_f32_16x16x32_bf16 v[112:115], a[24:27], a[12:15], v[112:115]
    ds_read_b64_tr_b16 a[68:69], v13 offset:57344
    s_mov_b32 s39, 0x3e8293ee
    v_mfma_f32_16x16x32_bf16 v[44:47], a[28:31], a[0:3], v[44:47]
    ds_read_b64_tr_b16 a[70:71], v13 offset:57856
    v_mul_f32 v152, s39, v216
    v_mfma_f32_16x16x32_bf16 v[68:71], a[28:31], a[4:7], v[68:71]
    ds_read_b64_tr_b16 a[72:73], v11 offset:61440
    v_mfma_f32_16x16x32_bf16 v[92:95], a[28:31], a[8:11], v[92:95]
    ds_read_b64_tr_b16 a[74:75], v11 offset:61952
    v_mul_f32 v153, s39, v217
    v_mfma_f32_16x16x32_bf16 v[116:119], a[28:31], a[12:15], v[116:119]
    ds_read_b64_tr_b16 a[76:77], v13 offset:61440
    v_mul_f32 v154, s39, v218
    v_mfma_f32_16x16x32_bf16 v[48:51], a[0:3], a[32:35], v[48:51]
    ds_read_b64_tr_b16 a[78:79], v13 offset:61952
    v_mfma_f32_16x16x32_bf16 v[72:75], a[4:7], a[32:35], v[72:75]
    v_mul_f32 v155, s39, v219
    v_mfma_f32_16x16x32_bf16 v[96:99], a[8:11], a[32:35], v[96:99]
    v_mul_f32 v156, s39, v220
    v_mfma_f32_16x16x32_bf16 v[120:123], a[12:15], a[32:35], v[120:123]
    v_mfma_f32_16x16x32_bf16 v[52:55], a[0:3], a[36:39], v[52:55]
    v_mul_f32 v157, s39, v221
    v_mfma_f32_16x16x32_bf16 v[76:79], a[4:7], a[36:39], v[76:79]
    v_mul_f32 v158, s39, v222
    v_mfma_f32_16x16x32_bf16 v[100:103], a[8:11], a[36:39], v[100:103]
    v_mfma_f32_16x16x32_bf16 v[124:127], a[12:15], a[36:39], v[124:127]
    v_mul_f32 v159, s39, v223
    s_waitcnt lgkmcnt(0)
    v_mfma_f32_16x16x32_bf16 v[32:35], a[56:59], a[40:43], v[32:35]
    v_mfma_f32_16x16x32_bf16 v[36:39], a[60:63], a[40:43], v[36:39]
    v_mfma_f32_16x16x32_bf16 v[56:59], a[56:59], a[44:47], v[56:59]
    v_mfma_f32_16x16x32_bf16 v[60:63], a[60:63], a[44:47], v[60:63]
    v_mfma_f32_16x16x32_bf16 v[80:83], a[56:59], a[48:51], v[80:83]
    v_mfma_f32_16x16x32_bf16 v[84:87], a[60:63], a[48:51], v[84:87]
    v_mfma_f32_16x16x32_bf16 v[104:107], a[56:59], a[52:55], v[104:107]
    v_mfma_f32_16x16x32_bf16 v[108:111], a[60:63], a[52:55], v[108:111]
    v_mfma_f32_16x16x32_bf16 v[40:43], a[64:67], a[40:43], v[40:43]
    v_mfma_f32_16x16x32_bf16 v[44:47], a[68:71], a[40:43], v[44:47]
    v_mul_f32 v32, v152, v32
    v_mul_f32 v33, v152, v33
    v_mul_f32 v34, v152, v34
    v_mul_f32 v35, v152, v35
    v_mul_f32 v36, v152, v36
    v_mul_f32 v37, v152, v37
    v_mul_f32 v38, v152, v38
    v_mul_f32 v39, v152, v39
    v_fmac_f32 v32, v156, v188
    v_fmac_f32 v33, v156, v189
    v_fmac_f32 v34, v156, v190
    v_fmac_f32 v35, v156, v191
    v_mfma_f32_16x16x32_bf16 v[64:67], a[64:67], a[44:47], v[64:67]
    v_fmac_f32 v36, v156, v192
    v_fmac_f32 v37, v156, v193
    v_fmac_f32 v38, v156, v194
    v_fmac_f32 v39, v156, v195
    v_cvt_pk_bf16_f32 v136, v32, v33
    v_cvt_pk_bf16_f32 v137, v34, v35
    v_cvt_pk_bf16_f32 v138, v36, v37
    v_cvt_pk_bf16_f32 v139, v38, v39
    buffer_store_dwordx4 v[136:139], v4, s[44:47], s38 offen offset:0 sc1
    v_mul_f32 v56, v153, v56
    v_mul_f32 v57, v153, v57
    v_mul_f32 v58, v153, v58
    v_mfma_f32_16x16x32_bf16 v[68:71], a[68:71], a[44:47], v[68:71]
    v_mul_f32 v59, v153, v59
    v_mul_f32 v60, v153, v60
    v_mul_f32 v61, v153, v61
    v_mul_f32 v62, v153, v62
    v_mul_f32 v63, v153, v63
    v_fmac_f32 v56, v157, v188
    v_fmac_f32 v57, v157, v189
    v_fmac_f32 v58, v157, v190
    v_fmac_f32 v59, v157, v191
    v_fmac_f32 v60, v157, v192
    v_fmac_f32 v61, v157, v193
    v_fmac_f32 v62, v157, v194
    v_mfma_f32_16x16x32_bf16 v[88:91], a[64:67], a[48:51], v[88:91]
    v_fmac_f32 v63, v157, v195
    v_cvt_pk_bf16_f32 v140, v56, v57
    v_cvt_pk_bf16_f32 v141, v58, v59
    v_cvt_pk_bf16_f32 v142, v60, v61
    v_cvt_pk_bf16_f32 v143, v62, v63
    buffer_store_dwordx4 v[140:143], v4, s[44:47], s38 offen offset:256 sc1
    v_mul_f32 v80, v154, v80
    v_mul_f32 v81, v154, v81
    v_mul_f32 v82, v154, v82
    v_mul_f32 v83, v154, v83
    v_mul_f32 v84, v154, v84
    v_mul_f32 v85, v154, v85
    v_mfma_f32_16x16x32_bf16 v[92:95], a[68:71], a[48:51], v[92:95]
    v_mul_f32 v86, v154, v86
    v_mul_f32 v87, v154, v87
    v_fmac_f32 v80, v158, v188
    v_fmac_f32 v81, v158, v189
    v_fmac_f32 v82, v158, v190
    v_fmac_f32 v83, v158, v191
    v_fmac_f32 v84, v158, v192
    v_fmac_f32 v85, v158, v193
    v_fmac_f32 v86, v158, v194
    v_fmac_f32 v87, v158, v195
    v_cvt_pk_bf16_f32 v144, v80, v81
    v_cvt_pk_bf16_f32 v145, v82, v83
    v_mfma_f32_16x16x32_bf16 v[112:115], a[64:67], a[52:55], v[112:115]
    v_cvt_pk_bf16_f32 v146, v84, v85
    v_cvt_pk_bf16_f32 v147, v86, v87
    buffer_store_dwordx4 v[144:147], v4, s[44:47], s38 offen offset:2048 sc1
    v_mul_f32 v104, v155, v104
    v_mul_f32 v105, v155, v105
    v_mul_f32 v106, v155, v106
    v_mul_f32 v107, v155, v107
    v_mul_f32 v108, v155, v108
    v_mul_f32 v109, v155, v109
    v_mul_f32 v110, v155, v110
    v_mul_f32 v111, v155, v111
    v_fmac_f32 v104, v159, v188
    v_mfma_f32_16x16x32_bf16 v[116:119], a[68:71], a[52:55], v[116:119]
    v_fmac_f32 v105, v159, v189
    v_fmac_f32 v106, v159, v190
    v_fmac_f32 v107, v159, v191
    v_fmac_f32 v108, v159, v192
    v_fmac_f32 v109, v159, v193
    v_fmac_f32 v110, v159, v194
    v_fmac_f32 v111, v159, v195
    v_cvt_pk_bf16_f32 v148, v104, v105
    v_cvt_pk_bf16_f32 v149, v106, v107
    v_cvt_pk_bf16_f32 v150, v108, v109
    v_cvt_pk_bf16_f32 v151, v110, v111
    buffer_store_dwordx4 v[148:151], v4, s[44:47], s38 offen offset:2304 sc1
    v_mfma_f32_16x16x32_bf16 v[48:51], a[40:43], a[72:75], v[48:51]
    v_mfma_f32_16x16x32_bf16 v[72:75], a[44:47], a[72:75], v[72:75]
    v_mul_f32 v40, v216, v40
    v_mul_f32 v41, v216, v41
    v_mul_f32 v42, v216, v42
    v_mul_f32 v43, v216, v43
    v_mul_f32 v44, v216, v44
    v_mul_f32 v45, v216, v45
    v_mul_f32 v46, v216, v46
    v_mul_f32 v47, v216, v47
    v_fmac_f32 v40, v220, v196
    v_fmac_f32 v41, v220, v197
    v_fmac_f32 v42, v220, v198
    v_fmac_f32 v43, v220, v199
    v_mfma_f32_16x16x32_bf16 v[96:99], a[48:51], a[72:75], v[96:99]
    v_fmac_f32 v44, v220, v200
    v_fmac_f32 v45, v220, v201
    v_fmac_f32 v46, v220, v202
    v_fmac_f32 v47, v220, v203
    v_cvt_pk_bf16_f32 v136, v40, v41
    v_cvt_pk_bf16_f32 v137, v42, v43
    v_cvt_pk_bf16_f32 v138, v44, v45
    v_cvt_pk_bf16_f32 v139, v46, v47
    buffer_store_dwordx4 v[136:139], v5, s[48:51], s40 offen offset:0 sc1
    v_mul_f32 v64, v217, v64
    v_mul_f32 v65, v217, v65
    v_mul_f32 v66, v217, v66
    v_mfma_f32_16x16x32_bf16 v[120:123], a[52:55], a[72:75], v[120:123]
    v_mul_f32 v67, v217, v67
    v_mul_f32 v68, v217, v68
    v_mul_f32 v69, v217, v69
    v_mul_f32 v70, v217, v70
    v_mul_f32 v71, v217, v71
    v_fmac_f32 v64, v221, v196
    v_fmac_f32 v65, v221, v197
    v_fmac_f32 v66, v221, v198
    v_fmac_f32 v67, v221, v199
    v_fmac_f32 v68, v221, v200
    v_fmac_f32 v69, v221, v201
    v_fmac_f32 v70, v221, v202
    v_mfma_f32_16x16x32_bf16 v[52:55], a[40:43], a[76:79], v[52:55]
    v_fmac_f32 v71, v221, v203
    v_cvt_pk_bf16_f32 v140, v64, v65
    v_cvt_pk_bf16_f32 v141, v66, v67
    v_cvt_pk_bf16_f32 v142, v68, v69
    v_cvt_pk_bf16_f32 v143, v70, v71
    buffer_store_dwordx4 v[140:143], v5, s[48:51], s40 offen offset:128 sc1
    v_mul_f32 v88, v218, v88
    v_mul_f32 v89, v218, v89
    v_mul_f32 v90, v218, v90
    v_mul_f32 v91, v218, v91
    v_mul_f32 v92, v218, v92
    v_mul_f32 v93, v218, v93
    v_mfma_f32_16x16x32_bf16 v[76:79], a[44:47], a[76:79], v[76:79]
    v_mul_f32 v94, v218, v94
    v_mul_f32 v95, v218, v95
    v_fmac_f32 v88, v222, v196
    v_fmac_f32 v89, v222, v197
    v_fmac_f32 v90, v222, v198
    v_fmac_f32 v91, v222, v199
    v_fmac_f32 v92, v222, v200
    v_fmac_f32 v93, v222, v201
    v_fmac_f32 v94, v222, v202
    v_fmac_f32 v95, v222, v203
    v_cvt_pk_bf16_f32 v144, v88, v89
    v_cvt_pk_bf16_f32 v145, v90, v91
    v_mfma_f32_16x16x32_bf16 v[100:103], a[48:51], a[76:79], v[100:103]
    v_cvt_pk_bf16_f32 v146, v92, v93
    v_cvt_pk_bf16_f32 v147, v94, v95
    buffer_store_dwordx4 v[144:147], v5, s[48:51], s41 offen offset:0 sc1
    v_mul_f32 v112, v219, v112
    v_mul_f32 v113, v219, v113
    v_mul_f32 v114, v219, v114
    v_mul_f32 v115, v219, v115
    v_mul_f32 v116, v219, v116
    v_mul_f32 v117, v219, v117
    v_mul_f32 v118, v219, v118
    v_mul_f32 v119, v219, v119
    v_fmac_f32 v112, v223, v196
    v_mfma_f32_16x16x32_bf16 v[124:127], a[52:55], a[76:79], v[124:127]
    v_fmac_f32 v113, v223, v197
    v_fmac_f32 v114, v223, v198
    v_fmac_f32 v115, v223, v199
    v_fmac_f32 v116, v223, v200
    v_fmac_f32 v117, v223, v201
    v_fmac_f32 v118, v223, v202
    v_fmac_f32 v119, v223, v203
    v_cvt_pk_bf16_f32 v148, v112, v113
    v_cvt_pk_bf16_f32 v149, v114, v115
    v_cvt_pk_bf16_f32 v150, v116, v117
    v_cvt_pk_bf16_f32 v151, v118, v119
    buffer_store_dwordx4 v[148:151], v5, s[48:51], s41 offen offset:128 sc1
    s_nop 7
    v_pk_mul_f32 v[48:49], v[48:49], v[224:225]
    v_pk_mul_f32 v[50:51], v[50:51], v[226:227]
    v_pk_fma_f32 v[48:49], v[240:241], v[204:205], v[48:49] op_sel_hi:[1,0,1]
    v_pk_fma_f32 v[50:51], v[242:243], v[204:205], v[50:51] op_sel_hi:[1,0,1]
    v_pk_mul_f32 v[72:73], v[72:73], v[228:229]
    v_pk_mul_f32 v[74:75], v[74:75], v[230:231]
    v_pk_fma_f32 v[72:73], v[244:245], v[204:205], v[72:73] op_sel_hi:[1,0,1]
    v_pk_fma_f32 v[74:75], v[246:247], v[204:205], v[74:75] op_sel_hi:[1,0,1]
    v_cvt_pk_bf16_f32 v136, v48, v49
    v_cvt_pk_bf16_f32 v137, v50, v51
    v_cvt_pk_bf16_f32 v138, v72, v73
    v_cvt_pk_bf16_f32 v139, v74, v75
    buffer_store_dwordx4 v[136:139], v4, s[48:51], s40 offen offset:2048 sc1
    v_pk_mul_f32 v[96:97], v[96:97], v[232:233]
    v_pk_mul_f32 v[98:99], v[98:99], v[234:235]
    v_pk_fma_f32 v[96:97], v[248:249], v[204:205], v[96:97] op_sel_hi:[1,0,1]
    v_pk_fma_f32 v[98:99], v[250:251], v[204:205], v[98:99] op_sel_hi:[1,0,1]
    v_pk_mul_f32 v[120:121], v[120:121], v[236:237]
    v_pk_mul_f32 v[122:123], v[122:123], v[238:239]
    v_pk_fma_f32 v[120:121], v[252:253], v[204:205], v[120:121] op_sel_hi:[1,0,1]
    v_pk_fma_f32 v[122:123], v[254:255], v[204:205], v[122:123] op_sel_hi:[1,0,1]
    v_cvt_pk_bf16_f32 v140, v96, v97
    v_cvt_pk_bf16_f32 v141, v98, v99
    v_cvt_pk_bf16_f32 v142, v120, v121
    v_cvt_pk_bf16_f32 v143, v122, v123
    buffer_store_dwordx4 v[140:143], v4, s[48:51], s41 offen offset:2048 sc1
    v_pk_mul_f32 v[52:53], v[52:53], v[224:225]
    v_pk_mul_f32 v[54:55], v[54:55], v[226:227]
    v_pk_fma_f32 v[52:53], v[240:241], v[208:209], v[52:53] op_sel_hi:[1,0,1]
    v_pk_fma_f32 v[54:55], v[242:243], v[208:209], v[54:55] op_sel_hi:[1,0,1]
    v_pk_mul_f32 v[76:77], v[76:77], v[228:229]
    v_pk_mul_f32 v[78:79], v[78:79], v[230:231]
    v_pk_fma_f32 v[76:77], v[244:245], v[208:209], v[76:77] op_sel_hi:[1,0,1]
    v_pk_fma_f32 v[78:79], v[246:247], v[208:209], v[78:79] op_sel_hi:[1,0,1]
    v_cvt_pk_bf16_f32 v144, v52, v53
    v_cvt_pk_bf16_f32 v145, v54, v55
    v_cvt_pk_bf16_f32 v146, v76, v77
    v_cvt_pk_bf16_f32 v147, v78, v79
    buffer_store_dwordx4 v[144:147], v4, s[48:51], s40 offen offset:2304 sc1
    v_pk_mul_f32 v[100:101], v[100:101], v[232:233]
    v_pk_mul_f32 v[102:103], v[102:103], v[234:235]
    v_pk_fma_f32 v[100:101], v[248:249], v[208:209], v[100:101] op_sel_hi:[1,0,1]
    v_pk_fma_f32 v[102:103], v[250:251], v[208:209], v[102:103] op_sel_hi:[1,0,1]
    v_pk_mul_f32 v[124:125], v[124:125], v[236:237]
    v_pk_mul_f32 v[126:127], v[126:127], v[238:239]
    v_pk_fma_f32 v[124:125], v[252:253], v[208:209], v[124:125] op_sel_hi:[1,0,1]
    v_pk_fma_f32 v[126:127], v[254:255], v[208:209], v[126:127] op_sel_hi:[1,0,1]
    v_cvt_pk_bf16_f32 v148, v100, v101
    v_cvt_pk_bf16_f32 v149, v102, v103
    v_cvt_pk_bf16_f32 v150, v124, v125
    v_cvt_pk_bf16_f32 v151, v126, v127
    buffer_store_dwordx4 v[148:151], v4, s[48:51], s41 offen offset:2304 sc1
    s_waitcnt vmcnt(13)
    s_mov_b32 s4, 0x40000
L_pure_5:
    v_subrev_u32 v3, s88, v130
    v_cmp_le_u32 vcc, 16, v3
    s_sub_u32 s4, s4, 1
    s_nop 3
    s_cbranch_vccz L_pure_5_ok
    s_cmp_eq_u32 s4, 0
    s_cbranch_scc1 L_pure_5_ok
    buffer_load_dword v130, v131, s[84:87], 0 offen sc1
    s_waitcnt vmcnt(0)
    s_branch L_pure_5
L_pure_5_ok:
    v_cmp_ne_u32 vcc, s91, v130
    s_nop 3
    s_cmp_eq_u64 vcc, 0
    s_cselect_b32 s89, 1, 0
    s_add_u32 s8, s82, 0x400000
    s_addc_u32 s9, s83, 0
    s_mov_b32 s10, 0x400000
    s_mov_b32 s11, 0x20000
    s_add_u32 s12, s82, 0x800000
    s_addc_u32 s13, s83, 0
    s_mov_b32 s14, 0x800000
    s_mov_b32 s15, 0x20000
    s_add_u32 s44, s82, 0x1000000
    s_addc_u32 s45, s83, 0
    s_mov_b32 s46, 0x400000
    s_mov_b32 s47, 0x20000
    v_lshlrev_b32 v24, 4, v1
    v_mov_b32 v28, v24
    v_add_u32 v29, 0x10000, v24
    v_add_u32 v30, 0x20000, v24
    s_lshl_b32 s38, s35, 3
    s_lshl_b32 s4, s3, 1
    s_add_u32 s38, s38, s4
    s_lshl_b32 s16, s34, 17
    s_lshl_b32 s4, s38, 11
    s_add_u32 s16, s16, s4
    s_lshl_b32 s39, s34, 18
    s_lshl_b32 s19, s3, 12
    s_add_u32 s17, s39, s19
    v_bfe_u32 v2, v1, 2, 1
    v_cmp_eq_u32 vcc, 0, v2
    v_mov_b32 v3, 0x3f803f80
    v_and_b32 v2, 1, v1
    v_mov_b32 v4, 0x44444444
    v_cndmask_b32 v48, 0, v3, vcc
    v_cndmask_b32 v49, 0, v3, vcc
    v_cndmask_b32 v50, v3, 0, vcc
    v_cndmask_b32 v51, v3, 0, vcc
    v_cmp_eq_u32 vcc, 0, v2
    v_mov_b32 v31, 0xeeeeeeee
    s_nop 0
    v_cndmask_b32 v31, v31, v4, vcc
    v_mov_b32 v248, 0
    v_mov_b32 v249, 0
    v_mov_b32 v250, 0
    v_mov_b32 v251, 0
    v_mov_b32 v252, 0
    v_mov_b32 v253, 0
    v_mov_b32 v254, 0
    v_mov_b32 v255, 0
    v_and_b32 v2, 1, v1
    v_lshlrev_b32 v2, 4, v2
    v_mov_b32 v3, 0x3f80
    v_lshlrev_b32 v3, v2, v3
    v_bfe_u32 v2, v1, 1, 3
    v_cmp_eq_u32 vcc, 0, v2
    s_nop 1
    v_cndmask_b32 v52, 0, v3, vcc
    v_cmp_eq_u32 vcc, 1, v2
    s_nop 1
    v_cndmask_b32 v53, 0, v3, vcc
    v_cmp_eq_u32 vcc, 2, v2
    s_nop 1
    v_cndmask_b32 v54, 0, v3, vcc
    v_cmp_eq_u32 vcc, 3, v2
    s_nop 1
    v_cndmask_b32 v55, 0, v3, vcc
    v_bfe_u32 v2, v1, 4, 1
    v_lshlrev_b32 v15, 10, v2
    v_lshrrev_b32 v2, 5, v1
    v_lshl_add_u32 v15, v2, 8, v15
    v_and_b32 v2, 15, v1
    v_lshl_add_u32 v15, v2, 4, v15
    s_lshr_b32 s40, s38, 2
    s_lshl_b32 s40, s40, 18
    s_lshl_b32 s4, s34, 13
    s_add_u32 s40, s40, s4
    s_and_b32 s4, s38, 3
    s_lshl_b32 s4, s4, 11
    s_add_u32 s40, s40, s4
    s_lshr_b32 s41, s2, 1
    s_cmp_ge_u32 s41, 56
    s_cselect_b32 s48, s74, s72
    s_cselect_b32 s49, s75, s73
    s_mov_b32 s50, 7340032
    s_mov_b32 s51, 0x20000
    s_cselect_b32 s4, 56, 0
    s_sub_u32 s4, s41, s4
    s_lshl_b32 s4, s4, 7
    s_and_b32 s5, s2, 1
    s_lshl_b32 s5, s5, 2
    s_add_u32 s5, s5, s3
    s_mul_i32 s42, s5, 917504
    s_add_u32 s42, s42, s4
    v_lshrrev_b32 v2, 3, v1
    v_mul_u32_u24 v16, 7168, v2
    v_and_b32 v2, 7, v1
    v_lshl_add_u32 v16, v2, 4, v16
    v_lshlrev_b32 v18, 5, v2
    v_lshrrev_b32 v2, 4, v1
    v_lshl_add_u32 v18, v2, 4, v18
    s_lshl_b32 s4, s3, 8
    s_add_u32 s4, s4, 147456
    v_add_u32 v18, s4, v18
    v_lshlrev_b32 v19, 2, v1
    s_lshl_b32 s43, s2, 2
    s_add_u32 s43, s43, s3
    s_mov_b32 s52, s76
    s_mov_b32 s53, s77
    s_mov_b32 s54, 0x700000
    s_mov_b32 s55, 0x20000
    s_mov_b32 s56, s68
    s_mov_b32 s57, s69
    s_mov_b32 s58, 0x200000
    s_mov_b32 s59, 0x20000
    s_add_u32 s60, s82, 0x2900000
    s_addc_u32 s61, s83, 0
    s_mov_b32 s62, 0xe000
    s_mov_b32 s63, 0x20000
    v_lshlrev_b32 v17, 7, v1
    s_mul_i32 s21, s43, 7168
    s_lshl_b32 s22, s43, 11
    s_cmp_ge_u32 s41, 56
    s_cselect_b32 s4, 56, 0
    s_cselect_b32 s5, 7168, 0
    s_sub_u32 s4, s41, s4
    s_lshl_b32 s4, s4, 1
    v_bfe_u32 v2, v1, 2, 1
    v_add_u32 v2, s4, v2
    v_mul_u32_u24 v3, 147, v2
    v_lshrrev_b32 v3, 10, v3
    v_mul_u32_u24 v4, 7, v3
    v_sub_u32 v2, v2, v4
    v_and_b32 v4, 1, v1
    v_bfe_u32 v5, v1, 1, 1
    v_cmp_lt_u32 vcc, 3, v2
    v_cmp_eq_u32 s[6:7], 3, v2
    v_and_b32 v6, 3, v2
    v_lshl_add_u32 v6, v6, 1, v5
    v_cndmask_b32 v7, 0, 1, vcc
    v_cndmask_b32 v6, v6, 6, s[6:7]
    v_cndmask_b32 v7, v7, v4, s[6:7]
    v_cndmask_b32 v4, v4, v5, s[6:7]
    v_lshl_add_u32 v3, v3, 1, v7
    s_mov_b32 s4, 458752
    v_mul_lo_u32 v14, v3, s4
    v_lshl_add_u32 v14, v6, 10, v14
    v_lshl_add_u32 v14, v4, 4, v14
    v_lshrrev_b32 v2, 3, v1
    v_lshl_add_u32 v14, v2, 5, v14
    v_add_u32 v14, s5, v14
    s_and_b32 s4, s2, 1
    s_lshl_b32 s4, s4, 2
    s_add_u32 s4, s4, s3
    s_mul_i32 s38, s4, 57344
    s_waitcnt vmcnt(0)
    s_barrier
    s_cmp_lg_u32 s3, 0
    s_cbranch_scc1 L_sig_6
    s_lshl_b32 s4, s93, 4
    s_add_u32 s4, s4, s92
    s_lshl_b32 s4, s4, 2
    s_add_u32 s4, s4, 3072
    v_mov_b32 v2, s88
    v_mov_b32 v3, 0
    s_mov_b64 exec, 1
    s_cmp_eq_u32 s89, 0
    s_cbranch_scc1 L_sig_6_g
    buffer_store_dword v2, v3, s[84:87], s4 offen
    s_branch L_sig_6_x
L_sig_6_g:
    buffer_store_dword v2, v3, s[84:87], s4 offen sc1
L_sig_6_x:
    s_mov_b64 exec, -1
L_sig_6:
    s_cmp_lg_u32 s3, 0
    s_cbranch_scc1 L_polld_8
    s_lshr_b32 s5, s34, 1
    v_lshrrev_b32 v2, 4, v1
    v_mul_u32_u24 v2, 16, v2
    v_add_u32 v2, s5, v2
    v_and_b32 v2, 15, v2
    v_lshlrev_b32 v2, 4, v2
    v_and_b32 v3, 15, v1
    v_add_u32 v2, v2, v3
    v_lshlrev_b32 v2, 2, v2
    v_add_u32 v2, 3072, v2
    s_mov_b64 exec, 0xffff
    s_mov_b32 s4, 0x20000
L_poll_7:
    buffer_load_dword v4, v2, s[84:87], 0 offen sc1
    s_waitcnt vmcnt(0)
    v_subrev_u32 v3, s88, v4
    v_cmp_le_u32 vcc, 16, v3
    s_nop 3
    s_cbranch_vccz L_poll_7_ok
    s_sub_u32 s4, s4, 1
    s_cmp_eq_u32 s4, 0
    s_cbranch_scc0 L_poll_7
L_poll_7_ok:
    s_mov_b64 exec, -1
    s_waitcnt vmcnt(0)
L_polld_8:
    s_barrier
    s_add_u32 m0, s19, 32768
    s_add_u32 s18, s17, 0
    buffer_load_dwordx4 v24, s[12:15], s18 offen offset:0 lds
    buffer_load_dwordx4 v24, s[12:15], s18 offen offset:1024 lds
    buffer_load_dwordx4 v24, s[12:15], s18 offen offset:2048 lds
    buffer_load_dwordx4 v24, s[12:15], s18 offen offset:3072 lds
    buffer_load_dwordx4 v[32:35], v24, s[8:11], s16 offen offset:0
    buffer_load_dwordx4 v[36:39], v24, s[8:11], s16 offen offset:1024
    buffer_load_dwordx4 v[40:43], v24, s[8:11], s16 offen offset:2048
    buffer_load_dwordx4 v[44:47], v24, s[8:11], s16 offen offset:3072
    s_waitcnt vmcnt(0)
    s_barrier
    ds_read_b128 v[56:59], v28 offset:32768
    ds_read_b128 v[60:63], v28 offset:33792
    ds_read_b128 v[64:67], v28 offset:36864
    ds_read_b128 v[68:71], v28 offset:37888
    s_add_u32 m0, s19, 49152
    s_add_u32 s18, s17, 16384
    buffer_load_dwordx4 v24, s[12:15], s18 offen offset:0 lds
    buffer_load_dwordx4 v24, s[12:15], s18 offen offset:1024 lds
    buffer_load_dwordx4 v24, s[12:15], s18 offen offset:2048 lds
    buffer_load_dwordx4 v24, s[12:15], s18 offen offset:3072 lds
    s_waitcnt lgkmcnt(2)
    v_mfma_f32_32x32x16_bf16 v[120:135], v[56:59], v[32:35], 0
    v_mfma_f32_32x32x16_bf16 v[120:135], v[60:63], v[36:39], v[120:135]
    v_mfma_f32_32x32x16_bf16 v[136:151], v[56:59], v[40:43], 0
    v_mfma_f32_32x32x16_bf16 v[136:151], v[60:63], v[44:47], v[136:151]
    s_add_u32 m0, s19, 65536
    s_add_u32 s18, s17, 32768
    buffer_load_dwordx4 v24, s[12:15], s18 offen offset:0 lds
    buffer_load_dwordx4 v24, s[12:15], s18 offen offset:1024 lds
    buffer_load_dwordx4 v24, s[12:15], s18 offen offset:2048 lds
    buffer_load_dwordx4 v24, s[12:15], s18 offen offset:3072 lds
    s_nop 5
    v_max3_f32 v2, v120, v121, v122
    v_max3_f32 v2, v2, v123, v124
    v_max3_f32 v2, v2, v125, v126
    v_max3_f32 v2, v2, v127, v128
    v_max3_f32 v2, v2, v129, v130
    v_max3_f32 v2, v2, v131, v132
    v_max3_f32 v2, v2, v133, v134
    v_max_f32 v2, v2, v135
    v_mov_b32 v4, v2
    s_nop 1
    v_permlane32_swap_b32 v2, v4
    v_max_f32 v2, v2, v4
    v_sub_f32 v88, 0, v2
    v_sub_f32 v89, 0, v2
    v_sub_f32 v90, 0, v2
    v_sub_f32 v91, 0, v2
    v_sub_f32 v92, 0, v2
    v_sub_f32 v93, 0, v2
    v_sub_f32 v94, 0, v2
    v_sub_f32 v95, 0, v2
    v_sub_f32 v96, 0, v2
    v_sub_f32 v97, 0, v2
    v_sub_f32 v98, 0, v2
    v_sub_f32 v99, 0, v2
    v_sub_f32 v100, 0, v2
    v_sub_f32 v101, 0, v2
    v_sub_f32 v102, 0, v2
    v_sub_f32 v103, 0, v2
    v_max3_f32 v3, v136, v137, v138
    v_max3_f32 v3, v3, v139, v140
    v_max3_f32 v3, v3, v141, v142
    v_max3_f32 v3, v3, v143, v144
    v_max3_f32 v3, v3, v145, v146
    v_max3_f32 v3, v3, v147, v148
    v_max3_f32 v3, v3, v149, v150
    v_max_f32 v3, v3, v151
    v_mov_b32 v4, v3
    s_nop 1
    v_permlane32_swap_b32 v3, v4
    v_max_f32 v3, v3, v4
    v_sub_f32 v104, 0, v3
    v_sub_f32 v105, 0, v3
    v_sub_f32 v106, 0, v3
    v_sub_f32 v107, 0, v3
    v_sub_f32 v108, 0, v3
    v_sub_f32 v109, 0, v3
    v_sub_f32 v110, 0, v3
    v_sub_f32 v111, 0, v3
    v_sub_f32 v112, 0, v3
    v_sub_f32 v113, 0, v3
    v_sub_f32 v114, 0, v3
    v_sub_f32 v115, 0, v3
    v_sub_f32 v116, 0, v3
    v_sub_f32 v117, 0, v3
    v_sub_f32 v118, 0, v3
    v_sub_f32 v119, 0, v3
    s_nop 1
    v_mfma_f32_32x32x16_bf16 v[120:135], v[56:59], v[32:35], v[88:103]
    v_mfma_f32_32x32x16_bf16 v[120:135], v[60:63], v[36:39], v[120:135]
    v_mfma_f32_32x32x16_bf16 v[136:151], v[56:59], v[40:43], v[104:119]
    v_mfma_f32_32x32x16_bf16 v[136:151], v[60:63], v[44:47], v[136:151]
    s_nop 7
    s_add_u32 s92, s82, 0x5000000
    s_addc_u32 s93, s83, 0
    s_mov_b32 s94, 0xe00000
    s_mov_b32 s95, 0x20000
    s_cmp_ge_u32 s2, 224
    s_cselect_b32 s94, 0, s94
    s_waitcnt lgkmcnt(0)
    v_mfma_f32_32x32x16_bf16 v[152:167], v[64:67], v[32:35], v[88:103]
    ds_read_b128 v[56:59], v28 offset:40960
    ds_read_b128 v[60:63], v28 offset:41984
    ds_read_b128 v[72:75], v28 offset:34816
    ds_read_b128 v[76:79], v28 offset:35840
    v_exp_f32 v120, v120
    v_exp_f32 v121, v121
    v_exp_f32 v122, v122
    v_exp_f32 v123, v123
    v_exp_f32 v124, v124
    v_exp_f32 v125, v125
    v_exp_f32 v126, v126
    v_exp_f32 v127, v127
    v_cvt_pk_bf16_f32 v216, v120, v121
    v_cvt_pk_bf16_f32 v217, v122, v123
    v_exp_f32 v128, v128
    v_exp_f32 v129, v129
    v_mfma_f32_32x32x16_bf16 v[152:167], v[68:71], v[36:39], v[152:167]
    v_exp_f32 v130, v130
    v_exp_f32 v131, v131
    v_cvt_pk_bf16_f32 v218, v124, v125
    v_cvt_pk_bf16_f32 v219, v126, v127
    v_exp_f32 v132, v132
    v_exp_f32 v133, v133
    v_exp_f32 v134, v134
    v_exp_f32 v135, v135
    v_cvt_pk_bf16_f32 v220, v128, v129
    v_cvt_pk_bf16_f32 v221, v130, v131
    v_cvt_pk_bf16_f32 v222, v132, v133
    v_cvt_pk_bf16_f32 v223, v134, v135
    v_mfma_f32_32x32x16_bf16 v[168:183], v[64:67], v[40:43], v[104:119]
    s_add_u32 m0, s19, 81920
    s_add_u32 s18, s17, 49152
    buffer_load_dwordx4 v24, s[12:15], s18 offen offset:0 lds
    v_exp_f32 v136, v136
    v_exp_f32 v137, v137
    v_exp_f32 v138, v138
    v_exp_f32 v139, v139
    v_exp_f32 v140, v140
    v_exp_f32 v141, v141
    v_exp_f32 v142, v142
    v_exp_f32 v143, v143
    v_cvt_pk_bf16_f32 v224, v136, v137
    v_cvt_pk_bf16_f32 v225, v138, v139
    v_exp_f32 v144, v144
    v_exp_f32 v145, v145
    v_mfma_f32_32x32x16_bf16 v[168:183], v[68:71], v[44:47], v[168:183]
    buffer_load_dwordx4 v24, s[12:15], s18 offen offset:1024 lds
    v_exp_f32 v146, v146
    v_exp_f32 v147, v147
    v_cvt_pk_bf16_f32 v226, v140, v141
    v_cvt_pk_bf16_f32 v227, v142, v143
    v_exp_f32 v148, v148
    v_exp_f32 v149, v149
    v_exp_f32 v150, v150
    v_exp_f32 v151, v151
    v_cvt_pk_bf16_f32 v228, v144, v145
    v_cvt_pk_bf16_f32 v229, v146, v147
    v_cvt_pk_bf16_f32 v230, v148, v149
    v_cvt_pk_bf16_f32 v231, v150, v151
    s_waitcnt lgkmcnt(0)
    v_mfma_f32_32x32x16_bf16 v[120:135], v[56:59], v[32:35], v[88:103]
    ds_read_b128 v[64:67], v28 offset:45056
    v_exp_f32 v152, v152
    v_exp_f32 v153, v153
    v_exp_f32 v154, v154
    v_exp_f32 v155, v155
    v_exp_f32 v156, v156
    v_mfma_f32_32x32x16_bf16 v[184:199], v[72:75], v[216:219], 0
    ds_read_b128 v[68:71], v28 offset:46080
    v_exp_f32 v157, v157
    v_exp_f32 v158, v158
    v_exp_f32 v159, v159
    v_cvt_pk_bf16_f32 v232, v152, v153
    v_cvt_pk_bf16_f32 v233, v154, v155
    v_mfma_f32_32x32x16_bf16 v[120:135], v[60:63], v[36:39], v[120:135]
    ds_read_b128 v[80:83], v28 offset:38912
    v_exp_f32 v160, v160
    v_exp_f32 v161, v161
    v_exp_f32 v162, v162
    v_exp_f32 v163, v163
    v_smfmac_f32_16x16x64_bf16 v[248:251], v[48:51], v[216:223], v31
    ds_read_b128 v[84:87], v28 offset:39936
    v_cvt_pk_bf16_f32 v234, v156, v157
    v_cvt_pk_bf16_f32 v235, v158, v159
    v_exp_f32 v164, v164
    v_exp_f32 v165, v165
    v_exp_f32 v166, v166
    v_mfma_f32_32x32x16_bf16 v[184:199], v[76:79], v[220:223], v[184:199]
    buffer_load_dwordx4 v24, s[12:15], s18 offen offset:2048 lds
    v_exp_f32 v167, v167
    v_cvt_pk_bf16_f32 v236, v160, v161
    v_cvt_pk_bf16_f32 v237, v162, v163
    v_cvt_pk_bf16_f32 v238, v164, v165
    v_cvt_pk_bf16_f32 v239, v166, v167
    v_mfma_f32_32x32x16_bf16 v[136:151], v[56:59], v[40:43], v[104:119]
    buffer_load_dwordx4 v24, s[12:15], s18 offen offset:3072 lds
    v_exp_f32 v168, v168
    v_exp_f32 v169, v169
    v_exp_f32 v170, v170
    v_exp_f32 v171, v171
    v_exp_f32 v172, v172
    v_mfma_f32_32x32x16_bf16 v[200:215], v[72:75], v[224:227], 0
    v_exp_f32 v173, v173
    v_exp_f32 v174, v174
    v_exp_f32 v175, v175
    v_cvt_pk_bf16_f32 v240, v168, v169
    v_cvt_pk_bf16_f32 v241, v170, v171
    v_mfma_f32_32x32x16_bf16 v[136:151], v[60:63], v[44:47], v[136:151]
    v_exp_f32 v176, v176
    v_exp_f32 v177, v177
    v_exp_f32 v178, v178
    v_exp_f32 v179, v179
    v_smfmac_f32_16x16x64_bf16 v[252:255], v[48:51], v[224:231], v31
    s_getpc_b64 s[96:97]
    s_and_b32 s96, s96, 0xffffff80
    s_mov_b32 s98, 0x122b4
    s_mov_b32 s99, 0x20000
    s_lshl_b32 s100, s29, 2
    s_add_u32 s100, s100, s3
    s_lshl_b32 s100, s100, 8
    v_lshlrev_b32 v23, 7, v1
    s_mov_b64 exec, 3
    buffer_load_dword a255, v23, s[96:99], s100 offen
    s_mov_b64 exec, -1
    v_cvt_pk_bf16_f32 v242, v172, v173
    v_cvt_pk_bf16_f32 v243, v174, v175
    v_exp_f32 v180, v180
    v_exp_f32 v181, v181
    v_exp_f32 v182, v182
    v_mfma_f32_32x32x16_bf16 v[200:215], v[76:79], v[228:231], v[200:215]
    v_exp_f32 v183, v183
    v_cvt_pk_bf16_f32 v244, v176, v177
    v_cvt_pk_bf16_f32 v245, v178, v179
    v_cvt_pk_bf16_f32 v246, v180, v181
    v_cvt_pk_bf16_f32 v247, v182, v183
    s_waitcnt vmcnt(5) lgkmcnt(0)
    s_barrier
    v_mfma_f32_32x32x16_bf16 v[152:167], v[64:67], v[32:35], v[88:103]
    ds_read_b128 v[56:59], v28 offset:49152
    v_exp_f32 v120, v120
    v_exp_f32 v121, v121
    v_exp_f32 v122, v122
    v_exp_f32 v123, v123
    v_exp_f32 v124, v124
    v_mfma_f32_32x32x16_bf16 v[184:199], v[80:83], v[232:235], v[184:199]
    ds_read_b128 v[60:63], v28 offset:50176
    v_exp_f32 v125, v125
    v_exp_f32 v126, v126
    v_exp_f32 v127, v127
    v_cvt_pk_bf16_f32 v216, v120, v121
    v_cvt_pk_bf16_f32 v217, v122, v123
    v_mfma_f32_32x32x16_bf16 v[152:167], v[68:71], v[36:39], v[152:167]
    ds_read_b128 v[72:75], v28 offset:43008
    v_exp_f32 v128, v128
    v_exp_f32 v129, v129
    v_exp_f32 v130, v130
    v_exp_f32 v131, v131
    v_smfmac_f32_16x16x64_bf16 v[248:251], v[48:51], v[232:239], v31
    ds_read_b128 v[76:79], v28 offset:44032
    v_cvt_pk_bf16_f32 v218, v124, v125
    v_cvt_pk_bf16_f32 v219, v126, v127
    v_exp_f32 v132, v132
    v_exp_f32 v133, v133
    v_exp_f32 v134, v134
    v_mfma_f32_32x32x16_bf16 v[184:199], v[84:87], v[236:239], v[184:199]
    s_add_u32 m0, s19, 98304
    s_add_u32 s18, s17, 65536
    buffer_load_dwordx4 v24, s[12:15], s18 offen offset:0 lds
    v_exp_f32 v135, v135
    v_cvt_pk_bf16_f32 v220, v128, v129
    v_cvt_pk_bf16_f32 v221, v130, v131
    v_cvt_pk_bf16_f32 v222, v132, v133
    v_cvt_pk_bf16_f32 v223, v134, v135
    v_mfma_f32_32x32x16_bf16 v[168:183], v[64:67], v[40:43], v[104:119]
    buffer_load_dwordx4 v24, s[12:15], s18 offen offset:1024 lds
    v_exp_f32 v136, v136
    v_exp_f32 v137, v137
    v_exp_f32 v138, v138
    v_exp_f32 v139, v139
    v_exp_f32 v140, v140
    v_mfma_f32_32x32x16_bf16 v[200:215], v[80:83], v[240:243], v[200:215]
    v_exp_f32 v141, v141
    v_exp_f32 v142, v142
    v_exp_f32 v143, v143
    v_cvt_pk_bf16_f32 v224, v136, v137
    v_cvt_pk_bf16_f32 v225, v138, v139
    v_mfma_f32_32x32x16_bf16 v[168:183], v[68:71], v[44:47], v[168:183]
    v_exp_f32 v144, v144
    v_exp_f32 v145, v145
    v_exp_f32 v146, v146
    v_exp_f32 v147, v147
    v_smfmac_f32_16x16x64_bf16 v[252:255], v[48:51], v[240:247], v31
    buffer_load_dwordx4 a[0:3], v16, s[48:51], s42 offen nt
    s_add_u32 s42, s42, 57344
    v_cvt_pk_bf16_f32 v226, v140, v141
    v_cvt_pk_bf16_f32 v227, v142, v143
    v_exp_f32 v148, v148
    v_exp_f32 v149, v149
    v_exp_f32 v150, v150
    v_mfma_f32_32x32x16_bf16 v[200:215], v[84:87], v[244:247], v[200:215]
    v_exp_f32 v151, v151
    v_cvt_pk_bf16_f32 v228, v144, v145
    v_cvt_pk_bf16_f32 v229, v146, v147
    v_cvt_pk_bf16_f32 v230, v148, v149
    v_cvt_pk_bf16_f32 v231, v150, v151
    s_waitcnt lgkmcnt(0)
    v_mfma_f32_32x32x16_bf16 v[120:135], v[56:59], v[32:35], v[88:103]
    ds_read_b128 v[64:67], v28 offset:53248
    v_exp_f32 v152, v152
    v_exp_f32 v153, v153
    v_exp_f32 v154, v154
    v_exp_f32 v155, v155
    v_exp_f32 v156, v156
    v_mfma_f32_32x32x16_bf16 v[184:199], v[72:75], v[216:219], v[184:199]
    ds_read_b128 v[68:71], v28 offset:54272
    v_exp_f32 v157, v157
    v_exp_f32 v158, v158
    v_exp_f32 v159, v159
    v_cvt_pk_bf16_f32 v232, v152, v153
    v_cvt_pk_bf16_f32 v233, v154, v155
    v_mfma_f32_32x32x16_bf16 v[120:135], v[60:63], v[36:39], v[120:135]
    ds_read_b128 v[80:83], v28 offset:47104
    v_exp_f32 v160, v160
    v_exp_f32 v161, v161
    v_exp_f32 v162, v162
    v_exp_f32 v163, v163
    v_smfmac_f32_16x16x64_bf16 v[248:251], v[48:51], v[216:223], v31
    ds_read_b128 v[84:87], v28 offset:48128
    v_cvt_pk_bf16_f32 v234, v156, v157
    v_cvt_pk_bf16_f32 v235, v158, v159
    v_exp_f32 v164, v164
    v_exp_f32 v165, v165
    v_exp_f32 v166, v166
    v_mfma_f32_32x32x16_bf16 v[184:199], v[76:79], v[220:223], v[184:199]
    v_exp_f32 v167, v167
    v_cvt_pk_bf16_f32 v236, v160, v161
    v_cvt_pk_bf16_f32 v237, v162, v163
    v_cvt_pk_bf16_f32 v238, v164, v165
    v_cvt_pk_bf16_f32 v239, v166, v167
    v_mfma_f32_32x32x16_bf16 v[136:151], v[56:59], v[40:43], v[104:119]
    buffer_load_dwordx4 v24, s[12:15], s18 offen offset:2048 lds
    v_exp_f32 v168, v168
    v_exp_f32 v169, v169
    v_exp_f32 v170, v170
    v_exp_f32 v171, v171
    v_exp_f32 v172, v172
    v_mfma_f32_32x32x16_bf16 v[200:215], v[72:75], v[224:227], v[200:215]
    v_exp_f32 v173, v173
    v_exp_f32 v174, v174
    v_exp_f32 v175, v175
    v_cvt_pk_bf16_f32 v240, v168, v169
    v_cvt_pk_bf16_f32 v241, v170, v171
    v_mfma_f32_32x32x16_bf16 v[136:151], v[60:63], v[44:47], v[136:151]
    v_exp_f32 v176, v176
    v_exp_f32 v177, v177
    v_exp_f32 v178, v178
    v_exp_f32 v179, v179
    v_smfmac_f32_16x16x64_bf16 v[252:255], v[48:51], v[224:231], v31
    buffer_load_dwordx4 v24, s[12:15], s18 offen offset:3072 lds
    v_cvt_pk_bf16_f32 v242, v172, v173
    v_cvt_pk_bf16_f32 v243, v174, v175
    v_exp_f32 v180, v180
    v_exp_f32 v181, v181
    v_exp_f32 v182, v182
    v_mfma_f32_32x32x16_bf16 v[200:215], v[76:79], v[228:231], v[200:215]
    v_exp_f32 v183, v183
    v_cvt_pk_bf16_f32 v244, v176, v177
    v_cvt_pk_bf16_f32 v245, v178, v179
    v_cvt_pk_bf16_f32 v246, v180, v181
    v_cvt_pk_bf16_f32 v247, v182, v183
    s_waitcnt lgkmcnt(0)
    v_mfma_f32_32x32x16_bf16 v[152:167], v[64:67], v[32:35], v[88:103]
    ds_read_b128 v[56:59], v28 offset:57344
    v_exp_f32 v120, v120
    v_exp_f32 v121, v121
    v_exp_f32 v122, v122
    v_exp_f32 v123, v123
    v_exp_f32 v124, v124
    v_mfma_f32_32x32x16_bf16 v[184:199], v[80:83], v[232:235], v[184:199]
    ds_read_b128 v[60:63], v28 offset:58368
    v_exp_f32 v125, v125
    v_exp_f32 v126, v126
    v_exp_f32 v127, v127
    v_cvt_pk_bf16_f32 v216, v120, v121
    v_cvt_pk_bf16_f32 v217, v122, v123
    v_mfma_f32_32x32x16_bf16 v[152:167], v[68:71], v[36:39], v[152:167]
    ds_read_b128 v[72:75], v28 offset:51200
    v_exp_f32 v128, v128
    v_exp_f32 v129, v129
    v_exp_f32 v130, v130
    v_exp_f32 v131, v131
    v_smfmac_f32_16x16x64_bf16 v[248:251], v[48:51], v[232:239], v31
    ds_read_b128 v[76:79], v28 offset:52224
    v_cvt_pk_bf16_f32 v218, v124, v125
    v_cvt_pk_bf16_f32 v219, v126, v127
    v_exp_f32 v132, v132
    v_exp_f32 v133, v133
    v_exp_f32 v134, v134
    v_mfma_f32_32x32x16_bf16 v[184:199], v[84:87], v[236:239], v[184:199]
    s_add_u32 m0, s19, 114688
    s_add_u32 s18, s17, 81920
    buffer_load_dwordx4 v24, s[12:15], s18 offen offset:0 lds
    v_exp_f32 v135, v135
    v_cvt_pk_bf16_f32 v220, v128, v129
    v_cvt_pk_bf16_f32 v221, v130, v131
    v_cvt_pk_bf16_f32 v222, v132, v133
    v_cvt_pk_bf16_f32 v223, v134, v135
    v_mfma_f32_32x32x16_bf16 v[168:183], v[64:67], v[40:43], v[104:119]
    buffer_load_dwordx4 v24, s[12:15], s18 offen offset:1024 lds
    v_exp_f32 v136, v136
    v_exp_f32 v137, v137
    v_exp_f32 v138, v138
    v_exp_f32 v139, v139
    v_exp_f32 v140, v140
    v_mfma_f32_32x32x16_bf16 v[200:215], v[80:83], v[240:243], v[200:215]
    v_exp_f32 v141, v141
    v_exp_f32 v142, v142
    v_exp_f32 v143, v143
    v_cvt_pk_bf16_f32 v224, v136, v137
    v_cvt_pk_bf16_f32 v225, v138, v139
    v_mfma_f32_32x32x16_bf16 v[168:183], v[68:71], v[44:47], v[168:183]
    v_exp_f32 v144, v144
    v_exp_f32 v145, v145
    v_exp_f32 v146, v146
    v_exp_f32 v147, v147
    v_smfmac_f32_16x16x64_bf16 v[252:255], v[48:51], v[240:247], v31
    buffer_load_dwordx4 a[4:7], v16, s[48:51], s42 offen nt
    s_add_u32 s42, s42, 57344
    v_cvt_pk_bf16_f32 v226, v140, v141
    v_cvt_pk_bf16_f32 v227, v142, v143
    v_exp_f32 v148, v148
    v_exp_f32 v149, v149
    v_exp_f32 v150, v150
    v_mfma_f32_32x32x16_bf16 v[200:215], v[84:87], v[244:247], v[200:215]
    s_lshl_b32 s4, s43, 10
    s_mov_b64 exec, 0xff
    buffer_load_dword a247, v17, s[84:87], s4 offen sc1
    s_mov_b64 exec, -1
    v_exp_f32 v151, v151
    v_cvt_pk_bf16_f32 v228, v144, v145
    v_cvt_pk_bf16_f32 v229, v146, v147
    v_cvt_pk_bf16_f32 v230, v148, v149
    v_cvt_pk_bf16_f32 v231, v150, v151
    s_waitcnt lgkmcnt(0)
    v_mfma_f32_32x32x16_bf16 v[120:135], v[56:59], v[32:35], v[88:103]
    ds_read_b128 v[64:67], v28 offset:61440
    v_exp_f32 v152, v152
    v_exp_f32 v153, v153
    v_exp_f32 v154, v154
    v_exp_f32 v155, v155
    v_exp_f32 v156, v156
    v_mfma_f32_32x32x16_bf16 v[184:199], v[72:75], v[216:219], v[184:199]
    ds_read_b128 v[68:71], v28 offset:62464
    v_exp_f32 v157, v157
    v_exp_f32 v158, v158
    v_exp_f32 v159, v159
    v_cvt_pk_bf16_f32 v232, v152, v153
    v_cvt_pk_bf16_f32 v233, v154, v155
    v_mfma_f32_32x32x16_bf16 v[120:135], v[60:63], v[36:39], v[120:135]
    ds_read_b128 v[80:83], v28 offset:55296
    v_exp_f32 v160, v160
    v_exp_f32 v161, v161
    v_exp_f32 v162, v162
    v_exp_f32 v163, v163
    v_smfmac_f32_16x16x64_bf16 v[248:251], v[48:51], v[216:223], v31
    ds_read_b128 v[84:87], v28 offset:56320
    v_cvt_pk_bf16_f32 v234, v156, v157
    v_cvt_pk_bf16_f32 v235, v158, v159
    v_exp_f32 v164, v164
    v_exp_f32 v165, v165
    v_exp_f32 v166, v166
    v_mfma_f32_32x32x16_bf16 v[184:199], v[76:79], v[220:223], v[184:199]
    buffer_load_dwordx4 v24, s[12:15], s18 offen offset:2048 lds
    v_exp_f32 v167, v167
    v_cvt_pk_bf16_f32 v236, v160, v161
    v_cvt_pk_bf16_f32 v237, v162, v163
    v_cvt_pk_bf16_f32 v238, v164, v165
    v_cvt_pk_bf16_f32 v239, v166, v167
    v_mfma_f32_32x32x16_bf16 v[136:151], v[56:59], v[40:43], v[104:119]
    buffer_load_dwordx4 v24, s[12:15], s18 offen offset:3072 lds
    v_exp_f32 v168, v168
    v_exp_f32 v169, v169
    v_exp_f32 v170, v170
    v_exp_f32 v171, v171
    v_exp_f32 v172, v172
    v_mfma_f32_32x32x16_bf16 v[200:215], v[72:75], v[224:227], v[200:215]
    v_exp_f32 v173, v173
    v_exp_f32 v174, v174
    v_exp_f32 v175, v175
    v_cvt_pk_bf16_f32 v240, v168, v169
    v_cvt_pk_bf16_f32 v241, v170, v171
    v_mfma_f32_32x32x16_bf16 v[136:151], v[60:63], v[44:47], v[136:151]
    v_exp_f32 v176, v176
    v_exp_f32 v177, v177
    v_exp_f32 v178, v178
    v_exp_f32 v179, v179
    v_smfmac_f32_16x16x64_bf16 v[252:255], v[48:51], v[224:231], v31
    s_mov_b64 exec, 0xffff
    buffer_load_dword a254, v17, s[56:59], s22 offen
    s_mov_b64 exec, -1
    v_cvt_pk_bf16_f32 v242, v172, v173
    v_cvt_pk_bf16_f32 v243, v174, v175
    v_exp_f32 v180, v180
    v_exp_f32 v181, v181
    v_exp_f32 v182, v182
    v_mfma_f32_32x32x16_bf16 v[200:215], v[76:79], v[228:231], v[200:215]
    v_exp_f32 v183, v183
    v_cvt_pk_bf16_f32 v244, v176, v177
    v_cvt_pk_bf16_f32 v245, v178, v179
    v_cvt_pk_bf16_f32 v246, v180, v181
    v_cvt_pk_bf16_f32 v247, v182, v183
    s_waitcnt lgkmcnt(0)
    v_mfma_f32_32x32x16_bf16 v[152:167], v[64:67], v[32:35], v[88:103]
    ds_read_b128 v[56:59], v29 offset:0
    v_exp_f32 v120, v120
    v_exp_f32 v121, v121
    v_exp_f32 v122, v122
    v_exp_f32 v123, v123
    v_exp_f32 v124, v124
    v_mfma_f32_32x32x16_bf16 v[184:199], v[80:83], v[232:235], v[184:199]
    ds_read_b128 v[60:63], v29 offset:1024
    v_exp_f32 v125, v125
    v_exp_f32 v126, v126
    v_exp_f32 v127, v127
    v_cvt_pk_bf16_f32 v216, v120, v121
    v_cvt_pk_bf16_f32 v217, v122, v123
    v_mfma_f32_32x32x16_bf16 v[152:167], v[68:71], v[36:39], v[152:167]
    ds_read_b128 v[72:75], v28 offset:59392
    v_exp_f32 v128, v128
    v_exp_f32 v129, v129
    v_exp_f32 v130, v130
    v_exp_f32 v131, v131
    v_smfmac_f32_16x16x64_bf16 v[248:251], v[48:51], v[232:239], v31
    ds_read_b128 v[76:79], v28 offset:60416
    v_cvt_pk_bf16_f32 v218, v124, v125
    v_cvt_pk_bf16_f32 v219, v126, v127
    v_exp_f32 v132, v132
    v_exp_f32 v133, v133
    v_exp_f32 v134, v134
    v_mfma_f32_32x32x16_bf16 v[184:199], v[84:87], v[236:239], v[184:199]
    v_exp_f32 v135, v135
    v_cvt_pk_bf16_f32 v220, v128, v129
    v_cvt_pk_bf16_f32 v221, v130, v131
    v_cvt_pk_bf16_f32 v222, v132, v133
    v_cvt_pk_bf16_f32 v223, v134, v135
    v_mfma_f32_32x32x16_bf16 v[168:183], v[64:67], v[40:43], v[104:119]
    s_add_u32 m0, s19, 131072
    s_add_u32 s18, s17, 98304
    buffer_load_dwordx4 v24, s[12:15], s18 offen offset:0 lds
    v_exp_f32 v136, v136
    v_exp_f32 v137, v137
    v_exp_f32 v138, v138
    v_exp_f32 v139, v139
    v_exp_f32 v140, v140
    v_mfma_f32_32x32x16_bf16 v[200:215], v[80:83], v[240:243], v[200:215]
    v_exp_f32 v141, v141
    v_exp_f32 v142, v142
    v_exp_f32 v143, v143
    v_cvt_pk_bf16_f32 v224, v136, v137
    v_cvt_pk_bf16_f32 v225, v138, v139
    v_mfma_f32_32x32x16_bf16 v[168:183], v[68:71], v[44:47], v[168:183]
    v_exp_f32 v144, v144
    v_exp_f32 v145, v145
    v_exp_f32 v146, v146
    v_exp_f32 v147, v147
    v_smfmac_f32_16x16x64_bf16 v[252:255], v[48:51], v[240:247], v31
    buffer_load_dwordx4 v24, s[12:15], s18 offen offset:1024 lds
    v_cvt_pk_bf16_f32 v226, v140, v141
    v_cvt_pk_bf16_f32 v227, v142, v143
    v_exp_f32 v148, v148
    v_exp_f32 v149, v149
    v_exp_f32 v150, v150
    v_mfma_f32_32x32x16_bf16 v[200:215], v[84:87], v[244:247], v[200:215]
    v_exp_f32 v151, v151
    v_cvt_pk_bf16_f32 v228, v144, v145
    v_cvt_pk_bf16_f32 v229, v146, v147
    v_cvt_pk_bf16_f32 v230, v148, v149
    v_cvt_pk_bf16_f32 v231, v150, v151
    s_waitcnt lgkmcnt(0)
    v_mfma_f32_32x32x16_bf16 v[120:135], v[56:59], v[32:35], v[88:103]
    ds_read_b128 v[64:67], v29 offset:4096
    v_exp_f32 v152, v152
    v_exp_f32 v153, v153
    v_exp_f32 v154, v154
    v_exp_f32 v155, v155
    v_exp_f32 v156, v156
    v_mfma_f32_32x32x16_bf16 v[184:199], v[72:75], v[216:219], v[184:199]
    ds_read_b128 v[68:71], v29 offset:5120
    v_exp_f32 v157, v157
    v_exp_f32 v158, v158
    v_exp_f32 v159, v159
    v_cvt_pk_bf16_f32 v232, v152, v153
    v_cvt_pk_bf16_f32 v233, v154, v155
    v_mfma_f32_32x32x16_bf16 v[120:135], v[60:63], v[36:39], v[120:135]
    ds_read_b128 v[80:83], v28 offset:63488
    v_exp_f32 v160, v160
    v_exp_f32 v161, v161
    v_exp_f32 v162, v162
    v_exp_f32 v163, v163
    v_smfmac_f32_16x16x64_bf16 v[248:251], v[48:51], v[216:223], v31
    ds_read_b128 v[84:87], v28 offset:64512
    v_cvt_pk_bf16_f32 v234, v156, v157
    v_cvt_pk_bf16_f32 v235, v158, v159
    v_exp_f32 v164, v164
    v_exp_f32 v165, v165
    v_exp_f32 v166, v166
    v_mfma_f32_32x32x16_bf16 v[184:199], v[76:79], v[220:223], v[184:199]
    buffer_load_dwordx4 v24, s[12:15], s18 offen offset:2048 lds
    v_exp_f32 v167, v167
    v_cvt_pk_bf16_f32 v236, v160, v161
    v_cvt_pk_bf16_f32 v237, v162, v163
    v_cvt_pk_bf16_f32 v238, v164, v165
    v_cvt_pk_bf16_f32 v239, v166, v167
    v_mfma_f32_32x32x16_bf16 v[136:151], v[56:59], v[40:43], v[104:119]
    buffer_load_dwordx4 v24, s[12:15], s18 offen offset:3072 lds
    v_exp_f32 v168, v168
    v_exp_f32 v169, v169
    v_exp_f32 v170, v170
    v_exp_f32 v171, v171
    v_exp_f32 v172, v172
    v_mfma_f32_32x32x16_bf16 v[200:215], v[72:75], v[224:227], v[200:215]
    v_exp_f32 v173, v173
    v_exp_f32 v174, v174
    v_exp_f32 v175, v175
    v_cvt_pk_bf16_f32 v240, v168, v169
    v_cvt_pk_bf16_f32 v241, v170, v171
    v_mfma_f32_32x32x16_bf16 v[136:151], v[60:63], v[44:47], v[136:151]
    v_exp_f32 v176, v176
    v_exp_f32 v177, v177
    v_exp_f32 v178, v178
    v_exp_f32 v179, v179
    v_smfmac_f32_16x16x64_bf16 v[252:255], v[48:51], v[224:231], v31
    buffer_load_dwordx4 a[8:11], v16, s[48:51], s42 offen nt
    s_add_u32 s42, s42, 57344
    v_cvt_pk_bf16_f32 v242, v172, v173
    v_cvt_pk_bf16_f32 v243, v174, v175
    v_exp_f32 v180, v180
    v_exp_f32 v181, v181
    v_exp_f32 v182, v182
    v_mfma_f32_32x32x16_bf16 v[200:215], v[76:79], v[228:231], v[200:215]
    v_exp_f32 v183, v183
    v_cvt_pk_bf16_f32 v244, v176, v177
    v_cvt_pk_bf16_f32 v245, v178, v179
    v_cvt_pk_bf16_f32 v246, v180, v181
    v_cvt_pk_bf16_f32 v247, v182, v183
    s_waitcnt lgkmcnt(0)
    v_mfma_f32_32x32x16_bf16 v[152:167], v[64:67], v[32:35], v[88:103]
    ds_read_b128 v[56:59], v29 offset:8192
    v_exp_f32 v120, v120
    v_exp_f32 v121, v121
    v_exp_f32 v122, v122
    v_exp_f32 v123, v123
    v_exp_f32 v124, v124
    v_mfma_f32_32x32x16_bf16 v[184:199], v[80:83], v[232:235], v[184:199]
    ds_read_b128 v[60:63], v29 offset:9216
    v_exp_f32 v125, v125
    v_exp_f32 v126, v126
    v_exp_f32 v127, v127
    v_cvt_pk_bf16_f32 v216, v120, v121
    v_cvt_pk_bf16_f32 v217, v122, v123
    v_mfma_f32_32x32x16_bf16 v[152:167], v[68:71], v[36:39], v[152:167]
    ds_read_b128 v[72:75], v29 offset:2048
    v_exp_f32 v128, v128
    v_exp_f32 v129, v129
    v_exp_f32 v130, v130
    v_exp_f32 v131, v131
    v_smfmac_f32_16x16x64_bf16 v[248:251], v[48:51], v[232:239], v31
    ds_read_b128 v[76:79], v29 offset:3072
    v_cvt_pk_bf16_f32 v218, v124, v125
    v_cvt_pk_bf16_f32 v219, v126, v127
    v_exp_f32 v132, v132
    v_exp_f32 v133, v133
    v_exp_f32 v134, v134
    v_mfma_f32_32x32x16_bf16 v[184:199], v[84:87], v[236:239], v[184:199]
    s_add_u32 m0, s19, 0
    s_add_u32 s18, s17, 114688
    buffer_load_dwordx4 v24, s[12:15], s18 offen offset:0 lds
    v_exp_f32 v135, v135
    v_cvt_pk_bf16_f32 v220, v128, v129
    v_cvt_pk_bf16_f32 v221, v130, v131
    v_cvt_pk_bf16_f32 v222, v132, v133
    v_cvt_pk_bf16_f32 v223, v134, v135
    v_mfma_f32_32x32x16_bf16 v[168:183], v[64:67], v[40:43], v[104:119]
    buffer_load_dwordx4 v24, s[12:15], s18 offen offset:1024 lds
    v_exp_f32 v136, v136
    v_exp_f32 v137, v137
    v_exp_f32 v138, v138
    v_exp_f32 v139, v139
    v_exp_f32 v140, v140
    v_mfma_f32_32x32x16_bf16 v[200:215], v[80:83], v[240:243], v[200:215]
    v_exp_f32 v141, v141
    v_exp_f32 v142, v142
    v_exp_f32 v143, v143
    v_cvt_pk_bf16_f32 v224, v136, v137
    v_cvt_pk_bf16_f32 v225, v138, v139
    v_mfma_f32_32x32x16_bf16 v[168:183], v[68:71], v[44:47], v[168:183]
    v_exp_f32 v144, v144
    v_exp_f32 v145, v145
    v_exp_f32 v146, v146
    v_exp_f32 v147, v147
    v_smfmac_f32_16x16x64_bf16 v[252:255], v[48:51], v[240:247], v31
    s_mov_b64 exec, 0x7f
    buffer_load_dword a253, v17, s[52:55], s21 offen
    s_mov_b64 exec, -1
    s_add_u32 s21, s21, 896
    v_cvt_pk_bf16_f32 v226, v140, v141
    v_cvt_pk_bf16_f32 v227, v142, v143
    v_exp_f32 v148, v148
    v_exp_f32 v149, v149
    v_exp_f32 v150, v150
    v_mfma_f32_32x32x16_bf16 v[200:215], v[84:87], v[244:247], v[200:215]
    v_exp_f32 v151, v151
    v_cvt_pk_bf16_f32 v228, v144, v145
    v_cvt_pk_bf16_f32 v229, v146, v147
    v_cvt_pk_bf16_f32 v230, v148, v149
    v_cvt_pk_bf16_f32 v231, v150, v151
    s_waitcnt lgkmcnt(0)
    v_mfma_f32_32x32x16_bf16 v[120:135], v[56:59], v[32:35], v[88:103]
    ds_read_b128 v[64:67], v29 offset:12288
    v_exp_f32 v152, v152
    v_exp_f32 v153, v153
    v_exp_f32 v154, v154
    v_exp_f32 v155, v155
    v_exp_f32 v156, v156
    v_mfma_f32_32x32x16_bf16 v[184:199], v[72:75], v[216:219], v[184:199]
    ds_read_b128 v[68:71], v29 offset:13312
    v_exp_f32 v157, v157
    v_exp_f32 v158, v158
    v_exp_f32 v159, v159
    v_cvt_pk_bf16_f32 v232, v152, v153
    v_cvt_pk_bf16_f32 v233, v154, v155
    v_mfma_f32_32x32x16_bf16 v[120:135], v[60:63], v[36:39], v[120:135]
    ds_read_b128 v[80:83], v29 offset:6144
    v_exp_f32 v160, v160
    v_exp_f32 v161, v161
    v_exp_f32 v162, v162
    v_exp_f32 v163, v163
    v_smfmac_f32_16x16x64_bf16 v[248:251], v[48:51], v[216:223], v31
    ds_read_b128 v[84:87], v29 offset:7168
    v_cvt_pk_bf16_f32 v234, v156, v157
    v_cvt_pk_bf16_f32 v235, v158, v159
    v_exp_f32 v164, v164
    v_exp_f32 v165, v165
    v_exp_f32 v166, v166
    v_mfma_f32_32x32x16_bf16 v[184:199], v[76:79], v[220:223], v[184:199]
    v_exp_f32 v167, v167
    v_cvt_pk_bf16_f32 v236, v160, v161
    v_cvt_pk_bf16_f32 v237, v162, v163
    v_cvt_pk_bf16_f32 v238, v164, v165
    v_cvt_pk_bf16_f32 v239, v166, v167
    v_mfma_f32_32x32x16_bf16 v[136:151], v[56:59], v[40:43], v[104:119]
    buffer_load_dwordx4 v24, s[12:15], s18 offen offset:2048 lds
    v_exp_f32 v168, v168
    v_exp_f32 v169, v169
    v_exp_f32 v170, v170
    v_exp_f32 v171, v171
    v_exp_f32 v172, v172
    v_mfma_f32_32x32x16_bf16 v[200:215], v[72:75], v[224:227], v[200:215]
    v_exp_f32 v173, v173
    v_exp_f32 v174, v174
    v_exp_f32 v175, v175
    v_cvt_pk_bf16_f32 v240, v168, v169
    v_cvt_pk_bf16_f32 v241, v170, v171
    v_mfma_f32_32x32x16_bf16 v[136:151], v[60:63], v[44:47], v[136:151]
    v_exp_f32 v176, v176
    v_exp_f32 v177, v177
    v_exp_f32 v178, v178
    v_exp_f32 v179, v179
    v_smfmac_f32_16x16x64_bf16 v[252:255], v[48:51], v[224:231], v31
    buffer_load_dwordx4 v24, s[12:15], s18 offen offset:3072 lds
    v_cvt_pk_bf16_f32 v242, v172, v173
    v_cvt_pk_bf16_f32 v243, v174, v175
    v_exp_f32 v180, v180
    v_exp_f32 v181, v181
    v_exp_f32 v182, v182
    v_mfma_f32_32x32x16_bf16 v[200:215], v[76:79], v[228:231], v[200:215]
    v_exp_f32 v183, v183
    v_cvt_pk_bf16_f32 v244, v176, v177
    v_cvt_pk_bf16_f32 v245, v178, v179
    v_cvt_pk_bf16_f32 v246, v180, v181
    v_cvt_pk_bf16_f32 v247, v182, v183
    s_waitcnt vmcnt(11) lgkmcnt(0)
    s_barrier
    v_mfma_f32_32x32x16_bf16 v[152:167], v[64:67], v[32:35], v[88:103]
    ds_read_b128 v[56:59], v29 offset:16384
    v_exp_f32 v120, v120
    v_exp_f32 v121, v121
    v_exp_f32 v122, v122
    v_exp_f32 v123, v123
    v_exp_f32 v124, v124
    v_mfma_f32_32x32x16_bf16 v[184:199], v[80:83], v[232:235], v[184:199]
    ds_read_b128 v[60:63], v29 offset:17408
    v_exp_f32 v125, v125
    v_exp_f32 v126, v126
    v_exp_f32 v127, v127
    v_cvt_pk_bf16_f32 v216, v120, v121
    v_cvt_pk_bf16_f32 v217, v122, v123
    v_mfma_f32_32x32x16_bf16 v[152:167], v[68:71], v[36:39], v[152:167]
    ds_read_b128 v[72:75], v29 offset:10240
    v_exp_f32 v128, v128
    v_exp_f32 v129, v129
    v_exp_f32 v130, v130
    v_exp_f32 v131, v131
    v_smfmac_f32_16x16x64_bf16 v[248:251], v[48:51], v[232:239], v31
    ds_read_b128 v[76:79], v29 offset:11264
    v_cvt_pk_bf16_f32 v218, v124, v125
    v_cvt_pk_bf16_f32 v219, v126, v127
    v_exp_f32 v132, v132
    v_exp_f32 v133, v133
    v_exp_f32 v134, v134
    v_mfma_f32_32x32x16_bf16 v[184:199], v[84:87], v[236:239], v[184:199]
    v_exp_f32 v135, v135
    v_cvt_pk_bf16_f32 v220, v128, v129
    v_cvt_pk_bf16_f32 v221, v130, v131
    v_cvt_pk_bf16_f32 v222, v132, v133
    v_cvt_pk_bf16_f32 v223, v134, v135
    v_mfma_f32_32x32x16_bf16 v[168:183], v[64:67], v[40:43], v[104:119]
    s_add_u32 m0, s19, 16384
    s_add_u32 s18, s17, 131072
    buffer_load_dwordx4 v24, s[12:15], s18 offen offset:0 lds
    v_exp_f32 v136, v136
    v_exp_f32 v137, v137
    v_exp_f32 v138, v138
    v_exp_f32 v139, v139
    v_exp_f32 v140, v140
    v_mfma_f32_32x32x16_bf16 v[200:215], v[80:83], v[240:243], v[200:215]
    v_exp_f32 v141, v141
    v_exp_f32 v142, v142
    v_exp_f32 v143, v143
    v_cvt_pk_bf16_f32 v224, v136, v137
    v_cvt_pk_bf16_f32 v225, v138, v139
    v_mfma_f32_32x32x16_bf16 v[168:183], v[68:71], v[44:47], v[168:183]
    v_exp_f32 v144, v144
    v_exp_f32 v145, v145
    v_exp_f32 v146, v146
    v_exp_f32 v147, v147
    v_smfmac_f32_16x16x64_bf16 v[252:255], v[48:51], v[240:247], v31
    buffer_load_dwordx4 a[12:15], v16, s[48:51], s42 offen nt
    s_add_u32 s42, s42, 57344
    v_cvt_pk_bf16_f32 v226, v140, v141
    v_cvt_pk_bf16_f32 v227, v142, v143
    v_exp_f32 v148, v148
    v_exp_f32 v149, v149
    v_exp_f32 v150, v150
    v_mfma_f32_32x32x16_bf16 v[200:215], v[84:87], v[244:247], v[200:215]
    v_exp_f32 v151, v151
    v_cvt_pk_bf16_f32 v228, v144, v145
    v_cvt_pk_bf16_f32 v229, v146, v147
    v_cvt_pk_bf16_f32 v230, v148, v149
    v_cvt_pk_bf16_f32 v231, v150, v151
    s_waitcnt lgkmcnt(0)
    v_mfma_f32_32x32x16_bf16 v[120:135], v[56:59], v[32:35], v[88:103]
    ds_read_b128 v[64:67], v29 offset:20480
    v_exp_f32 v152, v152
    v_exp_f32 v153, v153
    v_exp_f32 v154, v154
    v_exp_f32 v155, v155
    v_exp_f32 v156, v156
    v_mfma_f32_32x32x16_bf16 v[184:199], v[72:75], v[216:219], v[184:199]
    ds_read_b128 v[68:71], v29 offset:21504
    v_exp_f32 v157, v157
    v_exp_f32 v158, v158
    v_exp_f32 v159, v159
    v_cvt_pk_bf16_f32 v232, v152, v153
    v_cvt_pk_bf16_f32 v233, v154, v155
    v_mfma_f32_32x32x16_bf16 v[120:135], v[60:63], v[36:39], v[120:135]
    ds_read_b128 v[80:83], v29 offset:14336
    v_exp_f32 v160, v160
    v_exp_f32 v161, v161
    v_exp_f32 v162, v162
    v_exp_f32 v163, v163
    v_smfmac_f32_16x16x64_bf16 v[248:251], v[48:51], v[216:223], v31
    ds_read_b128 v[84:87], v29 offset:15360
    v_cvt_pk_bf16_f32 v234, v156, v157
    v_cvt_pk_bf16_f32 v235, v158, v159
    v_exp_f32 v164, v164
    v_exp_f32 v165, v165
    v_exp_f32 v166, v166
    v_mfma_f32_32x32x16_bf16 v[184:199], v[76:79], v[220:223], v[184:199]
    v_exp_f32 v167, v167
    v_cvt_pk_bf16_f32 v236, v160, v161
    v_cvt_pk_bf16_f32 v237, v162, v163
    v_cvt_pk_bf16_f32 v238, v164, v165
    v_cvt_pk_bf16_f32 v239, v166, v167
    v_mfma_f32_32x32x16_bf16 v[136:151], v[56:59], v[40:43], v[104:119]
    buffer_load_dwordx4 v24, s[12:15], s18 offen offset:1024 lds
    v_exp_f32 v168, v168
    v_exp_f32 v169, v169
    v_exp_f32 v170, v170
    v_exp_f32 v171, v171
    v_exp_f32 v172, v172
    v_mfma_f32_32x32x16_bf16 v[200:215], v[72:75], v[224:227], v[200:215]
    v_exp_f32 v173, v173
    v_exp_f32 v174, v174
    v_exp_f32 v175, v175
    v_cvt_pk_bf16_f32 v240, v168, v169
    v_cvt_pk_bf16_f32 v241, v170, v171
    v_mfma_f32_32x32x16_bf16 v[136:151], v[60:63], v[44:47], v[136:151]
    v_exp_f32 v176, v176
    v_exp_f32 v177, v177
    v_exp_f32 v178, v178
    v_exp_f32 v179, v179
    v_smfmac_f32_16x16x64_bf16 v[252:255], v[48:51], v[224:231], v31
    v_cvt_pk_bf16_f32 v242, v172, v173
    v_cvt_pk_bf16_f32 v243, v174, v175
    v_exp_f32 v180, v180
    v_exp_f32 v181, v181
    v_exp_f32 v182, v182
    v_mfma_f32_32x32x16_bf16 v[200:215], v[76:79], v[228:231], v[200:215]
    v_exp_f32 v183, v183
    v_cvt_pk_bf16_f32 v244, v176, v177
    v_cvt_pk_bf16_f32 v245, v178, v179
    v_cvt_pk_bf16_f32 v246, v180, v181
    v_cvt_pk_bf16_f32 v247, v182, v183
    s_waitcnt lgkmcnt(0)
    v_mfma_f32_32x32x16_bf16 v[152:167], v[64:67], v[32:35], v[88:103]
    ds_read_b128 v[56:59], v29 offset:24576
    v_exp_f32 v120, v120
    v_exp_f32 v121, v121
    v_exp_f32 v122, v122
    v_exp_f32 v123, v123
    v_exp_f32 v124, v124
    v_mfma_f32_32x32x16_bf16 v[184:199], v[80:83], v[232:235], v[184:199]
    ds_read_b128 v[60:63], v29 offset:25600
    v_exp_f32 v125, v125
    v_exp_f32 v126, v126
    v_exp_f32 v127, v127
    v_cvt_pk_bf16_f32 v216, v120, v121
    v_cvt_pk_bf16_f32 v217, v122, v123
    v_mfma_f32_32x32x16_bf16 v[152:167], v[68:71], v[36:39], v[152:167]
    ds_read_b128 v[72:75], v29 offset:18432
    v_exp_f32 v128, v128
    v_exp_f32 v129, v129
    v_exp_f32 v130, v130
    v_exp_f32 v131, v131
    v_smfmac_f32_16x16x64_bf16 v[248:251], v[48:51], v[232:239], v31
    ds_read_b128 v[76:79], v29 offset:19456
    v_cvt_pk_bf16_f32 v218, v124, v125
    v_cvt_pk_bf16_f32 v219, v126, v127
    v_exp_f32 v132, v132
    v_exp_f32 v133, v133
    v_exp_f32 v134, v134
    v_mfma_f32_32x32x16_bf16 v[184:199], v[84:87], v[236:239], v[184:199]
    v_exp_f32 v135, v135
    v_cvt_pk_bf16_f32 v220, v128, v129
    v_cvt_pk_bf16_f32 v221, v130, v131
    v_cvt_pk_bf16_f32 v222, v132, v133
    v_cvt_pk_bf16_f32 v223, v134, v135
    v_mfma_f32_32x32x16_bf16 v[168:183], v[64:67], v[40:43], v[104:119]
    buffer_load_dwordx4 v24, s[12:15], s18 offen offset:2048 lds
    v_exp_f32 v136, v136
    v_exp_f32 v137, v137
    v_exp_f32 v138, v138
    v_exp_f32 v139, v139
    v_exp_f32 v140, v140
    v_mfma_f32_32x32x16_bf16 v[200:215], v[80:83], v[240:243], v[200:215]
    v_exp_f32 v141, v141
    v_exp_f32 v142, v142
    v_exp_f32 v143, v143
    v_cvt_pk_bf16_f32 v224, v136, v137
    v_cvt_pk_bf16_f32 v225, v138, v139
    v_mfma_f32_32x32x16_bf16 v[168:183], v[68:71], v[44:47], v[168:183]
    v_exp_f32 v144, v144
    v_exp_f32 v145, v145
    v_exp_f32 v146, v146
    v_exp_f32 v147, v147
    v_smfmac_f32_16x16x64_bf16 v[252:255], v[48:51], v[240:247], v31
    s_add_u32 s24, s82, 0x2800000
    s_addc_u32 s25, s83, 0
    s_mov_b32 s26, 0xc0000
    s_mov_b32 s27, 0x20000
    s_mul_i32 s4, s43, 768
    s_mov_b64 exec, 0x3f
    buffer_load_dword a246, v17, s[24:27], s4 offen sc1
    s_mov_b64 exec, -1
    v_cvt_pk_bf16_f32 v226, v140, v141
    v_cvt_pk_bf16_f32 v227, v142, v143
    v_exp_f32 v148, v148
    v_exp_f32 v149, v149
    v_exp_f32 v150, v150
    v_mfma_f32_32x32x16_bf16 v[200:215], v[84:87], v[244:247], v[200:215]
    v_exp_f32 v151, v151
    v_cvt_pk_bf16_f32 v228, v144, v145
    v_cvt_pk_bf16_f32 v229, v146, v147
    v_cvt_pk_bf16_f32 v230, v148, v149
    v_cvt_pk_bf16_f32 v231, v150, v151
    s_waitcnt lgkmcnt(0)
    v_mfma_f32_32x32x16_bf16 v[120:135], v[56:59], v[32:35], v[88:103]
    ds_read_b128 v[64:67], v29 offset:28672
    v_exp_f32 v152, v152
    v_exp_f32 v153, v153
    v_exp_f32 v154, v154
    v_exp_f32 v155, v155
    v_exp_f32 v156, v156
    v_mfma_f32_32x32x16_bf16 v[184:199], v[72:75], v[216:219], v[184:199]
    ds_read_b128 v[68:71], v29 offset:29696
    v_exp_f32 v157, v157
    v_exp_f32 v158, v158
    v_exp_f32 v159, v159
    v_cvt_pk_bf16_f32 v232, v152, v153
    v_cvt_pk_bf16_f32 v233, v154, v155
    v_mfma_f32_32x32x16_bf16 v[120:135], v[60:63], v[36:39], v[120:135]
    ds_read_b128 v[80:83], v29 offset:22528
    v_exp_f32 v160, v160
    v_exp_f32 v161, v161
    v_exp_f32 v162, v162
    v_exp_f32 v163, v163
    v_smfmac_f32_16x16x64_bf16 v[248:251], v[48:51], v[216:223], v31
    ds_read_b128 v[84:87], v29 offset:23552
    v_cvt_pk_bf16_f32 v234, v156, v157
    v_cvt_pk_bf16_f32 v235, v158, v159
    v_exp_f32 v164, v164
    v_exp_f32 v165, v165
    v_exp_f32 v166, v166
    v_mfma_f32_32x32x16_bf16 v[184:199], v[76:79], v[220:223], v[184:199]
    v_exp_f32 v167, v167
    v_cvt_pk_bf16_f32 v236, v160, v161
    v_cvt_pk_bf16_f32 v237, v162, v163
    v_cvt_pk_bf16_f32 v238, v164, v165
    v_cvt_pk_bf16_f32 v239, v166, v167
    v_mfma_f32_32x32x16_bf16 v[136:151], v[56:59], v[40:43], v[104:119]
    buffer_load_dwordx4 v24, s[12:15], s18 offen offset:3072 lds
    v_exp_f32 v168, v168
    v_exp_f32 v169, v169
    v_exp_f32 v170, v170
    v_exp_f32 v171, v171
    v_exp_f32 v172, v172
    v_mfma_f32_32x32x16_bf16 v[200:215], v[72:75], v[224:227], v[200:215]
    v_exp_f32 v173, v173
    v_exp_f32 v174, v174
    v_exp_f32 v175, v175
    v_cvt_pk_bf16_f32 v240, v168, v169
    v_cvt_pk_bf16_f32 v241, v170, v171
    v_mfma_f32_32x32x16_bf16 v[136:151], v[60:63], v[44:47], v[136:151]
    v_exp_f32 v176, v176
    v_exp_f32 v177, v177
    v_exp_f32 v178, v178
    v_exp_f32 v179, v179
    v_smfmac_f32_16x16x64_bf16 v[252:255], v[48:51], v[224:231], v31
    buffer_load_dwordx4 a[16:19], v16, s[48:51], s42 offen nt
    s_add_u32 s42, s42, 57344
    v_cvt_pk_bf16_f32 v242, v172, v173
    v_cvt_pk_bf16_f32 v243, v174, v175
    v_exp_f32 v180, v180
    v_exp_f32 v181, v181
    v_exp_f32 v182, v182
    v_mfma_f32_32x32x16_bf16 v[200:215], v[76:79], v[228:231], v[200:215]
    v_exp_f32 v183, v183
    v_cvt_pk_bf16_f32 v244, v176, v177
    v_cvt_pk_bf16_f32 v245, v178, v179
    v_cvt_pk_bf16_f32 v246, v180, v181
    v_cvt_pk_bf16_f32 v247, v182, v183
    s_waitcnt lgkmcnt(0)
    v_mfma_f32_32x32x16_bf16 v[152:167], v[64:67], v[32:35], v[88:103]
    ds_read_b128 v[56:59], v29 offset:32768
    v_exp_f32 v120, v120
    v_exp_f32 v121, v121
    v_exp_f32 v122, v122
    v_exp_f32 v123, v123
    v_exp_f32 v124, v124
    v_mfma_f32_32x32x16_bf16 v[184:199], v[80:83], v[232:235], v[184:199]
    ds_read_b128 v[60:63], v29 offset:33792
    v_exp_f32 v125, v125
    v_exp_f32 v126, v126
    v_exp_f32 v127, v127
    v_cvt_pk_bf16_f32 v216, v120, v121
    v_cvt_pk_bf16_f32 v217, v122, v123
    v_mfma_f32_32x32x16_bf16 v[152:167], v[68:71], v[36:39], v[152:167]
    ds_read_b128 v[72:75], v29 offset:26624
    v_exp_f32 v128, v128
    v_exp_f32 v129, v129
    v_exp_f32 v130, v130
    v_exp_f32 v131, v131
    v_smfmac_f32_16x16x64_bf16 v[248:251], v[48:51], v[232:239], v31
    ds_read_b128 v[76:79], v29 offset:27648
    v_cvt_pk_bf16_f32 v218, v124, v125
    v_cvt_pk_bf16_f32 v219, v126, v127
    v_exp_f32 v132, v132
    v_exp_f32 v133, v133
    v_exp_f32 v134, v134
    v_mfma_f32_32x32x16_bf16 v[184:199], v[84:87], v[236:239], v[184:199]
    s_add_u32 m0, s19, 32768
    s_add_u32 s18, s17, 147456
    buffer_load_dwordx4 v24, s[12:15], s18 offen offset:0 lds
    v_exp_f32 v135, v135
    v_cvt_pk_bf16_f32 v220, v128, v129
    v_cvt_pk_bf16_f32 v221, v130, v131
    v_cvt_pk_bf16_f32 v222, v132, v133
    v_cvt_pk_bf16_f32 v223, v134, v135
    v_mfma_f32_32x32x16_bf16 v[168:183], v[64:67], v[40:43], v[104:119]
    s_mov_b64 exec, 0x7f
    buffer_load_dword a253, v17, s[52:55], s21 offen
    s_mov_b64 exec, -1
    s_add_u32 s21, s21, 896
    v_exp_f32 v136, v136
    v_exp_f32 v137, v137
    v_exp_f32 v138, v138
    v_exp_f32 v139, v139
    v_exp_f32 v140, v140
    v_mfma_f32_32x32x16_bf16 v[200:215], v[80:83], v[240:243], v[200:215]
    v_exp_f32 v141, v141
    v_exp_f32 v142, v142
    v_exp_f32 v143, v143
    v_cvt_pk_bf16_f32 v224, v136, v137
    v_cvt_pk_bf16_f32 v225, v138, v139
    v_mfma_f32_32x32x16_bf16 v[168:183], v[68:71], v[44:47], v[168:183]
    v_exp_f32 v144, v144
    v_exp_f32 v145, v145
    v_exp_f32 v146, v146
    v_exp_f32 v147, v147
    v_smfmac_f32_16x16x64_bf16 v[252:255], v[48:51], v[240:247], v31
    s_mov_b32 s24, s64
    s_mov_b32 s25, s65
    s_mov_b32 s26, 0x400000
    s_mov_b32 s27, 0x20000
    s_lshl_b32 s4, s32, 2
    s_add_u32 s4, s4, s3
    s_lshl_b32 s4, s4, 16
    s_lshl_b32 s5, s33, 7
    s_add_u32 s23, s4, s5
    v_and_b32 v22, 15, v1
    v_lshlrev_b32 v22, 11, v22
    v_lshrrev_b32 v23, 4, v1
    v_lshl_add_u32 v22, v23, 3, v22
    buffer_load_dwordx2 a[128:129], v22, s[24:27], s23 offen offset:0
    v_cvt_pk_bf16_f32 v226, v140, v141
    v_cvt_pk_bf16_f32 v227, v142, v143
    v_exp_f32 v148, v148
    v_exp_f32 v149, v149
    v_exp_f32 v150, v150
    v_mfma_f32_32x32x16_bf16 v[200:215], v[84:87], v[244:247], v[200:215]
    v_exp_f32 v151, v151
    v_cvt_pk_bf16_f32 v228, v144, v145
    v_cvt_pk_bf16_f32 v229, v146, v147
    v_cvt_pk_bf16_f32 v230, v148, v149
    v_cvt_pk_bf16_f32 v231, v150, v151
    s_waitcnt vmcnt(29) lgkmcnt(0)
    v_mfma_f32_32x32x16_bf16 v[120:135], v[56:59], v[32:35], v[88:103]
    ds_read_b128 v[64:67], v29 offset:36864
    v_exp_f32 v152, v152
    v_exp_f32 v153, v153
    v_exp_f32 v154, v154
    v_exp_f32 v155, v155
    v_exp_f32 v156, v156
    v_mfma_f32_32x32x16_bf16 v[184:199], v[72:75], v[216:219], v[184:199]
    ds_read_b128 v[68:71], v29 offset:37888
    v_exp_f32 v157, v157
    v_exp_f32 v158, v158
    v_exp_f32 v159, v159
    v_cvt_pk_bf16_f32 v232, v152, v153
    v_cvt_pk_bf16_f32 v233, v154, v155
    v_mfma_f32_32x32x16_bf16 v[120:135], v[60:63], v[36:39], v[120:135]
    ds_read_b128 v[80:83], v29 offset:30720
    v_exp_f32 v160, v160
    v_exp_f32 v161, v161
    v_exp_f32 v162, v162
    v_exp_f32 v163, v163
    v_smfmac_f32_16x16x64_bf16 v[248:251], v[48:51], v[216:223], v31
    ds_read_b128 v[84:87], v29 offset:31744
    v_cvt_pk_bf16_f32 v234, v156, v157
    v_cvt_pk_bf16_f32 v235, v158, v159
    v_exp_f32 v164, v164
    v_exp_f32 v165, v165
    v_exp_f32 v166, v166
    v_mfma_f32_32x32x16_bf16 v[184:199], v[76:79], v[220:223], v[184:199]
    buffer_load_dwordx4 v24, s[12:15], s18 offen offset:1024 lds
    v_exp_f32 v167, v167
    v_cvt_pk_bf16_f32 v236, v160, v161
    v_cvt_pk_bf16_f32 v237, v162, v163
    v_cvt_pk_bf16_f32 v238, v164, v165
    v_cvt_pk_bf16_f32 v239, v166, v167
    v_mfma_f32_32x32x16_bf16 v[136:151], v[56:59], v[40:43], v[104:119]
    buffer_load_dwordx4 a[20:23], v16, s[48:51], s42 offen nt
    s_add_u32 s42, s42, 57344
    v_exp_f32 v168, v168
    v_exp_f32 v169, v169
    v_exp_f32 v170, v170
    v_exp_f32 v171, v171
    v_exp_f32 v172, v172
    v_mfma_f32_32x32x16_bf16 v[200:215], v[72:75], v[224:227], v[200:215]
    v_mfma_f32_16x16x32_bf16 v[8:11], v[52:55], a[0:3], 0
    v_exp_f32 v173, v173
    v_exp_f32 v174, v174
    v_exp_f32 v175, v175
    v_cvt_pk_bf16_f32 v240, v168, v169
    v_cvt_pk_bf16_f32 v241, v170, v171
    v_mfma_f32_32x32x16_bf16 v[136:151], v[60:63], v[44:47], v[136:151]
    v_exp_f32 v176, v176
    v_exp_f32 v177, v177
    v_exp_f32 v178, v178
    v_exp_f32 v179, v179
    v_smfmac_f32_16x16x64_bf16 v[252:255], v[48:51], v[224:231], v31
    buffer_store_dwordx4 a[0:3], v14, s[92:95], s38 offen offset:0 sc1
    v_cvt_pk_bf16_f32 v242, v172, v173
    v_cvt_pk_bf16_f32 v243, v174, v175
    v_exp_f32 v180, v180
    v_exp_f32 v181, v181
    v_exp_f32 v182, v182
    v_mfma_f32_32x32x16_bf16 v[200:215], v[76:79], v[228:231], v[200:215]
    v_exp_f32 v183, v183
    v_cvt_pk_bf16_f32 v244, v176, v177
    v_cvt_pk_bf16_f32 v245, v178, v179
    v_cvt_pk_bf16_f32 v246, v180, v181
    v_cvt_pk_bf16_f32 v247, v182, v183
    s_waitcnt lgkmcnt(0)
    v_mfma_f32_32x32x16_bf16 v[152:167], v[64:67], v[32:35], v[88:103]
    ds_read_b128 v[56:59], v29 offset:40960
    v_exp_f32 v120, v120
    v_exp_f32 v121, v121
    v_exp_f32 v122, v122
    v_exp_f32 v123, v123
    v_exp_f32 v124, v124
    v_mfma_f32_32x32x16_bf16 v[184:199], v[80:83], v[232:235], v[184:199]
    ds_read_b128 v[60:63], v29 offset:41984
    v_exp_f32 v125, v125
    v_exp_f32 v126, v126
    v_exp_f32 v127, v127
    v_cvt_pk_bf16_f32 v216, v120, v121
    v_cvt_pk_bf16_f32 v217, v122, v123
    v_mfma_f32_32x32x16_bf16 v[152:167], v[68:71], v[36:39], v[152:167]
    ds_read_b128 v[72:75], v29 offset:34816
    v_exp_f32 v128, v128
    v_exp_f32 v129, v129
    v_exp_f32 v130, v130
    v_exp_f32 v131, v131
    v_smfmac_f32_16x16x64_bf16 v[248:251], v[48:51], v[232:239], v31
    ds_read_b128 v[76:79], v29 offset:35840
    v_cvt_pk_bf16_f32 v218, v124, v125
    v_cvt_pk_bf16_f32 v219, v126, v127
    v_exp_f32 v132, v132
    v_exp_f32 v133, v133
    v_exp_f32 v134, v134
    v_mfma_f32_32x32x16_bf16 v[184:199], v[84:87], v[236:239], v[184:199]
    v_exp_f32 v135, v135
    v_cvt_pk_bf16_f32 v220, v128, v129
    v_cvt_pk_bf16_f32 v221, v130, v131
    v_cvt_pk_bf16_f32 v222, v132, v133
    v_cvt_pk_bf16_f32 v223, v134, v135
    v_mfma_f32_32x32x16_bf16 v[168:183], v[64:67], v[40:43], v[104:119]
    buffer_load_dwordx4 v24, s[12:15], s18 offen offset:2048 lds
    v_exp_f32 v136, v136
    v_exp_f32 v137, v137
    v_exp_f32 v138, v138
    v_exp_f32 v139, v139
    v_exp_f32 v140, v140
    v_mfma_f32_32x32x16_bf16 v[200:215], v[80:83], v[240:243], v[200:215]
    v_exp_f32 v141, v141
    v_exp_f32 v142, v142
    v_exp_f32 v143, v143
    v_cvt_pk_bf16_f32 v224, v136, v137
    v_cvt_pk_bf16_f32 v225, v138, v139
    v_mfma_f32_32x32x16_bf16 v[168:183], v[68:71], v[44:47], v[168:183]
    v_exp_f32 v144, v144
    v_exp_f32 v145, v145
    v_exp_f32 v146, v146
    v_exp_f32 v147, v147
    v_smfmac_f32_16x16x64_bf16 v[252:255], v[48:51], v[240:247], v31
    v_cvt_pk_bf16_f32 v226, v140, v141
    v_cvt_pk_bf16_f32 v227, v142, v143
    v_exp_f32 v148, v148
    v_exp_f32 v149, v149
    v_exp_f32 v150, v150
    v_mfma_f32_32x32x16_bf16 v[200:215], v[84:87], v[244:247], v[200:215]
    v_exp_f32 v151, v151
    v_cvt_pk_bf16_f32 v228, v144, v145
    v_cvt_pk_bf16_f32 v229, v146, v147
    v_cvt_pk_bf16_f32 v230, v148, v149
    v_cvt_pk_bf16_f32 v231, v150, v151
    s_waitcnt vmcnt(28) lgkmcnt(0)
    v_mfma_f32_32x32x16_bf16 v[120:135], v[56:59], v[32:35], v[88:103]
    ds_read_b128 v[64:67], v29 offset:45056
    v_exp_f32 v152, v152
    v_exp_f32 v153, v153
    v_exp_f32 v154, v154
    v_exp_f32 v155, v155
    v_exp_f32 v156, v156
    v_mfma_f32_32x32x16_bf16 v[184:199], v[72:75], v[216:219], v[184:199]
    ds_read_b128 v[68:71], v29 offset:46080
    v_exp_f32 v157, v157
    v_exp_f32 v158, v158
    v_exp_f32 v159, v159
    v_cvt_pk_bf16_f32 v232, v152, v153
    v_cvt_pk_bf16_f32 v233, v154, v155
    v_mfma_f32_32x32x16_bf16 v[120:135], v[60:63], v[36:39], v[120:135]
    ds_read_b128 v[80:83], v29 offset:38912
    v_exp_f32 v160, v160
    v_exp_f32 v161, v161
    v_exp_f32 v162, v162
    v_exp_f32 v163, v163
    v_smfmac_f32_16x16x64_bf16 v[248:251], v[48:51], v[216:223], v31
    ds_read_b128 v[84:87], v29 offset:39936
    v_cvt_pk_bf16_f32 v234, v156, v157
    v_cvt_pk_bf16_f32 v235, v158, v159
    v_exp_f32 v164, v164
    v_exp_f32 v165, v165
    v_exp_f32 v166, v166
    v_mfma_f32_32x32x16_bf16 v[184:199], v[76:79], v[220:223], v[184:199]
    buffer_load_dwordx4 v24, s[12:15], s18 offen offset:3072 lds
    v_exp_f32 v167, v167
    v_cvt_pk_bf16_f32 v236, v160, v161
    v_cvt_pk_bf16_f32 v237, v162, v163
    v_cvt_pk_bf16_f32 v238, v164, v165
    v_cvt_pk_bf16_f32 v239, v166, v167
    v_mfma_f32_32x32x16_bf16 v[136:151], v[56:59], v[40:43], v[104:119]
    buffer_load_dwordx2 a[130:131], v22, s[24:27], s23 offen offset:32
    v_exp_f32 v168, v168
    v_exp_f32 v169, v169
    v_exp_f32 v170, v170
    v_exp_f32 v171, v171
    v_exp_f32 v172, v172
    v_mfma_f32_32x32x16_bf16 v[200:215], v[72:75], v[224:227], v[200:215]
    v_mfma_f32_16x16x32_bf16 v[8:11], v[52:55], a[4:7], v[8:11]
    v_exp_f32 v173, v173
    v_exp_f32 v174, v174
    v_exp_f32 v175, v175
    v_cvt_pk_bf16_f32 v240, v168, v169
    v_cvt_pk_bf16_f32 v241, v170, v171
    v_mfma_f32_32x32x16_bf16 v[136:151], v[60:63], v[44:47], v[136:151]
    v_exp_f32 v176, v176
    v_exp_f32 v177, v177
    v_exp_f32 v178, v178
    v_exp_f32 v179, v179
    v_smfmac_f32_16x16x64_bf16 v[252:255], v[48:51], v[224:231], v31
    buffer_store_dwordx4 a[4:7], v14, s[92:95], s38 offen offset:256 sc1
    v_cvt_pk_bf16_f32 v242, v172, v173
    v_cvt_pk_bf16_f32 v243, v174, v175
    v_exp_f32 v180, v180
    v_exp_f32 v181, v181
    v_exp_f32 v182, v182
    v_mfma_f32_32x32x16_bf16 v[200:215], v[76:79], v[228:231], v[200:215]
    v_exp_f32 v183, v183
    v_cvt_pk_bf16_f32 v244, v176, v177
    v_cvt_pk_bf16_f32 v245, v178, v179
    v_cvt_pk_bf16_f32 v246, v180, v181
    v_cvt_pk_bf16_f32 v247, v182, v183
    s_waitcnt lgkmcnt(0)
    v_mfma_f32_32x32x16_bf16 v[152:167], v[64:67], v[32:35], v[88:103]
    ds_read_b128 v[56:59], v29 offset:49152
    v_exp_f32 v120, v120
    v_exp_f32 v121, v121
    v_exp_f32 v122, v122
    v_exp_f32 v123, v123
    v_exp_f32 v124, v124
    v_mfma_f32_32x32x16_bf16 v[184:199], v[80:83], v[232:235], v[184:199]
    ds_read_b128 v[60:63], v29 offset:50176
    v_exp_f32 v125, v125
    v_exp_f32 v126, v126
    v_exp_f32 v127, v127
    v_cvt_pk_bf16_f32 v216, v120, v121
    v_cvt_pk_bf16_f32 v217, v122, v123
    v_mfma_f32_32x32x16_bf16 v[152:167], v[68:71], v[36:39], v[152:167]
    ds_read_b128 v[72:75], v29 offset:43008
    v_exp_f32 v128, v128
    v_exp_f32 v129, v129
    v_exp_f32 v130, v130
    v_exp_f32 v131, v131
    v_smfmac_f32_16x16x64_bf16 v[248:251], v[48:51], v[232:239], v31
    ds_read_b128 v[76:79], v29 offset:44032
    v_cvt_pk_bf16_f32 v218, v124, v125
    v_cvt_pk_bf16_f32 v219, v126, v127
    v_exp_f32 v132, v132
    v_exp_f32 v133, v133
    v_exp_f32 v134, v134
    v_mfma_f32_32x32x16_bf16 v[184:199], v[84:87], v[236:239], v[184:199]
    v_exp_f32 v135, v135
    v_cvt_pk_bf16_f32 v220, v128, v129
    v_cvt_pk_bf16_f32 v221, v130, v131
    v_cvt_pk_bf16_f32 v222, v132, v133
    v_cvt_pk_bf16_f32 v223, v134, v135
    v_mfma_f32_32x32x16_bf16 v[168:183], v[64:67], v[40:43], v[104:119]
    s_add_u32 m0, s19, 49152
    s_add_u32 s18, s17, 163840
    buffer_load_dwordx4 v24, s[12:15], s18 offen offset:0 lds
    v_exp_f32 v136, v136
    v_exp_f32 v137, v137
    v_exp_f32 v138, v138
    v_exp_f32 v139, v139
    v_exp_f32 v140, v140
    v_mfma_f32_32x32x16_bf16 v[200:215], v[80:83], v[240:243], v[200:215]
    v_exp_f32 v141, v141
    v_exp_f32 v142, v142
    v_exp_f32 v143, v143
    v_cvt_pk_bf16_f32 v224, v136, v137
    v_cvt_pk_bf16_f32 v225, v138, v139
    v_mfma_f32_32x32x16_bf16 v[168:183], v[68:71], v[44:47], v[168:183]
    v_exp_f32 v144, v144
    v_exp_f32 v145, v145
    v_exp_f32 v146, v146
    v_exp_f32 v147, v147
    v_smfmac_f32_16x16x64_bf16 v[252:255], v[48:51], v[240:247], v31
    buffer_load_dwordx4 a[24:27], v16, s[48:51], s42 offen nt
    s_add_u32 s42, s42, 57344
    v_cvt_pk_bf16_f32 v226, v140, v141
    v_cvt_pk_bf16_f32 v227, v142, v143
    v_exp_f32 v148, v148
    v_exp_f32 v149, v149
    v_exp_f32 v150, v150
    v_mfma_f32_32x32x16_bf16 v[200:215], v[84:87], v[244:247], v[200:215]
    v_exp_f32 v151, v151
    v_cvt_pk_bf16_f32 v228, v144, v145
    v_cvt_pk_bf16_f32 v229, v146, v147
    v_cvt_pk_bf16_f32 v230, v148, v149
    v_cvt_pk_bf16_f32 v231, v150, v151
    s_waitcnt lgkmcnt(0)
    v_mfma_f32_32x32x16_bf16 v[120:135], v[56:59], v[32:35], v[88:103]
    ds_read_b128 v[64:67], v29 offset:53248
    v_exp_f32 v152, v152
    v_exp_f32 v153, v153
    v_exp_f32 v154, v154
    v_exp_f32 v155, v155
    v_exp_f32 v156, v156
    v_mfma_f32_32x32x16_bf16 v[184:199], v[72:75], v[216:219], v[184:199]
    ds_read_b128 v[68:71], v29 offset:54272
    v_exp_f32 v157, v157
    v_exp_f32 v158, v158
    v_exp_f32 v159, v159
    v_cvt_pk_bf16_f32 v232, v152, v153
    v_cvt_pk_bf16_f32 v233, v154, v155
    v_mfma_f32_32x32x16_bf16 v[120:135], v[60:63], v[36:39], v[120:135]
    ds_read_b128 v[80:83], v29 offset:47104
    v_exp_f32 v160, v160
    v_exp_f32 v161, v161
    v_exp_f32 v162, v162
    v_exp_f32 v163, v163
    v_smfmac_f32_16x16x64_bf16 v[248:251], v[48:51], v[216:223], v31
    ds_read_b128 v[84:87], v29 offset:48128
    v_cvt_pk_bf16_f32 v234, v156, v157
    v_cvt_pk_bf16_f32 v235, v158, v159
    v_exp_f32 v164, v164
    v_exp_f32 v165, v165
    v_exp_f32 v166, v166
    v_mfma_f32_32x32x16_bf16 v[184:199], v[76:79], v[220:223], v[184:199]
    v_exp_f32 v167, v167
    v_cvt_pk_bf16_f32 v236, v160, v161
    v_cvt_pk_bf16_f32 v237, v162, v163
    v_cvt_pk_bf16_f32 v238, v164, v165
    v_cvt_pk_bf16_f32 v239, v166, v167
    v_mfma_f32_32x32x16_bf16 v[136:151], v[56:59], v[40:43], v[104:119]
    buffer_load_dwordx4 v24, s[12:15], s18 offen offset:1024 lds
    v_exp_f32 v168, v168
    v_exp_f32 v169, v169
    v_exp_f32 v170, v170
    v_exp_f32 v171, v171
    v_exp_f32 v172, v172
    v_mfma_f32_32x32x16_bf16 v[200:215], v[72:75], v[224:227], v[200:215]
    v_exp_f32 v173, v173
    v_exp_f32 v174, v174
    v_exp_f32 v175, v175
    v_cvt_pk_bf16_f32 v240, v168, v169
    v_cvt_pk_bf16_f32 v241, v170, v171
    v_mfma_f32_32x32x16_bf16 v[136:151], v[60:63], v[44:47], v[136:151]
    v_exp_f32 v176, v176
    v_exp_f32 v177, v177
    v_exp_f32 v178, v178
    v_exp_f32 v179, v179
    v_smfmac_f32_16x16x64_bf16 v[252:255], v[48:51], v[224:231], v31
    v_cvt_pk_bf16_f32 v242, v172, v173
    v_cvt_pk_bf16_f32 v243, v174, v175
    v_exp_f32 v180, v180
    v_exp_f32 v181, v181
    v_exp_f32 v182, v182
    v_mfma_f32_32x32x16_bf16 v[200:215], v[76:79], v[228:231], v[200:215]
    v_exp_f32 v183, v183
    v_cvt_pk_bf16_f32 v244, v176, v177
    v_cvt_pk_bf16_f32 v245, v178, v179
    v_cvt_pk_bf16_f32 v246, v180, v181
    v_cvt_pk_bf16_f32 v247, v182, v183
    s_waitcnt vmcnt(25) lgkmcnt(0)
    v_mfma_f32_32x32x16_bf16 v[152:167], v[64:67], v[32:35], v[88:103]
    ds_read_b128 v[56:59], v29 offset:57344
    v_exp_f32 v120, v120
    v_exp_f32 v121, v121
    v_exp_f32 v122, v122
    v_exp_f32 v123, v123
    v_exp_f32 v124, v124
    v_mfma_f32_32x32x16_bf16 v[184:199], v[80:83], v[232:235], v[184:199]
    ds_read_b128 v[60:63], v29 offset:58368
    v_exp_f32 v125, v125
    v_exp_f32 v126, v126
    v_exp_f32 v127, v127
    v_cvt_pk_bf16_f32 v216, v120, v121
    v_cvt_pk_bf16_f32 v217, v122, v123
    v_mfma_f32_32x32x16_bf16 v[152:167], v[68:71], v[36:39], v[152:167]
    ds_read_b128 v[72:75], v29 offset:51200
    v_exp_f32 v128, v128
    v_exp_f32 v129, v129
    v_exp_f32 v130, v130
    v_exp_f32 v131, v131
    v_smfmac_f32_16x16x64_bf16 v[248:251], v[48:51], v[232:239], v31
    ds_read_b128 v[76:79], v29 offset:52224
    v_cvt_pk_bf16_f32 v218, v124, v125
    v_cvt_pk_bf16_f32 v219, v126, v127
    v_exp_f32 v132, v132
    v_exp_f32 v133, v133
    v_exp_f32 v134, v134
    v_mfma_f32_32x32x16_bf16 v[184:199], v[84:87], v[236:239], v[184:199]
    buffer_load_dwordx4 v24, s[12:15], s18 offen offset:2048 lds
    v_exp_f32 v135, v135
    v_cvt_pk_bf16_f32 v220, v128, v129
    v_cvt_pk_bf16_f32 v221, v130, v131
    v_cvt_pk_bf16_f32 v222, v132, v133
    v_cvt_pk_bf16_f32 v223, v134, v135
    v_mfma_f32_32x32x16_bf16 v[168:183], v[64:67], v[40:43], v[104:119]
    s_mov_b64 exec, 0x7f
    buffer_load_dword a253, v17, s[52:55], s21 offen
    s_mov_b64 exec, -1
    s_add_u32 s21, s21, 896
    v_exp_f32 v136, v136
    v_exp_f32 v137, v137
    v_exp_f32 v138, v138
    v_exp_f32 v139, v139
    v_exp_f32 v140, v140
    v_mfma_f32_32x32x16_bf16 v[200:215], v[80:83], v[240:243], v[200:215]
    v_mfma_f32_16x16x32_bf16 v[8:11], v[52:55], a[8:11], v[8:11]
    v_exp_f32 v141, v141
    v_exp_f32 v142, v142
    v_exp_f32 v143, v143
    v_cvt_pk_bf16_f32 v224, v136, v137
    v_cvt_pk_bf16_f32 v225, v138, v139
    v_mfma_f32_32x32x16_bf16 v[168:183], v[68:71], v[44:47], v[168:183]
    v_exp_f32 v144, v144
    v_exp_f32 v145, v145
    v_exp_f32 v146, v146
    v_exp_f32 v147, v147
    v_smfmac_f32_16x16x64_bf16 v[252:255], v[48:51], v[240:247], v31
    buffer_load_dwordx2 a[132:133], v22, s[24:27], s23 offen offset:64
    v_cvt_pk_bf16_f32 v226, v140, v141
    v_cvt_pk_bf16_f32 v227, v142, v143
    v_exp_f32 v148, v148
    v_exp_f32 v149, v149
    v_exp_f32 v150, v150
    v_mfma_f32_32x32x16_bf16 v[200:215], v[84:87], v[244:247], v[200:215]
    buffer_store_dwordx4 a[8:11], v14, s[92:95], s38 offen offset:512 sc1
    v_exp_f32 v151, v151
    v_cvt_pk_bf16_f32 v228, v144, v145
    v_cvt_pk_bf16_f32 v229, v146, v147
    v_cvt_pk_bf16_f32 v230, v148, v149
    v_cvt_pk_bf16_f32 v231, v150, v151
    s_waitcnt lgkmcnt(0)
    v_mfma_f32_32x32x16_bf16 v[120:135], v[56:59], v[32:35], v[88:103]
    ds_read_b128 v[64:67], v29 offset:61440
    v_exp_f32 v152, v152
    v_exp_f32 v153, v153
    v_exp_f32 v154, v154
    v_exp_f32 v155, v155
    v_exp_f32 v156, v156
    v_mfma_f32_32x32x16_bf16 v[184:199], v[72:75], v[216:219], v[184:199]
    ds_read_b128 v[68:71], v29 offset:62464
    v_exp_f32 v157, v157
    v_exp_f32 v158, v158
    v_exp_f32 v159, v159
    v_cvt_pk_bf16_f32 v232, v152, v153
    v_cvt_pk_bf16_f32 v233, v154, v155
    v_mfma_f32_32x32x16_bf16 v[120:135], v[60:63], v[36:39], v[120:135]
    ds_read_b128 v[80:83], v29 offset:55296
    v_exp_f32 v160, v160
    v_exp_f32 v161, v161
    v_exp_f32 v162, v162
    v_exp_f32 v163, v163
    v_smfmac_f32_16x16x64_bf16 v[248:251], v[48:51], v[216:223], v31
    ds_read_b128 v[84:87], v29 offset:56320
    v_cvt_pk_bf16_f32 v234, v156, v157
    v_cvt_pk_bf16_f32 v235, v158, v159
    v_exp_f32 v164, v164
    v_exp_f32 v165, v165
    v_exp_f32 v166, v166
    v_mfma_f32_32x32x16_bf16 v[184:199], v[76:79], v[220:223], v[184:199]
    v_exp_f32 v167, v167
    v_cvt_pk_bf16_f32 v236, v160, v161
    v_cvt_pk_bf16_f32 v237, v162, v163
    v_cvt_pk_bf16_f32 v238, v164, v165
    v_cvt_pk_bf16_f32 v239, v166, v167
    v_mfma_f32_32x32x16_bf16 v[136:151], v[56:59], v[40:43], v[104:119]
    buffer_load_dwordx4 v24, s[12:15], s18 offen offset:3072 lds
    v_exp_f32 v168, v168
    v_exp_f32 v169, v169
    v_exp_f32 v170, v170
    v_exp_f32 v171, v171
    v_exp_f32 v172, v172
    v_mfma_f32_32x32x16_bf16 v[200:215], v[72:75], v[224:227], v[200:215]
    v_exp_f32 v173, v173
    v_exp_f32 v174, v174
    v_exp_f32 v175, v175
    v_cvt_pk_bf16_f32 v240, v168, v169
    v_cvt_pk_bf16_f32 v241, v170, v171
    v_mfma_f32_32x32x16_bf16 v[136:151], v[60:63], v[44:47], v[136:151]
    v_exp_f32 v176, v176
    v_exp_f32 v177, v177
    v_exp_f32 v178, v178
    v_exp_f32 v179, v179
    v_smfmac_f32_16x16x64_bf16 v[252:255], v[48:51], v[224:231], v31
    buffer_load_dwordx4 a[28:31], v16, s[48:51], s42 offen nt
    s_add_u32 s42, s42, 57344
    v_cvt_pk_bf16_f32 v242, v172, v173
    v_cvt_pk_bf16_f32 v243, v174, v175
    v_exp_f32 v180, v180
    v_exp_f32 v181, v181
    v_exp_f32 v182, v182
    v_mfma_f32_32x32x16_bf16 v[200:215], v[76:79], v[228:231], v[200:215]
    v_exp_f32 v183, v183
    v_cvt_pk_bf16_f32 v244, v176, v177
    v_cvt_pk_bf16_f32 v245, v178, v179
    v_cvt_pk_bf16_f32 v246, v180, v181
    v_cvt_pk_bf16_f32 v247, v182, v183
    s_waitcnt vmcnt(20) lgkmcnt(0)
    s_barrier
    v_mfma_f32_32x32x16_bf16 v[152:167], v[64:67], v[32:35], v[88:103]
    ds_read_b128 v[56:59], v30 offset:0
    v_exp_f32 v120, v120
    v_exp_f32 v121, v121
    v_exp_f32 v122, v122
    v_exp_f32 v123, v123
    v_exp_f32 v124, v124
    v_mfma_f32_32x32x16_bf16 v[184:199], v[80:83], v[232:235], v[184:199]
    ds_read_b128 v[60:63], v30 offset:1024
    v_exp_f32 v125, v125
    v_exp_f32 v126, v126
    v_exp_f32 v127, v127
    v_cvt_pk_bf16_f32 v216, v120, v121
    v_cvt_pk_bf16_f32 v217, v122, v123
    v_mfma_f32_32x32x16_bf16 v[152:167], v[68:71], v[36:39], v[152:167]
    ds_read_b128 v[72:75], v29 offset:59392
    v_exp_f32 v128, v128
    v_exp_f32 v129, v129
    v_exp_f32 v130, v130
    v_exp_f32 v131, v131
    v_smfmac_f32_16x16x64_bf16 v[248:251], v[48:51], v[232:239], v31
    ds_read_b128 v[76:79], v29 offset:60416
    v_cvt_pk_bf16_f32 v218, v124, v125
    v_cvt_pk_bf16_f32 v219, v126, v127
    v_exp_f32 v132, v132
    v_exp_f32 v133, v133
    v_exp_f32 v134, v134
    v_mfma_f32_32x32x16_bf16 v[184:199], v[84:87], v[236:239], v[184:199]
    v_exp_f32 v135, v135
    v_cvt_pk_bf16_f32 v220, v128, v129
    v_cvt_pk_bf16_f32 v221, v130, v131
    v_cvt_pk_bf16_f32 v222, v132, v133
    v_cvt_pk_bf16_f32 v223, v134, v135
    v_mfma_f32_32x32x16_bf16 v[168:183], v[64:67], v[40:43], v[104:119]
    s_add_u32 m0, s19, 65536
    s_add_u32 s18, s17, 180224
    buffer_load_dwordx4 v24, s[12:15], s18 offen offset:0 lds
    v_exp_f32 v136, v136
    v_exp_f32 v137, v137
    v_exp_f32 v138, v138
    v_exp_f32 v139, v139
    v_exp_f32 v140, v140
    v_mfma_f32_32x32x16_bf16 v[200:215], v[80:83], v[240:243], v[200:215]
    v_exp_f32 v141, v141
    v_exp_f32 v142, v142
    v_exp_f32 v143, v143
    v_cvt_pk_bf16_f32 v224, v136, v137
    v_cvt_pk_bf16_f32 v225, v138, v139
    v_mfma_f32_32x32x16_bf16 v[168:183], v[68:71], v[44:47], v[168:183]
    v_exp_f32 v144, v144
    v_exp_f32 v145, v145
    v_exp_f32 v146, v146
    v_exp_f32 v147, v147
    v_smfmac_f32_16x16x64_bf16 v[252:255], v[48:51], v[240:247], v31
    v_cvt_pk_bf16_f32 v226, v140, v141
    v_cvt_pk_bf16_f32 v227, v142, v143
    v_exp_f32 v148, v148
    v_exp_f32 v149, v149
    v_exp_f32 v150, v150
    v_mfma_f32_32x32x16_bf16 v[200:215], v[84:87], v[244:247], v[200:215]
    v_exp_f32 v151, v151
    v_cvt_pk_bf16_f32 v228, v144, v145
    v_cvt_pk_bf16_f32 v229, v146, v147
    v_cvt_pk_bf16_f32 v230, v148, v149
    v_cvt_pk_bf16_f32 v231, v150, v151
    s_waitcnt vmcnt(25) lgkmcnt(0)
    v_mfma_f32_32x32x16_bf16 v[120:135], v[56:59], v[32:35], v[88:103]
    ds_read_b128 v[64:67], v30 offset:4096
    v_exp_f32 v152, v152
    v_exp_f32 v153, v153
    v_exp_f32 v154, v154
    v_exp_f32 v155, v155
    v_exp_f32 v156, v156
    v_mfma_f32_32x32x16_bf16 v[184:199], v[72:75], v[216:219], v[184:199]
    ds_read_b128 v[68:71], v30 offset:5120
    v_exp_f32 v157, v157
    v_exp_f32 v158, v158
    v_exp_f32 v159, v159
    v_cvt_pk_bf16_f32 v232, v152, v153
    v_cvt_pk_bf16_f32 v233, v154, v155
    v_mfma_f32_32x32x16_bf16 v[120:135], v[60:63], v[36:39], v[120:135]
    ds_read_b128 v[80:83], v29 offset:63488
    v_exp_f32 v160, v160
    v_exp_f32 v161, v161
    v_exp_f32 v162, v162
    v_exp_f32 v163, v163
    v_smfmac_f32_16x16x64_bf16 v[248:251], v[48:51], v[216:223], v31
    ds_read_b128 v[84:87], v29 offset:64512
    v_cvt_pk_bf16_f32 v234, v156, v157
    v_cvt_pk_bf16_f32 v235, v158, v159
    v_exp_f32 v164, v164
    v_exp_f32 v165, v165
    v_exp_f32 v166, v166
    v_mfma_f32_32x32x16_bf16 v[184:199], v[76:79], v[220:223], v[184:199]
    buffer_load_dwordx4 v24, s[12:15], s18 offen offset:1024 lds
    v_exp_f32 v167, v167
    v_cvt_pk_bf16_f32 v236, v160, v161
    v_cvt_pk_bf16_f32 v237, v162, v163
    v_cvt_pk_bf16_f32 v238, v164, v165
    v_cvt_pk_bf16_f32 v239, v166, v167
    v_mfma_f32_32x32x16_bf16 v[136:151], v[56:59], v[40:43], v[104:119]
    buffer_load_dwordx2 a[134:135], v22, s[24:27], s23 offen offset:96
    v_exp_f32 v168, v168
    v_exp_f32 v169, v169
    v_exp_f32 v170, v170
    v_exp_f32 v171, v171
    v_exp_f32 v172, v172
    v_mfma_f32_32x32x16_bf16 v[200:215], v[72:75], v[224:227], v[200:215]
    v_mfma_f32_16x16x32_bf16 v[8:11], v[52:55], a[12:15], v[8:11]
    v_exp_f32 v173, v173
    v_exp_f32 v174, v174
    v_exp_f32 v175, v175
    v_cvt_pk_bf16_f32 v240, v168, v169
    v_cvt_pk_bf16_f32 v241, v170, v171
    v_mfma_f32_32x32x16_bf16 v[136:151], v[60:63], v[44:47], v[136:151]
    v_exp_f32 v176, v176
    v_exp_f32 v177, v177
    v_exp_f32 v178, v178
    v_exp_f32 v179, v179
    v_smfmac_f32_16x16x64_bf16 v[252:255], v[48:51], v[224:231], v31
    buffer_store_dwordx4 a[12:15], v14, s[92:95], s38 offen offset:768 sc1
    s_add_u32 s38, s38, 14336
    v_cvt_pk_bf16_f32 v242, v172, v173
    v_cvt_pk_bf16_f32 v243, v174, v175
    v_exp_f32 v180, v180
    v_exp_f32 v181, v181
    v_exp_f32 v182, v182
    v_mfma_f32_32x32x16_bf16 v[200:215], v[76:79], v[228:231], v[200:215]
    v_exp_f32 v183, v183
    v_cvt_pk_bf16_f32 v244, v176, v177
    v_cvt_pk_bf16_f32 v245, v178, v179
    v_cvt_pk_bf16_f32 v246, v180, v181
    v_cvt_pk_bf16_f32 v247, v182, v183
    s_waitcnt lgkmcnt(0)
    v_mfma_f32_32x32x16_bf16 v[152:167], v[64:67], v[32:35], v[88:103]
    ds_read_b128 v[56:59], v30 offset:8192
    v_exp_f32 v120, v120
    v_exp_f32 v121, v121
    v_exp_f32 v122, v122
    v_exp_f32 v123, v123
    v_exp_f32 v124, v124
    v_mfma_f32_32x32x16_bf16 v[184:199], v[80:83], v[232:235], v[184:199]
    ds_read_b128 v[60:63], v30 offset:9216
    v_exp_f32 v125, v125
    v_exp_f32 v126, v126
    v_exp_f32 v127, v127
    v_cvt_pk_bf16_f32 v216, v120, v121
    v_cvt_pk_bf16_f32 v217, v122, v123
    v_mfma_f32_32x32x16_bf16 v[152:167], v[68:71], v[36:39], v[152:167]
    ds_read_b128 v[72:75], v30 offset:2048
    v_exp_f32 v128, v128
    v_exp_f32 v129, v129
    v_exp_f32 v130, v130
    v_exp_f32 v131, v131
    v_smfmac_f32_16x16x64_bf16 v[248:251], v[48:51], v[232:239], v31
    ds_read_b128 v[76:79], v30 offset:3072
    v_cvt_pk_bf16_f32 v218, v124, v125
    v_cvt_pk_bf16_f32 v219, v126, v127
    v_exp_f32 v132, v132
    v_exp_f32 v133, v133
    v_exp_f32 v134, v134
    v_mfma_f32_32x32x16_bf16 v[184:199], v[84:87], v[236:239], v[184:199]
    v_exp_f32 v135, v135
    v_cvt_pk_bf16_f32 v220, v128, v129
    v_cvt_pk_bf16_f32 v221, v130, v131
    v_cvt_pk_bf16_f32 v222, v132, v133
    v_cvt_pk_bf16_f32 v223, v134, v135
    v_mfma_f32_32x32x16_bf16 v[168:183], v[64:67], v[40:43], v[104:119]
    buffer_load_dwordx4 v24, s[12:15], s18 offen offset:2048 lds
    v_exp_f32 v136, v136
    v_exp_f32 v137, v137
    v_exp_f32 v138, v138
    v_exp_f32 v139, v139
    v_exp_f32 v140, v140
    v_mfma_f32_32x32x16_bf16 v[200:215], v[80:83], v[240:243], v[200:215]
    v_exp_f32 v141, v141
    v_exp_f32 v142, v142
    v_exp_f32 v143, v143
    v_cvt_pk_bf16_f32 v224, v136, v137
    v_cvt_pk_bf16_f32 v225, v138, v139
    v_mfma_f32_32x32x16_bf16 v[168:183], v[68:71], v[44:47], v[168:183]
    v_exp_f32 v144, v144
    v_exp_f32 v145, v145
    v_exp_f32 v146, v146
    v_exp_f32 v147, v147
    v_smfmac_f32_16x16x64_bf16 v[252:255], v[48:51], v[240:247], v31
    buffer_load_dwordx4 a[32:35], v16, s[48:51], s42 offen nt
    s_add_u32 s42, s42, 57344
    v_cvt_pk_bf16_f32 v226, v140, v141
    v_cvt_pk_bf16_f32 v227, v142, v143
    v_exp_f32 v148, v148
    v_exp_f32 v149, v149
    v_exp_f32 v150, v150
    v_mfma_f32_32x32x16_bf16 v[200:215], v[84:87], v[244:247], v[200:215]
    v_exp_f32 v151, v151
    v_cvt_pk_bf16_f32 v228, v144, v145
    v_cvt_pk_bf16_f32 v229, v146, v147
    v_cvt_pk_bf16_f32 v230, v148, v149
    v_cvt_pk_bf16_f32 v231, v150, v151
    s_waitcnt lgkmcnt(0)
    v_mfma_f32_32x32x16_bf16 v[120:135], v[56:59], v[32:35], v[88:103]
    ds_read_b128 v[64:67], v30 offset:12288
    v_exp_f32 v152, v152
    v_exp_f32 v153, v153
    v_exp_f32 v154, v154
    v_exp_f32 v155, v155
    v_exp_f32 v156, v156
    v_mfma_f32_32x32x16_bf16 v[184:199], v[72:75], v[216:219], v[184:199]
    ds_read_b128 v[68:71], v30 offset:13312
    v_exp_f32 v157, v157
    v_exp_f32 v158, v158
    v_exp_f32 v159, v159
    v_cvt_pk_bf16_f32 v232, v152, v153
    v_cvt_pk_bf16_f32 v233, v154, v155
    v_mfma_f32_32x32x16_bf16 v[120:135], v[60:63], v[36:39], v[120:135]
    ds_read_b128 v[80:83], v30 offset:6144
    v_exp_f32 v160, v160
    v_exp_f32 v161, v161
    v_exp_f32 v162, v162
    v_exp_f32 v163, v163
    v_smfmac_f32_16x16x64_bf16 v[248:251], v[48:51], v[216:223], v31
    ds_read_b128 v[84:87], v30 offset:7168
    v_cvt_pk_bf16_f32 v234, v156, v157
    v_cvt_pk_bf16_f32 v235, v158, v159
    v_exp_f32 v164, v164
    v_exp_f32 v165, v165
    v_exp_f32 v166, v166
    v_mfma_f32_32x32x16_bf16 v[184:199], v[76:79], v[220:223], v[184:199]
    v_exp_f32 v167, v167
    v_cvt_pk_bf16_f32 v236, v160, v161
    v_cvt_pk_bf16_f32 v237, v162, v163
    v_cvt_pk_bf16_f32 v238, v164, v165
    v_cvt_pk_bf16_f32 v239, v166, v167
    v_mfma_f32_32x32x16_bf16 v[136:151], v[56:59], v[40:43], v[104:119]
    buffer_load_dwordx4 v24, s[12:15], s18 offen offset:3072 lds
    v_exp_f32 v168, v168
    v_exp_f32 v169, v169
    v_exp_f32 v170, v170
    v_exp_f32 v171, v171
    v_exp_f32 v172, v172
    v_mfma_f32_32x32x16_bf16 v[200:215], v[72:75], v[224:227], v[200:215]
    v_exp_f32 v173, v173
    v_exp_f32 v174, v174
    v_exp_f32 v175, v175
    v_cvt_pk_bf16_f32 v240, v168, v169
    v_cvt_pk_bf16_f32 v241, v170, v171
    v_mfma_f32_32x32x16_bf16 v[136:151], v[60:63], v[44:47], v[136:151]
    v_exp_f32 v176, v176
    v_exp_f32 v177, v177
    v_exp_f32 v178, v178
    v_exp_f32 v179, v179
    v_smfmac_f32_16x16x64_bf16 v[252:255], v[48:51], v[224:231], v31
    v_cvt_pk_bf16_f32 v242, v172, v173
    v_cvt_pk_bf16_f32 v243, v174, v175
    v_exp_f32 v180, v180
    v_exp_f32 v181, v181
    v_exp_f32 v182, v182
    v_mfma_f32_32x32x16_bf16 v[200:215], v[76:79], v[228:231], v[200:215]
    v_exp_f32 v183, v183
    v_cvt_pk_bf16_f32 v244, v176, v177
    v_cvt_pk_bf16_f32 v245, v178, v179
    v_cvt_pk_bf16_f32 v246, v180, v181
    v_cvt_pk_bf16_f32 v247, v182, v183
    s_waitcnt vmcnt(26) lgkmcnt(0)
    v_mfma_f32_32x32x16_bf16 v[152:167], v[64:67], v[32:35], v[88:103]
    ds_read_b128 v[56:59], v28 offset:0
    v_exp_f32 v120, v120
    v_exp_f32 v121, v121
    v_exp_f32 v122, v122
    v_exp_f32 v123, v123
    v_exp_f32 v124, v124
    v_mfma_f32_32x32x16_bf16 v[184:199], v[80:83], v[232:235], v[184:199]
    ds_read_b128 v[60:63], v28 offset:1024
    v_exp_f32 v125, v125
    v_exp_f32 v126, v126
    v_exp_f32 v127, v127
    v_cvt_pk_bf16_f32 v216, v120, v121
    v_cvt_pk_bf16_f32 v217, v122, v123
    v_mfma_f32_32x32x16_bf16 v[152:167], v[68:71], v[36:39], v[152:167]
    ds_read_b128 v[72:75], v30 offset:10240
    v_exp_f32 v128, v128
    v_exp_f32 v129, v129
    v_exp_f32 v130, v130
    v_exp_f32 v131, v131
    v_smfmac_f32_16x16x64_bf16 v[248:251], v[48:51], v[232:239], v31
    ds_read_b128 v[76:79], v30 offset:11264
    v_cvt_pk_bf16_f32 v218, v124, v125
    v_cvt_pk_bf16_f32 v219, v126, v127
    v_exp_f32 v132, v132
    v_exp_f32 v133, v133
    v_exp_f32 v134, v134
    v_mfma_f32_32x32x16_bf16 v[184:199], v[84:87], v[236:239], v[184:199]
    s_add_u32 m0, s19, 81920
    s_add_u32 s18, s17, 196608
    buffer_load_dwordx4 v24, s[12:15], s18 offen offset:0 lds
    v_exp_f32 v135, v135
    v_cvt_pk_bf16_f32 v220, v128, v129
    v_cvt_pk_bf16_f32 v221, v130, v131
    v_cvt_pk_bf16_f32 v222, v132, v133
    v_cvt_pk_bf16_f32 v223, v134, v135
    v_mfma_f32_32x32x16_bf16 v[168:183], v[64:67], v[40:43], v[104:119]
    buffer_load_dwordx4 a[36:39], v16, s[48:51], s42 offen nt
    s_add_u32 s42, s42, 57344
    v_exp_f32 v136, v136
    v_exp_f32 v137, v137
    v_exp_f32 v138, v138
    v_exp_f32 v139, v139
    v_exp_f32 v140, v140
    v_mfma_f32_32x32x16_bf16 v[200:215], v[80:83], v[240:243], v[200:215]
    v_mfma_f32_16x16x32_bf16 v[8:11], v[52:55], a[16:19], v[8:11]
    v_exp_f32 v141, v141
    v_exp_f32 v142, v142
    v_exp_f32 v143, v143
    v_cvt_pk_bf16_f32 v224, v136, v137
    v_cvt_pk_bf16_f32 v225, v138, v139
    v_mfma_f32_32x32x16_bf16 v[168:183], v[68:71], v[44:47], v[168:183]
    s_mov_b64 exec, 0x7f
    buffer_load_dword a253, v17, s[52:55], s21 offen
    s_mov_b64 exec, -1
    s_add_u32 s21, s21, 896
    v_exp_f32 v144, v144
    v_exp_f32 v145, v145
    v_exp_f32 v146, v146
    v_exp_f32 v147, v147
    v_smfmac_f32_16x16x64_bf16 v[252:255], v[48:51], v[240:247], v31
    s_add_u32 s23, s23, 32768
    buffer_load_dwordx2 a[136:137], v22, s[24:27], s23 offen offset:0
    v_cvt_pk_bf16_f32 v226, v140, v141
    v_cvt_pk_bf16_f32 v227, v142, v143
    v_exp_f32 v148, v148
    v_exp_f32 v149, v149
    v_exp_f32 v150, v150
    v_mfma_f32_32x32x16_bf16 v[200:215], v[84:87], v[244:247], v[200:215]
    buffer_store_dwordx4 a[16:19], v14, s[92:95], s38 offen offset:0 sc1
    v_exp_f32 v151, v151
    v_cvt_pk_bf16_f32 v228, v144, v145
    v_cvt_pk_bf16_f32 v229, v146, v147
    v_cvt_pk_bf16_f32 v230, v148, v149
    v_cvt_pk_bf16_f32 v231, v150, v151
    s_waitcnt lgkmcnt(0)
    v_mfma_f32_32x32x16_bf16 v[120:135], v[56:59], v[32:35], v[88:103]
    ds_read_b128 v[64:67], v28 offset:4096
    v_exp_f32 v152, v152
    v_exp_f32 v153, v153
    v_exp_f32 v154, v154
    v_exp_f32 v155, v155
    v_exp_f32 v156, v156
    v_mfma_f32_32x32x16_bf16 v[184:199], v[72:75], v[216:219], v[184:199]
    ds_read_b128 v[68:71], v28 offset:5120
    v_exp_f32 v157, v157
    v_exp_f32 v158, v158
    v_exp_f32 v159, v159
    v_cvt_pk_bf16_f32 v232, v152, v153
    v_cvt_pk_bf16_f32 v233, v154, v155
    v_mfma_f32_32x32x16_bf16 v[120:135], v[60:63], v[36:39], v[120:135]
    ds_read_b128 v[80:83], v30 offset:14336
    v_exp_f32 v160, v160
    v_exp_f32 v161, v161
    v_exp_f32 v162, v162
    v_exp_f32 v163, v163
    v_smfmac_f32_16x16x64_bf16 v[248:251], v[48:51], v[216:223], v31
    ds_read_b128 v[84:87], v30 offset:15360
    v_cvt_pk_bf16_f32 v234, v156, v157
    v_cvt_pk_bf16_f32 v235, v158, v159
    v_exp_f32 v164, v164
    v_exp_f32 v165, v165
    v_exp_f32 v166, v166
    v_mfma_f32_32x32x16_bf16 v[184:199], v[76:79], v[220:223], v[184:199]
    v_exp_f32 v167, v167
    v_cvt_pk_bf16_f32 v236, v160, v161
    v_cvt_pk_bf16_f32 v237, v162, v163
    v_cvt_pk_bf16_f32 v238, v164, v165
    v_cvt_pk_bf16_f32 v239, v166, v167
    v_mfma_f32_32x32x16_bf16 v[136:151], v[56:59], v[40:43], v[104:119]
    buffer_load_dwordx4 v24, s[12:15], s18 offen offset:1024 lds
    v_exp_f32 v168, v168
    v_exp_f32 v169, v169
    v_exp_f32 v170, v170
    v_exp_f32 v171, v171
    v_exp_f32 v172, v172
    v_mfma_f32_32x32x16_bf16 v[200:215], v[72:75], v[224:227], v[200:215]
    v_exp_f32 v173, v173
    v_exp_f32 v174, v174
    v_exp_f32 v175, v175
    v_cvt_pk_bf16_f32 v240, v168, v169
    v_cvt_pk_bf16_f32 v241, v170, v171
    v_mfma_f32_32x32x16_bf16 v[136:151], v[60:63], v[44:47], v[136:151]
    v_exp_f32 v176, v176
    v_exp_f32 v177, v177
    v_exp_f32 v178, v178
    v_exp_f32 v179, v179
    v_smfmac_f32_16x16x64_bf16 v[252:255], v[48:51], v[224:231], v31
    v_cvt_pk_bf16_f32 v242, v172, v173
    v_cvt_pk_bf16_f32 v243, v174, v175
    v_exp_f32 v180, v180
    v_exp_f32 v181, v181
    v_exp_f32 v182, v182
    v_mfma_f32_32x32x16_bf16 v[200:215], v[76:79], v[228:231], v[200:215]
    v_exp_f32 v183, v183
    v_cvt_pk_bf16_f32 v244, v176, v177
    v_cvt_pk_bf16_f32 v245, v178, v179
    v_cvt_pk_bf16_f32 v246, v180, v181
    v_cvt_pk_bf16_f32 v247, v182, v183
    s_waitcnt vmcnt(27) lgkmcnt(0)
    v_mfma_f32_32x32x16_bf16 v[152:167], v[64:67], v[32:35], v[88:103]
    ds_read_b128 v[56:59], v28 offset:8192
    v_exp_f32 v120, v120
    v_exp_f32 v121, v121
    v_exp_f32 v122, v122
    v_exp_f32 v123, v123
    v_exp_f32 v124, v124
    v_mfma_f32_32x32x16_bf16 v[184:199], v[80:83], v[232:235], v[184:199]
    ds_read_b128 v[60:63], v28 offset:9216
    v_exp_f32 v125, v125
    v_exp_f32 v126, v126
    v_exp_f32 v127, v127
    v_cvt_pk_bf16_f32 v216, v120, v121
    v_cvt_pk_bf16_f32 v217, v122, v123
    v_mfma_f32_32x32x16_bf16 v[152:167], v[68:71], v[36:39], v[152:167]
    ds_read_b128 v[72:75], v28 offset:2048
    v_exp_f32 v128, v128
    v_exp_f32 v129, v129
    v_exp_f32 v130, v130
    v_exp_f32 v131, v131
    v_smfmac_f32_16x16x64_bf16 v[248:251], v[48:51], v[232:239], v31
    ds_read_b128 v[76:79], v28 offset:3072
    v_cvt_pk_bf16_f32 v218, v124, v125
    v_cvt_pk_bf16_f32 v219, v126, v127
    v_exp_f32 v132, v132
    v_exp_f32 v133, v133
    v_exp_f32 v134, v134
    v_mfma_f32_32x32x16_bf16 v[184:199], v[84:87], v[236:239], v[184:199]
    v_exp_f32 v135, v135
    v_cvt_pk_bf16_f32 v220, v128, v129
    v_cvt_pk_bf16_f32 v221, v130, v131
    v_cvt_pk_bf16_f32 v222, v132, v133
    v_cvt_pk_bf16_f32 v223, v134, v135
    v_mfma_f32_32x32x16_bf16 v[168:183], v[64:67], v[40:43], v[104:119]
    buffer_load_dwordx4 v24, s[12:15], s18 offen offset:2048 lds
    v_exp_f32 v136, v136
    v_exp_f32 v137, v137
    v_exp_f32 v138, v138
    v_exp_f32 v139, v139
    v_exp_f32 v140, v140
    v_mfma_f32_32x32x16_bf16 v[200:215], v[80:83], v[240:243], v[200:215]
    v_mfma_f32_16x16x32_bf16 v[8:11], v[52:55], a[20:23], v[8:11]
    v_exp_f32 v141, v141
    v_exp_f32 v142, v142
    v_exp_f32 v143, v143
    v_cvt_pk_bf16_f32 v224, v136, v137
    v_cvt_pk_bf16_f32 v225, v138, v139
    v_mfma_f32_32x32x16_bf16 v[168:183], v[68:71], v[44:47], v[168:183]
    v_exp_f32 v144, v144
    v_exp_f32 v145, v145
    v_exp_f32 v146, v146
    v_exp_f32 v147, v147
    v_smfmac_f32_16x16x64_bf16 v[252:255], v[48:51], v[240:247], v31
    buffer_store_dwordx4 a[20:23], v14, s[92:95], s38 offen offset:256 sc1
    v_cvt_pk_bf16_f32 v226, v140, v141
    v_cvt_pk_bf16_f32 v227, v142, v143
    v_exp_f32 v148, v148
    v_exp_f32 v149, v149
    v_exp_f32 v150, v150
    v_mfma_f32_32x32x16_bf16 v[200:215], v[84:87], v[244:247], v[200:215]
    v_exp_f32 v151, v151
    v_cvt_pk_bf16_f32 v228, v144, v145
    v_cvt_pk_bf16_f32 v229, v146, v147
    v_cvt_pk_bf16_f32 v230, v148, v149
    v_cvt_pk_bf16_f32 v231, v150, v151
    s_waitcnt lgkmcnt(0)
    v_mfma_f32_32x32x16_bf16 v[120:135], v[56:59], v[32:35], v[88:103]
    ds_read_b128 v[64:67], v28 offset:12288
    v_exp_f32 v152, v152
    v_exp_f32 v153, v153
    v_exp_f32 v154, v154
    v_exp_f32 v155, v155
    v_exp_f32 v156, v156
    v_mfma_f32_32x32x16_bf16 v[184:199], v[72:75], v[216:219], v[184:199]
    ds_read_b128 v[68:71], v28 offset:13312
    v_exp_f32 v157, v157
    v_exp_f32 v158, v158
    v_exp_f32 v159, v159
    v_cvt_pk_bf16_f32 v232, v152, v153
    v_cvt_pk_bf16_f32 v233, v154, v155
    v_mfma_f32_32x32x16_bf16 v[120:135], v[60:63], v[36:39], v[120:135]
    ds_read_b128 v[80:83], v28 offset:6144
    v_exp_f32 v160, v160
    v_exp_f32 v161, v161
    v_exp_f32 v162, v162
    v_exp_f32 v163, v163
    v_smfmac_f32_16x16x64_bf16 v[248:251], v[48:51], v[216:223], v31
    ds_read_b128 v[84:87], v28 offset:7168
    v_cvt_pk_bf16_f32 v234, v156, v157
    v_cvt_pk_bf16_f32 v235, v158, v159
    v_exp_f32 v164, v164
    v_exp_f32 v165, v165
    v_exp_f32 v166, v166
    v_mfma_f32_32x32x16_bf16 v[184:199], v[76:79], v[220:223], v[184:199]
    buffer_load_dwordx4 v24, s[12:15], s18 offen offset:3072 lds
    v_exp_f32 v167, v167
    v_cvt_pk_bf16_f32 v236, v160, v161
    v_cvt_pk_bf16_f32 v237, v162, v163
    v_cvt_pk_bf16_f32 v238, v164, v165
    v_cvt_pk_bf16_f32 v239, v166, v167
    v_mfma_f32_32x32x16_bf16 v[136:151], v[56:59], v[40:43], v[104:119]
    buffer_load_dwordx4 a[40:43], v16, s[48:51], s42 offen nt
    s_add_u32 s42, s42, 57344
    v_exp_f32 v168, v168
    v_exp_f32 v169, v169
    v_exp_f32 v170, v170
    v_exp_f32 v171, v171
    v_exp_f32 v172, v172
    v_mfma_f32_32x32x16_bf16 v[200:215], v[72:75], v[224:227], v[200:215]
    v_exp_f32 v173, v173
    v_exp_f32 v174, v174
    v_exp_f32 v175, v175
    v_cvt_pk_bf16_f32 v240, v168, v169
    v_cvt_pk_bf16_f32 v241, v170, v171
    v_mfma_f32_32x32x16_bf16 v[136:151], v[60:63], v[44:47], v[136:151]
    v_exp_f32 v176, v176
    v_exp_f32 v177, v177
    v_exp_f32 v178, v178
    v_exp_f32 v179, v179
    v_smfmac_f32_16x16x64_bf16 v[252:255], v[48:51], v[224:231], v31
    buffer_load_dwordx2 a[138:139], v22, s[24:27], s23 offen offset:32
    v_cvt_pk_bf16_f32 v242, v172, v173
    v_cvt_pk_bf16_f32 v243, v174, v175
    v_exp_f32 v180, v180
    v_exp_f32 v181, v181
    v_exp_f32 v182, v182
    v_mfma_f32_32x32x16_bf16 v[200:215], v[76:79], v[228:231], v[200:215]
    v_exp_f32 v183, v183
    v_cvt_pk_bf16_f32 v244, v176, v177
    v_cvt_pk_bf16_f32 v245, v178, v179
    v_cvt_pk_bf16_f32 v246, v180, v181
    v_cvt_pk_bf16_f32 v247, v182, v183
    s_waitcnt lgkmcnt(0)
    v_mfma_f32_32x32x16_bf16 v[152:167], v[64:67], v[32:35], v[88:103]
    ds_read_b128 v[56:59], v28 offset:16384
    v_exp_f32 v120, v120
    v_exp_f32 v121, v121
    v_exp_f32 v122, v122
    v_exp_f32 v123, v123
    v_exp_f32 v124, v124
    v_mfma_f32_32x32x16_bf16 v[184:199], v[80:83], v[232:235], v[184:199]
    ds_read_b128 v[60:63], v28 offset:17408
    v_exp_f32 v125, v125
    v_exp_f32 v126, v126
    v_exp_f32 v127, v127
    v_cvt_pk_bf16_f32 v216, v120, v121
    v_cvt_pk_bf16_f32 v217, v122, v123
    v_mfma_f32_32x32x16_bf16 v[152:167], v[68:71], v[36:39], v[152:167]
    ds_read_b128 v[72:75], v28 offset:10240
    v_exp_f32 v128, v128
    v_exp_f32 v129, v129
    v_exp_f32 v130, v130
    v_exp_f32 v131, v131
    v_smfmac_f32_16x16x64_bf16 v[248:251], v[48:51], v[232:239], v31
    ds_read_b128 v[76:79], v28 offset:11264
    v_cvt_pk_bf16_f32 v218, v124, v125
    v_cvt_pk_bf16_f32 v219, v126, v127
    v_exp_f32 v132, v132
    v_exp_f32 v133, v133
    v_exp_f32 v134, v134
    v_mfma_f32_32x32x16_bf16 v[184:199], v[84:87], v[236:239], v[184:199]
    v_exp_f32 v135, v135
    v_cvt_pk_bf16_f32 v220, v128, v129
    v_cvt_pk_bf16_f32 v221, v130, v131
    v_cvt_pk_bf16_f32 v222, v132, v133
    v_cvt_pk_bf16_f32 v223, v134, v135
    v_mfma_f32_32x32x16_bf16 v[168:183], v[64:67], v[40:43], v[104:119]
    s_add_u32 m0, s19, 98304
    s_add_u32 s18, s17, 212992
    buffer_load_dwordx4 v24, s[12:15], s18 offen offset:0 lds
    v_exp_f32 v136, v136
    v_exp_f32 v137, v137
    v_exp_f32 v138, v138
    v_exp_f32 v139, v139
    v_exp_f32 v140, v140
    v_mfma_f32_32x32x16_bf16 v[200:215], v[80:83], v[240:243], v[200:215]
    v_exp_f32 v141, v141
    v_exp_f32 v142, v142
    v_exp_f32 v143, v143
    v_cvt_pk_bf16_f32 v224, v136, v137
    v_cvt_pk_bf16_f32 v225, v138, v139
    v_mfma_f32_32x32x16_bf16 v[168:183], v[68:71], v[44:47], v[168:183]
    v_exp_f32 v144, v144
    v_exp_f32 v145, v145
    v_exp_f32 v146, v146
    v_exp_f32 v147, v147
    v_smfmac_f32_16x16x64_bf16 v[252:255], v[48:51], v[240:247], v31
    v_cvt_pk_bf16_f32 v226, v140, v141
    v_cvt_pk_bf16_f32 v227, v142, v143
    v_exp_f32 v148, v148
    v_exp_f32 v149, v149
    v_exp_f32 v150, v150
    v_mfma_f32_32x32x16_bf16 v[200:215], v[84:87], v[244:247], v[200:215]
    v_exp_f32 v151, v151
    v_cvt_pk_bf16_f32 v228, v144, v145
    v_cvt_pk_bf16_f32 v229, v146, v147
    v_cvt_pk_bf16_f32 v230, v148, v149
    v_cvt_pk_bf16_f32 v231, v150, v151
    s_waitcnt vmcnt(26) lgkmcnt(0)
    v_mfma_f32_32x32x16_bf16 v[120:135], v[56:59], v[32:35], v[88:103]
    ds_read_b128 v[64:67], v28 offset:20480
    v_exp_f32 v152, v152
    v_exp_f32 v153, v153
    v_exp_f32 v154, v154
    v_exp_f32 v155, v155
    v_exp_f32 v156, v156
    v_mfma_f32_32x32x16_bf16 v[184:199], v[72:75], v[216:219], v[184:199]
    ds_read_b128 v[68:71], v28 offset:21504
    v_exp_f32 v157, v157
    v_exp_f32 v158, v158
    v_exp_f32 v159, v159
    v_cvt_pk_bf16_f32 v232, v152, v153
    v_cvt_pk_bf16_f32 v233, v154, v155
    v_mfma_f32_32x32x16_bf16 v[120:135], v[60:63], v[36:39], v[120:135]
    ds_read_b128 v[80:83], v28 offset:14336
    v_exp_f32 v160, v160
    v_exp_f32 v161, v161
    v_exp_f32 v162, v162
    v_exp_f32 v163, v163
    v_smfmac_f32_16x16x64_bf16 v[248:251], v[48:51], v[216:223], v31
    ds_read_b128 v[84:87], v28 offset:15360
    v_cvt_pk_bf16_f32 v234, v156, v157
    v_cvt_pk_bf16_f32 v235, v158, v159
    v_exp_f32 v164, v164
    v_exp_f32 v165, v165
    v_exp_f32 v166, v166
    v_mfma_f32_32x32x16_bf16 v[184:199], v[76:79], v[220:223], v[184:199]
    v_exp_f32 v167, v167
    v_cvt_pk_bf16_f32 v236, v160, v161
    v_cvt_pk_bf16_f32 v237, v162, v163
    v_cvt_pk_bf16_f32 v238, v164, v165
    v_cvt_pk_bf16_f32 v239, v166, v167
    v_mfma_f32_32x32x16_bf16 v[136:151], v[56:59], v[40:43], v[104:119]
    buffer_load_dwordx4 v24, s[12:15], s18 offen offset:1024 lds
    v_exp_f32 v168, v168
    v_exp_f32 v169, v169
    v_exp_f32 v170, v170
    v_exp_f32 v171, v171
    v_exp_f32 v172, v172
    v_mfma_f32_32x32x16_bf16 v[200:215], v[72:75], v[224:227], v[200:215]
    v_mfma_f32_16x16x32_bf16 v[8:11], v[52:55], a[24:27], v[8:11]
    v_exp_f32 v173, v173
    v_exp_f32 v174, v174
    v_exp_f32 v175, v175
    v_cvt_pk_bf16_f32 v240, v168, v169
    v_cvt_pk_bf16_f32 v241, v170, v171
    v_mfma_f32_32x32x16_bf16 v[136:151], v[60:63], v[44:47], v[136:151]
    v_exp_f32 v176, v176
    v_exp_f32 v177, v177
    v_exp_f32 v178, v178
    v_exp_f32 v179, v179
    v_smfmac_f32_16x16x64_bf16 v[252:255], v[48:51], v[224:231], v31
    buffer_store_dwordx4 a[24:27], v14, s[92:95], s38 offen offset:512 sc1
    v_cvt_pk_bf16_f32 v242, v172, v173
    v_cvt_pk_bf16_f32 v243, v174, v175
    v_exp_f32 v180, v180
    v_exp_f32 v181, v181
    v_exp_f32 v182, v182
    v_mfma_f32_32x32x16_bf16 v[200:215], v[76:79], v[228:231], v[200:215]
    v_exp_f32 v183, v183
    v_cvt_pk_bf16_f32 v244, v176, v177
    v_cvt_pk_bf16_f32 v245, v178, v179
    v_cvt_pk_bf16_f32 v246, v180, v181
    v_cvt_pk_bf16_f32 v247, v182, v183
    s_waitcnt lgkmcnt(0)
    v_mfma_f32_32x32x16_bf16 v[152:167], v[64:67], v[32:35], v[88:103]
    ds_read_b128 v[56:59], v28 offset:24576
    v_exp_f32 v120, v120
    v_exp_f32 v121, v121
    v_exp_f32 v122, v122
    v_exp_f32 v123, v123
    v_exp_f32 v124, v124
    v_mfma_f32_32x32x16_bf16 v[184:199], v[80:83], v[232:235], v[184:199]
    ds_read_b128 v[60:63], v28 offset:25600
    v_exp_f32 v125, v125
    v_exp_f32 v126, v126
    v_exp_f32 v127, v127
    v_cvt_pk_bf16_f32 v216, v120, v121
    v_cvt_pk_bf16_f32 v217, v122, v123
    v_mfma_f32_32x32x16_bf16 v[152:167], v[68:71], v[36:39], v[152:167]
    ds_read_b128 v[72:75], v28 offset:18432
    v_exp_f32 v128, v128
    v_exp_f32 v129, v129
    v_exp_f32 v130, v130
    v_exp_f32 v131, v131
    v_smfmac_f32_16x16x64_bf16 v[248:251], v[48:51], v[232:239], v31
    ds_read_b128 v[76:79], v28 offset:19456
    v_cvt_pk_bf16_f32 v218, v124, v125
    v_cvt_pk_bf16_f32 v219, v126, v127
    v_exp_f32 v132, v132
    v_exp_f32 v133, v133
    v_exp_f32 v134, v134
    v_mfma_f32_32x32x16_bf16 v[184:199], v[84:87], v[236:239], v[184:199]
    buffer_load_dwordx4 v24, s[12:15], s18 offen offset:2048 lds
    v_exp_f32 v135, v135
    v_cvt_pk_bf16_f32 v220, v128, v129
    v_cvt_pk_bf16_f32 v221, v130, v131
    v_cvt_pk_bf16_f32 v222, v132, v133
    v_cvt_pk_bf16_f32 v223, v134, v135
    v_mfma_f32_32x32x16_bf16 v[168:183], v[64:67], v[40:43], v[104:119]
    buffer_load_dwordx4 a[44:47], v16, s[48:51], s42 offen nt
    s_add_u32 s42, s42, 57344
    v_exp_f32 v136, v136
    v_exp_f32 v137, v137
    v_exp_f32 v138, v138
    v_exp_f32 v139, v139
    v_exp_f32 v140, v140
    v_mfma_f32_32x32x16_bf16 v[200:215], v[80:83], v[240:243], v[200:215]
    v_exp_f32 v141, v141
    v_exp_f32 v142, v142
    v_exp_f32 v143, v143
    v_cvt_pk_bf16_f32 v224, v136, v137
    v_cvt_pk_bf16_f32 v225, v138, v139
    v_mfma_f32_32x32x16_bf16 v[168:183], v[68:71], v[44:47], v[168:183]
    v_exp_f32 v144, v144
    v_exp_f32 v145, v145
    v_exp_f32 v146, v146
    v_exp_f32 v147, v147
    v_smfmac_f32_16x16x64_bf16 v[252:255], v[48:51], v[240:247], v31
    s_mov_b64 exec, 0x7f
    buffer_load_dword a253, v17, s[52:55], s21 offen
    s_mov_b64 exec, -1
    s_add_u32 s21, s21, 896
    v_cvt_pk_bf16_f32 v226, v140, v141
    v_cvt_pk_bf16_f32 v227, v142, v143
    v_exp_f32 v148, v148
    v_exp_f32 v149, v149
    v_exp_f32 v150, v150
    v_mfma_f32_32x32x16_bf16 v[200:215], v[84:87], v[244:247], v[200:215]
    buffer_load_dwordx2 a[140:141], v22, s[24:27], s23 offen offset:64
    v_exp_f32 v151, v151
    v_cvt_pk_bf16_f32 v228, v144, v145
    v_cvt_pk_bf16_f32 v229, v146, v147
    v_cvt_pk_bf16_f32 v230, v148, v149
    v_cvt_pk_bf16_f32 v231, v150, v151
    s_waitcnt lgkmcnt(0)
    v_mfma_f32_32x32x16_bf16 v[120:135], v[56:59], v[32:35], v[88:103]
    ds_read_b128 v[64:67], v28 offset:28672
    v_exp_f32 v152, v152
    v_exp_f32 v153, v153
    v_exp_f32 v154, v154
    v_exp_f32 v155, v155
    v_exp_f32 v156, v156
    v_mfma_f32_32x32x16_bf16 v[184:199], v[72:75], v[216:219], v[184:199]
    ds_read_b128 v[68:71], v28 offset:29696
    v_exp_f32 v157, v157
    v_exp_f32 v158, v158
    v_exp_f32 v159, v159
    v_cvt_pk_bf16_f32 v232, v152, v153
    v_cvt_pk_bf16_f32 v233, v154, v155
    v_mfma_f32_32x32x16_bf16 v[120:135], v[60:63], v[36:39], v[120:135]
    ds_read_b128 v[80:83], v28 offset:22528
    v_exp_f32 v160, v160
    v_exp_f32 v161, v161
    v_exp_f32 v162, v162
    v_exp_f32 v163, v163
    v_smfmac_f32_16x16x64_bf16 v[248:251], v[48:51], v[216:223], v31
    ds_read_b128 v[84:87], v28 offset:23552
    v_cvt_pk_bf16_f32 v234, v156, v157
    v_cvt_pk_bf16_f32 v235, v158, v159
    v_exp_f32 v164, v164
    v_exp_f32 v165, v165
    v_exp_f32 v166, v166
    v_mfma_f32_32x32x16_bf16 v[184:199], v[76:79], v[220:223], v[184:199]
    v_exp_f32 v167, v167
    v_cvt_pk_bf16_f32 v236, v160, v161
    v_cvt_pk_bf16_f32 v237, v162, v163
    v_cvt_pk_bf16_f32 v238, v164, v165
    v_cvt_pk_bf16_f32 v239, v166, v167
    v_mfma_f32_32x32x16_bf16 v[136:151], v[56:59], v[40:43], v[104:119]
    buffer_load_dwordx4 v24, s[12:15], s18 offen offset:3072 lds
    v_exp_f32 v168, v168
    v_exp_f32 v169, v169
    v_exp_f32 v170, v170
    v_exp_f32 v171, v171
    v_exp_f32 v172, v172
    v_mfma_f32_32x32x16_bf16 v[200:215], v[72:75], v[224:227], v[200:215]
    v_exp_f32 v173, v173
    v_exp_f32 v174, v174
    v_exp_f32 v175, v175
    v_cvt_pk_bf16_f32 v240, v168, v169
    v_cvt_pk_bf16_f32 v241, v170, v171
    v_mfma_f32_32x32x16_bf16 v[136:151], v[60:63], v[44:47], v[136:151]
    v_exp_f32 v176, v176
    v_exp_f32 v177, v177
    v_exp_f32 v178, v178
    v_exp_f32 v179, v179
    v_smfmac_f32_16x16x64_bf16 v[252:255], v[48:51], v[224:231], v31
    v_cvt_pk_bf16_f32 v242, v172, v173
    v_cvt_pk_bf16_f32 v243, v174, v175
    v_exp_f32 v180, v180
    v_exp_f32 v181, v181
    v_exp_f32 v182, v182
    v_mfma_f32_32x32x16_bf16 v[200:215], v[76:79], v[228:231], v[200:215]
    v_exp_f32 v183, v183
    v_cvt_pk_bf16_f32 v244, v176, v177
    v_cvt_pk_bf16_f32 v245, v178, v179
    v_cvt_pk_bf16_f32 v246, v180, v181
    v_cvt_pk_bf16_f32 v247, v182, v183
    s_waitcnt vmcnt(19) lgkmcnt(0)
    s_barrier
    s_waitcnt vmcnt(26)
    v_mfma_f32_32x32x16_bf16 v[152:167], v[64:67], v[32:35], v[88:103]
    ds_read_b128 v[56:59], v28 offset:32768
    v_exp_f32 v120, v120
    v_exp_f32 v121, v121
    v_exp_f32 v122, v122
    v_exp_f32 v123, v123
    v_exp_f32 v124, v124
    v_mfma_f32_32x32x16_bf16 v[184:199], v[80:83], v[232:235], v[184:199]
    ds_read_b128 v[60:63], v28 offset:33792
    v_exp_f32 v125, v125
    v_exp_f32 v126, v126
    v_exp_f32 v127, v127
    v_cvt_pk_bf16_f32 v216, v120, v121
    v_cvt_pk_bf16_f32 v217, v122, v123
    v_mfma_f32_32x32x16_bf16 v[152:167], v[68:71], v[36:39], v[152:167]
    ds_read_b128 v[72:75], v28 offset:26624
    v_exp_f32 v128, v128
    v_exp_f32 v129, v129
    v_exp_f32 v130, v130
    v_exp_f32 v131, v131
    v_smfmac_f32_16x16x64_bf16 v[248:251], v[48:51], v[232:239], v31
    ds_read_b128 v[76:79], v28 offset:27648
    v_cvt_pk_bf16_f32 v218, v124, v125
    v_cvt_pk_bf16_f32 v219, v126, v127
    v_exp_f32 v132, v132
    v_exp_f32 v133, v133
    v_exp_f32 v134, v134
    v_mfma_f32_32x32x16_bf16 v[184:199], v[84:87], v[236:239], v[184:199]
    v_exp_f32 v135, v135
    v_cvt_pk_bf16_f32 v220, v128, v129
    v_cvt_pk_bf16_f32 v221, v130, v131
    v_cvt_pk_bf16_f32 v222, v132, v133
    v_cvt_pk_bf16_f32 v223, v134, v135
    v_mfma_f32_32x32x16_bf16 v[168:183], v[64:67], v[40:43], v[104:119]
    s_add_u32 m0, s19, 114688
    s_add_u32 s18, s17, 229376
    buffer_load_dwordx4 v24, s[12:15], s18 offen offset:0 lds
    v_exp_f32 v136, v136
    v_exp_f32 v137, v137
    v_exp_f32 v138, v138
    v_exp_f32 v139, v139
    v_exp_f32 v140, v140
    v_mfma_f32_32x32x16_bf16 v[200:215], v[80:83], v[240:243], v[200:215]
    v_mfma_f32_16x16x32_bf16 v[8:11], v[52:55], a[28:31], v[8:11]
    v_exp_f32 v141, v141
    v_exp_f32 v142, v142
    v_exp_f32 v143, v143
    v_cvt_pk_bf16_f32 v224, v136, v137
    v_cvt_pk_bf16_f32 v225, v138, v139
    v_mfma_f32_32x32x16_bf16 v[168:183], v[68:71], v[44:47], v[168:183]
    v_exp_f32 v144, v144
    v_exp_f32 v145, v145
    v_exp_f32 v146, v146
    v_exp_f32 v147, v147
    v_smfmac_f32_16x16x64_bf16 v[252:255], v[48:51], v[240:247], v31
    buffer_store_dwordx4 a[28:31], v14, s[92:95], s38 offen offset:768 sc1
    s_add_u32 s38, s38, 14336
    v_cvt_pk_bf16_f32 v226, v140, v141
    v_cvt_pk_bf16_f32 v227, v142, v143
    v_exp_f32 v148, v148
    v_exp_f32 v149, v149
    v_exp_f32 v150, v150
    v_mfma_f32_32x32x16_bf16 v[200:215], v[84:87], v[244:247], v[200:215]
    v_exp_f32 v151, v151
    v_cvt_pk_bf16_f32 v228, v144, v145
    v_cvt_pk_bf16_f32 v229, v146, v147
    v_cvt_pk_bf16_f32 v230, v148, v149
    v_cvt_pk_bf16_f32 v231, v150, v151
    s_waitcnt lgkmcnt(0)
    v_mfma_f32_32x32x16_bf16 v[120:135], v[56:59], v[32:35], v[88:103]
    ds_read_b128 v[64:67], v28 offset:36864
    v_exp_f32 v152, v152
    v_exp_f32 v153, v153
    v_exp_f32 v154, v154
    v_exp_f32 v155, v155
    v_exp_f32 v156, v156
    v_mfma_f32_32x32x16_bf16 v[184:199], v[72:75], v[216:219], v[184:199]
    ds_read_b128 v[68:71], v28 offset:37888
    v_exp_f32 v157, v157
    v_exp_f32 v158, v158
    v_exp_f32 v159, v159
    v_cvt_pk_bf16_f32 v232, v152, v153
    v_cvt_pk_bf16_f32 v233, v154, v155
    v_mfma_f32_32x32x16_bf16 v[120:135], v[60:63], v[36:39], v[120:135]
    ds_read_b128 v[80:83], v28 offset:30720
    v_exp_f32 v160, v160
    v_exp_f32 v161, v161
    v_exp_f32 v162, v162
    v_exp_f32 v163, v163
    v_smfmac_f32_16x16x64_bf16 v[248:251], v[48:51], v[216:223], v31
    ds_read_b128 v[84:87], v28 offset:31744
    v_cvt_pk_bf16_f32 v234, v156, v157
    v_cvt_pk_bf16_f32 v235, v158, v159
    v_exp_f32 v164, v164
    v_exp_f32 v165, v165
    v_exp_f32 v166, v166
    v_mfma_f32_32x32x16_bf16 v[184:199], v[76:79], v[220:223], v[184:199]
    buffer_load_dwordx4 v24, s[12:15], s18 offen offset:1024 lds
    v_exp_f32 v167, v167
    v_cvt_pk_bf16_f32 v236, v160, v161
    v_cvt_pk_bf16_f32 v237, v162, v163
    v_cvt_pk_bf16_f32 v238, v164, v165
    v_cvt_pk_bf16_f32 v239, v166, v167
    v_mfma_f32_32x32x16_bf16 v[136:151], v[56:59], v[40:43], v[104:119]
    buffer_load_dwordx4 a[48:51], v16, s[48:51], s42 offen nt
    s_add_u32 s42, s42, 57344
    v_exp_f32 v168, v168
    v_exp_f32 v169, v169
    v_exp_f32 v170, v170
    v_exp_f32 v171, v171
    v_exp_f32 v172, v172
    v_mfma_f32_32x32x16_bf16 v[200:215], v[72:75], v[224:227], v[200:215]
    v_exp_f32 v173, v173
    v_exp_f32 v174, v174
    v_exp_f32 v175, v175
    v_cvt_pk_bf16_f32 v240, v168, v169
    v_cvt_pk_bf16_f32 v241, v170, v171
    v_mfma_f32_32x32x16_bf16 v[136:151], v[60:63], v[44:47], v[136:151]
    v_exp_f32 v176, v176
    v_exp_f32 v177, v177
    v_exp_f32 v178, v178
    v_exp_f32 v179, v179
    v_smfmac_f32_16x16x64_bf16 v[252:255], v[48:51], v[224:231], v31
    buffer_load_dwordx2 a[142:143], v22, s[24:27], s23 offen offset:96
    v_cvt_pk_bf16_f32 v242, v172, v173
    v_cvt_pk_bf16_f32 v243, v174, v175
    v_exp_f32 v180, v180
    v_exp_f32 v181, v181
    v_exp_f32 v182, v182
    v_mfma_f32_32x32x16_bf16 v[200:215], v[76:79], v[228:231], v[200:215]
    v_exp_f32 v183, v183
    v_cvt_pk_bf16_f32 v244, v176, v177
    v_cvt_pk_bf16_f32 v245, v178, v179
    v_cvt_pk_bf16_f32 v246, v180, v181
    v_cvt_pk_bf16_f32 v247, v182, v183
    s_waitcnt lgkmcnt(0)
    v_mfma_f32_32x32x16_bf16 v[152:167], v[64:67], v[32:35], v[88:103]
    ds_read_b128 v[56:59], v28 offset:40960
    v_exp_f32 v120, v120
    v_exp_f32 v121, v121
    v_exp_f32 v122, v122
    v_exp_f32 v123, v123
    v_exp_f32 v124, v124
    v_mfma_f32_32x32x16_bf16 v[184:199], v[80:83], v[232:235], v[184:199]
    ds_read_b128 v[60:63], v28 offset:41984
    v_exp_f32 v125, v125
    v_exp_f32 v126, v126
    v_exp_f32 v127, v127
    v_cvt_pk_bf16_f32 v216, v120, v121
    v_cvt_pk_bf16_f32 v217, v122, v123
    v_mfma_f32_32x32x16_bf16 v[152:167], v[68:71], v[36:39], v[152:167]
    ds_read_b128 v[72:75], v28 offset:34816
    v_exp_f32 v128, v128
    v_exp_f32 v129, v129
    v_exp_f32 v130, v130
    v_exp_f32 v131, v131
    v_smfmac_f32_16x16x64_bf16 v[248:251], v[48:51], v[232:239], v31
    ds_read_b128 v[76:79], v28 offset:35840
    v_cvt_pk_bf16_f32 v218, v124, v125
    v_cvt_pk_bf16_f32 v219, v126, v127
    v_exp_f32 v132, v132
    v_exp_f32 v133, v133
    v_exp_f32 v134, v134
    v_mfma_f32_32x32x16_bf16 v[184:199], v[84:87], v[236:239], v[184:199]
    v_exp_f32 v135, v135
    v_cvt_pk_bf16_f32 v220, v128, v129
    v_cvt_pk_bf16_f32 v221, v130, v131
    v_cvt_pk_bf16_f32 v222, v132, v133
    v_cvt_pk_bf16_f32 v223, v134, v135
    v_mfma_f32_32x32x16_bf16 v[168:183], v[64:67], v[40:43], v[104:119]
    buffer_load_dwordx4 v24, s[12:15], s18 offen offset:2048 lds
    v_exp_f32 v136, v136
    v_exp_f32 v137, v137
    v_exp_f32 v138, v138
    v_exp_f32 v139, v139
    v_exp_f32 v140, v140
    v_mfma_f32_32x32x16_bf16 v[200:215], v[80:83], v[240:243], v[200:215]
    v_exp_f32 v141, v141
    v_exp_f32 v142, v142
    v_exp_f32 v143, v143
    v_cvt_pk_bf16_f32 v224, v136, v137
    v_cvt_pk_bf16_f32 v225, v138, v139
    v_mfma_f32_32x32x16_bf16 v[168:183], v[68:71], v[44:47], v[168:183]
    v_exp_f32 v144, v144
    v_exp_f32 v145, v145
    v_exp_f32 v146, v146
    v_exp_f32 v147, v147
    v_smfmac_f32_16x16x64_bf16 v[252:255], v[48:51], v[240:247], v31
    v_cvt_pk_bf16_f32 v226, v140, v141
    v_cvt_pk_bf16_f32 v227, v142, v143
    v_exp_f32 v148, v148
    v_exp_f32 v149, v149
    v_exp_f32 v150, v150
    v_mfma_f32_32x32x16_bf16 v[200:215], v[84:87], v[244:247], v[200:215]
    v_exp_f32 v151, v151
    v_cvt_pk_bf16_f32 v228, v144, v145
    v_cvt_pk_bf16_f32 v229, v146, v147
    v_cvt_pk_bf16_f32 v230, v148, v149
    v_cvt_pk_bf16_f32 v231, v150, v151
    s_waitcnt vmcnt(26) lgkmcnt(0)
    v_mfma_f32_32x32x16_bf16 v[120:135], v[56:59], v[32:35], v[88:103]
    ds_read_b128 v[64:67], v28 offset:45056
    v_exp_f32 v152, v152
    v_exp_f32 v153, v153
    v_exp_f32 v154, v154
    v_exp_f32 v155, v155
    v_exp_f32 v156, v156
    v_mfma_f32_32x32x16_bf16 v[184:199], v[72:75], v[216:219], v[184:199]
    ds_read_b128 v[68:71], v28 offset:46080
    v_exp_f32 v157, v157
    v_exp_f32 v158, v158
    v_exp_f32 v159, v159
    v_cvt_pk_bf16_f32 v232, v152, v153
    v_cvt_pk_bf16_f32 v233, v154, v155
    v_mfma_f32_32x32x16_bf16 v[120:135], v[60:63], v[36:39], v[120:135]
    ds_read_b128 v[80:83], v28 offset:38912
    v_exp_f32 v160, v160
    v_exp_f32 v161, v161
    v_exp_f32 v162, v162
    v_exp_f32 v163, v163
    v_smfmac_f32_16x16x64_bf16 v[248:251], v[48:51], v[216:223], v31
    ds_read_b128 v[84:87], v28 offset:39936
    v_cvt_pk_bf16_f32 v234, v156, v157
    v_cvt_pk_bf16_f32 v235, v158, v159
    v_exp_f32 v164, v164
    v_exp_f32 v165, v165
    v_exp_f32 v166, v166
    v_mfma_f32_32x32x16_bf16 v[184:199], v[76:79], v[220:223], v[184:199]
    buffer_load_dwordx4 v24, s[12:15], s18 offen offset:3072 lds
    v_exp_f32 v167, v167
    v_cvt_pk_bf16_f32 v236, v160, v161
    v_cvt_pk_bf16_f32 v237, v162, v163
    v_cvt_pk_bf16_f32 v238, v164, v165
    v_cvt_pk_bf16_f32 v239, v166, v167
    v_mfma_f32_32x32x16_bf16 v[136:151], v[56:59], v[40:43], v[104:119]
    buffer_load_dwordx4 a[52:55], v16, s[48:51], s42 offen nt
    s_add_u32 s42, s42, 57344
    v_exp_f32 v168, v168
    v_exp_f32 v169, v169
    v_exp_f32 v170, v170
    v_exp_f32 v171, v171
    v_exp_f32 v172, v172
    v_mfma_f32_32x32x16_bf16 v[200:215], v[72:75], v[224:227], v[200:215]
    v_mfma_f32_16x16x32_bf16 v[8:11], v[52:55], a[32:35], v[8:11]
    v_exp_f32 v173, v173
    v_exp_f32 v174, v174
    v_exp_f32 v175, v175
    v_cvt_pk_bf16_f32 v240, v168, v169
    v_cvt_pk_bf16_f32 v241, v170, v171
    v_mfma_f32_32x32x16_bf16 v[136:151], v[60:63], v[44:47], v[136:151]
    v_exp_f32 v176, v176
    v_exp_f32 v177, v177
    v_exp_f32 v178, v178
    v_exp_f32 v179, v179
    v_smfmac_f32_16x16x64_bf16 v[252:255], v[48:51], v[224:231], v31
    buffer_store_dwordx4 a[32:35], v14, s[92:95], s38 offen offset:0 sc1
    v_cvt_pk_bf16_f32 v242, v172, v173
    v_cvt_pk_bf16_f32 v243, v174, v175
    v_exp_f32 v180, v180
    v_exp_f32 v181, v181
    v_exp_f32 v182, v182
    v_mfma_f32_32x32x16_bf16 v[200:215], v[76:79], v[228:231], v[200:215]
    v_exp_f32 v183, v183
    v_cvt_pk_bf16_f32 v244, v176, v177
    v_cvt_pk_bf16_f32 v245, v178, v179
    v_cvt_pk_bf16_f32 v246, v180, v181
    v_cvt_pk_bf16_f32 v247, v182, v183
    s_waitcnt lgkmcnt(0)
    v_mfma_f32_32x32x16_bf16 v[152:167], v[64:67], v[32:35], v[88:103]
    ds_read_b128 v[56:59], v28 offset:49152
    v_exp_f32 v120, v120
    v_exp_f32 v121, v121
    v_exp_f32 v122, v122
    v_exp_f32 v123, v123
    v_exp_f32 v124, v124
    v_mfma_f32_32x32x16_bf16 v[184:199], v[80:83], v[232:235], v[184:199]
    ds_read_b128 v[60:63], v28 offset:50176
    v_exp_f32 v125, v125
    v_exp_f32 v126, v126
    v_exp_f32 v127, v127
    v_cvt_pk_bf16_f32 v216, v120, v121
    v_cvt_pk_bf16_f32 v217, v122, v123
    v_mfma_f32_32x32x16_bf16 v[152:167], v[68:71], v[36:39], v[152:167]
    ds_read_b128 v[72:75], v28 offset:43008
    v_exp_f32 v128, v128
    v_exp_f32 v129, v129
    v_exp_f32 v130, v130
    v_exp_f32 v131, v131
    v_smfmac_f32_16x16x64_bf16 v[248:251], v[48:51], v[232:239], v31
    ds_read_b128 v[76:79], v28 offset:44032
    v_cvt_pk_bf16_f32 v218, v124, v125
    v_cvt_pk_bf16_f32 v219, v126, v127
    v_exp_f32 v132, v132
    v_exp_f32 v133, v133
    v_exp_f32 v134, v134
    v_mfma_f32_32x32x16_bf16 v[184:199], v[84:87], v[236:239], v[184:199]
    s_add_u32 m0, s19, 131072
    s_add_u32 s18, s17, 245760
    buffer_load_dwordx4 v24, s[12:15], s18 offen offset:0 lds
    v_exp_f32 v135, v135
    v_cvt_pk_bf16_f32 v220, v128, v129
    v_cvt_pk_bf16_f32 v221, v130, v131
    v_cvt_pk_bf16_f32 v222, v132, v133
    v_cvt_pk_bf16_f32 v223, v134, v135
    v_mfma_f32_32x32x16_bf16 v[168:183], v[64:67], v[40:43], v[104:119]
    s_mov_b64 exec, 0x7f
    buffer_load_dword a253, v17, s[52:55], s21 offen
    s_mov_b64 exec, -1
    s_add_u32 s21, s21, 896
    v_exp_f32 v136, v136
    v_exp_f32 v137, v137
    v_exp_f32 v138, v138
    v_exp_f32 v139, v139
    v_exp_f32 v140, v140
    v_mfma_f32_32x32x16_bf16 v[200:215], v[80:83], v[240:243], v[200:215]
    v_exp_f32 v141, v141
    v_exp_f32 v142, v142
    v_exp_f32 v143, v143
    v_cvt_pk_bf16_f32 v224, v136, v137
    v_cvt_pk_bf16_f32 v225, v138, v139
    v_mfma_f32_32x32x16_bf16 v[168:183], v[68:71], v[44:47], v[168:183]
    v_exp_f32 v144, v144
    v_exp_f32 v145, v145
    v_exp_f32 v146, v146
    v_exp_f32 v147, v147
    v_smfmac_f32_16x16x64_bf16 v[252:255], v[48:51], v[240:247], v31
    s_getpc_b64 s[96:97]
    s_and_b32 s96, s96, 0xffffff80
    s_mov_b32 s98, 0xe76c
    s_mov_b32 s99, 0x20000
    s_lshl_b32 s100, s29, 2
    s_add_u32 s100, s100, s3
    s_lshl_b32 s100, s100, 8
    v_lshlrev_b32 v23, 7, v1
    s_mov_b64 exec, 3
    buffer_load_dword a255, v23, s[96:99], s100 offen
    s_mov_b64 exec, -1
    v_cvt_pk_bf16_f32 v226, v140, v141
    v_cvt_pk_bf16_f32 v227, v142, v143
    v_exp_f32 v148, v148
    v_exp_f32 v149, v149
    v_exp_f32 v150, v150
    v_mfma_f32_32x32x16_bf16 v[200:215], v[84:87], v[244:247], v[200:215]
    v_exp_f32 v151, v151
    v_cvt_pk_bf16_f32 v228, v144, v145
    v_cvt_pk_bf16_f32 v229, v146, v147
    v_cvt_pk_bf16_f32 v230, v148, v149
    v_cvt_pk_bf16_f32 v231, v150, v151
    s_waitcnt vmcnt(29) lgkmcnt(0)
    v_mfma_f32_32x32x16_bf16 v[120:135], v[56:59], v[32:35], v[88:103]
    ds_read_b128 v[64:67], v28 offset:53248
    v_exp_f32 v152, v152
    v_exp_f32 v153, v153
    v_exp_f32 v154, v154
    v_exp_f32 v155, v155
    v_exp_f32 v156, v156
    v_mfma_f32_32x32x16_bf16 v[184:199], v[72:75], v[216:219], v[184:199]
    ds_read_b128 v[68:71], v28 offset:54272
    v_exp_f32 v157, v157
    v_exp_f32 v158, v158
    v_exp_f32 v159, v159
    v_cvt_pk_bf16_f32 v232, v152, v153
    v_cvt_pk_bf16_f32 v233, v154, v155
    v_mfma_f32_32x32x16_bf16 v[120:135], v[60:63], v[36:39], v[120:135]
    ds_read_b128 v[80:83], v28 offset:47104
    v_exp_f32 v160, v160
    v_exp_f32 v161, v161
    v_exp_f32 v162, v162
    v_exp_f32 v163, v163
    v_smfmac_f32_16x16x64_bf16 v[248:251], v[48:51], v[216:223], v31
    ds_read_b128 v[84:87], v28 offset:48128
    v_cvt_pk_bf16_f32 v234, v156, v157
    v_cvt_pk_bf16_f32 v235, v158, v159
    v_exp_f32 v164, v164
    v_exp_f32 v165, v165
    v_exp_f32 v166, v166
    v_mfma_f32_32x32x16_bf16 v[184:199], v[76:79], v[220:223], v[184:199]
    v_exp_f32 v167, v167
    v_cvt_pk_bf16_f32 v236, v160, v161
    v_cvt_pk_bf16_f32 v237, v162, v163
    v_cvt_pk_bf16_f32 v238, v164, v165
    v_cvt_pk_bf16_f32 v239, v166, v167
    v_mfma_f32_32x32x16_bf16 v[136:151], v[56:59], v[40:43], v[104:119]
    buffer_load_dwordx4 v24, s[12:15], s18 offen offset:1024 lds
    v_exp_f32 v168, v168
    v_exp_f32 v169, v169
    v_exp_f32 v170, v170
    v_exp_f32 v171, v171
    v_exp_f32 v172, v172
    v_mfma_f32_32x32x16_bf16 v[200:215], v[72:75], v[224:227], v[200:215]
    v_mfma_f32_16x16x32_bf16 v[8:11], v[52:55], a[36:39], v[8:11]
    v_exp_f32 v173, v173
    v_exp_f32 v174, v174
    v_exp_f32 v175, v175
    v_cvt_pk_bf16_f32 v240, v168, v169
    v_cvt_pk_bf16_f32 v241, v170, v171
    v_mfma_f32_32x32x16_bf16 v[136:151], v[60:63], v[44:47], v[136:151]
    v_exp_f32 v176, v176
    v_exp_f32 v177, v177
    v_exp_f32 v178, v178
    v_exp_f32 v179, v179
    v_smfmac_f32_16x16x64_bf16 v[252:255], v[48:51], v[224:231], v31
    buffer_store_dwordx4 a[36:39], v14, s[92:95], s38 offen offset:256 sc1
    v_cvt_pk_bf16_f32 v242, v172, v173
    v_cvt_pk_bf16_f32 v243, v174, v175
    v_exp_f32 v180, v180
    v_exp_f32 v181, v181
    v_exp_f32 v182, v182
    v_mfma_f32_32x32x16_bf16 v[200:215], v[76:79], v[228:231], v[200:215]
    v_exp_f32 v183, v183
    v_cvt_pk_bf16_f32 v244, v176, v177
    v_cvt_pk_bf16_f32 v245, v178, v179
    v_cvt_pk_bf16_f32 v246, v180, v181
    v_cvt_pk_bf16_f32 v247, v182, v183
    s_waitcnt lgkmcnt(0)
    v_mfma_f32_32x32x16_bf16 v[152:167], v[64:67], v[32:35], v[88:103]
    ds_read_b128 v[56:59], v28 offset:57344
    v_exp_f32 v120, v120
    v_exp_f32 v121, v121
    v_exp_f32 v122, v122
    v_exp_f32 v123, v123
    v_exp_f32 v124, v124
    v_mfma_f32_32x32x16_bf16 v[184:199], v[80:83], v[232:235], v[184:199]
    ds_read_b128 v[60:63], v28 offset:58368
    v_exp_f32 v125, v125
    v_exp_f32 v126, v126
    v_exp_f32 v127, v127
    v_cvt_pk_bf16_f32 v216, v120, v121
    v_cvt_pk_bf16_f32 v217, v122, v123
    v_mfma_f32_32x32x16_bf16 v[152:167], v[68:71], v[36:39], v[152:167]
    ds_read_b128 v[72:75], v28 offset:51200
    v_exp_f32 v128, v128
    v_exp_f32 v129, v129
    v_exp_f32 v130, v130
    v_exp_f32 v131, v131
    v_smfmac_f32_16x16x64_bf16 v[248:251], v[48:51], v[232:239], v31
    ds_read_b128 v[76:79], v28 offset:52224
    v_cvt_pk_bf16_f32 v218, v124, v125
    v_cvt_pk_bf16_f32 v219, v126, v127
    v_exp_f32 v132, v132
    v_exp_f32 v133, v133
    v_exp_f32 v134, v134
    v_mfma_f32_32x32x16_bf16 v[184:199], v[84:87], v[236:239], v[184:199]
    v_exp_f32 v135, v135
    v_cvt_pk_bf16_f32 v220, v128, v129
    v_cvt_pk_bf16_f32 v221, v130, v131
    v_cvt_pk_bf16_f32 v222, v132, v133
    v_cvt_pk_bf16_f32 v223, v134, v135
    v_mfma_f32_32x32x16_bf16 v[168:183], v[64:67], v[40:43], v[104:119]
    buffer_load_dwordx4 v24, s[12:15], s18 offen offset:2048 lds
    v_exp_f32 v136, v136
    v_exp_f32 v137, v137
    v_exp_f32 v138, v138
    v_exp_f32 v139, v139
    v_exp_f32 v140, v140
    v_mfma_f32_32x32x16_bf16 v[200:215], v[80:83], v[240:243], v[200:215]
    v_exp_f32 v141, v141
    v_exp_f32 v142, v142
    v_exp_f32 v143, v143
    v_cvt_pk_bf16_f32 v224, v136, v137
    v_cvt_pk_bf16_f32 v225, v138, v139
    v_mfma_f32_32x32x16_bf16 v[168:183], v[68:71], v[44:47], v[168:183]
    v_exp_f32 v144, v144
    v_exp_f32 v145, v145
    v_exp_f32 v146, v146
    v_exp_f32 v147, v147
    v_smfmac_f32_16x16x64_bf16 v[252:255], v[48:51], v[240:247], v31
    buffer_load_dwordx4 a[56:59], v16, s[48:51], s42 offen nt
    s_add_u32 s42, s42, 57344
    v_cvt_pk_bf16_f32 v226, v140, v141
    v_cvt_pk_bf16_f32 v227, v142, v143
    v_exp_f32 v148, v148
    v_exp_f32 v149, v149
    v_exp_f32 v150, v150
    v_mfma_f32_32x32x16_bf16 v[200:215], v[84:87], v[244:247], v[200:215]
    v_exp_f32 v151, v151
    v_cvt_pk_bf16_f32 v228, v144, v145
    v_cvt_pk_bf16_f32 v229, v146, v147
    v_cvt_pk_bf16_f32 v230, v148, v149
    v_cvt_pk_bf16_f32 v231, v150, v151
    s_waitcnt lgkmcnt(0)
    v_mfma_f32_32x32x16_bf16 v[120:135], v[56:59], v[32:35], v[88:103]
    ds_read_b128 v[64:67], v28 offset:61440
    v_exp_f32 v152, v152
    v_exp_f32 v153, v153
    v_exp_f32 v154, v154
    v_exp_f32 v155, v155
    v_exp_f32 v156, v156
    v_mfma_f32_32x32x16_bf16 v[184:199], v[72:75], v[216:219], v[184:199]
    ds_read_b128 v[68:71], v28 offset:62464
    v_exp_f32 v157, v157
    v_exp_f32 v158, v158
    v_exp_f32 v159, v159
    v_cvt_pk_bf16_f32 v232, v152, v153
    v_cvt_pk_bf16_f32 v233, v154, v155
    v_mfma_f32_32x32x16_bf16 v[120:135], v[60:63], v[36:39], v[120:135]
    ds_read_b128 v[80:83], v28 offset:55296
    v_exp_f32 v160, v160
    v_exp_f32 v161, v161
    v_exp_f32 v162, v162
    v_exp_f32 v163, v163
    v_smfmac_f32_16x16x64_bf16 v[248:251], v[48:51], v[216:223], v31
    ds_read_b128 v[84:87], v28 offset:56320
    v_cvt_pk_bf16_f32 v234, v156, v157
    v_cvt_pk_bf16_f32 v235, v158, v159
    v_exp_f32 v164, v164
    v_exp_f32 v165, v165
    v_exp_f32 v166, v166
    v_mfma_f32_32x32x16_bf16 v[184:199], v[76:79], v[220:223], v[184:199]
    v_exp_f32 v167, v167
    v_cvt_pk_bf16_f32 v236, v160, v161
    v_cvt_pk_bf16_f32 v237, v162, v163
    v_cvt_pk_bf16_f32 v238, v164, v165
    v_cvt_pk_bf16_f32 v239, v166, v167
    v_mfma_f32_32x32x16_bf16 v[136:151], v[56:59], v[40:43], v[104:119]
    buffer_load_dwordx4 v24, s[12:15], s18 offen offset:3072 lds
    v_exp_f32 v168, v168
    v_exp_f32 v169, v169
    v_exp_f32 v170, v170
    v_exp_f32 v171, v171
    v_exp_f32 v172, v172
    v_mfma_f32_32x32x16_bf16 v[200:215], v[72:75], v[224:227], v[200:215]
    v_exp_f32 v173, v173
    v_exp_f32 v174, v174
    v_exp_f32 v175, v175
    v_cvt_pk_bf16_f32 v240, v168, v169
    v_cvt_pk_bf16_f32 v241, v170, v171
    v_mfma_f32_32x32x16_bf16 v[136:151], v[60:63], v[44:47], v[136:151]
    v_exp_f32 v176, v176
    v_exp_f32 v177, v177
    v_exp_f32 v178, v178
    v_exp_f32 v179, v179
    v_smfmac_f32_16x16x64_bf16 v[252:255], v[48:51], v[224:231], v31
    v_cvt_pk_bf16_f32 v242, v172, v173
    v_cvt_pk_bf16_f32 v243, v174, v175
    v_exp_f32 v180, v180
    v_exp_f32 v181, v181
    v_exp_f32 v182, v182
    v_mfma_f32_32x32x16_bf16 v[200:215], v[76:79], v[228:231], v[200:215]
    v_exp_f32 v183, v183
    v_cvt_pk_bf16_f32 v244, v176, v177
    v_cvt_pk_bf16_f32 v245, v178, v179
    v_cvt_pk_bf16_f32 v246, v180, v181
    v_cvt_pk_bf16_f32 v247, v182, v183
    s_waitcnt vmcnt(26) lgkmcnt(0)
    v_mfma_f32_32x32x16_bf16 v[152:167], v[64:67], v[32:35], v[88:103]
    ds_read_b128 v[56:59], v29 offset:0
    v_exp_f32 v120, v120
    v_exp_f32 v121, v121
    v_exp_f32 v122, v122
    v_exp_f32 v123, v123
    v_exp_f32 v124, v124
    v_mfma_f32_32x32x16_bf16 v[184:199], v[80:83], v[232:235], v[184:199]
    ds_read_b128 v[60:63], v29 offset:1024
    v_exp_f32 v125, v125
    v_exp_f32 v126, v126
    v_exp_f32 v127, v127
    v_cvt_pk_bf16_f32 v216, v120, v121
    v_cvt_pk_bf16_f32 v217, v122, v123
    v_mfma_f32_32x32x16_bf16 v[152:167], v[68:71], v[36:39], v[152:167]
    ds_read_b128 v[72:75], v28 offset:59392
    v_exp_f32 v128, v128
    v_exp_f32 v129, v129
    v_exp_f32 v130, v130
    v_exp_f32 v131, v131
    v_smfmac_f32_16x16x64_bf16 v[248:251], v[48:51], v[232:239], v31
    ds_read_b128 v[76:79], v28 offset:60416
    v_cvt_pk_bf16_f32 v218, v124, v125
    v_cvt_pk_bf16_f32 v219, v126, v127
    v_exp_f32 v132, v132
    v_exp_f32 v133, v133
    v_exp_f32 v134, v134
    v_mfma_f32_32x32x16_bf16 v[184:199], v[84:87], v[236:239], v[184:199]
    v_exp_f32 v135, v135
    v_cvt_pk_bf16_f32 v220, v128, v129
    v_cvt_pk_bf16_f32 v221, v130, v131
    v_cvt_pk_bf16_f32 v222, v132, v133
    v_cvt_pk_bf16_f32 v223, v134, v135
    v_mfma_f32_32x32x16_bf16 v[168:183], v[64:67], v[40:43], v[104:119]
    buffer_store_dwordx4 a[40:43], v14, s[92:95], s38 offen offset:512 sc1
    v_exp_f32 v136, v136
    v_exp_f32 v137, v137
    v_exp_f32 v138, v138
    v_exp_f32 v139, v139
    v_exp_f32 v140, v140
    v_mfma_f32_32x32x16_bf16 v[200:215], v[80:83], v[240:243], v[200:215]
    v_mfma_f32_16x16x32_bf16 v[8:11], v[52:55], a[40:43], v[8:11]
    v_exp_f32 v141, v141
    v_exp_f32 v142, v142
    v_exp_f32 v143, v143
    v_cvt_pk_bf16_f32 v224, v136, v137
    v_cvt_pk_bf16_f32 v225, v138, v139
    v_mfma_f32_32x32x16_bf16 v[168:183], v[68:71], v[44:47], v[168:183]
    v_exp_f32 v144, v144
    v_exp_f32 v145, v145
    v_exp_f32 v146, v146
    v_exp_f32 v147, v147
    v_smfmac_f32_16x16x64_bf16 v[252:255], v[48:51], v[240:247], v31
    v_cvt_pk_bf16_f32 v226, v140, v141
    v_cvt_pk_bf16_f32 v227, v142, v143
    v_exp_f32 v148, v148
    v_exp_f32 v149, v149
    v_exp_f32 v150, v150
    v_mfma_f32_32x32x16_bf16 v[200:215], v[84:87], v[244:247], v[200:215]
    v_exp_f32 v151, v151
    v_cvt_pk_bf16_f32 v228, v144, v145
    v_cvt_pk_bf16_f32 v229, v146, v147
    v_cvt_pk_bf16_f32 v230, v148, v149
    v_cvt_pk_bf16_f32 v231, v150, v151
    s_waitcnt lgkmcnt(0)
    v_mfma_f32_32x32x16_bf16 v[120:135], v[56:59], v[32:35], v[88:103]
    ds_read_b128 v[64:67], v29 offset:4096
    v_exp_f32 v152, v152
    v_exp_f32 v153, v153
    v_exp_f32 v154, v154
    v_exp_f32 v155, v155
    v_exp_f32 v156, v156
    v_mfma_f32_32x32x16_bf16 v[184:199], v[72:75], v[216:219], v[184:199]
    ds_read_b128 v[68:71], v29 offset:5120
    v_exp_f32 v157, v157
    v_exp_f32 v158, v158
    v_exp_f32 v159, v159
    v_cvt_pk_bf16_f32 v232, v152, v153
    v_cvt_pk_bf16_f32 v233, v154, v155
    v_mfma_f32_32x32x16_bf16 v[120:135], v[60:63], v[36:39], v[120:135]
    ds_read_b128 v[80:83], v28 offset:63488
    v_exp_f32 v160, v160
    v_exp_f32 v161, v161
    v_exp_f32 v162, v162
    v_exp_f32 v163, v163
    v_smfmac_f32_16x16x64_bf16 v[248:251], v[48:51], v[216:223], v31
    ds_read_b128 v[84:87], v28 offset:64512
    v_cvt_pk_bf16_f32 v234, v156, v157
    v_cvt_pk_bf16_f32 v235, v158, v159
    v_exp_f32 v164, v164
    v_exp_f32 v165, v165
    v_exp_f32 v166, v166
    v_mfma_f32_32x32x16_bf16 v[184:199], v[76:79], v[220:223], v[184:199]
    v_exp_f32 v167, v167
    v_cvt_pk_bf16_f32 v236, v160, v161
    v_cvt_pk_bf16_f32 v237, v162, v163
    v_cvt_pk_bf16_f32 v238, v164, v165
    v_cvt_pk_bf16_f32 v239, v166, v167
    v_mfma_f32_32x32x16_bf16 v[136:151], v[56:59], v[40:43], v[104:119]
    buffer_load_dwordx4 a[60:63], v16, s[48:51], s42 offen nt
    s_add_u32 s42, s42, 57344
    v_exp_f32 v168, v168
    v_exp_f32 v169, v169
    v_exp_f32 v170, v170
    v_exp_f32 v171, v171
    v_exp_f32 v172, v172
    v_mfma_f32_32x32x16_bf16 v[200:215], v[72:75], v[224:227], v[200:215]
    v_exp_f32 v173, v173
    v_exp_f32 v174, v174
    v_exp_f32 v175, v175
    v_cvt_pk_bf16_f32 v240, v168, v169
    v_cvt_pk_bf16_f32 v241, v170, v171
    v_mfma_f32_32x32x16_bf16 v[136:151], v[60:63], v[44:47], v[136:151]
    v_exp_f32 v176, v176
    v_exp_f32 v177, v177
    v_exp_f32 v178, v178
    v_exp_f32 v179, v179
    v_smfmac_f32_16x16x64_bf16 v[252:255], v[48:51], v[224:231], v31
    v_cvt_pk_bf16_f32 v242, v172, v173
    v_cvt_pk_bf16_f32 v243, v174, v175
    v_exp_f32 v180, v180
    v_exp_f32 v181, v181
    v_exp_f32 v182, v182
    v_mfma_f32_32x32x16_bf16 v[200:215], v[76:79], v[228:231], v[200:215]
    v_exp_f32 v183, v183
    v_cvt_pk_bf16_f32 v244, v176, v177
    v_cvt_pk_bf16_f32 v245, v178, v179
    v_cvt_pk_bf16_f32 v246, v180, v181
    v_cvt_pk_bf16_f32 v247, v182, v183
    s_waitcnt lgkmcnt(0)
    v_mfma_f32_32x32x16_bf16 v[152:167], v[64:67], v[32:35], v[88:103]
    ds_read_b128 v[56:59], v29 offset:8192
    v_exp_f32 v120, v120
    v_exp_f32 v121, v121
    v_exp_f32 v122, v122
    v_exp_f32 v123, v123
    v_exp_f32 v124, v124
    v_mfma_f32_32x32x16_bf16 v[184:199], v[80:83], v[232:235], v[184:199]
    ds_read_b128 v[60:63], v29 offset:9216
    v_exp_f32 v125, v125
    v_exp_f32 v126, v126
    v_exp_f32 v127, v127
    v_cvt_pk_bf16_f32 v216, v120, v121
    v_cvt_pk_bf16_f32 v217, v122, v123
    v_mfma_f32_32x32x16_bf16 v[152:167], v[68:71], v[36:39], v[152:167]
    ds_read_b128 v[72:75], v29 offset:2048
    v_exp_f32 v128, v128
    v_exp_f32 v129, v129
    v_exp_f32 v130, v130
    v_exp_f32 v131, v131
    v_smfmac_f32_16x16x64_bf16 v[248:251], v[48:51], v[232:239], v31
    ds_read_b128 v[76:79], v29 offset:3072
    v_cvt_pk_bf16_f32 v218, v124, v125
    v_cvt_pk_bf16_f32 v219, v126, v127
    v_exp_f32 v132, v132
    v_exp_f32 v133, v133
    v_exp_f32 v134, v134
    v_mfma_f32_32x32x16_bf16 v[184:199], v[84:87], v[236:239], v[184:199]
    v_exp_f32 v135, v135
    v_cvt_pk_bf16_f32 v220, v128, v129
    v_cvt_pk_bf16_f32 v221, v130, v131
    v_cvt_pk_bf16_f32 v222, v132, v133
    v_cvt_pk_bf16_f32 v223, v134, v135
    v_mfma_f32_32x32x16_bf16 v[168:183], v[64:67], v[40:43], v[104:119]
    s_mov_b64 exec, 0x7f
    buffer_load_dword a253, v17, s[52:55], s21 offen
    s_mov_b64 exec, -1
    s_add_u32 s21, s21, 896
    v_exp_f32 v136, v136
    v_exp_f32 v137, v137
    v_exp_f32 v138, v138
    v_exp_f32 v139, v139
    v_exp_f32 v140, v140
    v_mfma_f32_32x32x16_bf16 v[200:215], v[80:83], v[240:243], v[200:215]
    v_exp_f32 v141, v141
    v_exp_f32 v142, v142
    v_exp_f32 v143, v143
    v_cvt_pk_bf16_f32 v224, v136, v137
    v_cvt_pk_bf16_f32 v225, v138, v139
    v_mfma_f32_32x32x16_bf16 v[168:183], v[68:71], v[44:47], v[168:183]
    v_exp_f32 v144, v144
    v_exp_f32 v145, v145
    v_exp_f32 v146, v146
    v_exp_f32 v147, v147
    v_smfmac_f32_16x16x64_bf16 v[252:255], v[48:51], v[240:247], v31
    v_cvt_pk_bf16_f32 v226, v140, v141
    v_cvt_pk_bf16_f32 v227, v142, v143
    v_exp_f32 v148, v148
    v_exp_f32 v149, v149
    v_exp_f32 v150, v150
    v_mfma_f32_32x32x16_bf16 v[200:215], v[84:87], v[244:247], v[200:215]
    v_exp_f32 v151, v151
    v_cvt_pk_bf16_f32 v228, v144, v145
    v_cvt_pk_bf16_f32 v229, v146, v147
    v_cvt_pk_bf16_f32 v230, v148, v149
    v_cvt_pk_bf16_f32 v231, v150, v151
    s_waitcnt vmcnt(23) lgkmcnt(0)
    v_mfma_f32_32x32x16_bf16 v[120:135], v[56:59], v[32:35], v[88:103]
    ds_read_b128 v[64:67], v29 offset:12288
    v_exp_f32 v152, v152
    v_exp_f32 v153, v153
    v_exp_f32 v154, v154
    v_exp_f32 v155, v155
    v_exp_f32 v156, v156
    v_mfma_f32_32x32x16_bf16 v[184:199], v[72:75], v[216:219], v[184:199]
    ds_read_b128 v[68:71], v29 offset:13312
    v_exp_f32 v157, v157
    v_exp_f32 v158, v158
    v_exp_f32 v159, v159
    v_cvt_pk_bf16_f32 v232, v152, v153
    v_cvt_pk_bf16_f32 v233, v154, v155
    v_mfma_f32_32x32x16_bf16 v[120:135], v[60:63], v[36:39], v[120:135]
    ds_read_b128 v[80:83], v29 offset:6144
    v_exp_f32 v160, v160
    v_exp_f32 v161, v161
    v_exp_f32 v162, v162
    v_exp_f32 v163, v163
    v_smfmac_f32_16x16x64_bf16 v[248:251], v[48:51], v[216:223], v31
    ds_read_b128 v[84:87], v29 offset:7168
    v_cvt_pk_bf16_f32 v234, v156, v157
    v_cvt_pk_bf16_f32 v235, v158, v159
    v_exp_f32 v164, v164
    v_exp_f32 v165, v165
    v_exp_f32 v166, v166
    v_mfma_f32_32x32x16_bf16 v[184:199], v[76:79], v[220:223], v[184:199]
    v_exp_f32 v167, v167
    v_cvt_pk_bf16_f32 v236, v160, v161
    v_cvt_pk_bf16_f32 v237, v162, v163
    v_cvt_pk_bf16_f32 v238, v164, v165
    v_cvt_pk_bf16_f32 v239, v166, v167
    v_mfma_f32_32x32x16_bf16 v[136:151], v[56:59], v[40:43], v[104:119]
    buffer_store_dwordx4 a[44:47], v14, s[92:95], s38 offen offset:768 sc1
    s_add_u32 s38, s38, 14336
    v_exp_f32 v168, v168
    v_exp_f32 v169, v169
    v_exp_f32 v170, v170
    v_exp_f32 v171, v171
    v_exp_f32 v172, v172
    v_mfma_f32_32x32x16_bf16 v[200:215], v[72:75], v[224:227], v[200:215]
    v_mfma_f32_16x16x32_bf16 v[8:11], v[52:55], a[44:47], v[8:11]
    v_exp_f32 v173, v173
    v_exp_f32 v174, v174
    v_exp_f32 v175, v175
    v_cvt_pk_bf16_f32 v240, v168, v169
    v_cvt_pk_bf16_f32 v241, v170, v171
    v_mfma_f32_32x32x16_bf16 v[136:151], v[60:63], v[44:47], v[136:151]
    v_exp_f32 v176, v176
    v_exp_f32 v177, v177
    v_exp_f32 v178, v178
    v_exp_f32 v179, v179
    v_smfmac_f32_16x16x64_bf16 v[252:255], v[48:51], v[224:231], v31
    v_cvt_pk_bf16_f32 v242, v172, v173
    v_cvt_pk_bf16_f32 v243, v174, v175
    v_exp_f32 v180, v180
    v_exp_f32 v181, v181
    v_exp_f32 v182, v182
    v_mfma_f32_32x32x16_bf16 v[200:215], v[76:79], v[228:231], v[200:215]
    v_exp_f32 v183, v183
    v_cvt_pk_bf16_f32 v244, v176, v177
    v_cvt_pk_bf16_f32 v245, v178, v179
    v_cvt_pk_bf16_f32 v246, v180, v181
    v_cvt_pk_bf16_f32 v247, v182, v183
    s_waitcnt vmcnt(4) lgkmcnt(0)
    s_barrier
    v_mfma_f32_32x32x16_bf16 v[152:167], v[64:67], v[32:35], v[88:103]
    ds_read_b128 v[56:59], v29 offset:16384
    v_exp_f32 v120, v120
    v_exp_f32 v121, v121
    v_exp_f32 v122, v122
    v_exp_f32 v123, v123
    v_exp_f32 v124, v124
    v_mfma_f32_32x32x16_bf16 v[184:199], v[80:83], v[232:235], v[184:199]
    ds_read_b128 v[60:63], v29 offset:17408
    v_exp_f32 v125, v125
    v_exp_f32 v126, v126
    v_exp_f32 v127, v127
    v_cvt_pk_bf16_f32 v216, v120, v121
    v_cvt_pk_bf16_f32 v217, v122, v123
    v_mfma_f32_32x32x16_bf16 v[152:167], v[68:71], v[36:39], v[152:167]
    ds_read_b128 v[72:75], v29 offset:10240
    v_exp_f32 v128, v128
    v_exp_f32 v129, v129
    v_exp_f32 v130, v130
    v_exp_f32 v131, v131
    v_smfmac_f32_16x16x64_bf16 v[248:251], v[48:51], v[232:239], v31
    ds_read_b128 v[76:79], v29 offset:11264
    v_cvt_pk_bf16_f32 v218, v124, v125
    v_cvt_pk_bf16_f32 v219, v126, v127
    v_exp_f32 v132, v132
    v_exp_f32 v133, v133
    v_exp_f32 v134, v134
    v_mfma_f32_32x32x16_bf16 v[184:199], v[84:87], v[236:239], v[184:199]
    v_exp_f32 v135, v135
    v_cvt_pk_bf16_f32 v220, v128, v129
    v_cvt_pk_bf16_f32 v221, v130, v131
    v_cvt_pk_bf16_f32 v222, v132, v133
    v_cvt_pk_bf16_f32 v223, v134, v135
    v_mfma_f32_32x32x16_bf16 v[168:183], v[64:67], v[40:43], v[104:119]
    v_exp_f32 v136, v136
    v_exp_f32 v137, v137
    v_exp_f32 v138, v138
    v_exp_f32 v139, v139
    v_exp_f32 v140, v140
    v_mfma_f32_32x32x16_bf16 v[200:215], v[80:83], v[240:243], v[200:215]
    v_exp_f32 v141, v141
    v_exp_f32 v142, v142
    v_exp_f32 v143, v143
    v_cvt_pk_bf16_f32 v224, v136, v137
    v_cvt_pk_bf16_f32 v225, v138, v139
    v_mfma_f32_32x32x16_bf16 v[168:183], v[68:71], v[44:47], v[168:183]
    v_exp_f32 v144, v144
    v_exp_f32 v145, v145
    v_exp_f32 v146, v146
    v_exp_f32 v147, v147
    v_smfmac_f32_16x16x64_bf16 v[252:255], v[48:51], v[240:247], v31
    v_cvt_pk_bf16_f32 v226, v140, v141
    v_cvt_pk_bf16_f32 v227, v142, v143
    v_exp_f32 v148, v148
    v_exp_f32 v149, v149
    v_exp_f32 v150, v150
    v_mfma_f32_32x32x16_bf16 v[200:215], v[84:87], v[244:247], v[200:215]
    v_exp_f32 v151, v151
    v_cvt_pk_bf16_f32 v228, v144, v145
    v_cvt_pk_bf16_f32 v229, v146, v147
    v_cvt_pk_bf16_f32 v230, v148, v149
    v_cvt_pk_bf16_f32 v231, v150, v151
    s_waitcnt lgkmcnt(0)
    v_mfma_f32_32x32x16_bf16 v[120:135], v[56:59], v[32:35], v[88:103]
    ds_read_b128 v[64:67], v29 offset:20480
    v_exp_f32 v152, v152
    v_exp_f32 v153, v153
    v_exp_f32 v154, v154
    v_exp_f32 v155, v155
    v_exp_f32 v156, v156
    v_mfma_f32_32x32x16_bf16 v[184:199], v[72:75], v[216:219], v[184:199]
    ds_read_b128 v[68:71], v29 offset:21504
    v_exp_f32 v157, v157
    v_exp_f32 v158, v158
    v_exp_f32 v159, v159
    v_cvt_pk_bf16_f32 v232, v152, v153
    v_cvt_pk_bf16_f32 v233, v154, v155
    v_mfma_f32_32x32x16_bf16 v[120:135], v[60:63], v[36:39], v[120:135]
    ds_read_b128 v[80:83], v29 offset:14336
    v_exp_f32 v160, v160
    v_exp_f32 v161, v161
    v_exp_f32 v162, v162
    v_exp_f32 v163, v163
    v_smfmac_f32_16x16x64_bf16 v[248:251], v[48:51], v[216:223], v31
    ds_read_b128 v[84:87], v29 offset:15360
    v_cvt_pk_bf16_f32 v234, v156, v157
    v_cvt_pk_bf16_f32 v235, v158, v159
    v_exp_f32 v164, v164
    v_exp_f32 v165, v165
    v_exp_f32 v166, v166
    v_mfma_f32_32x32x16_bf16 v[184:199], v[76:79], v[220:223], v[184:199]
    v_exp_f32 v167, v167
    v_cvt_pk_bf16_f32 v236, v160, v161
    v_cvt_pk_bf16_f32 v237, v162, v163
    v_cvt_pk_bf16_f32 v238, v164, v165
    v_cvt_pk_bf16_f32 v239, v166, v167
    v_mfma_f32_32x32x16_bf16 v[136:151], v[56:59], v[40:43], v[104:119]
    v_exp_f32 v168, v168
    v_exp_f32 v169, v169
    v_exp_f32 v170, v170
    v_exp_f32 v171, v171
    v_exp_f32 v172, v172
    v_mfma_f32_32x32x16_bf16 v[200:215], v[72:75], v[224:227], v[200:215]
    v_exp_f32 v173, v173
    v_exp_f32 v174, v174
    v_exp_f32 v175, v175
    v_cvt_pk_bf16_f32 v240, v168, v169
    v_cvt_pk_bf16_f32 v241, v170, v171
    v_mfma_f32_32x32x16_bf16 v[136:151], v[60:63], v[44:47], v[136:151]
    v_exp_f32 v176, v176
    v_exp_f32 v177, v177
    v_exp_f32 v178, v178
    v_exp_f32 v179, v179
    v_smfmac_f32_16x16x64_bf16 v[252:255], v[48:51], v[224:231], v31
    v_cvt_pk_bf16_f32 v242, v172, v173
    v_cvt_pk_bf16_f32 v243, v174, v175
    v_exp_f32 v180, v180
    v_exp_f32 v181, v181
    v_exp_f32 v182, v182
    v_mfma_f32_32x32x16_bf16 v[200:215], v[76:79], v[228:231], v[200:215]
    v_exp_f32 v183, v183
    v_cvt_pk_bf16_f32 v244, v176, v177
    v_cvt_pk_bf16_f32 v245, v178, v179
    v_cvt_pk_bf16_f32 v246, v180, v181
    v_cvt_pk_bf16_f32 v247, v182, v183
    s_waitcnt vmcnt(17) lgkmcnt(0)
    v_mfma_f32_32x32x16_bf16 v[152:167], v[64:67], v[32:35], v[88:103]
    ds_read_b128 v[56:59], v29 offset:24576
    v_exp_f32 v120, v120
    v_exp_f32 v121, v121
    v_exp_f32 v122, v122
    v_exp_f32 v123, v123
    v_exp_f32 v124, v124
    v_mfma_f32_32x32x16_bf16 v[184:199], v[80:83], v[232:235], v[184:199]
    ds_read_b128 v[60:63], v29 offset:25600
    v_exp_f32 v125, v125
    v_exp_f32 v126, v126
    v_exp_f32 v127, v127
    v_cvt_pk_bf16_f32 v216, v120, v121
    v_cvt_pk_bf16_f32 v217, v122, v123
    v_mfma_f32_32x32x16_bf16 v[152:167], v[68:71], v[36:39], v[152:167]
    ds_read_b128 v[72:75], v29 offset:18432
    v_exp_f32 v128, v128
    v_exp_f32 v129, v129
    v_exp_f32 v130, v130
    v_exp_f32 v131, v131
    v_smfmac_f32_16x16x64_bf16 v[248:251], v[48:51], v[232:239], v31
    ds_read_b128 v[76:79], v29 offset:19456
    v_cvt_pk_bf16_f32 v218, v124, v125
    v_cvt_pk_bf16_f32 v219, v126, v127
    v_exp_f32 v132, v132
    v_exp_f32 v133, v133
    v_exp_f32 v134, v134
    v_mfma_f32_32x32x16_bf16 v[184:199], v[84:87], v[236:239], v[184:199]
    v_exp_f32 v135, v135
    v_cvt_pk_bf16_f32 v220, v128, v129
    v_cvt_pk_bf16_f32 v221, v130, v131
    v_cvt_pk_bf16_f32 v222, v132, v133
    v_cvt_pk_bf16_f32 v223, v134, v135
    v_mfma_f32_32x32x16_bf16 v[168:183], v[64:67], v[40:43], v[104:119]
    buffer_store_dwordx4 a[48:51], v14, s[92:95], s38 offen offset:0 sc1
    v_exp_f32 v136, v136
    v_exp_f32 v137, v137
    v_exp_f32 v138, v138
    v_exp_f32 v139, v139
    v_exp_f32 v140, v140
    v_mfma_f32_32x32x16_bf16 v[200:215], v[80:83], v[240:243], v[200:215]
    v_mfma_f32_16x16x32_bf16 v[8:11], v[52:55], a[48:51], v[8:11]
    v_exp_f32 v141, v141
    v_exp_f32 v142, v142
    v_exp_f32 v143, v143
    v_cvt_pk_bf16_f32 v224, v136, v137
    v_cvt_pk_bf16_f32 v225, v138, v139
    v_mfma_f32_32x32x16_bf16 v[168:183], v[68:71], v[44:47], v[168:183]
    v_exp_f32 v144, v144
    v_exp_f32 v145, v145
    v_exp_f32 v146, v146
    v_exp_f32 v147, v147
    v_smfmac_f32_16x16x64_bf16 v[252:255], v[48:51], v[240:247], v31
    v_cvt_pk_bf16_f32 v226, v140, v141
    v_cvt_pk_bf16_f32 v227, v142, v143
    v_exp_f32 v148, v148
    v_exp_f32 v149, v149
    v_exp_f32 v150, v150
    v_mfma_f32_32x32x16_bf16 v[200:215], v[84:87], v[244:247], v[200:215]
    v_exp_f32 v151, v151
    v_cvt_pk_bf16_f32 v228, v144, v145
    v_cvt_pk_bf16_f32 v229, v146, v147
    v_cvt_pk_bf16_f32 v230, v148, v149
    v_cvt_pk_bf16_f32 v231, v150, v151
    s_waitcnt lgkmcnt(0)
    v_mfma_f32_32x32x16_bf16 v[120:135], v[56:59], v[32:35], v[88:103]
    ds_read_b128 v[64:67], v29 offset:28672
    v_exp_f32 v152, v152
    v_exp_f32 v153, v153
    v_exp_f32 v154, v154
    v_exp_f32 v155, v155
    v_exp_f32 v156, v156
    v_mfma_f32_32x32x16_bf16 v[184:199], v[72:75], v[216:219], v[184:199]
    ds_read_b128 v[68:71], v29 offset:29696
    v_exp_f32 v157, v157
    v_exp_f32 v158, v158
    v_exp_f32 v159, v159
    v_cvt_pk_bf16_f32 v232, v152, v153
    v_cvt_pk_bf16_f32 v233, v154, v155
    v_mfma_f32_32x32x16_bf16 v[120:135], v[60:63], v[36:39], v[120:135]
    ds_read_b128 v[80:83], v29 offset:22528
    v_exp_f32 v160, v160
    v_exp_f32 v161, v161
    v_exp_f32 v162, v162
    v_exp_f32 v163, v163
    v_smfmac_f32_16x16x64_bf16 v[248:251], v[48:51], v[216:223], v31
    ds_read_b128 v[84:87], v29 offset:23552
    v_cvt_pk_bf16_f32 v234, v156, v157
    v_cvt_pk_bf16_f32 v235, v158, v159
    v_exp_f32 v164, v164
    v_exp_f32 v165, v165
    v_exp_f32 v166, v166
    v_mfma_f32_32x32x16_bf16 v[184:199], v[76:79], v[220:223], v[184:199]
    v_exp_f32 v167, v167
    v_cvt_pk_bf16_f32 v236, v160, v161
    v_cvt_pk_bf16_f32 v237, v162, v163
    v_cvt_pk_bf16_f32 v238, v164, v165
    v_cvt_pk_bf16_f32 v239, v166, v167
    v_mfma_f32_32x32x16_bf16 v[136:151], v[56:59], v[40:43], v[104:119]
    v_exp_f32 v168, v168
    v_exp_f32 v169, v169
    v_exp_f32 v170, v170
    v_exp_f32 v171, v171
    v_exp_f32 v172, v172
    v_mfma_f32_32x32x16_bf16 v[200:215], v[72:75], v[224:227], v[200:215]
    v_exp_f32 v173, v173
    v_exp_f32 v174, v174
    v_exp_f32 v175, v175
    v_cvt_pk_bf16_f32 v240, v168, v169
    v_cvt_pk_bf16_f32 v241, v170, v171
    v_mfma_f32_32x32x16_bf16 v[136:151], v[60:63], v[44:47], v[136:151]
    v_exp_f32 v176, v176
    v_exp_f32 v177, v177
    v_exp_f32 v178, v178
    v_exp_f32 v179, v179
    v_smfmac_f32_16x16x64_bf16 v[252:255], v[48:51], v[224:231], v31
    v_cvt_pk_bf16_f32 v242, v172, v173
    v_cvt_pk_bf16_f32 v243, v174, v175
    v_exp_f32 v180, v180
    v_exp_f32 v181, v181
    v_exp_f32 v182, v182
    v_mfma_f32_32x32x16_bf16 v[200:215], v[76:79], v[228:231], v[200:215]
    v_exp_f32 v183, v183
    v_cvt_pk_bf16_f32 v244, v176, v177
    v_cvt_pk_bf16_f32 v245, v178, v179
    v_cvt_pk_bf16_f32 v246, v180, v181
    v_cvt_pk_bf16_f32 v247, v182, v183
    s_waitcnt vmcnt(14) lgkmcnt(0)
    v_mfma_f32_32x32x16_bf16 v[152:167], v[64:67], v[32:35], v[88:103]
    ds_read_b128 v[56:59], v29 offset:32768
    v_exp_f32 v120, v120
    v_exp_f32 v121, v121
    v_exp_f32 v122, v122
    v_exp_f32 v123, v123
    v_exp_f32 v124, v124
    v_mfma_f32_32x32x16_bf16 v[184:199], v[80:83], v[232:235], v[184:199]
    ds_read_b128 v[60:63], v29 offset:33792
    v_exp_f32 v125, v125
    v_exp_f32 v126, v126
    v_exp_f32 v127, v127
    v_cvt_pk_bf16_f32 v216, v120, v121
    v_cvt_pk_bf16_f32 v217, v122, v123
    v_mfma_f32_32x32x16_bf16 v[152:167], v[68:71], v[36:39], v[152:167]
    ds_read_b128 v[72:75], v29 offset:26624
    v_exp_f32 v128, v128
    v_exp_f32 v129, v129
    v_exp_f32 v130, v130
    v_exp_f32 v131, v131
    v_smfmac_f32_16x16x64_bf16 v[248:251], v[48:51], v[232:239], v31
    ds_read_b128 v[76:79], v29 offset:27648
    v_cvt_pk_bf16_f32 v218, v124, v125
    v_cvt_pk_bf16_f32 v219, v126, v127
    v_exp_f32 v132, v132
    v_exp_f32 v133, v133
    v_exp_f32 v134, v134
    v_mfma_f32_32x32x16_bf16 v[184:199], v[84:87], v[236:239], v[184:199]
    v_exp_f32 v135, v135
    v_cvt_pk_bf16_f32 v220, v128, v129
    v_cvt_pk_bf16_f32 v221, v130, v131
    v_cvt_pk_bf16_f32 v222, v132, v133
    v_cvt_pk_bf16_f32 v223, v134, v135
    v_mfma_f32_32x32x16_bf16 v[168:183], v[64:67], v[40:43], v[104:119]
    s_mov_b64 exec, 0x7f
    buffer_load_dword a253, v17, s[52:55], s21 offen
    s_mov_b64 exec, -1
    s_add_u32 s21, s21, 896
    v_exp_f32 v136, v136
    v_exp_f32 v137, v137
    v_exp_f32 v138, v138
    v_exp_f32 v139, v139
    v_exp_f32 v140, v140
    v_mfma_f32_32x32x16_bf16 v[200:215], v[80:83], v[240:243], v[200:215]
    v_mfma_f32_16x16x32_bf16 v[8:11], v[52:55], a[52:55], v[8:11]
    v_exp_f32 v141, v141
    v_exp_f32 v142, v142
    v_exp_f32 v143, v143
    v_cvt_pk_bf16_f32 v224, v136, v137
    v_cvt_pk_bf16_f32 v225, v138, v139
    v_mfma_f32_32x32x16_bf16 v[168:183], v[68:71], v[44:47], v[168:183]
    v_exp_f32 v144, v144
    v_exp_f32 v145, v145
    v_exp_f32 v146, v146
    v_exp_f32 v147, v147
    v_smfmac_f32_16x16x64_bf16 v[252:255], v[48:51], v[240:247], v31
    buffer_store_dwordx4 a[52:55], v14, s[92:95], s38 offen offset:256 sc1
    v_cvt_pk_bf16_f32 v226, v140, v141
    v_cvt_pk_bf16_f32 v227, v142, v143
    v_exp_f32 v148, v148
    v_exp_f32 v149, v149
    v_exp_f32 v150, v150
    v_mfma_f32_32x32x16_bf16 v[200:215], v[84:87], v[244:247], v[200:215]
    v_exp_f32 v151, v151
    v_cvt_pk_bf16_f32 v228, v144, v145
    v_cvt_pk_bf16_f32 v229, v146, v147
    v_cvt_pk_bf16_f32 v230, v148, v149
    v_cvt_pk_bf16_f32 v231, v150, v151
    s_waitcnt lgkmcnt(0)
    v_mfma_f32_32x32x16_bf16 v[120:135], v[56:59], v[32:35], v[88:103]
    ds_read_b128 v[64:67], v29 offset:36864
    v_exp_f32 v152, v152
    v_exp_f32 v153, v153
    v_exp_f32 v154, v154
    v_exp_f32 v155, v155
    v_exp_f32 v156, v156
    v_mfma_f32_32x32x16_bf16 v[184:199], v[72:75], v[216:219], v[184:199]
    ds_read_b128 v[68:71], v29 offset:37888
    v_exp_f32 v157, v157
    v_exp_f32 v158, v158
    v_exp_f32 v159, v159
    v_cvt_pk_bf16_f32 v232, v152, v153
    v_cvt_pk_bf16_f32 v233, v154, v155
    v_mfma_f32_32x32x16_bf16 v[120:135], v[60:63], v[36:39], v[120:135]
    ds_read_b128 v[80:83], v29 offset:30720
    v_exp_f32 v160, v160
    v_exp_f32 v161, v161
    v_exp_f32 v162, v162
    v_exp_f32 v163, v163
    v_smfmac_f32_16x16x64_bf16 v[248:251], v[48:51], v[216:223], v31
    ds_read_b128 v[84:87], v29 offset:31744
    v_cvt_pk_bf16_f32 v234, v156, v157
    v_cvt_pk_bf16_f32 v235, v158, v159
    v_exp_f32 v164, v164
    v_exp_f32 v165, v165
    v_exp_f32 v166, v166
    v_mfma_f32_32x32x16_bf16 v[184:199], v[76:79], v[220:223], v[184:199]
    v_exp_f32 v167, v167
    v_cvt_pk_bf16_f32 v236, v160, v161
    v_cvt_pk_bf16_f32 v237, v162, v163
    v_cvt_pk_bf16_f32 v238, v164, v165
    v_cvt_pk_bf16_f32 v239, v166, v167
    v_mfma_f32_32x32x16_bf16 v[136:151], v[56:59], v[40:43], v[104:119]
    v_exp_f32 v168, v168
    v_exp_f32 v169, v169
    v_exp_f32 v170, v170
    v_exp_f32 v171, v171
    v_exp_f32 v172, v172
    v_mfma_f32_32x32x16_bf16 v[200:215], v[72:75], v[224:227], v[200:215]
    v_exp_f32 v173, v173
    v_exp_f32 v174, v174
    v_exp_f32 v175, v175
    v_cvt_pk_bf16_f32 v240, v168, v169
    v_cvt_pk_bf16_f32 v241, v170, v171
    v_mfma_f32_32x32x16_bf16 v[136:151], v[60:63], v[44:47], v[136:151]
    v_exp_f32 v176, v176
    v_exp_f32 v177, v177
    v_exp_f32 v178, v178
    v_exp_f32 v179, v179
    v_smfmac_f32_16x16x64_bf16 v[252:255], v[48:51], v[224:231], v31
    v_cvt_pk_bf16_f32 v242, v172, v173
    v_cvt_pk_bf16_f32 v243, v174, v175
    v_exp_f32 v180, v180
    v_exp_f32 v181, v181
    v_exp_f32 v182, v182
    v_mfma_f32_32x32x16_bf16 v[200:215], v[76:79], v[228:231], v[200:215]
    v_exp_f32 v183, v183
    v_cvt_pk_bf16_f32 v244, v176, v177
    v_cvt_pk_bf16_f32 v245, v178, v179
    v_cvt_pk_bf16_f32 v246, v180, v181
    v_cvt_pk_bf16_f32 v247, v182, v183
    s_waitcnt lgkmcnt(0)
    v_mfma_f32_32x32x16_bf16 v[152:167], v[64:67], v[32:35], v[88:103]
    ds_read_b128 v[56:59], v29 offset:40960
    v_exp_f32 v120, v120
    v_exp_f32 v121, v121
    v_exp_f32 v122, v122
    v_exp_f32 v123, v123
    v_exp_f32 v124, v124
    v_mfma_f32_32x32x16_bf16 v[184:199], v[80:83], v[232:235], v[184:199]
    ds_read_b128 v[60:63], v29 offset:41984
    v_exp_f32 v125, v125
    v_exp_f32 v126, v126
    v_exp_f32 v127, v127
    v_cvt_pk_bf16_f32 v216, v120, v121
    v_cvt_pk_bf16_f32 v217, v122, v123
    v_mfma_f32_32x32x16_bf16 v[152:167], v[68:71], v[36:39], v[152:167]
    ds_read_b128 v[72:75], v29 offset:34816
    v_exp_f32 v128, v128
    v_exp_f32 v129, v129
    v_exp_f32 v130, v130
    v_exp_f32 v131, v131
    v_smfmac_f32_16x16x64_bf16 v[248:251], v[48:51], v[232:239], v31
    ds_read_b128 v[76:79], v29 offset:35840
    v_cvt_pk_bf16_f32 v218, v124, v125
    v_cvt_pk_bf16_f32 v219, v126, v127
    v_exp_f32 v132, v132
    v_exp_f32 v133, v133
    v_exp_f32 v134, v134
    v_mfma_f32_32x32x16_bf16 v[184:199], v[84:87], v[236:239], v[184:199]
    v_exp_f32 v135, v135
    v_cvt_pk_bf16_f32 v220, v128, v129
    v_cvt_pk_bf16_f32 v221, v130, v131
    v_cvt_pk_bf16_f32 v222, v132, v133
    v_cvt_pk_bf16_f32 v223, v134, v135
    v_mfma_f32_32x32x16_bf16 v[168:183], v[64:67], v[40:43], v[104:119]
    v_exp_f32 v136, v136
    v_exp_f32 v137, v137
    v_exp_f32 v138, v138
    v_exp_f32 v139, v139
    v_exp_f32 v140, v140
    v_mfma_f32_32x32x16_bf16 v[200:215], v[80:83], v[240:243], v[200:215]
    v_exp_f32 v141, v141
    v_exp_f32 v142, v142
    v_exp_f32 v143, v143
    v_cvt_pk_bf16_f32 v224, v136, v137
    v_cvt_pk_bf16_f32 v225, v138, v139
    v_mfma_f32_32x32x16_bf16 v[168:183], v[68:71], v[44:47], v[168:183]
    v_exp_f32 v144, v144
    v_exp_f32 v145, v145
    v_exp_f32 v146, v146
    v_exp_f32 v147, v147
    v_smfmac_f32_16x16x64_bf16 v[252:255], v[48:51], v[240:247], v31
    v_cvt_pk_bf16_f32 v226, v140, v141
    v_cvt_pk_bf16_f32 v227, v142, v143
    v_exp_f32 v148, v148
    v_exp_f32 v149, v149
    v_exp_f32 v150, v150
    v_mfma_f32_32x32x16_bf16 v[200:215], v[84:87], v[244:247], v[200:215]
    v_exp_f32 v151, v151
    v_cvt_pk_bf16_f32 v228, v144, v145
    v_cvt_pk_bf16_f32 v229, v146, v147
    v_cvt_pk_bf16_f32 v230, v148, v149
    v_cvt_pk_bf16_f32 v231, v150, v151
    s_waitcnt vmcnt(8) lgkmcnt(0)
    v_mfma_f32_32x32x16_bf16 v[120:135], v[56:59], v[32:35], v[88:103]
    ds_read_b128 v[64:67], v29 offset:45056
    v_exp_f32 v152, v152
    v_exp_f32 v153, v153
    v_exp_f32 v154, v154
    v_exp_f32 v155, v155
    v_exp_f32 v156, v156
    v_mfma_f32_32x32x16_bf16 v[184:199], v[72:75], v[216:219], v[184:199]
    ds_read_b128 v[68:71], v29 offset:46080
    v_exp_f32 v157, v157
    v_exp_f32 v158, v158
    v_exp_f32 v159, v159
    v_cvt_pk_bf16_f32 v232, v152, v153
    v_cvt_pk_bf16_f32 v233, v154, v155
    v_mfma_f32_32x32x16_bf16 v[120:135], v[60:63], v[36:39], v[120:135]
    ds_read_b128 v[80:83], v29 offset:38912
    v_exp_f32 v160, v160
    v_exp_f32 v161, v161
    v_exp_f32 v162, v162
    v_exp_f32 v163, v163
    v_smfmac_f32_16x16x64_bf16 v[248:251], v[48:51], v[216:223], v31
    ds_read_b128 v[84:87], v29 offset:39936
    v_cvt_pk_bf16_f32 v234, v156, v157
    v_cvt_pk_bf16_f32 v235, v158, v159
    v_exp_f32 v164, v164
    v_exp_f32 v165, v165
    v_exp_f32 v166, v166
    v_mfma_f32_32x32x16_bf16 v[184:199], v[76:79], v[220:223], v[184:199]
    v_exp_f32 v167, v167
    v_cvt_pk_bf16_f32 v236, v160, v161
    v_cvt_pk_bf16_f32 v237, v162, v163
    v_cvt_pk_bf16_f32 v238, v164, v165
    v_cvt_pk_bf16_f32 v239, v166, v167
    v_mfma_f32_32x32x16_bf16 v[136:151], v[56:59], v[40:43], v[104:119]
    buffer_store_dwordx4 a[56:59], v14, s[92:95], s38 offen offset:512 sc1
    v_exp_f32 v168, v168
    v_exp_f32 v169, v169
    v_exp_f32 v170, v170
    v_exp_f32 v171, v171
    v_exp_f32 v172, v172
    v_mfma_f32_32x32x16_bf16 v[200:215], v[72:75], v[224:227], v[200:215]
    v_mfma_f32_16x16x32_bf16 v[8:11], v[52:55], a[56:59], v[8:11]
    v_exp_f32 v173, v173
    v_exp_f32 v174, v174
    v_exp_f32 v175, v175
    v_cvt_pk_bf16_f32 v240, v168, v169
    v_cvt_pk_bf16_f32 v241, v170, v171
    v_mfma_f32_32x32x16_bf16 v[136:151], v[60:63], v[44:47], v[136:151]
    v_exp_f32 v176, v176
    v_exp_f32 v177, v177
    v_exp_f32 v178, v178
    v_exp_f32 v179, v179
    v_smfmac_f32_16x16x64_bf16 v[252:255], v[48:51], v[224:231], v31
    v_cvt_pk_bf16_f32 v242, v172, v173
    v_cvt_pk_bf16_f32 v243, v174, v175
    v_exp_f32 v180, v180
    v_exp_f32 v181, v181
    v_exp_f32 v182, v182
    v_mfma_f32_32x32x16_bf16 v[200:215], v[76:79], v[228:231], v[200:215]
    v_exp_f32 v183, v183
    v_cvt_pk_bf16_f32 v244, v176, v177
    v_cvt_pk_bf16_f32 v245, v178, v179
    v_cvt_pk_bf16_f32 v246, v180, v181
    v_cvt_pk_bf16_f32 v247, v182, v183
    s_waitcnt lgkmcnt(0)
    v_mfma_f32_32x32x16_bf16 v[152:167], v[64:67], v[32:35], v[88:103]
    ds_read_b128 v[56:59], v29 offset:49152
    v_exp_f32 v120, v120
    v_exp_f32 v121, v121
    v_exp_f32 v122, v122
    v_exp_f32 v123, v123
    v_exp_f32 v124, v124
    v_mfma_f32_32x32x16_bf16 v[184:199], v[80:83], v[232:235], v[184:199]
    ds_read_b128 v[60:63], v29 offset:50176
    v_exp_f32 v125, v125
    v_exp_f32 v126, v126
    v_exp_f32 v127, v127
    v_cvt_pk_bf16_f32 v216, v120, v121
    v_cvt_pk_bf16_f32 v217, v122, v123
    v_mfma_f32_32x32x16_bf16 v[152:167], v[68:71], v[36:39], v[152:167]
    ds_read_b128 v[72:75], v29 offset:43008
    v_exp_f32 v128, v128
    v_exp_f32 v129, v129
    v_exp_f32 v130, v130
    v_exp_f32 v131, v131
    v_smfmac_f32_16x16x64_bf16 v[248:251], v[48:51], v[232:239], v31
    ds_read_b128 v[76:79], v29 offset:44032
    v_cvt_pk_bf16_f32 v218, v124, v125
    v_cvt_pk_bf16_f32 v219, v126, v127
    v_exp_f32 v132, v132
    v_exp_f32 v133, v133
    v_exp_f32 v134, v134
    v_mfma_f32_32x32x16_bf16 v[184:199], v[84:87], v[236:239], v[184:199]
    v_exp_f32 v135, v135
    v_cvt_pk_bf16_f32 v220, v128, v129
    v_cvt_pk_bf16_f32 v221, v130, v131
    v_cvt_pk_bf16_f32 v222, v132, v133
    v_cvt_pk_bf16_f32 v223, v134, v135
    v_mfma_f32_32x32x16_bf16 v[168:183], v[64:67], v[40:43], v[104:119]
    v_exp_f32 v136, v136
    v_exp_f32 v137, v137
    v_exp_f32 v138, v138
    v_exp_f32 v139, v139
    v_exp_f32 v140, v140
    v_mfma_f32_32x32x16_bf16 v[200:215], v[80:83], v[240:243], v[200:215]
    v_exp_f32 v141, v141
    v_exp_f32 v142, v142
    v_exp_f32 v143, v143
    v_cvt_pk_bf16_f32 v224, v136, v137
    v_cvt_pk_bf16_f32 v225, v138, v139
    v_mfma_f32_32x32x16_bf16 v[168:183], v[68:71], v[44:47], v[168:183]
    v_exp_f32 v144, v144
    v_exp_f32 v145, v145
    v_exp_f32 v146, v146
    v_exp_f32 v147, v147
    v_smfmac_f32_16x16x64_bf16 v[252:255], v[48:51], v[240:247], v31
    v_cvt_pk_bf16_f32 v226, v140, v141
    v_cvt_pk_bf16_f32 v227, v142, v143
    v_exp_f32 v148, v148
    v_exp_f32 v149, v149
    v_exp_f32 v150, v150
    v_mfma_f32_32x32x16_bf16 v[200:215], v[84:87], v[244:247], v[200:215]
    v_exp_f32 v151, v151
    v_cvt_pk_bf16_f32 v228, v144, v145
    v_cvt_pk_bf16_f32 v229, v146, v147
    v_cvt_pk_bf16_f32 v230, v148, v149
    v_cvt_pk_bf16_f32 v231, v150, v151
    s_waitcnt lgkmcnt(0)
    v_mfma_f32_32x32x16_bf16 v[120:135], v[56:59], v[32:35], v[88:103]
    ds_read_b128 v[64:67], v29 offset:53248
    v_exp_f32 v152, v152
    v_exp_f32 v153, v153
    v_exp_f32 v154, v154
    v_exp_f32 v155, v155
    v_exp_f32 v156, v156
    v_mfma_f32_32x32x16_bf16 v[184:199], v[72:75], v[216:219], v[184:199]
    ds_read_b128 v[68:71], v29 offset:54272
    v_exp_f32 v157, v157
    v_exp_f32 v158, v158
    v_exp_f32 v159, v159
    v_cvt_pk_bf16_f32 v232, v152, v153
    v_cvt_pk_bf16_f32 v233, v154, v155
    v_mfma_f32_32x32x16_bf16 v[120:135], v[60:63], v[36:39], v[120:135]
    ds_read_b128 v[80:83], v29 offset:47104
    v_exp_f32 v160, v160
    v_exp_f32 v161, v161
    v_exp_f32 v162, v162
    v_exp_f32 v163, v163
    v_smfmac_f32_16x16x64_bf16 v[248:251], v[48:51], v[216:223], v31
    ds_read_b128 v[84:87], v29 offset:48128
    v_cvt_pk_bf16_f32 v234, v156, v157
    v_cvt_pk_bf16_f32 v235, v158, v159
    v_exp_f32 v164, v164
    v_exp_f32 v165, v165
    v_exp_f32 v166, v166
    v_mfma_f32_32x32x16_bf16 v[184:199], v[76:79], v[220:223], v[184:199]
    v_exp_f32 v167, v167
    v_cvt_pk_bf16_f32 v236, v160, v161
    v_cvt_pk_bf16_f32 v237, v162, v163
    v_cvt_pk_bf16_f32 v238, v164, v165
    v_cvt_pk_bf16_f32 v239, v166, v167
    v_mfma_f32_32x32x16_bf16 v[136:151], v[56:59], v[40:43], v[104:119]
    v_exp_f32 v168, v168
    v_exp_f32 v169, v169
    v_exp_f32 v170, v170
    v_exp_f32 v171, v171
    v_exp_f32 v172, v172
    v_mfma_f32_32x32x16_bf16 v[200:215], v[72:75], v[224:227], v[200:215]
    v_exp_f32 v173, v173
    v_exp_f32 v174, v174
    v_exp_f32 v175, v175
    v_cvt_pk_bf16_f32 v240, v168, v169
    v_cvt_pk_bf16_f32 v241, v170, v171
    v_mfma_f32_32x32x16_bf16 v[136:151], v[60:63], v[44:47], v[136:151]
    v_exp_f32 v176, v176
    v_exp_f32 v177, v177
    v_exp_f32 v178, v178
    v_exp_f32 v179, v179
    v_smfmac_f32_16x16x64_bf16 v[252:255], v[48:51], v[224:231], v31
    v_cvt_pk_bf16_f32 v242, v172, v173
    v_cvt_pk_bf16_f32 v243, v174, v175
    v_exp_f32 v180, v180
    v_exp_f32 v181, v181
    v_exp_f32 v182, v182
    v_mfma_f32_32x32x16_bf16 v[200:215], v[76:79], v[228:231], v[200:215]
    v_exp_f32 v183, v183
    v_cvt_pk_bf16_f32 v244, v176, v177
    v_cvt_pk_bf16_f32 v245, v178, v179
    v_cvt_pk_bf16_f32 v246, v180, v181
    v_cvt_pk_bf16_f32 v247, v182, v183
    s_waitcnt vmcnt(6) lgkmcnt(0)
    v_mfma_f32_32x32x16_bf16 v[152:167], v[64:67], v[32:35], v[88:103]
    ds_read_b128 v[56:59], v29 offset:57344
    v_exp_f32 v120, v120
    v_exp_f32 v121, v121
    v_exp_f32 v122, v122
    v_exp_f32 v123, v123
    v_exp_f32 v124, v124
    v_mfma_f32_32x32x16_bf16 v[184:199], v[80:83], v[232:235], v[184:199]
    ds_read_b128 v[60:63], v29 offset:58368
    v_exp_f32 v125, v125
    v_exp_f32 v126, v126
    v_exp_f32 v127, v127
    v_cvt_pk_bf16_f32 v216, v120, v121
    v_cvt_pk_bf16_f32 v217, v122, v123
    v_mfma_f32_32x32x16_bf16 v[152:167], v[68:71], v[36:39], v[152:167]
    ds_read_b128 v[72:75], v29 offset:51200
    v_exp_f32 v128, v128
    v_exp_f32 v129, v129
    v_exp_f32 v130, v130
    v_exp_f32 v131, v131
    v_smfmac_f32_16x16x64_bf16 v[248:251], v[48:51], v[232:239], v31
    ds_read_b128 v[76:79], v29 offset:52224
    v_cvt_pk_bf16_f32 v218, v124, v125
    v_cvt_pk_bf16_f32 v219, v126, v127
    v_exp_f32 v132, v132
    v_exp_f32 v133, v133
    v_exp_f32 v134, v134
    v_mfma_f32_32x32x16_bf16 v[184:199], v[84:87], v[236:239], v[184:199]
    v_exp_f32 v135, v135
    v_cvt_pk_bf16_f32 v220, v128, v129
    v_cvt_pk_bf16_f32 v221, v130, v131
    v_cvt_pk_bf16_f32 v222, v132, v133
    v_cvt_pk_bf16_f32 v223, v134, v135
    v_mfma_f32_32x32x16_bf16 v[168:183], v[64:67], v[40:43], v[104:119]
    buffer_store_dwordx4 a[60:63], v14, s[92:95], s38 offen offset:768 sc1
    s_add_u32 s38, s38, 14336
    v_exp_f32 v136, v136
    v_exp_f32 v137, v137
    v_exp_f32 v138, v138
    v_exp_f32 v139, v139
    v_exp_f32 v140, v140
    v_mfma_f32_32x32x16_bf16 v[200:215], v[80:83], v[240:243], v[200:215]
    v_mfma_f32_16x16x32_bf16 v[8:11], v[52:55], a[60:63], v[8:11]
    v_exp_f32 v141, v141
    v_exp_f32 v142, v142
    v_exp_f32 v143, v143
    v_cvt_pk_bf16_f32 v224, v136, v137
    v_cvt_pk_bf16_f32 v225, v138, v139
    v_mfma_f32_32x32x16_bf16 v[168:183], v[68:71], v[44:47], v[168:183]
    v_exp_f32 v144, v144
    v_exp_f32 v145, v145
    v_exp_f32 v146, v146
    v_exp_f32 v147, v147
    v_smfmac_f32_16x16x64_bf16 v[252:255], v[48:51], v[240:247], v31
    v_cvt_pk_bf16_f32 v226, v140, v141
    v_cvt_pk_bf16_f32 v227, v142, v143
    v_exp_f32 v148, v148
    v_exp_f32 v149, v149
    v_exp_f32 v150, v150
    v_mfma_f32_32x32x16_bf16 v[200:215], v[84:87], v[244:247], v[200:215]
    v_exp_f32 v151, v151
    v_cvt_pk_bf16_f32 v228, v144, v145
    v_cvt_pk_bf16_f32 v229, v146, v147
    v_cvt_pk_bf16_f32 v230, v148, v149
    v_cvt_pk_bf16_f32 v231, v150, v151
    s_waitcnt lgkmcnt(0)
    v_add_f32_dpp v8, v8, v8 row_ror:8 row_mask:0xf bank_mask:0xf
    v_add_f32_dpp v9, v9, v9 row_ror:8 row_mask:0xf bank_mask:0xf
    v_add_f32_dpp v10, v10, v10 row_ror:8 row_mask:0xf bank_mask:0xf
    v_add_f32_dpp v11, v11, v11 row_ror:8 row_mask:0xf bank_mask:0xf
    s_mov_b64 exec, 0xff00ff
    ds_write_b128 v18, v[8:11]
    s_mov_b64 exec, -1
    v_mfma_f32_32x32x16_bf16 v[120:135], v[56:59], v[32:35], v[88:103]
    ds_read_b128 v[64:67], v29 offset:61440
    v_exp_f32 v152, v152
    v_exp_f32 v153, v153
    v_exp_f32 v154, v154
    v_exp_f32 v155, v155
    v_exp_f32 v156, v156
    v_mfma_f32_32x32x16_bf16 v[184:199], v[72:75], v[216:219], v[184:199]
    ds_read_b128 v[68:71], v29 offset:62464
    v_exp_f32 v157, v157
    v_exp_f32 v158, v158
    v_exp_f32 v159, v159
    v_cvt_pk_bf16_f32 v232, v152, v153
    v_cvt_pk_bf16_f32 v233, v154, v155
    v_mfma_f32_32x32x16_bf16 v[120:135], v[60:63], v[36:39], v[120:135]
    ds_read_b128 v[80:83], v29 offset:55296
    v_exp_f32 v160, v160
    v_exp_f32 v161, v161
    v_exp_f32 v162, v162
    v_exp_f32 v163, v163
    v_smfmac_f32_16x16x64_bf16 v[248:251], v[48:51], v[216:223], v31
    ds_read_b128 v[84:87], v29 offset:56320
    v_cvt_pk_bf16_f32 v234, v156, v157
    v_cvt_pk_bf16_f32 v235, v158, v159
    v_exp_f32 v164, v164
    v_exp_f32 v165, v165
    v_exp_f32 v166, v166
    v_mfma_f32_32x32x16_bf16 v[184:199], v[76:79], v[220:223], v[184:199]
    v_exp_f32 v167, v167
    v_cvt_pk_bf16_f32 v236, v160, v161
    v_cvt_pk_bf16_f32 v237, v162, v163
    v_cvt_pk_bf16_f32 v238, v164, v165
    v_cvt_pk_bf16_f32 v239, v166, v167
    v_mfma_f32_32x32x16_bf16 v[136:151], v[56:59], v[40:43], v[104:119]
    v_exp_f32 v168, v168
    v_exp_f32 v169, v169
    v_exp_f32 v170, v170
    v_exp_f32 v171, v171
    v_exp_f32 v172, v172
    v_mfma_f32_32x32x16_bf16 v[200:215], v[72:75], v[224:227], v[200:215]
    v_exp_f32 v173, v173
    v_exp_f32 v174, v174
    v_exp_f32 v175, v175
    v_cvt_pk_bf16_f32 v240, v168, v169
    v_cvt_pk_bf16_f32 v241, v170, v171
    v_mfma_f32_32x32x16_bf16 v[136:151], v[60:63], v[44:47], v[136:151]
    v_exp_f32 v176, v176
    v_exp_f32 v177, v177
    v_exp_f32 v178, v178
    v_exp_f32 v179, v179
    v_smfmac_f32_16x16x64_bf16 v[252:255], v[48:51], v[224:231], v31
    v_cvt_pk_bf16_f32 v242, v172, v173
    v_cvt_pk_bf16_f32 v243, v174, v175
    v_exp_f32 v180, v180
    v_exp_f32 v181, v181
    v_exp_f32 v182, v182
    v_mfma_f32_32x32x16_bf16 v[200:215], v[76:79], v[228:231], v[200:215]
    v_exp_f32 v183, v183
    v_cvt_pk_bf16_f32 v244, v176, v177
    v_cvt_pk_bf16_f32 v245, v178, v179
    v_cvt_pk_bf16_f32 v246, v180, v181
    v_cvt_pk_bf16_f32 v247, v182, v183
    s_waitcnt vmcnt(9) lgkmcnt(0)
    s_barrier
    s_cmp_lg_u32 s3, 0
    s_cbranch_scc1 L_cs_9
    s_cmp_ge_u32 s2, 224
    s_cbranch_scc1 L_cs_9
    v_add_u32 v2, 147456, v19
    ds_read_b32 v8, v2 offset:0
    ds_read_b32 v9, v2 offset:256
    ds_read_b32 v10, v2 offset:512
    ds_read_b32 v11, v2 offset:768
    s_and_b32 s4, s2, 1
    s_mul_i32 s4, s4, 28672
    s_lshl_b32 s5, s41, 8
    s_add_u32 s4, s4, s5
    s_waitcnt lgkmcnt(0)
    v_add_f32 v8, v8, v9
    v_add_f32 v10, v10, v11
    v_add_f32 v8, v8, v10
    buffer_store_dword v8, v19, s[60:63], s4 offen sc1
L_cs_9:
    s_mov_b32 s12, s68
    s_mov_b32 s13, s69
    s_mov_b32 s14, 0x200000
    s_mov_b32 s15, 0x20000
    v_lshrrev_b32 v2, 3, v1
    v_mul_u32_u24 v4, 2048, v2
    v_bfe_u32 v2, v1, 4, 2
    v_lshlrev_b32 v2, 1, v2
    v_and_b32 v3, 7, v1
    v_xor_b32 v2, v2, v3
    v_lshl_add_u32 v4, v2, 4, v4
    s_mul_i32 s5, s3, 16384
    s_lshl_b32 s6, s33, 7
    s_add_u32 s5, s5, s6
    v_add_u32 v26, s5, v4
    v_add_u32 v27, 65536, v26
    s_mov_b32 s17, 0
    s_lshl_b32 s20, s3, 10
    v_mfma_f32_32x32x16_bf16 v[152:167], v[64:67], v[32:35], v[88:103]
    ds_read_b128 v[56:59], v30 offset:0
    v_exp_f32 v120, v120
    v_exp_f32 v121, v121
    v_exp_f32 v122, v122
    v_exp_f32 v123, v123
    v_exp_f32 v124, v124
    v_mfma_f32_32x32x16_bf16 v[184:199], v[80:83], v[232:235], v[184:199]
    ds_read_b128 v[60:63], v30 offset:1024
    v_exp_f32 v125, v125
    v_exp_f32 v126, v126
    v_exp_f32 v127, v127
    v_cvt_pk_bf16_f32 v216, v120, v121
    v_cvt_pk_bf16_f32 v217, v122, v123
    v_mfma_f32_32x32x16_bf16 v[152:167], v[68:71], v[36:39], v[152:167]
    ds_read_b128 v[72:75], v29 offset:59392
    v_exp_f32 v128, v128
    v_exp_f32 v129, v129
    v_exp_f32 v130, v130
    v_exp_f32 v131, v131
    v_smfmac_f32_16x16x64_bf16 v[248:251], v[48:51], v[232:239], v31
    ds_read_b128 v[76:79], v29 offset:60416
    v_cvt_pk_bf16_f32 v218, v124, v125
    v_cvt_pk_bf16_f32 v219, v126, v127
    v_exp_f32 v132, v132
    v_exp_f32 v133, v133
    v_exp_f32 v134, v134
    v_mfma_f32_32x32x16_bf16 v[184:199], v[84:87], v[236:239], v[184:199]
    s_add_u32 m0, s20, 32768
    s_nop 0
    buffer_load_dwordx4 v26, s[12:15], s17 offen lds
    v_exp_f32 v135, v135
    v_cvt_pk_bf16_f32 v220, v128, v129
    v_cvt_pk_bf16_f32 v221, v130, v131
    v_cvt_pk_bf16_f32 v222, v132, v133
    v_cvt_pk_bf16_f32 v223, v134, v135
    v_mfma_f32_32x32x16_bf16 v[168:183], v[64:67], v[40:43], v[104:119]
    s_add_u32 m0, s20, 36864
    s_nop 0
    buffer_load_dwordx4 v27, s[12:15], s17 offen lds
    s_add_u32 s17, s17, 131072
    v_exp_f32 v136, v136
    v_exp_f32 v137, v137
    v_exp_f32 v138, v138
    v_exp_f32 v139, v139
    v_exp_f32 v140, v140
    v_mfma_f32_32x32x16_bf16 v[200:215], v[80:83], v[240:243], v[200:215]
    v_exp_f32 v141, v141
    v_exp_f32 v142, v142
    v_exp_f32 v143, v143
    v_cvt_pk_bf16_f32 v224, v136, v137
    v_cvt_pk_bf16_f32 v225, v138, v139
    v_mfma_f32_32x32x16_bf16 v[168:183], v[68:71], v[44:47], v[168:183]
    v_exp_f32 v144, v144
    v_exp_f32 v145, v145
    v_exp_f32 v146, v146
    v_exp_f32 v147, v147
    v_smfmac_f32_16x16x64_bf16 v[252:255], v[48:51], v[240:247], v31
    s_add_u32 m0, s20, 40960
    s_nop 0
    buffer_load_dwordx4 v26, s[12:15], s17 offen lds
    v_cvt_pk_bf16_f32 v226, v140, v141
    v_cvt_pk_bf16_f32 v227, v142, v143
    v_exp_f32 v148, v148
    v_exp_f32 v149, v149
    v_exp_f32 v150, v150
    v_mfma_f32_32x32x16_bf16 v[200:215], v[84:87], v[244:247], v[200:215]
    s_add_u32 m0, s20, 45056
    s_nop 0
    buffer_load_dwordx4 v27, s[12:15], s17 offen lds
    s_add_u32 s17, s17, 131072
    v_exp_f32 v151, v151
    v_cvt_pk_bf16_f32 v228, v144, v145
    v_cvt_pk_bf16_f32 v229, v146, v147
    v_cvt_pk_bf16_f32 v230, v148, v149
    v_cvt_pk_bf16_f32 v231, v150, v151
    s_waitcnt lgkmcnt(0)
    v_mfma_f32_32x32x16_bf16 v[120:135], v[56:59], v[32:35], v[88:103]
    ds_read_b128 v[64:67], v30 offset:4096
    v_exp_f32 v152, v152
    v_exp_f32 v153, v153
    v_exp_f32 v154, v154
    v_exp_f32 v155, v155
    v_exp_f32 v156, v156
    v_mfma_f32_32x32x16_bf16 v[184:199], v[72:75], v[216:219], v[184:199]
    ds_read_b128 v[68:71], v30 offset:5120
    v_exp_f32 v157, v157
    v_exp_f32 v158, v158
    v_exp_f32 v159, v159
    v_cvt_pk_bf16_f32 v232, v152, v153
    v_cvt_pk_bf16_f32 v233, v154, v155
    v_mfma_f32_32x32x16_bf16 v[120:135], v[60:63], v[36:39], v[120:135]
    ds_read_b128 v[80:83], v29 offset:63488
    v_exp_f32 v160, v160
    v_exp_f32 v161, v161
    v_exp_f32 v162, v162
    v_exp_f32 v163, v163
    v_smfmac_f32_16x16x64_bf16 v[248:251], v[48:51], v[216:223], v31
    ds_read_b128 v[84:87], v29 offset:64512
    v_cvt_pk_bf16_f32 v234, v156, v157
    v_cvt_pk_bf16_f32 v235, v158, v159
    v_exp_f32 v164, v164
    v_exp_f32 v165, v165
    v_exp_f32 v166, v166
    v_mfma_f32_32x32x16_bf16 v[184:199], v[76:79], v[220:223], v[184:199]
    s_add_u32 m0, s20, 49152
    s_nop 0
    buffer_load_dwordx4 v26, s[12:15], s17 offen lds
    v_exp_f32 v167, v167
    v_cvt_pk_bf16_f32 v236, v160, v161
    v_cvt_pk_bf16_f32 v237, v162, v163
    v_cvt_pk_bf16_f32 v238, v164, v165
    v_cvt_pk_bf16_f32 v239, v166, v167
    v_mfma_f32_32x32x16_bf16 v[136:151], v[56:59], v[40:43], v[104:119]
    s_add_u32 m0, s20, 53248
    s_nop 0
    buffer_load_dwordx4 v27, s[12:15], s17 offen lds
    s_add_u32 s17, s17, 131072
    v_exp_f32 v168, v168
    v_exp_f32 v169, v169
    v_exp_f32 v170, v170
    v_exp_f32 v171, v171
    v_exp_f32 v172, v172
    v_mfma_f32_32x32x16_bf16 v[200:215], v[72:75], v[224:227], v[200:215]
    v_exp_f32 v173, v173
    v_exp_f32 v174, v174
    v_exp_f32 v175, v175
    v_cvt_pk_bf16_f32 v240, v168, v169
    v_cvt_pk_bf16_f32 v241, v170, v171
    v_mfma_f32_32x32x16_bf16 v[136:151], v[60:63], v[44:47], v[136:151]
    v_exp_f32 v176, v176
    v_exp_f32 v177, v177
    v_exp_f32 v178, v178
    v_exp_f32 v179, v179
    v_smfmac_f32_16x16x64_bf16 v[252:255], v[48:51], v[224:231], v31
    s_add_u32 m0, s20, 57344
    s_nop 0
    buffer_load_dwordx4 v26, s[12:15], s17 offen lds
    v_cvt_pk_bf16_f32 v242, v172, v173
    v_cvt_pk_bf16_f32 v243, v174, v175
    v_exp_f32 v180, v180
    v_exp_f32 v181, v181
    v_exp_f32 v182, v182
    v_mfma_f32_32x32x16_bf16 v[200:215], v[76:79], v[228:231], v[200:215]
    s_add_u32 m0, s20, 61440
    s_nop 0
    buffer_load_dwordx4 v27, s[12:15], s17 offen lds
    s_add_u32 s17, s17, 131072
    v_exp_f32 v183, v183
    v_cvt_pk_bf16_f32 v244, v176, v177
    v_cvt_pk_bf16_f32 v245, v178, v179
    v_cvt_pk_bf16_f32 v246, v180, v181
    v_cvt_pk_bf16_f32 v247, v182, v183
    s_waitcnt lgkmcnt(0)
    v_mfma_f32_32x32x16_bf16 v[152:167], v[64:67], v[32:35], v[88:103]
    ds_read_b128 v[56:59], v30 offset:8192
    v_exp_f32 v120, v120
    v_exp_f32 v121, v121
    v_exp_f32 v122, v122
    v_exp_f32 v123, v123
    v_exp_f32 v124, v124
    v_mfma_f32_32x32x16_bf16 v[184:199], v[80:83], v[232:235], v[184:199]
    ds_read_b128 v[60:63], v30 offset:9216
    v_exp_f32 v125, v125
    v_exp_f32 v126, v126
    v_exp_f32 v127, v127
    v_cvt_pk_bf16_f32 v216, v120, v121
    v_cvt_pk_bf16_f32 v217, v122, v123
    v_mfma_f32_32x32x16_bf16 v[152:167], v[68:71], v[36:39], v[152:167]
    ds_read_b128 v[72:75], v30 offset:2048
    v_exp_f32 v128, v128
    v_exp_f32 v129, v129
    v_exp_f32 v130, v130
    v_exp_f32 v131, v131
    v_smfmac_f32_16x16x64_bf16 v[248:251], v[48:51], v[232:239], v31
    ds_read_b128 v[76:79], v30 offset:3072
    v_cvt_pk_bf16_f32 v218, v124, v125
    v_cvt_pk_bf16_f32 v219, v126, v127
    v_exp_f32 v132, v132
    v_exp_f32 v133, v133
    v_exp_f32 v134, v134
    v_mfma_f32_32x32x16_bf16 v[184:199], v[84:87], v[236:239], v[184:199]
    s_add_u32 m0, s20, 65536
    s_nop 0
    buffer_load_dwordx4 v26, s[12:15], s17 offen lds
    v_exp_f32 v135, v135
    v_cvt_pk_bf16_f32 v220, v128, v129
    v_cvt_pk_bf16_f32 v221, v130, v131
    v_cvt_pk_bf16_f32 v222, v132, v133
    v_cvt_pk_bf16_f32 v223, v134, v135
    v_mfma_f32_32x32x16_bf16 v[168:183], v[64:67], v[40:43], v[104:119]
    s_add_u32 m0, s20, 69632
    s_nop 0
    buffer_load_dwordx4 v27, s[12:15], s17 offen lds
    s_add_u32 s17, s17, 131072
    v_exp_f32 v136, v136
    v_exp_f32 v137, v137
    v_exp_f32 v138, v138
    v_exp_f32 v139, v139
    v_exp_f32 v140, v140
    v_mfma_f32_32x32x16_bf16 v[200:215], v[80:83], v[240:243], v[200:215]
    v_exp_f32 v141, v141
    v_exp_f32 v142, v142
    v_exp_f32 v143, v143
    v_cvt_pk_bf16_f32 v224, v136, v137
    v_cvt_pk_bf16_f32 v225, v138, v139
    v_mfma_f32_32x32x16_bf16 v[168:183], v[68:71], v[44:47], v[168:183]
    v_exp_f32 v144, v144
    v_exp_f32 v145, v145
    v_exp_f32 v146, v146
    v_exp_f32 v147, v147
    v_smfmac_f32_16x16x64_bf16 v[252:255], v[48:51], v[240:247], v31
    s_add_u32 m0, s20, 73728
    s_nop 0
    buffer_load_dwordx4 v26, s[12:15], s17 offen lds
    v_cvt_pk_bf16_f32 v226, v140, v141
    v_cvt_pk_bf16_f32 v227, v142, v143
    v_exp_f32 v148, v148
    v_exp_f32 v149, v149
    v_exp_f32 v150, v150
    v_mfma_f32_32x32x16_bf16 v[200:215], v[84:87], v[244:247], v[200:215]
    s_add_u32 m0, s20, 77824
    s_nop 0
    buffer_load_dwordx4 v27, s[12:15], s17 offen lds
    s_add_u32 s17, s17, 131072
    v_exp_f32 v151, v151
    v_cvt_pk_bf16_f32 v228, v144, v145
    v_cvt_pk_bf16_f32 v229, v146, v147
    v_cvt_pk_bf16_f32 v230, v148, v149
    v_cvt_pk_bf16_f32 v231, v150, v151
    s_waitcnt lgkmcnt(0)
    v_mfma_f32_32x32x16_bf16 v[120:135], v[56:59], v[32:35], v[88:103]
    ds_read_b128 v[64:67], v30 offset:12288
    v_exp_f32 v152, v152
    v_exp_f32 v153, v153
    v_exp_f32 v154, v154
    v_exp_f32 v155, v155
    v_exp_f32 v156, v156
    v_mfma_f32_32x32x16_bf16 v[184:199], v[72:75], v[216:219], v[184:199]
    ds_read_b128 v[68:71], v30 offset:13312
    v_exp_f32 v157, v157
    v_exp_f32 v158, v158
    v_exp_f32 v159, v159
    v_cvt_pk_bf16_f32 v232, v152, v153
    v_cvt_pk_bf16_f32 v233, v154, v155
    v_mfma_f32_32x32x16_bf16 v[120:135], v[60:63], v[36:39], v[120:135]
    ds_read_b128 v[80:83], v30 offset:6144
    v_exp_f32 v160, v160
    v_exp_f32 v161, v161
    v_exp_f32 v162, v162
    v_exp_f32 v163, v163
    v_smfmac_f32_16x16x64_bf16 v[248:251], v[48:51], v[216:223], v31
    ds_read_b128 v[84:87], v30 offset:7168
    v_cvt_pk_bf16_f32 v234, v156, v157
    v_cvt_pk_bf16_f32 v235, v158, v159
    v_exp_f32 v164, v164
    v_exp_f32 v165, v165
    v_exp_f32 v166, v166
    v_mfma_f32_32x32x16_bf16 v[184:199], v[76:79], v[220:223], v[184:199]
    s_add_u32 m0, s20, 81920
    s_nop 0
    buffer_load_dwordx4 v26, s[12:15], s17 offen lds
    v_exp_f32 v167, v167
    v_cvt_pk_bf16_f32 v236, v160, v161
    v_cvt_pk_bf16_f32 v237, v162, v163
    v_cvt_pk_bf16_f32 v238, v164, v165
    v_cvt_pk_bf16_f32 v239, v166, v167
    v_mfma_f32_32x32x16_bf16 v[136:151], v[56:59], v[40:43], v[104:119]
    s_add_u32 m0, s20, 86016
    s_nop 0
    buffer_load_dwordx4 v27, s[12:15], s17 offen lds
    s_add_u32 s17, s17, 131072
    v_exp_f32 v168, v168
    v_exp_f32 v169, v169
    v_exp_f32 v170, v170
    v_exp_f32 v171, v171
    v_exp_f32 v172, v172
    v_mfma_f32_32x32x16_bf16 v[200:215], v[72:75], v[224:227], v[200:215]
    v_exp_f32 v173, v173
    v_exp_f32 v174, v174
    v_exp_f32 v175, v175
    v_cvt_pk_bf16_f32 v240, v168, v169
    v_cvt_pk_bf16_f32 v241, v170, v171
    v_mfma_f32_32x32x16_bf16 v[136:151], v[60:63], v[44:47], v[136:151]
    v_exp_f32 v176, v176
    v_exp_f32 v177, v177
    v_exp_f32 v178, v178
    v_exp_f32 v179, v179
    v_smfmac_f32_16x16x64_bf16 v[252:255], v[48:51], v[224:231], v31
    s_add_u32 m0, s20, 90112
    s_nop 0
    buffer_load_dwordx4 v26, s[12:15], s17 offen lds
    v_cvt_pk_bf16_f32 v242, v172, v173
    v_cvt_pk_bf16_f32 v243, v174, v175
    v_exp_f32 v180, v180
    v_exp_f32 v181, v181
    v_exp_f32 v182, v182
    v_mfma_f32_32x32x16_bf16 v[200:215], v[76:79], v[228:231], v[200:215]
    s_add_u32 m0, s20, 94208
    s_nop 0
    buffer_load_dwordx4 v27, s[12:15], s17 offen lds
    s_add_u32 s17, s17, 131072
    v_exp_f32 v183, v183
    v_cvt_pk_bf16_f32 v244, v176, v177
    v_cvt_pk_bf16_f32 v245, v178, v179
    v_cvt_pk_bf16_f32 v246, v180, v181
    v_cvt_pk_bf16_f32 v247, v182, v183
    s_waitcnt lgkmcnt(0)
    v_mfma_f32_32x32x16_bf16 v[152:167], v[64:67], v[32:35], v[88:103]
    ds_read_b128 v[72:75], v30 offset:10240
    v_exp_f32 v120, v120
    v_exp_f32 v121, v121
    v_exp_f32 v122, v122
    v_exp_f32 v123, v123
    v_exp_f32 v124, v124
    v_mfma_f32_32x32x16_bf16 v[184:199], v[80:83], v[232:235], v[184:199]
    ds_read_b128 v[76:79], v30 offset:11264
    v_exp_f32 v125, v125
    v_exp_f32 v126, v126
    v_exp_f32 v127, v127
    v_cvt_pk_bf16_f32 v216, v120, v121
    v_cvt_pk_bf16_f32 v217, v122, v123
    v_mfma_f32_32x32x16_bf16 v[152:167], v[68:71], v[36:39], v[152:167]
    v_exp_f32 v128, v128
    v_exp_f32 v129, v129
    v_exp_f32 v130, v130
    v_exp_f32 v131, v131
    v_smfmac_f32_16x16x64_bf16 v[248:251], v[48:51], v[232:239], v31
    v_cvt_pk_bf16_f32 v218, v124, v125
    v_cvt_pk_bf16_f32 v219, v126, v127
    v_exp_f32 v132, v132
    v_exp_f32 v133, v133
    v_exp_f32 v134, v134
    v_mfma_f32_32x32x16_bf16 v[184:199], v[84:87], v[236:239], v[184:199]
    v_exp_f32 v135, v135
    v_cvt_pk_bf16_f32 v220, v128, v129
    v_cvt_pk_bf16_f32 v221, v130, v131
    v_cvt_pk_bf16_f32 v222, v132, v133
    v_cvt_pk_bf16_f32 v223, v134, v135
    v_mfma_f32_32x32x16_bf16 v[168:183], v[64:67], v[40:43], v[104:119]
    v_exp_f32 v136, v136
    v_exp_f32 v137, v137
    v_exp_f32 v138, v138
    v_exp_f32 v139, v139
    v_exp_f32 v140, v140
    v_mfma_f32_32x32x16_bf16 v[200:215], v[80:83], v[240:243], v[200:215]
    v_exp_f32 v141, v141
    v_exp_f32 v142, v142
    v_exp_f32 v143, v143
    v_cvt_pk_bf16_f32 v224, v136, v137
    v_cvt_pk_bf16_f32 v225, v138, v139
    v_mfma_f32_32x32x16_bf16 v[168:183], v[68:71], v[44:47], v[168:183]
    v_exp_f32 v144, v144
    v_exp_f32 v145, v145
    v_exp_f32 v146, v146
    v_exp_f32 v147, v147
    v_smfmac_f32_16x16x64_bf16 v[252:255], v[48:51], v[240:247], v31
    v_cvt_pk_bf16_f32 v226, v140, v141
    v_cvt_pk_bf16_f32 v227, v142, v143
    v_exp_f32 v148, v148
    v_exp_f32 v149, v149
    v_exp_f32 v150, v150
    v_mfma_f32_32x32x16_bf16 v[200:215], v[84:87], v[244:247], v[200:215]
    v_exp_f32 v151, v151
    v_cvt_pk_bf16_f32 v228, v144, v145
    v_cvt_pk_bf16_f32 v229, v146, v147
    v_cvt_pk_bf16_f32 v230, v148, v149
    v_cvt_pk_bf16_f32 v231, v150, v151
    s_waitcnt lgkmcnt(0)
    v_mfma_f32_32x32x16_bf16 v[184:199], v[72:75], v[216:219], v[184:199]
    ds_read_b128 v[80:83], v30 offset:14336
    ds_read_b128 v[84:87], v30 offset:15360
    v_exp_f32 v152, v152
    v_exp_f32 v153, v153
    v_exp_f32 v154, v154
    v_exp_f32 v155, v155
    v_exp_f32 v156, v156
    v_exp_f32 v157, v157
    v_exp_f32 v158, v158
    v_exp_f32 v159, v159
    v_mfma_f32_32x32x16_bf16 v[184:199], v[76:79], v[220:223], v[184:199]
    v_cvt_pk_bf16_f32 v232, v152, v153
    v_cvt_pk_bf16_f32 v233, v154, v155
    v_exp_f32 v160, v160
    v_exp_f32 v161, v161
    v_exp_f32 v162, v162
    v_exp_f32 v163, v163
    v_cvt_pk_bf16_f32 v234, v156, v157
    v_cvt_pk_bf16_f32 v235, v158, v159
    v_smfmac_f32_16x16x64_bf16 v[248:251], v[48:51], v[216:223], v31
    v_exp_f32 v164, v164
    v_exp_f32 v165, v165
    v_exp_f32 v166, v166
    v_exp_f32 v167, v167
    v_cvt_pk_bf16_f32 v236, v160, v161
    v_cvt_pk_bf16_f32 v237, v162, v163
    v_cvt_pk_bf16_f32 v238, v164, v165
    v_cvt_pk_bf16_f32 v239, v166, v167
    v_mfma_f32_32x32x16_bf16 v[200:215], v[72:75], v[224:227], v[200:215]
    v_exp_f32 v168, v168
    v_exp_f32 v169, v169
    v_exp_f32 v170, v170
    v_exp_f32 v171, v171
    v_exp_f32 v172, v172
    v_exp_f32 v173, v173
    v_exp_f32 v174, v174
    v_exp_f32 v175, v175
    v_mfma_f32_32x32x16_bf16 v[200:215], v[76:79], v[228:231], v[200:215]
    v_cvt_pk_bf16_f32 v240, v168, v169
    v_cvt_pk_bf16_f32 v241, v170, v171
    v_exp_f32 v176, v176
    v_exp_f32 v177, v177
    v_exp_f32 v178, v178
    v_exp_f32 v179, v179
    v_cvt_pk_bf16_f32 v242, v172, v173
    v_cvt_pk_bf16_f32 v243, v174, v175
    v_smfmac_f32_16x16x64_bf16 v[252:255], v[48:51], v[224:231], v31
    v_exp_f32 v180, v180
    v_exp_f32 v181, v181
    v_exp_f32 v182, v182
    v_exp_f32 v183, v183
    v_cvt_pk_bf16_f32 v244, v176, v177
    v_cvt_pk_bf16_f32 v245, v178, v179
    v_cvt_pk_bf16_f32 v246, v180, v181
    v_cvt_pk_bf16_f32 v247, v182, v183
    s_waitcnt lgkmcnt(0)
    s_nop 0
    v_mfma_f32_32x32x16_bf16 v[184:199], v[80:83], v[232:235], v[184:199]
    v_mfma_f32_32x32x16_bf16 v[184:199], v[84:87], v[236:239], v[184:199]
    v_smfmac_f32_16x16x64_bf16 v[248:251], v[48:51], v[232:239], v31
    v_mfma_f32_32x32x16_bf16 v[200:215], v[80:83], v[240:243], v[200:215]
    v_mfma_f32_32x32x16_bf16 v[200:215], v[84:87], v[244:247], v[200:215]
    v_smfmac_f32_16x16x64_bf16 v[252:255], v[48:51], v[240:247], v31
    s_nop 15
    v_add_f32 v2, v248, v252
    v_add_f32 v3, v249, v253
    v_add_f32 v2, v2, v3
    v_fmac_f32 v2, 0, v184
    v_fmac_f32 v2, 0, v185
    v_fmac_f32 v2, 0, v186
    v_fmac_f32 v2, 0, v187
    v_fmac_f32 v2, 0, v188
    v_fmac_f32 v2, 0, v189
    v_fmac_f32 v2, 0, v190
    v_fmac_f32 v2, 0, v191
    v_fmac_f32 v2, 0, v192
    v_fmac_f32 v2, 0, v193
    v_fmac_f32 v2, 0, v194
    v_fmac_f32 v2, 0, v195
    v_fmac_f32 v2, 0, v196
    v_fmac_f32 v2, 0, v197
    v_fmac_f32 v2, 0, v198
    v_fmac_f32 v2, 0, v199
    v_fmac_f32 v2, 0, v200
    v_fmac_f32 v2, 0, v201
    v_fmac_f32 v2, 0, v202
    v_fmac_f32 v2, 0, v203
    v_fmac_f32 v2, 0, v204
    v_fmac_f32 v2, 0, v205
    v_fmac_f32 v2, 0, v206
    v_fmac_f32 v2, 0, v207
    v_fmac_f32 v2, 0, v208
    v_fmac_f32 v2, 0, v209
    v_fmac_f32 v2, 0, v210
    v_fmac_f32 v2, 0, v211
    v_fmac_f32 v2, 0, v212
    v_fmac_f32 v2, 0, v213
    v_fmac_f32 v2, 0, v214
    v_fmac_f32 v2, 0, v215
    v_mov_b32 v3, 0x207
    v_cmp_class_f32 vcc, v2, v3
    s_nop 4
    s_cbranch_vccnz L_slow_10
L_fin_11:
    v_add_f32 v2, v248, v249
    v_add_f32 v3, v252, v253
    v_rcp_f32 v2, v2
    v_rcp_f32 v3, v3
    s_nop 0
    v_mul_f32 v184, v184, v2
    v_mul_f32 v185, v185, v2
    v_mul_f32 v186, v186, v2
    v_mul_f32 v187, v187, v2
    v_mul_f32 v188, v188, v2
    v_mul_f32 v189, v189, v2
    v_mul_f32 v190, v190, v2
    v_mul_f32 v191, v191, v2
    v_mul_f32 v192, v192, v2
    v_mul_f32 v193, v193, v2
    v_mul_f32 v194, v194, v2
    v_mul_f32 v195, v195, v2
    v_mul_f32 v196, v196, v2
    v_mul_f32 v197, v197, v2
    v_mul_f32 v198, v198, v2
    v_mul_f32 v199, v199, v2
    v_cvt_pk_bf16_f32 v216, v184, v185
    v_cvt_pk_bf16_f32 v217, v186, v187
    v_cvt_pk_bf16_f32 v218, v188, v189
    v_cvt_pk_bf16_f32 v219, v190, v191
    v_cvt_pk_bf16_f32 v220, v192, v193
    v_cvt_pk_bf16_f32 v221, v194, v195
    v_cvt_pk_bf16_f32 v222, v196, v197
    v_cvt_pk_bf16_f32 v223, v198, v199
    buffer_store_dwordx4 v[216:219], v15, s[44:47], s40 offen offset:0 sc1
    buffer_store_dwordx4 v[220:223], v15, s[44:47], s40 offen offset:512 sc1
    v_mul_f32 v200, v200, v3
    v_mul_f32 v201, v201, v3
    v_mul_f32 v202, v202, v3
    v_mul_f32 v203, v203, v3
    v_mul_f32 v204, v204, v3
    v_mul_f32 v205, v205, v3
    v_mul_f32 v206, v206, v3
    v_mul_f32 v207, v207, v3
    v_mul_f32 v208, v208, v3
    v_mul_f32 v209, v209, v3
    v_mul_f32 v210, v210, v3
    v_mul_f32 v211, v211, v3
    v_mul_f32 v212, v212, v3
    v_mul_f32 v213, v213, v3
    v_mul_f32 v214, v214, v3
    v_mul_f32 v215, v215, v3
    v_cvt_pk_bf16_f32 v224, v200, v201
    v_cvt_pk_bf16_f32 v225, v202, v203
    v_cvt_pk_bf16_f32 v226, v204, v205
    v_cvt_pk_bf16_f32 v227, v206, v207
    v_cvt_pk_bf16_f32 v228, v208, v209
    v_cvt_pk_bf16_f32 v229, v210, v211
    v_cvt_pk_bf16_f32 v230, v212, v213
    v_cvt_pk_bf16_f32 v231, v214, v215
    buffer_store_dwordx4 v[224:227], v15, s[44:47], s40 offen offset:2048 sc1
    buffer_store_dwordx4 v[228:231], v15, s[44:47], s40 offen offset:2560 sc1
    s_branch L_p2x_12
L_slow_10:
    s_add_u32 s92, s82, 0x800000
    s_addc_u32 s93, s83, 0
    s_mov_b32 s94, 0x800000
    s_mov_b32 s95, 0x20000
    v_mov_b32 v5, 0xff800000
    v_mov_b32 v6, 0xff800000
    s_mov_b32 s4, s39
    s_mov_b32 s5, 64
L_s1_13:
    buffer_load_dwordx4 v[56:59], v24, s[92:95], s4 offen offset:0
    buffer_load_dwordx4 v[60:63], v24, s[92:95], s4 offen offset:1024
    s_waitcnt vmcnt(0)
    v_mfma_f32_32x32x16_bf16 v[120:135], v[56:59], v[32:35], 0
    v_mfma_f32_32x32x16_bf16 v[120:135], v[60:63], v[36:39], v[120:135]
    v_mfma_f32_32x32x16_bf16 v[136:151], v[56:59], v[40:43], 0
    v_mfma_f32_32x32x16_bf16 v[136:151], v[60:63], v[44:47], v[136:151]
    s_nop 15
    v_max3_f32 v2, v120, v121, v122
    v_max3_f32 v2, v2, v123, v124
    v_max3_f32 v2, v2, v125, v126
    v_max3_f32 v2, v2, v127, v128
    v_max3_f32 v2, v2, v129, v130
    v_max3_f32 v2, v2, v131, v132
    v_max3_f32 v2, v2, v133, v134
    v_max_f32 v2, v2, v135
    v_max_f32 v5, v5, v2
    v_max3_f32 v2, v136, v137, v138
    v_max3_f32 v2, v2, v139, v140
    v_max3_f32 v2, v2, v141, v142
    v_max3_f32 v2, v2, v143, v144
    v_max3_f32 v2, v2, v145, v146
    v_max3_f32 v2, v2, v147, v148
    v_max3_f32 v2, v2, v149, v150
    v_max_f32 v2, v2, v151
    v_max_f32 v6, v6, v2
    s_add_u32 s4, s4, 4096
    s_sub_u32 s5, s5, 1
    s_cmp_lg_u32 s5, 0
    s_cbranch_scc1 L_s1_13
    v_mov_b32 v4, v5
    s_nop 1
    v_permlane32_swap_b32 v5, v4
    v_max_f32 v5, v5, v4
    v_sub_f32 v88, 0, v5
    v_sub_f32 v89, 0, v5
    v_sub_f32 v90, 0, v5
    v_sub_f32 v91, 0, v5
    v_sub_f32 v92, 0, v5
    v_sub_f32 v93, 0, v5
    v_sub_f32 v94, 0, v5
    v_sub_f32 v95, 0, v5
    v_sub_f32 v96, 0, v5
    v_sub_f32 v97, 0, v5
    v_sub_f32 v98, 0, v5
    v_sub_f32 v99, 0, v5
    v_sub_f32 v100, 0, v5
    v_sub_f32 v101, 0, v5
    v_sub_f32 v102, 0, v5
    v_sub_f32 v103, 0, v5
    v_mov_b32 v4, v6
    s_nop 1
    v_permlane32_swap_b32 v6, v4
    v_max_f32 v6, v6, v4
    v_sub_f32 v104, 0, v6
    v_sub_f32 v105, 0, v6
    v_sub_f32 v106, 0, v6
    v_sub_f32 v107, 0, v6
    v_sub_f32 v108, 0, v6
    v_sub_f32 v109, 0, v6
    v_sub_f32 v110, 0, v6
    v_sub_f32 v111, 0, v6
    v_sub_f32 v112, 0, v6
    v_sub_f32 v113, 0, v6
    v_sub_f32 v114, 0, v6
    v_sub_f32 v115, 0, v6
    v_sub_f32 v116, 0, v6
    v_sub_f32 v117, 0, v6
    v_sub_f32 v118, 0, v6
    v_sub_f32 v119, 0, v6
    v_mov_b32 v184, 0
    v_mov_b32 v185, 0
    v_mov_b32 v186, 0
    v_mov_b32 v187, 0
    v_mov_b32 v188, 0
    v_mov_b32 v189, 0
    v_mov_b32 v190, 0
    v_mov_b32 v191, 0
    v_mov_b32 v192, 0
    v_mov_b32 v193, 0
    v_mov_b32 v194, 0
    v_mov_b32 v195, 0
    v_mov_b32 v196, 0
    v_mov_b32 v197, 0
    v_mov_b32 v198, 0
    v_mov_b32 v199, 0
    v_mov_b32 v200, 0
    v_mov_b32 v201, 0
    v_mov_b32 v202, 0
    v_mov_b32 v203, 0
    v_mov_b32 v204, 0
    v_mov_b32 v205, 0
    v_mov_b32 v206, 0
    v_mov_b32 v207, 0
    v_mov_b32 v208, 0
    v_mov_b32 v209, 0
    v_mov_b32 v210, 0
    v_mov_b32 v211, 0
    v_mov_b32 v212, 0
    v_mov_b32 v213, 0
    v_mov_b32 v214, 0
    v_mov_b32 v215, 0
    v_mov_b32 v248, 0
    v_mov_b32 v249, 0
    v_mov_b32 v250, 0
    v_mov_b32 v251, 0
    v_mov_b32 v252, 0
    v_mov_b32 v253, 0
    v_mov_b32 v254, 0
    v_mov_b32 v255, 0
    s_mov_b32 s4, s39
    s_mov_b32 s5, 64
L_s2_14:
    buffer_load_dwordx4 v[56:59], v24, s[92:95], s4 offen offset:0
    buffer_load_dwordx4 v[72:75], v24, s[92:95], s4 offen offset:2048
    buffer_load_dwordx4 v[60:63], v24, s[92:95], s4 offen offset:1024
    buffer_load_dwordx4 v[76:79], v24, s[92:95], s4 offen offset:3072
    s_waitcnt vmcnt(0)
    v_mfma_f32_32x32x16_bf16 v[120:135], v[56:59], v[32:35], v[88:103]
    v_mfma_f32_32x32x16_bf16 v[120:135], v[60:63], v[36:39], v[120:135]
    v_mfma_f32_32x32x16_bf16 v[136:151], v[56:59], v[40:43], v[104:119]
    v_mfma_f32_32x32x16_bf16 v[136:151], v[60:63], v[44:47], v[136:151]
    s_nop 15
    v_exp_f32 v120, v120
    v_exp_f32 v121, v121
    v_exp_f32 v122, v122
    v_exp_f32 v123, v123
    v_exp_f32 v124, v124
    v_exp_f32 v125, v125
    v_exp_f32 v126, v126
    v_exp_f32 v127, v127
    v_cvt_pk_bf16_f32 v216, v120, v121
    v_cvt_pk_bf16_f32 v217, v122, v123
    v_exp_f32 v128, v128
    v_exp_f32 v129, v129
    v_exp_f32 v130, v130
    v_exp_f32 v131, v131
    v_cvt_pk_bf16_f32 v218, v124, v125
    v_cvt_pk_bf16_f32 v219, v126, v127
    v_exp_f32 v132, v132
    v_exp_f32 v133, v133
    v_exp_f32 v134, v134
    v_exp_f32 v135, v135
    v_cvt_pk_bf16_f32 v220, v128, v129
    v_cvt_pk_bf16_f32 v221, v130, v131
    v_cvt_pk_bf16_f32 v222, v132, v133
    v_cvt_pk_bf16_f32 v223, v134, v135
    v_exp_f32 v136, v136
    v_exp_f32 v137, v137
    v_exp_f32 v138, v138
    v_exp_f32 v139, v139
    v_exp_f32 v140, v140
    v_exp_f32 v141, v141
    v_exp_f32 v142, v142
    v_exp_f32 v143, v143
    v_cvt_pk_bf16_f32 v224, v136, v137
    v_cvt_pk_bf16_f32 v225, v138, v139
    v_exp_f32 v144, v144
    v_exp_f32 v145, v145
    v_exp_f32 v146, v146
    v_exp_f32 v147, v147
    v_cvt_pk_bf16_f32 v226, v140, v141
    v_cvt_pk_bf16_f32 v227, v142, v143
    v_exp_f32 v148, v148
    v_exp_f32 v149, v149
    v_exp_f32 v150, v150
    v_exp_f32 v151, v151
    v_cvt_pk_bf16_f32 v228, v144, v145
    v_cvt_pk_bf16_f32 v229, v146, v147
    v_cvt_pk_bf16_f32 v230, v148, v149
    v_cvt_pk_bf16_f32 v231, v150, v151
    s_nop 1
    v_mfma_f32_32x32x16_bf16 v[184:199], v[72:75], v[216:219], v[184:199]
    v_mfma_f32_32x32x16_bf16 v[184:199], v[76:79], v[220:223], v[184:199]
    v_smfmac_f32_16x16x64_bf16 v[248:251], v[48:51], v[216:223], v31
    v_mfma_f32_32x32x16_bf16 v[200:215], v[72:75], v[224:227], v[200:215]
    v_mfma_f32_32x32x16_bf16 v[200:215], v[76:79], v[228:231], v[200:215]
    v_smfmac_f32_16x16x64_bf16 v[252:255], v[48:51], v[224:231], v31
    s_nop 15
    s_add_u32 s4, s4, 4096
    s_sub_u32 s5, s5, 1
    s_cmp_lg_u32 s5, 0
    s_cbranch_scc1 L_s2_14
    s_branch L_fin_11
L_p2x_12:
    s_add_u32 s8, s82, 0x1000000
    s_addc_u32 s9, s83, 0
    s_mov_b32 s10, 0x400000
    s_mov_b32 s11, 0x20000
    s_add_u32 s48, s82, 0x1400000
    s_addc_u32 s49, s83, 0
    s_mov_b32 s50, 0x400000
    s_mov_b32 s51, 0x20000
    s_add_u32 s52, s82, 0x2800000
    s_addc_u32 s53, s83, 0
    s_mov_b32 s54, 0x80000
    s_mov_b32 s55, 0x20000
    v_lshlrev_b32 v24, 4, v1
    s_lshl_b32 s16, s32, 18
    s_lshl_b32 s4, s3, 11
    s_add_u32 s16, s16, s4
    s_lshl_b32 s57, s33, 14
    s_add_u32 s57, s57, s16
    s_add_u32 s58, s57, 8192
    v_bfe_u32 v2, v1, 3, 2
    v_xor_b32 v2, 0, v2
    v_lshlrev_b32 v9, 5, v2
    v_and_b32 v2, 3, v1
    v_lshl_add_u32 v9, v2, 3, v9
    v_bfe_u32 v2, v1, 2, 3
    v_lshl_add_u32 v9, v2, 7, v9
    v_lshrrev_b32 v2, 5, v1
    v_lshl_add_u32 v9, v2, 11, v9
    v_add_u32 v9, 32768, v9
    v_add_u32 v10, 49152, v9
    v_add_u32 v11, 98304, v9
    v_bfe_u32 v2, v1, 3, 2
    v_xor_b32 v2, 1, v2
    v_lshlrev_b32 v12, 5, v2
    v_and_b32 v2, 3, v1
    v_lshl_add_u32 v12, v2, 3, v12
    v_bfe_u32 v2, v1, 2, 3
    v_lshl_add_u32 v12, v2, 7, v12
    v_lshrrev_b32 v2, 5, v1
    v_lshl_add_u32 v12, v2, 11, v12
    v_add_u32 v12, 32768, v12
    v_add_u32 v13, 49152, v12
    v_add_u32 v14, 98304, v12
    v_bfe_u32 v2, v1, 3, 2
    v_xor_b32 v2, 2, v2
    v_lshlrev_b32 v15, 5, v2
    v_and_b32 v2, 3, v1
    v_lshl_add_u32 v15, v2, 3, v15
    v_bfe_u32 v2, v1, 2, 3
    v_lshl_add_u32 v15, v2, 7, v15
    v_lshrrev_b32 v2, 5, v1
    v_lshl_add_u32 v15, v2, 11, v15
    v_add_u32 v15, 32768, v15
    v_add_u32 v16, 49152, v15
    v_add_u32 v17, 98304, v15
    v_bfe_u32 v2, v1, 3, 2
    v_xor_b32 v2, 3, v2
    v_lshlrev_b32 v18, 5, v2
    v_and_b32 v2, 3, v1
    v_lshl_add_u32 v18, v2, 3, v18
    v_bfe_u32 v2, v1, 2, 3
    v_lshl_add_u32 v18, v2, 7, v18
    v_lshrrev_b32 v2, 5, v1
    v_lshl_add_u32 v18, v2, 11, v18
    v_add_u32 v18, 32768, v18
    v_add_u32 v19, 49152, v18
    v_add_u32 v20, 98304, v18
    v_accvgpr_read_b32 v33, a128
    v_accvgpr_read_b32 v35, a129
    v_accvgpr_read_b32 v37, a130
    v_accvgpr_read_b32 v39, a131
    v_accvgpr_read_b32 v41, a132
    v_accvgpr_read_b32 v43, a133
    v_accvgpr_read_b32 v45, a134
    v_accvgpr_read_b32 v47, a135
    v_accvgpr_read_b32 v49, a136
    v_accvgpr_read_b32 v51, a137
    v_accvgpr_read_b32 v53, a138
    v_accvgpr_read_b32 v55, a139
    v_accvgpr_read_b32 v57, a140
    v_accvgpr_read_b32 v59, a141
    v_accvgpr_read_b32 v61, a142
    v_accvgpr_read_b32 v63, a143
    v_lshlrev_b32 v32, 16, v33
    v_and_b32 v33, 0xffff0000, v33
    v_lshlrev_b32 v34, 16, v35
    v_and_b32 v35, 0xffff0000, v35
    v_lshlrev_b32 v36, 16, v37
    v_and_b32 v37, 0xffff0000, v37
    v_lshlrev_b32 v38, 16, v39
    v_and_b32 v39, 0xffff0000, v39
    v_lshlrev_b32 v40, 16, v41
    v_and_b32 v41, 0xffff0000, v41
    v_lshlrev_b32 v42, 16, v43
    v_and_b32 v43, 0xffff0000, v43
    v_lshlrev_b32 v44, 16, v45
    v_and_b32 v45, 0xffff0000, v45
    v_lshlrev_b32 v46, 16, v47
    v_and_b32 v47, 0xffff0000, v47
    v_lshlrev_b32 v48, 16, v49
    v_and_b32 v49, 0xffff0000, v49
    v_lshlrev_b32 v50, 16, v51
    v_and_b32 v51, 0xffff0000, v51
    v_lshlrev_b32 v52, 16, v53
    v_and_b32 v53, 0xffff0000, v53
    v_lshlrev_b32 v54, 16, v55
    v_and_b32 v55, 0xffff0000, v55
    v_lshlrev_b32 v56, 16, v57
    v_and_b32 v57, 0xffff0000, v57
    v_lshlrev_b32 v58, 16, v59
    v_and_b32 v59, 0xffff0000, v59
    v_lshlrev_b32 v60, 16, v61
    v_and_b32 v61, 0xffff0000, v61
    v_lshlrev_b32 v62, 16, v63
    v_and_b32 v63, 0xffff0000, v63
    s_lshl_b32 s4, s35, 2
    s_add_u32 s4, s4, s3
    s_lshl_b32 s4, s4, 5
    s_add_u32 s4, s4, s34
    s_lshl_b32 s4, s4, 7
    s_add_u32 s4, s4, 524288
    v_mov_b32 v2, s88
    v_mov_b32 v3, 0
    s_mov_b64 exec, 1
    s_waitcnt vmcnt(0)
    buffer_store_dword v2, v3, s[84:87], s4 offen sc1
    s_mov_b64 exec, -1
    s_barrier
    s_cmp_lg_u32 s3, 0
    s_cbranch_scc1 L_s2_15
    s_lshl_b32 s4, s2, 2
    s_add_u32 s4, s4, 7168
    s_mov_b64 exec, 1
    buffer_store_dword v2, v3, s[84:87], s4 offen sc1
    s_mov_b64 exec, -1
L_s2_15:
    s_add_u32 m0, s20, 98304
    s_nop 0
    buffer_load_dwordx4 v26, s[12:15], s17 offen lds
    s_add_u32 m0, s20, 102400
    s_nop 0
    buffer_load_dwordx4 v27, s[12:15], s17 offen lds
    s_add_u32 s17, s17, 131072
    s_add_u32 m0, s20, 106496
    s_nop 0
    buffer_load_dwordx4 v26, s[12:15], s17 offen lds
    s_add_u32 m0, s20, 110592
    s_nop 0
    buffer_load_dwordx4 v27, s[12:15], s17 offen lds
    s_add_u32 s17, s17, 131072
    s_add_u32 m0, s20, 114688
    s_nop 0
    buffer_load_dwordx4 v26, s[12:15], s17 offen lds
    s_add_u32 m0, s20, 118784
    s_nop 0
    buffer_load_dwordx4 v27, s[12:15], s17 offen lds
    s_add_u32 s17, s17, 131072
    s_add_u32 m0, s20, 122880
    s_nop 0
    buffer_load_dwordx4 v26, s[12:15], s17 offen lds
    s_add_u32 m0, s20, 126976
    s_nop 0
    buffer_load_dwordx4 v27, s[12:15], s17 offen lds
    s_add_u32 s17, s17, 131072
    s_add_u32 m0, s20, 131072
    s_nop 0
    buffer_load_dwordx4 v26, s[12:15], s17 offen lds
    s_add_u32 m0, s20, 135168
    s_nop 0
    buffer_load_dwordx4 v27, s[12:15], s17 offen lds
    s_add_u32 s17, s17, 131072
    s_add_u32 m0, s20, 139264
    s_nop 0
    buffer_load_dwordx4 v26, s[12:15], s17 offen lds
    s_add_u32 m0, s20, 143360
    s_nop 0
    buffer_load_dwordx4 v27, s[12:15], s17 offen lds
    s_add_u32 s17, s17, 131072
    s_add_u32 m0, s20, 147456
    s_nop 0
    buffer_load_dwordx4 v26, s[12:15], s17 offen lds
    s_add_u32 m0, s20, 151552
    s_nop 0
    buffer_load_dwordx4 v27, s[12:15], s17 offen lds
    s_add_u32 s17, s17, 131072
    s_add_u32 m0, s20, 155648
    s_nop 0
    buffer_load_dwordx4 v26, s[12:15], s17 offen lds
    s_add_u32 m0, s20, 159744
    s_nop 0
    buffer_load_dwordx4 v27, s[12:15], s17 offen lds
    s_add_u32 s17, s17, 131072
    ds_read_b64_tr_b16 v[96:97], v9 offset:0
    ds_read_b64_tr_b16 v[98:99], v9 offset:1024
    ds_read_b64_tr_b16 v[100:101], v12 offset:0
    ds_read_b64_tr_b16 v[102:103], v12 offset:1024
    ds_read_b64_tr_b16 v[104:105], v15 offset:0
    ds_read_b64_tr_b16 v[106:107], v15 offset:1024
    ds_read_b64_tr_b16 v[108:109], v18 offset:0
    ds_read_b64_tr_b16 v[110:111], v18 offset:1024
    ds_read_b64_tr_b16 v[112:113], v9 offset:4096
    ds_read_b64_tr_b16 v[114:115], v9 offset:5120
    ds_read_b64_tr_b16 v[116:117], v12 offset:4096
    ds_read_b64_tr_b16 v[118:119], v12 offset:5120
    ds_read_b64_tr_b16 v[120:121], v15 offset:4096
    ds_read_b64_tr_b16 v[122:123], v15 offset:5120
    ds_read_b64_tr_b16 v[124:125], v18 offset:4096
    ds_read_b64_tr_b16 v[126:127], v18 offset:5120
    s_lshr_b32 s5, s32, 1
    s_lshl_b32 s5, s5, 2
    s_and_b32 s6, s32, 1
    s_lshl_b32 s6, s6, 1
    s_add_u32 s5, s5, s6
    s_add_u32 s5, s5, s36
    s_lshl_b32 s5, s5, 12
    s_add_u32 s5, s5, 524288
    v_lshlrev_b32 v2, 7, v1
    s_mov_b64 exec, 0xffffffff
    s_mov_b32 s4, 0x20000
L_spin_16:
    buffer_load_dword v4, v2, s[84:87], s5 offen sc1
    s_waitcnt vmcnt(0)
    v_cmp_ne_u32 vcc, s88, v4
    s_sub_u32 s4, s4, 1
    s_nop 3
    s_cbranch_vccz L_spin_16_ok
    s_cmp_eq_u32 s4, 0
    s_cbranch_scc0 L_spin_16
L_spin_16_ok:
    s_mov_b64 exec, -1
    buffer_load_dwordx4 a[0:3], v24, s[8:11], s16 offen
    buffer_load_dwordx4 a[4:7], v24, s[8:11], s16 offen offset:1024
    s_add_u32 s16, s16, 8192
    buffer_load_dwordx4 a[8:11], v24, s[8:11], s16 offen
    buffer_load_dwordx4 a[12:15], v24, s[8:11], s16 offen offset:1024
    s_add_u32 s16, s16, 8192
    buffer_load_dwordx4 a[16:19], v24, s[8:11], s16 offen
    buffer_load_dwordx4 a[20:23], v24, s[8:11], s16 offen offset:1024
    s_add_u32 s16, s16, 8192
    buffer_load_dwordx4 a[24:27], v24, s[8:11], s16 offen
    buffer_load_dwordx4 a[28:31], v24, s[8:11], s16 offen offset:1024
    s_add_u32 s16, s16, 8192
    s_lshl_b32 s61, s3, 8
    s_add_u32 s61, s61, 7168
    v_lshlrev_b32 v7, 2, v1
    buffer_load_dword v90, v7, s[84:87], s61 offen sc1
    buffer_load_dwordx4 a[32:35], v24, s[8:11], s16 offen
    buffer_load_dwordx4 a[36:39], v24, s[8:11], s16 offen offset:1024
    s_add_u32 s16, s16, 8192
    buffer_load_dwordx4 a[40:43], v24, s[8:11], s16 offen
    buffer_load_dwordx4 a[44:47], v24, s[8:11], s16 offen offset:1024
    s_add_u32 s16, s16, 8192
    buffer_load_dwordx4 a[48:51], v24, s[8:11], s16 offen
    buffer_load_dwordx4 a[52:55], v24, s[8:11], s16 offen offset:1024
    s_add_u32 s16, s16, 8192
    buffer_load_dwordx4 a[56:59], v24, s[8:11], s16 offen
    buffer_load_dwordx4 a[60:63], v24, s[8:11], s16 offen offset:1024
    s_add_u32 s16, s16, 8192
    s_waitcnt vmcnt(15) lgkmcnt(8)
    v_mfma_f32_16x16x32_bf16 v[32:35], v[96:99], a[0:3], v[32:35]
    ds_read_b64_tr_b16 v[128:129], v9 offset:8192
    v_mfma_f32_16x16x32_bf16 v[36:39], v[100:103], a[0:3], v[36:39]
    ds_read_b64_tr_b16 v[130:131], v9 offset:9216
    buffer_load_dwordx4 a[64:67], v24, s[8:11], s16 offen
    v_mfma_f32_16x16x32_bf16 v[40:43], v[104:107], a[0:3], v[40:43]
    ds_read_b64_tr_b16 v[132:133], v12 offset:8192
    v_mfma_f32_16x16x32_bf16 v[44:47], v[108:111], a[0:3], v[44:47]
    ds_read_b64_tr_b16 v[134:135], v12 offset:9216
    v_mfma_f32_16x16x32_bf16 v[48:51], v[96:99], a[4:7], v[48:51]
    ds_read_b64_tr_b16 v[136:137], v15 offset:8192
    buffer_load_dwordx4 a[68:71], v24, s[8:11], s16 offen offset:1024
    v_mfma_f32_16x16x32_bf16 v[52:55], v[100:103], a[4:7], v[52:55]
    ds_read_b64_tr_b16 v[138:139], v15 offset:9216
    v_mfma_f32_16x16x32_bf16 v[56:59], v[104:107], a[4:7], v[56:59]
    ds_read_b64_tr_b16 v[140:141], v18 offset:8192
    s_add_u32 s16, s16, 8192
    v_mfma_f32_16x16x32_bf16 v[60:63], v[108:111], a[4:7], v[60:63]
    ds_read_b64_tr_b16 v[142:143], v18 offset:9216
    s_waitcnt vmcnt(15) lgkmcnt(8)
    v_mfma_f32_16x16x32_bf16 v[32:35], v[112:115], a[8:11], v[32:35]
    ds_read_b64_tr_b16 v[96:97], v9 offset:12288
    v_mfma_f32_16x16x32_bf16 v[36:39], v[116:119], a[8:11], v[36:39]
    ds_read_b64_tr_b16 v[98:99], v9 offset:13312
    buffer_load_dwordx4 a[72:75], v24, s[8:11], s16 offen
    v_mfma_f32_16x16x32_bf16 v[40:43], v[120:123], a[8:11], v[40:43]
    ds_read_b64_tr_b16 v[100:101], v12 offset:12288
    v_mfma_f32_16x16x32_bf16 v[44:47], v[124:127], a[8:11], v[44:47]
    ds_read_b64_tr_b16 v[102:103], v12 offset:13312
    v_mfma_f32_16x16x32_bf16 v[48:51], v[112:115], a[12:15], v[48:51]
    ds_read_b64_tr_b16 v[104:105], v15 offset:12288
    buffer_load_dwordx4 a[76:79], v24, s[8:11], s16 offen offset:1024
    v_mfma_f32_16x16x32_bf16 v[52:55], v[116:119], a[12:15], v[52:55]
    ds_read_b64_tr_b16 v[106:107], v15 offset:13312
    v_mfma_f32_16x16x32_bf16 v[56:59], v[120:123], a[12:15], v[56:59]
    ds_read_b64_tr_b16 v[108:109], v18 offset:12288
    s_add_u32 s16, s16, 8192
    v_mfma_f32_16x16x32_bf16 v[60:63], v[124:127], a[12:15], v[60:63]
    ds_read_b64_tr_b16 v[110:111], v18 offset:13312
    s_waitcnt vmcnt(15) lgkmcnt(8)
    v_mfma_f32_16x16x32_bf16 v[32:35], v[128:131], a[16:19], v[32:35]
    ds_read_b64_tr_b16 v[112:113], v9 offset:16384
    v_mfma_f32_16x16x32_bf16 v[36:39], v[132:135], a[16:19], v[36:39]
    ds_read_b64_tr_b16 v[114:115], v9 offset:17408
    buffer_load_dwordx4 a[80:83], v24, s[8:11], s16 offen
    v_mfma_f32_16x16x32_bf16 v[40:43], v[136:139], a[16:19], v[40:43]
    ds_read_b64_tr_b16 v[116:117], v12 offset:16384
    v_mfma_f32_16x16x32_bf16 v[44:47], v[140:143], a[16:19], v[44:47]
    ds_read_b64_tr_b16 v[118:119], v12 offset:17408
    v_mfma_f32_16x16x32_bf16 v[48:51], v[128:131], a[20:23], v[48:51]
    ds_read_b64_tr_b16 v[120:121], v15 offset:16384
    buffer_load_dwordx4 a[84:87], v24, s[8:11], s16 offen offset:1024
    v_mfma_f32_16x16x32_bf16 v[52:55], v[132:135], a[20:23], v[52:55]
    ds_read_b64_tr_b16 v[122:123], v15 offset:17408
    v_mfma_f32_16x16x32_bf16 v[56:59], v[136:139], a[20:23], v[56:59]
    ds_read_b64_tr_b16 v[124:125], v18 offset:16384
    s_add_u32 s16, s16, 8192
    v_mfma_f32_16x16x32_bf16 v[60:63], v[140:143], a[20:23], v[60:63]
    ds_read_b64_tr_b16 v[126:127], v18 offset:17408
    s_waitcnt vmcnt(15) lgkmcnt(8)
    v_mfma_f32_16x16x32_bf16 v[32:35], v[96:99], a[24:27], v[32:35]
    ds_read_b64_tr_b16 v[128:129], v9 offset:20480
    v_mfma_f32_16x16x32_bf16 v[36:39], v[100:103], a[24:27], v[36:39]
    ds_read_b64_tr_b16 v[130:131], v9 offset:21504
    buffer_load_dwordx4 a[88:91], v24, s[8:11], s16 offen
    v_mfma_f32_16x16x32_bf16 v[40:43], v[104:107], a[24:27], v[40:43]
    ds_read_b64_tr_b16 v[132:133], v12 offset:20480
    v_mfma_f32_16x16x32_bf16 v[44:47], v[108:111], a[24:27], v[44:47]
    ds_read_b64_tr_b16 v[134:135], v12 offset:21504
    v_mfma_f32_16x16x32_bf16 v[48:51], v[96:99], a[28:31], v[48:51]
    ds_read_b64_tr_b16 v[136:137], v15 offset:20480
    buffer_load_dwordx4 a[92:95], v24, s[8:11], s16 offen offset:1024
    v_mfma_f32_16x16x32_bf16 v[52:55], v[100:103], a[28:31], v[52:55]
    ds_read_b64_tr_b16 v[138:139], v15 offset:21504
    v_mfma_f32_16x16x32_bf16 v[56:59], v[104:107], a[28:31], v[56:59]
    ds_read_b64_tr_b16 v[140:141], v18 offset:20480
    s_add_u32 s16, s16, 8192
    v_mfma_f32_16x16x32_bf16 v[60:63], v[108:111], a[28:31], v[60:63]
    ds_read_b64_tr_b16 v[142:143], v18 offset:21504
    s_waitcnt vmcnt(14) lgkmcnt(8)
    v_mfma_f32_16x16x32_bf16 v[32:35], v[112:115], a[32:35], v[32:35]
    ds_read_b64_tr_b16 v[96:97], v9 offset:24576
    v_mfma_f32_16x16x32_bf16 v[36:39], v[116:119], a[32:35], v[36:39]
    ds_read_b64_tr_b16 v[98:99], v9 offset:25600
    buffer_load_dwordx4 a[96:99], v24, s[8:11], s16 offen
    v_mfma_f32_16x16x32_bf16 v[40:43], v[120:123], a[32:35], v[40:43]
    ds_read_b64_tr_b16 v[100:101], v12 offset:24576
    v_mfma_f32_16x16x32_bf16 v[44:47], v[124:127], a[32:35], v[44:47]
    ds_read_b64_tr_b16 v[102:103], v12 offset:25600
    v_mfma_f32_16x16x32_bf16 v[48:51], v[112:115], a[36:39], v[48:51]
    ds_read_b64_tr_b16 v[104:105], v15 offset:24576
    buffer_load_dwordx4 a[100:103], v24, s[8:11], s16 offen offset:1024
    v_mfma_f32_16x16x32_bf16 v[52:55], v[116:119], a[36:39], v[52:55]
    ds_read_b64_tr_b16 v[106:107], v15 offset:25600
    v_mfma_f32_16x16x32_bf16 v[56:59], v[120:123], a[36:39], v[56:59]
    ds_read_b64_tr_b16 v[108:109], v18 offset:24576
    s_add_u32 s16, s16, 8192
    v_mfma_f32_16x16x32_bf16 v[60:63], v[124:127], a[36:39], v[60:63]
    ds_read_b64_tr_b16 v[110:111], v18 offset:25600
    s_waitcnt vmcnt(14) lgkmcnt(8)
    v_mfma_f32_16x16x32_bf16 v[32:35], v[128:131], a[40:43], v[32:35]
    ds_read_b64_tr_b16 v[112:113], v9 offset:28672
    v_mfma_f32_16x16x32_bf16 v[36:39], v[132:135], a[40:43], v[36:39]
    ds_read_b64_tr_b16 v[114:115], v9 offset:29696
    buffer_load_dwordx4 a[104:107], v24, s[8:11], s16 offen
    v_mfma_f32_16x16x32_bf16 v[40:43], v[136:139], a[40:43], v[40:43]
    ds_read_b64_tr_b16 v[116:117], v12 offset:28672
    v_mfma_f32_16x16x32_bf16 v[44:47], v[140:143], a[40:43], v[44:47]
    ds_read_b64_tr_b16 v[118:119], v12 offset:29696
    v_mfma_f32_16x16x32_bf16 v[48:51], v[128:131], a[44:47], v[48:51]
    ds_read_b64_tr_b16 v[120:121], v15 offset:28672
    buffer_load_dwordx4 a[108:111], v24, s[8:11], s16 offen offset:1024
    v_mfma_f32_16x16x32_bf16 v[52:55], v[132:135], a[44:47], v[52:55]
    ds_read_b64_tr_b16 v[122:123], v15 offset:29696
    v_mfma_f32_16x16x32_bf16 v[56:59], v[136:139], a[44:47], v[56:59]
    ds_read_b64_tr_b16 v[124:125], v18 offset:28672
    s_add_u32 s16, s16, 8192
    v_mfma_f32_16x16x32_bf16 v[60:63], v[140:143], a[44:47], v[60:63]
    ds_read_b64_tr_b16 v[126:127], v18 offset:29696
    s_waitcnt vmcnt(14) lgkmcnt(8)
    v_mfma_f32_16x16x32_bf16 v[32:35], v[96:99], a[48:51], v[32:35]
    ds_read_b64_tr_b16 v[128:129], v9 offset:32768
    v_mfma_f32_16x16x32_bf16 v[36:39], v[100:103], a[48:51], v[36:39]
    ds_read_b64_tr_b16 v[130:131], v9 offset:33792
    buffer_load_dwordx4 a[112:115], v24, s[8:11], s16 offen
    v_mfma_f32_16x16x32_bf16 v[40:43], v[104:107], a[48:51], v[40:43]
    ds_read_b64_tr_b16 v[132:133], v12 offset:32768
    v_mfma_f32_16x16x32_bf16 v[44:47], v[108:111], a[48:51], v[44:47]
    ds_read_b64_tr_b16 v[134:135], v12 offset:33792
    v_mfma_f32_16x16x32_bf16 v[48:51], v[96:99], a[52:55], v[48:51]
    ds_read_b64_tr_b16 v[136:137], v15 offset:32768
    buffer_load_dwordx4 a[116:119], v24, s[8:11], s16 offen offset:1024
    v_mfma_f32_16x16x32_bf16 v[52:55], v[100:103], a[52:55], v[52:55]
    ds_read_b64_tr_b16 v[138:139], v15 offset:33792
    v_mfma_f32_16x16x32_bf16 v[56:59], v[104:107], a[52:55], v[56:59]
    ds_read_b64_tr_b16 v[140:141], v18 offset:32768
    s_add_u32 s16, s16, 8192
    v_mfma_f32_16x16x32_bf16 v[60:63], v[108:111], a[52:55], v[60:63]
    ds_read_b64_tr_b16 v[142:143], v18 offset:33792
    s_waitcnt vmcnt(14) lgkmcnt(8)
    v_mfma_f32_16x16x32_bf16 v[32:35], v[112:115], a[56:59], v[32:35]
    ds_read_b64_tr_b16 v[96:97], v9 offset:36864
    v_mfma_f32_16x16x32_bf16 v[36:39], v[116:119], a[56:59], v[36:39]
    ds_read_b64_tr_b16 v[98:99], v9 offset:37888
    buffer_load_dwordx4 a[120:123], v24, s[8:11], s16 offen
    v_mfma_f32_16x16x32_bf16 v[40:43], v[120:123], a[56:59], v[40:43]
    ds_read_b64_tr_b16 v[100:101], v12 offset:36864
    v_mfma_f32_16x16x32_bf16 v[44:47], v[124:127], a[56:59], v[44:47]
    ds_read_b64_tr_b16 v[102:103], v12 offset:37888
    v_mfma_f32_16x16x32_bf16 v[48:51], v[112:115], a[60:63], v[48:51]
    ds_read_b64_tr_b16 v[104:105], v15 offset:36864
    buffer_load_dwordx4 a[124:127], v24, s[8:11], s16 offen offset:1024
    v_mfma_f32_16x16x32_bf16 v[52:55], v[116:119], a[60:63], v[52:55]
    ds_read_b64_tr_b16 v[106:107], v15 offset:37888
    v_mfma_f32_16x16x32_bf16 v[56:59], v[120:123], a[60:63], v[56:59]
    ds_read_b64_tr_b16 v[108:109], v18 offset:36864
    s_add_u32 s16, s16, 8192
    v_mfma_f32_16x16x32_bf16 v[60:63], v[124:127], a[60:63], v[60:63]
    ds_read_b64_tr_b16 v[110:111], v18 offset:37888
    s_waitcnt vmcnt(14) lgkmcnt(8)
    v_mfma_f32_16x16x32_bf16 v[32:35], v[128:131], a[64:67], v[32:35]
    ds_read_b64_tr_b16 v[112:113], v9 offset:40960
    v_mfma_f32_16x16x32_bf16 v[36:39], v[132:135], a[64:67], v[36:39]
    ds_read_b64_tr_b16 v[114:115], v9 offset:41984
    buffer_load_dwordx4 a[128:131], v24, s[8:11], s16 offen
    v_mfma_f32_16x16x32_bf16 v[40:43], v[136:139], a[64:67], v[40:43]
    ds_read_b64_tr_b16 v[116:117], v12 offset:40960
    v_mfma_f32_16x16x32_bf16 v[44:47], v[140:143], a[64:67], v[44:47]
    ds_read_b64_tr_b16 v[118:119], v12 offset:41984
    v_mfma_f32_16x16x32_bf16 v[48:51], v[128:131], a[68:71], v[48:51]
    ds_read_b64_tr_b16 v[120:121], v15 offset:40960
    buffer_load_dwordx4 a[132:135], v24, s[8:11], s16 offen offset:1024
    v_mfma_f32_16x16x32_bf16 v[52:55], v[132:135], a[68:71], v[52:55]
    ds_read_b64_tr_b16 v[122:123], v15 offset:41984
    v_mfma_f32_16x16x32_bf16 v[56:59], v[136:139], a[68:71], v[56:59]
    ds_read_b64_tr_b16 v[124:125], v18 offset:40960
    s_add_u32 s16, s16, 8192
    v_mfma_f32_16x16x32_bf16 v[60:63], v[140:143], a[68:71], v[60:63]
    ds_read_b64_tr_b16 v[126:127], v18 offset:41984
    s_waitcnt vmcnt(14) lgkmcnt(8)
    v_mfma_f32_16x16x32_bf16 v[32:35], v[96:99], a[72:75], v[32:35]
    ds_read_b64_tr_b16 v[128:129], v9 offset:45056
    v_mfma_f32_16x16x32_bf16 v[36:39], v[100:103], a[72:75], v[36:39]
    ds_read_b64_tr_b16 v[130:131], v9 offset:46080
    buffer_load_dwordx4 a[136:139], v24, s[8:11], s16 offen
    v_mfma_f32_16x16x32_bf16 v[40:43], v[104:107], a[72:75], v[40:43]
    ds_read_b64_tr_b16 v[132:133], v12 offset:45056
    v_mfma_f32_16x16x32_bf16 v[44:47], v[108:111], a[72:75], v[44:47]
    ds_read_b64_tr_b16 v[134:135], v12 offset:46080
    v_mfma_f32_16x16x32_bf16 v[48:51], v[96:99], a[76:79], v[48:51]
    ds_read_b64_tr_b16 v[136:137], v15 offset:45056
    buffer_load_dwordx4 a[140:143], v24, s[8:11], s16 offen offset:1024
    v_mfma_f32_16x16x32_bf16 v[52:55], v[100:103], a[76:79], v[52:55]
    ds_read_b64_tr_b16 v[138:139], v15 offset:46080
    v_mfma_f32_16x16x32_bf16 v[56:59], v[104:107], a[76:79], v[56:59]
    ds_read_b64_tr_b16 v[140:141], v18 offset:45056
    s_add_u32 s16, s16, 8192
    v_mfma_f32_16x16x32_bf16 v[60:63], v[108:111], a[76:79], v[60:63]
    ds_read_b64_tr_b16 v[142:143], v18 offset:46080
    s_waitcnt vmcnt(14) lgkmcnt(8)
    v_mfma_f32_16x16x32_bf16 v[32:35], v[112:115], a[80:83], v[32:35]
    ds_read_b64_tr_b16 v[96:97], v10 offset:0
    v_mfma_f32_16x16x32_bf16 v[36:39], v[116:119], a[80:83], v[36:39]
    ds_read_b64_tr_b16 v[98:99], v10 offset:1024
    buffer_load_dwordx4 a[144:147], v24, s[8:11], s16 offen
    v_mfma_f32_16x16x32_bf16 v[40:43], v[120:123], a[80:83], v[40:43]
    ds_read_b64_tr_b16 v[100:101], v13 offset:0
    v_mfma_f32_16x16x32_bf16 v[44:47], v[124:127], a[80:83], v[44:47]
    ds_read_b64_tr_b16 v[102:103], v13 offset:1024
    v_mfma_f32_16x16x32_bf16 v[48:51], v[112:115], a[84:87], v[48:51]
    ds_read_b64_tr_b16 v[104:105], v16 offset:0
    buffer_load_dwordx4 a[148:151], v24, s[8:11], s16 offen offset:1024
    v_mfma_f32_16x16x32_bf16 v[52:55], v[116:119], a[84:87], v[52:55]
    ds_read_b64_tr_b16 v[106:107], v16 offset:1024
    v_mfma_f32_16x16x32_bf16 v[56:59], v[120:123], a[84:87], v[56:59]
    ds_read_b64_tr_b16 v[108:109], v19 offset:0
    s_add_u32 s16, s16, 8192
    v_mfma_f32_16x16x32_bf16 v[60:63], v[124:127], a[84:87], v[60:63]
    ds_read_b64_tr_b16 v[110:111], v19 offset:1024
    s_waitcnt vmcnt(14) lgkmcnt(8)
    v_mfma_f32_16x16x32_bf16 v[32:35], v[128:131], a[88:91], v[32:35]
    ds_read_b64_tr_b16 v[112:113], v10 offset:4096
    v_mfma_f32_16x16x32_bf16 v[36:39], v[132:135], a[88:91], v[36:39]
    ds_read_b64_tr_b16 v[114:115], v10 offset:5120
    buffer_load_dwordx4 a[152:155], v24, s[8:11], s16 offen
    v_mfma_f32_16x16x32_bf16 v[40:43], v[136:139], a[88:91], v[40:43]
    ds_read_b64_tr_b16 v[116:117], v13 offset:4096
    v_mfma_f32_16x16x32_bf16 v[44:47], v[140:143], a[88:91], v[44:47]
    ds_read_b64_tr_b16 v[118:119], v13 offset:5120
    v_mfma_f32_16x16x32_bf16 v[48:51], v[128:131], a[92:95], v[48:51]
    ds_read_b64_tr_b16 v[120:121], v16 offset:4096
    buffer_load_dwordx4 a[156:159], v24, s[8:11], s16 offen offset:1024
    v_mfma_f32_16x16x32_bf16 v[52:55], v[132:135], a[92:95], v[52:55]
    ds_read_b64_tr_b16 v[122:123], v16 offset:5120
    v_mfma_f32_16x16x32_bf16 v[56:59], v[136:139], a[92:95], v[56:59]
    ds_read_b64_tr_b16 v[124:125], v19 offset:4096
    s_add_u32 s16, s16, 8192
    v_mfma_f32_16x16x32_bf16 v[60:63], v[140:143], a[92:95], v[60:63]
    ds_read_b64_tr_b16 v[126:127], v19 offset:5120
    s_waitcnt vmcnt(14) lgkmcnt(8)
    v_mfma_f32_16x16x32_bf16 v[32:35], v[96:99], a[96:99], v[32:35]
    ds_read_b64_tr_b16 v[128:129], v10 offset:8192
    v_mfma_f32_16x16x32_bf16 v[36:39], v[100:103], a[96:99], v[36:39]
    ds_read_b64_tr_b16 v[130:131], v10 offset:9216
    buffer_load_dwordx4 a[160:163], v24, s[8:11], s16 offen
    v_mfma_f32_16x16x32_bf16 v[40:43], v[104:107], a[96:99], v[40:43]
    ds_read_b64_tr_b16 v[132:133], v13 offset:8192
    v_mfma_f32_16x16x32_bf16 v[44:47], v[108:111], a[96:99], v[44:47]
    ds_read_b64_tr_b16 v[134:135], v13 offset:9216
    v_mfma_f32_16x16x32_bf16 v[48:51], v[96:99], a[100:103], v[48:51]
    ds_read_b64_tr_b16 v[136:137], v16 offset:8192
    buffer_load_dwordx4 a[164:167], v24, s[8:11], s16 offen offset:1024
    v_mfma_f32_16x16x32_bf16 v[52:55], v[100:103], a[100:103], v[52:55]
    ds_read_b64_tr_b16 v[138:139], v16 offset:9216
    v_mfma_f32_16x16x32_bf16 v[56:59], v[104:107], a[100:103], v[56:59]
    ds_read_b64_tr_b16 v[140:141], v19 offset:8192
    s_add_u32 s16, s16, 8192
    v_mfma_f32_16x16x32_bf16 v[60:63], v[108:111], a[100:103], v[60:63]
    ds_read_b64_tr_b16 v[142:143], v19 offset:9216
    s_waitcnt vmcnt(14) lgkmcnt(8)
    v_mfma_f32_16x16x32_bf16 v[32:35], v[112:115], a[104:107], v[32:35]
    ds_read_b64_tr_b16 v[96:97], v10 offset:12288
    v_mfma_f32_16x16x32_bf16 v[36:39], v[116:119], a[104:107], v[36:39]
    ds_read_b64_tr_b16 v[98:99], v10 offset:13312
    buffer_load_dwordx4 a[168:171], v24, s[8:11], s16 offen
    v_mfma_f32_16x16x32_bf16 v[40:43], v[120:123], a[104:107], v[40:43]
    ds_read_b64_tr_b16 v[100:101], v13 offset:12288
    v_mfma_f32_16x16x32_bf16 v[44:47], v[124:127], a[104:107], v[44:47]
    ds_read_b64_tr_b16 v[102:103], v13 offset:13312
    v_mfma_f32_16x16x32_bf16 v[48:51], v[112:115], a[108:111], v[48:51]
    ds_read_b64_tr_b16 v[104:105], v16 offset:12288
    buffer_load_dwordx4 a[172:175], v24, s[8:11], s16 offen offset:1024
    v_mfma_f32_16x16x32_bf16 v[52:55], v[116:119], a[108:111], v[52:55]
    ds_read_b64_tr_b16 v[106:107], v16 offset:13312
    v_mfma_f32_16x16x32_bf16 v[56:59], v[120:123], a[108:111], v[56:59]
    ds_read_b64_tr_b16 v[108:109], v19 offset:12288
    s_add_u32 s16, s16, 8192
    v_mfma_f32_16x16x32_bf16 v[60:63], v[124:127], a[108:111], v[60:63]
    ds_read_b64_tr_b16 v[110:111], v19 offset:13312
    s_waitcnt vmcnt(14) lgkmcnt(8)
    v_mfma_f32_16x16x32_bf16 v[32:35], v[128:131], a[112:115], v[32:35]
    ds_read_b64_tr_b16 v[112:113], v10 offset:16384
    v_mfma_f32_16x16x32_bf16 v[36:39], v[132:135], a[112:115], v[36:39]
    ds_read_b64_tr_b16 v[114:115], v10 offset:17408
    buffer_load_dwordx4 a[176:179], v24, s[8:11], s16 offen
    v_mfma_f32_16x16x32_bf16 v[40:43], v[136:139], a[112:115], v[40:43]
    ds_read_b64_tr_b16 v[116:117], v13 offset:16384
    v_mfma_f32_16x16x32_bf16 v[44:47], v[140:143], a[112:115], v[44:47]
    ds_read_b64_tr_b16 v[118:119], v13 offset:17408
    v_mfma_f32_16x16x32_bf16 v[48:51], v[128:131], a[116:119], v[48:51]
    ds_read_b64_tr_b16 v[120:121], v16 offset:16384
    buffer_load_dwordx4 a[180:183], v24, s[8:11], s16 offen offset:1024
    v_mfma_f32_16x16x32_bf16 v[52:55], v[132:135], a[116:119], v[52:55]
    ds_read_b64_tr_b16 v[122:123], v16 offset:17408
    v_mfma_f32_16x16x32_bf16 v[56:59], v[136:139], a[116:119], v[56:59]
    ds_read_b64_tr_b16 v[124:125], v19 offset:16384
    s_add_u32 s16, s16, 8192
    v_mfma_f32_16x16x32_bf16 v[60:63], v[140:143], a[116:119], v[60:63]
    ds_read_b64_tr_b16 v[126:127], v19 offset:17408
    s_waitcnt vmcnt(14) lgkmcnt(8)
    v_mfma_f32_16x16x32_bf16 v[32:35], v[96:99], a[120:123], v[32:35]
    ds_read_b64_tr_b16 v[128:129], v10 offset:20480
    v_mfma_f32_16x16x32_bf16 v[36:39], v[100:103], a[120:123], v[36:39]
    ds_read_b64_tr_b16 v[130:131], v10 offset:21504
    buffer_load_dwordx4 a[184:187], v24, s[8:11], s16 offen
    v_mfma_f32_16x16x32_bf16 v[40:43], v[104:107], a[120:123], v[40:43]
    ds_read_b64_tr_b16 v[132:133], v13 offset:20480
    v_mfma_f32_16x16x32_bf16 v[44:47], v[108:111], a[120:123], v[44:47]
    ds_read_b64_tr_b16 v[134:135], v13 offset:21504
    v_mfma_f32_16x16x32_bf16 v[48:51], v[96:99], a[124:127], v[48:51]
    ds_read_b64_tr_b16 v[136:137], v16 offset:20480
    buffer_load_dwordx4 a[188:191], v24, s[8:11], s16 offen offset:1024
    v_mfma_f32_16x16x32_bf16 v[52:55], v[100:103], a[124:127], v[52:55]
    ds_read_b64_tr_b16 v[138:139], v16 offset:21504
    v_mfma_f32_16x16x32_bf16 v[56:59], v[104:107], a[124:127], v[56:59]
    ds_read_b64_tr_b16 v[140:141], v19 offset:20480
    s_add_u32 s16, s16, 8192
    v_mfma_f32_16x16x32_bf16 v[60:63], v[108:111], a[124:127], v[60:63]
    ds_read_b64_tr_b16 v[142:143], v19 offset:21504
    s_waitcnt vmcnt(14) lgkmcnt(8)
    s_mov_b32 s4, 0x40000
L_f5_17:
    v_cmp_ne_u32 vcc, s88, v90
    s_sub_u32 s4, s4, 1
    s_nop 3
    s_cbranch_vccz L_f5_17_ok
    s_cmp_eq_u32 s4, 0
    s_cbranch_scc1 L_f5_17_ok
    buffer_load_dword v90, v7, s[84:87], s61 offen sc1
    s_waitcnt vmcnt(0)
    s_branch L_f5_17
L_f5_17_ok:
    s_or_b32 s4, s2, s3
    s_cmp_lg_u32 s4, 0
    s_cbranch_scc1 L_epoch_18
    v_mov_b32 v2, s90
    v_mov_b32 v3, 0
    s_mov_b64 exec, 1
    buffer_store_dword v2, v3, s[84:87], 0 offen sc1
    s_mov_b64 exec, -1
L_epoch_18:
    s_barrier
    v_mfma_f32_16x16x32_bf16 v[32:35], v[112:115], a[128:131], v[32:35]
    ds_read_b64_tr_b16 v[96:97], v10 offset:24576
    buffer_load_dwordx4 a[192:195], v24, s[8:11], s16 offen
    v_mfma_f32_16x16x32_bf16 v[36:39], v[116:119], a[128:131], v[36:39]
    ds_read_b64_tr_b16 v[98:99], v10 offset:25600
    v_mfma_f32_16x16x32_bf16 v[40:43], v[120:123], a[128:131], v[40:43]
    ds_read_b64_tr_b16 v[100:101], v13 offset:24576
    buffer_load_dwordx4 a[196:199], v24, s[8:11], s16 offen offset:1024
    v_mfma_f32_16x16x32_bf16 v[44:47], v[124:127], a[128:131], v[44:47]
    ds_read_b64_tr_b16 v[102:103], v13 offset:25600
    s_add_u32 s16, s16, 8192
    v_mfma_f32_16x16x32_bf16 v[48:51], v[112:115], a[132:135], v[48:51]
    ds_read_b64_tr_b16 v[104:105], v16 offset:24576
    s_and_b32 s94, s28, 1
    v_mfma_f32_16x16x32_bf16 v[52:55], v[116:119], a[132:135], v[52:55]
    ds_read_b64_tr_b16 v[106:107], v16 offset:25600
    v_mfma_f32_16x16x32_bf16 v[56:59], v[120:123], a[132:135], v[56:59]
    ds_read_b64_tr_b16 v[108:109], v19 offset:24576
    s_lshl_b32 s94, s94, 2
    v_mfma_f32_16x16x32_bf16 v[60:63], v[124:127], a[132:135], v[60:63]
    ds_read_b64_tr_b16 v[110:111], v19 offset:25600
    s_and_b32 s4, s29, 3
    s_waitcnt vmcnt(14) lgkmcnt(8)
    v_mfma_f32_16x16x32_bf16 v[32:35], v[128:131], a[136:139], v[32:35]
    ds_read_b64_tr_b16 v[112:113], v10 offset:28672
    buffer_load_dwordx4 a[200:203], v24, s[8:11], s16 offen
    v_mfma_f32_16x16x32_bf16 v[36:39], v[132:135], a[136:139], v[36:39]
    ds_read_b64_tr_b16 v[114:115], v10 offset:29696
    v_mfma_f32_16x16x32_bf16 v[40:43], v[136:139], a[136:139], v[40:43]
    ds_read_b64_tr_b16 v[116:117], v13 offset:28672
    buffer_load_dwordx4 a[204:207], v24, s[8:11], s16 offen offset:1024
    v_mfma_f32_16x16x32_bf16 v[44:47], v[140:143], a[136:139], v[44:47]
    ds_read_b64_tr_b16 v[118:119], v13 offset:29696
    s_add_u32 s16, s16, 8192
    v_mfma_f32_16x16x32_bf16 v[48:51], v[128:131], a[140:143], v[48:51]
    ds_read_b64_tr_b16 v[120:121], v16 offset:28672
    s_add_u32 s94, s94, s4
    v_mfma_f32_16x16x32_bf16 v[52:55], v[132:135], a[140:143], v[52:55]
    ds_read_b64_tr_b16 v[122:123], v16 offset:29696
    v_mfma_f32_16x16x32_bf16 v[56:59], v[136:139], a[140:143], v[56:59]
    ds_read_b64_tr_b16 v[124:125], v19 offset:28672
    s_lshr_b32 s95, s28, 1
    v_mfma_f32_16x16x32_bf16 v[60:63], v[140:143], a[140:143], v[60:63]
    ds_read_b64_tr_b16 v[126:127], v19 offset:29696
    s_lshl_b32 s95, s95, 3
    s_waitcnt vmcnt(14) lgkmcnt(8)
    v_mfma_f32_16x16x32_bf16 v[32:35], v[96:99], a[144:147], v[32:35]
    ds_read_b64_tr_b16 v[128:129], v10 offset:32768
    buffer_load_dwordx4 a[208:211], v24, s[8:11], s16 offen
    v_mfma_f32_16x16x32_bf16 v[36:39], v[100:103], a[144:147], v[36:39]
    ds_read_b64_tr_b16 v[130:131], v10 offset:33792
    v_mfma_f32_16x16x32_bf16 v[40:43], v[104:107], a[144:147], v[40:43]
    ds_read_b64_tr_b16 v[132:133], v13 offset:32768
    buffer_load_dwordx4 a[212:215], v24, s[8:11], s16 offen offset:1024
    v_mfma_f32_16x16x32_bf16 v[44:47], v[108:111], a[144:147], v[44:47]
    ds_read_b64_tr_b16 v[134:135], v13 offset:33792
    s_add_u32 s16, s16, 8192
    v_mfma_f32_16x16x32_bf16 v[48:51], v[96:99], a[148:151], v[48:51]
    ds_read_b64_tr_b16 v[136:137], v16 offset:32768
    s_lshr_b32 s4, s29, 2
    v_mfma_f32_16x16x32_bf16 v[52:55], v[100:103], a[148:151], v[52:55]
    ds_read_b64_tr_b16 v[138:139], v16 offset:33792
    v_mfma_f32_16x16x32_bf16 v[56:59], v[104:107], a[148:151], v[56:59]
    ds_read_b64_tr_b16 v[140:141], v19 offset:32768
    s_add_u32 s95, s95, s4
    v_mfma_f32_16x16x32_bf16 v[60:63], v[108:111], a[148:151], v[60:63]
    ds_read_b64_tr_b16 v[142:143], v19 offset:33792
    s_add_u32 s12, s82, 0x5000000
    s_addc_u32 s13, s83, 0
    s_waitcnt vmcnt(14) lgkmcnt(8)
    v_mfma_f32_16x16x32_bf16 v[32:35], v[112:115], a[152:155], v[32:35]
    ds_read_b64_tr_b16 v[96:97], v10 offset:36864
    buffer_load_dwordx4 a[216:219], v24, s[8:11], s16 offen
    v_mfma_f32_16x16x32_bf16 v[36:39], v[116:119], a[152:155], v[36:39]
    ds_read_b64_tr_b16 v[98:99], v10 offset:37888
    v_mfma_f32_16x16x32_bf16 v[40:43], v[120:123], a[152:155], v[40:43]
    ds_read_b64_tr_b16 v[100:101], v13 offset:36864
    buffer_load_dwordx4 a[220:223], v24, s[8:11], s16 offen offset:1024
    v_mfma_f32_16x16x32_bf16 v[44:47], v[124:127], a[152:155], v[44:47]
    ds_read_b64_tr_b16 v[102:103], v13 offset:37888
    s_add_u32 s16, s16, 8192
    v_mfma_f32_16x16x32_bf16 v[48:51], v[112:115], a[156:159], v[48:51]
    ds_read_b64_tr_b16 v[104:105], v16 offset:36864
    s_mov_b32 s14, 0xe00000
    v_mfma_f32_16x16x32_bf16 v[52:55], v[116:119], a[156:159], v[52:55]
    ds_read_b64_tr_b16 v[106:107], v16 offset:37888
    v_mfma_f32_16x16x32_bf16 v[56:59], v[120:123], a[156:159], v[56:59]
    ds_read_b64_tr_b16 v[108:109], v19 offset:36864
    s_mov_b32 s15, 0x20000
    v_mfma_f32_16x16x32_bf16 v[60:63], v[124:127], a[156:159], v[60:63]
    ds_read_b64_tr_b16 v[110:111], v19 offset:37888
    v_lshlrev_b32 v25, 4, v1
    s_waitcnt vmcnt(14) lgkmcnt(8)
    v_mfma_f32_16x16x32_bf16 v[32:35], v[128:131], a[160:163], v[32:35]
    ds_read_b64_tr_b16 v[112:113], v10 offset:40960
    buffer_load_dwordx4 a[224:227], v24, s[8:11], s16 offen
    v_mfma_f32_16x16x32_bf16 v[36:39], v[132:135], a[160:163], v[36:39]
    ds_read_b64_tr_b16 v[114:115], v10 offset:41984
    v_mfma_f32_16x16x32_bf16 v[40:43], v[136:139], a[160:163], v[40:43]
    ds_read_b64_tr_b16 v[116:117], v13 offset:40960
    buffer_load_dwordx4 a[228:231], v24, s[8:11], s16 offen offset:1024
    v_mfma_f32_16x16x32_bf16 v[44:47], v[140:143], a[160:163], v[44:47]
    ds_read_b64_tr_b16 v[118:119], v13 offset:41984
    s_add_u32 s16, s16, 8192
    v_mfma_f32_16x16x32_bf16 v[48:51], v[128:131], a[164:167], v[48:51]
    ds_read_b64_tr_b16 v[120:121], v16 offset:40960
    s_mul_i32 s17, s95, 458752
    v_mfma_f32_16x16x32_bf16 v[52:55], v[132:135], a[164:167], v[52:55]
    ds_read_b64_tr_b16 v[122:123], v16 offset:41984
    v_mfma_f32_16x16x32_bf16 v[56:59], v[136:139], a[164:167], v[56:59]
    ds_read_b64_tr_b16 v[124:125], v19 offset:40960
    s_mul_i32 s20, s3, 7168
    v_mfma_f32_16x16x32_bf16 v[60:63], v[140:143], a[164:167], v[60:63]
    ds_read_b64_tr_b16 v[126:127], v19 offset:41984
    s_add_u32 s17, s17, s20
    s_waitcnt vmcnt(14) lgkmcnt(8)
    v_mfma_f32_16x16x32_bf16 v[32:35], v[96:99], a[168:171], v[32:35]
    ds_read_b64_tr_b16 v[128:129], v10 offset:45056
    buffer_load_dwordx4 a[232:235], v24, s[8:11], s16 offen
    v_mfma_f32_16x16x32_bf16 v[36:39], v[100:103], a[168:171], v[36:39]
    ds_read_b64_tr_b16 v[130:131], v10 offset:46080
    v_mfma_f32_16x16x32_bf16 v[40:43], v[104:107], a[168:171], v[40:43]
    ds_read_b64_tr_b16 v[132:133], v13 offset:45056
    buffer_load_dwordx4 a[236:239], v24, s[8:11], s16 offen offset:1024
    v_mfma_f32_16x16x32_bf16 v[44:47], v[108:111], a[168:171], v[44:47]
    ds_read_b64_tr_b16 v[134:135], v13 offset:46080
    s_add_u32 s16, s16, 8192
    v_mfma_f32_16x16x32_bf16 v[48:51], v[96:99], a[172:175], v[48:51]
    ds_read_b64_tr_b16 v[136:137], v16 offset:45056
    s_add_u32 s21, s17, 4096
    v_mfma_f32_16x16x32_bf16 v[52:55], v[100:103], a[172:175], v[52:55]
    ds_read_b64_tr_b16 v[138:139], v16 offset:46080
    s_add_u32 m0, s20, 0
    v_mfma_f32_16x16x32_bf16 v[56:59], v[104:107], a[172:175], v[56:59]
    ds_read_b64_tr_b16 v[140:141], v19 offset:45056
    buffer_load_dwordx4 v25, s[12:15], s17 offen lds
    v_mfma_f32_16x16x32_bf16 v[60:63], v[108:111], a[172:175], v[60:63]
    ds_read_b64_tr_b16 v[142:143], v19 offset:46080
    buffer_load_dwordx4 v25, s[12:15], s17 offen offset:1024 lds
    s_waitcnt vmcnt(16) lgkmcnt(8)
    v_mfma_f32_16x16x32_bf16 v[32:35], v[112:115], a[176:179], v[32:35]
    ds_read_b64_tr_b16 v[96:97], v11 offset:0
    buffer_load_dwordx4 a[0:3], v24, s[8:11], s16 offen
    v_mfma_f32_16x16x32_bf16 v[36:39], v[116:119], a[176:179], v[36:39]
    ds_read_b64_tr_b16 v[98:99], v11 offset:1024
    v_mfma_f32_16x16x32_bf16 v[40:43], v[120:123], a[176:179], v[40:43]
    ds_read_b64_tr_b16 v[100:101], v14 offset:0
    buffer_load_dwordx4 a[4:7], v24, s[8:11], s16 offen offset:1024
    v_mfma_f32_16x16x32_bf16 v[44:47], v[124:127], a[176:179], v[44:47]
    ds_read_b64_tr_b16 v[102:103], v14 offset:1024
    s_add_u32 s16, s16, 8192
    v_mfma_f32_16x16x32_bf16 v[48:51], v[112:115], a[180:183], v[48:51]
    ds_read_b64_tr_b16 v[104:105], v17 offset:0
    buffer_load_dwordx4 v25, s[12:15], s17 offen offset:2048 lds
    v_mfma_f32_16x16x32_bf16 v[52:55], v[116:119], a[180:183], v[52:55]
    ds_read_b64_tr_b16 v[106:107], v17 offset:1024
    v_mfma_f32_16x16x32_bf16 v[56:59], v[120:123], a[180:183], v[56:59]
    ds_read_b64_tr_b16 v[108:109], v20 offset:0
    buffer_load_dwordx4 v25, s[12:15], s17 offen offset:3072 lds
    s_add_u32 m0, s20, 4096
    v_mfma_f32_16x16x32_bf16 v[60:63], v[124:127], a[180:183], v[60:63]
    ds_read_b64_tr_b16 v[110:111], v20 offset:1024
    buffer_load_dwordx4 v25, s[12:15], s21 offen lds
    s_waitcnt vmcnt(19) lgkmcnt(8)
    v_mfma_f32_16x16x32_bf16 v[32:35], v[128:131], a[184:187], v[32:35]
    ds_read_b64_tr_b16 v[112:113], v11 offset:4096
    buffer_load_dwordx4 a[8:11], v24, s[8:11], s16 offen
    v_mfma_f32_16x16x32_bf16 v[36:39], v[132:135], a[184:187], v[36:39]
    ds_read_b64_tr_b16 v[114:115], v11 offset:5120
    v_mfma_f32_16x16x32_bf16 v[40:43], v[136:139], a[184:187], v[40:43]
    ds_read_b64_tr_b16 v[116:117], v14 offset:4096
    buffer_load_dwordx4 a[12:15], v24, s[8:11], s16 offen offset:1024
    v_mfma_f32_16x16x32_bf16 v[44:47], v[140:143], a[184:187], v[44:47]
    ds_read_b64_tr_b16 v[118:119], v14 offset:5120
    s_add_u32 s16, s16, 8192
    v_mfma_f32_16x16x32_bf16 v[48:51], v[128:131], a[188:191], v[48:51]
    ds_read_b64_tr_b16 v[120:121], v17 offset:4096
    buffer_load_dwordx4 v25, s[12:15], s21 offen offset:1024 lds
    v_mfma_f32_16x16x32_bf16 v[52:55], v[132:135], a[188:191], v[52:55]
    ds_read_b64_tr_b16 v[122:123], v17 offset:5120
    v_mfma_f32_16x16x32_bf16 v[56:59], v[136:139], a[188:191], v[56:59]
    ds_read_b64_tr_b16 v[124:125], v20 offset:4096
    buffer_load_dwordx4 v25, s[12:15], s21 offen offset:2048 lds
    v_mfma_f32_16x16x32_bf16 v[60:63], v[140:143], a[188:191], v[60:63]
    ds_read_b64_tr_b16 v[126:127], v20 offset:5120
    s_add_u32 s17, s17, 28672
    s_waitcnt vmcnt(21) lgkmcnt(8)
    v_mfma_f32_16x16x32_bf16 v[32:35], v[96:99], a[192:195], v[32:35]
    ds_read_b64_tr_b16 v[128:129], v11 offset:8192
    v_mfma_f32_16x16x32_bf16 v[36:39], v[100:103], a[192:195], v[36:39]
    ds_read_b64_tr_b16 v[130:131], v11 offset:9216
    s_add_u32 s21, s21, 28672
    v_mfma_f32_16x16x32_bf16 v[40:43], v[104:107], a[192:195], v[40:43]
    ds_read_b64_tr_b16 v[132:133], v14 offset:8192
    v_mfma_f32_16x16x32_bf16 v[44:47], v[108:111], a[192:195], v[44:47]
    ds_read_b64_tr_b16 v[134:135], v14 offset:9216
    s_add_u32 m0, s20, 28672
    v_mfma_f32_16x16x32_bf16 v[48:51], v[96:99], a[196:199], v[48:51]
    ds_read_b64_tr_b16 v[136:137], v17 offset:8192
    buffer_load_dwordx4 v25, s[12:15], s17 offen lds
    v_mfma_f32_16x16x32_bf16 v[52:55], v[100:103], a[196:199], v[52:55]
    ds_read_b64_tr_b16 v[138:139], v17 offset:9216
    v_mfma_f32_16x16x32_bf16 v[56:59], v[104:107], a[196:199], v[56:59]
    ds_read_b64_tr_b16 v[140:141], v20 offset:8192
    buffer_load_dwordx4 v25, s[12:15], s17 offen offset:1024 lds
    v_mfma_f32_16x16x32_bf16 v[60:63], v[108:111], a[196:199], v[60:63]
    ds_read_b64_tr_b16 v[142:143], v20 offset:9216
    s_waitcnt vmcnt(21) lgkmcnt(8)
    v_mfma_f32_16x16x32_bf16 v[32:35], v[112:115], a[200:203], v[32:35]
    ds_read_b64_tr_b16 v[96:97], v11 offset:12288
    v_mfma_f32_16x16x32_bf16 v[36:39], v[116:119], a[200:203], v[36:39]
    ds_read_b64_tr_b16 v[98:99], v11 offset:13312
    buffer_load_dwordx4 v25, s[12:15], s17 offen offset:2048 lds
    v_mfma_f32_16x16x32_bf16 v[40:43], v[120:123], a[200:203], v[40:43]
    ds_read_b64_tr_b16 v[100:101], v14 offset:12288
    v_mfma_f32_16x16x32_bf16 v[44:47], v[124:127], a[200:203], v[44:47]
    ds_read_b64_tr_b16 v[102:103], v14 offset:13312
    v_mfma_f32_16x16x32_bf16 v[48:51], v[112:115], a[204:207], v[48:51]
    ds_read_b64_tr_b16 v[104:105], v17 offset:12288
    buffer_load_dwordx4 v25, s[12:15], s17 offen offset:3072 lds
    v_mfma_f32_16x16x32_bf16 v[52:55], v[116:119], a[204:207], v[52:55]
    ds_read_b64_tr_b16 v[106:107], v17 offset:13312
    s_add_u32 m0, s20, 32768
    v_mfma_f32_16x16x32_bf16 v[56:59], v[120:123], a[204:207], v[56:59]
    ds_read_b64_tr_b16 v[108:109], v20 offset:12288
    buffer_load_dwordx4 v25, s[12:15], s21 offen lds
    v_mfma_f32_16x16x32_bf16 v[60:63], v[124:127], a[204:207], v[60:63]
    ds_read_b64_tr_b16 v[110:111], v20 offset:13312
    s_waitcnt vmcnt(22) lgkmcnt(8)
    v_mfma_f32_16x16x32_bf16 v[32:35], v[128:131], a[208:211], v[32:35]
    ds_read_b64_tr_b16 v[112:113], v11 offset:16384
    v_mfma_f32_16x16x32_bf16 v[36:39], v[132:135], a[208:211], v[36:39]
    ds_read_b64_tr_b16 v[114:115], v11 offset:17408
    buffer_load_dwordx4 v25, s[12:15], s21 offen offset:1024 lds
    v_mfma_f32_16x16x32_bf16 v[40:43], v[136:139], a[208:211], v[40:43]
    ds_read_b64_tr_b16 v[116:117], v14 offset:16384
    v_mfma_f32_16x16x32_bf16 v[44:47], v[140:143], a[208:211], v[44:47]
    ds_read_b64_tr_b16 v[118:119], v14 offset:17408
    v_mfma_f32_16x16x32_bf16 v[48:51], v[128:131], a[212:215], v[48:51]
    ds_read_b64_tr_b16 v[120:121], v17 offset:16384
    buffer_load_dwordx4 v25, s[12:15], s21 offen offset:2048 lds
    v_mfma_f32_16x16x32_bf16 v[52:55], v[132:135], a[212:215], v[52:55]
    ds_read_b64_tr_b16 v[122:123], v17 offset:17408
    v_mfma_f32_16x16x32_bf16 v[56:59], v[136:139], a[212:215], v[56:59]
    ds_read_b64_tr_b16 v[124:125], v20 offset:16384
    s_add_u32 s17, s17, 28672
    v_mfma_f32_16x16x32_bf16 v[60:63], v[140:143], a[212:215], v[60:63]
    ds_read_b64_tr_b16 v[126:127], v20 offset:17408
    s_waitcnt vmcnt(22) lgkmcnt(8)
    v_mfma_f32_16x16x32_bf16 v[32:35], v[96:99], a[216:219], v[32:35]
    ds_read_b64_tr_b16 v[128:129], v11 offset:20480
    v_mfma_f32_16x16x32_bf16 v[36:39], v[100:103], a[216:219], v[36:39]
    ds_read_b64_tr_b16 v[130:131], v11 offset:21504
    s_add_u32 s21, s21, 28672
    v_mfma_f32_16x16x32_bf16 v[40:43], v[104:107], a[216:219], v[40:43]
    ds_read_b64_tr_b16 v[132:133], v14 offset:20480
    v_mfma_f32_16x16x32_bf16 v[44:47], v[108:111], a[216:219], v[44:47]
    ds_read_b64_tr_b16 v[134:135], v14 offset:21504
    s_add_u32 m0, s20, 57344
    v_mfma_f32_16x16x32_bf16 v[48:51], v[96:99], a[220:223], v[48:51]
    ds_read_b64_tr_b16 v[136:137], v17 offset:20480
    buffer_load_dwordx4 v25, s[12:15], s17 offen lds
    v_mfma_f32_16x16x32_bf16 v[52:55], v[100:103], a[220:223], v[52:55]
    ds_read_b64_tr_b16 v[138:139], v17 offset:21504
    v_mfma_f32_16x16x32_bf16 v[56:59], v[104:107], a[220:223], v[56:59]
    ds_read_b64_tr_b16 v[140:141], v20 offset:20480
    buffer_load_dwordx4 v25, s[12:15], s17 offen offset:1024 lds
    v_mfma_f32_16x16x32_bf16 v[60:63], v[108:111], a[220:223], v[60:63]
    ds_read_b64_tr_b16 v[142:143], v20 offset:21504
    s_waitcnt vmcnt(22) lgkmcnt(8)
    v_mfma_f32_16x16x32_bf16 v[32:35], v[112:115], a[224:227], v[32:35]
    ds_read_b64_tr_b16 v[96:97], v11 offset:24576
    v_mfma_f32_16x16x32_bf16 v[36:39], v[116:119], a[224:227], v[36:39]
    ds_read_b64_tr_b16 v[98:99], v11 offset:25600
    buffer_load_dwordx4 v25, s[12:15], s17 offen offset:2048 lds
    v_mfma_f32_16x16x32_bf16 v[40:43], v[120:123], a[224:227], v[40:43]
    ds_read_b64_tr_b16 v[100:101], v14 offset:24576
    v_mfma_f32_16x16x32_bf16 v[44:47], v[124:127], a[224:227], v[44:47]
    ds_read_b64_tr_b16 v[102:103], v14 offset:25600
    v_mfma_f32_16x16x32_bf16 v[48:51], v[112:115], a[228:231], v[48:51]
    ds_read_b64_tr_b16 v[104:105], v17 offset:24576
    buffer_load_dwordx4 v25, s[12:15], s17 offen offset:3072 lds
    v_mfma_f32_16x16x32_bf16 v[52:55], v[116:119], a[228:231], v[52:55]
    ds_read_b64_tr_b16 v[106:107], v17 offset:25600
    s_add_u32 m0, s20, 61440
    v_mfma_f32_16x16x32_bf16 v[56:59], v[120:123], a[228:231], v[56:59]
    ds_read_b64_tr_b16 v[108:109], v20 offset:24576
    buffer_load_dwordx4 v25, s[12:15], s21 offen lds
    v_mfma_f32_16x16x32_bf16 v[60:63], v[124:127], a[228:231], v[60:63]
    ds_read_b64_tr_b16 v[110:111], v20 offset:25600
    s_waitcnt vmcnt(23) lgkmcnt(8)
    v_mfma_f32_16x16x32_bf16 v[32:35], v[128:131], a[232:235], v[32:35]
    ds_read_b64_tr_b16 v[112:113], v11 offset:28672
    v_mfma_f32_16x16x32_bf16 v[36:39], v[132:135], a[232:235], v[36:39]
    ds_read_b64_tr_b16 v[114:115], v11 offset:29696
    v_mfma_f32_16x16x32_bf16 v[40:43], v[136:139], a[232:235], v[40:43]
    ds_read_b64_tr_b16 v[116:117], v14 offset:28672
    buffer_load_dwordx4 v25, s[12:15], s21 offen offset:1024 lds
    v_mfma_f32_16x16x32_bf16 v[44:47], v[140:143], a[232:235], v[44:47]
    ds_read_b64_tr_b16 v[118:119], v14 offset:29696
    v_mfma_f32_16x16x32_bf16 v[48:51], v[128:131], a[236:239], v[48:51]
    ds_read_b64_tr_b16 v[120:121], v17 offset:28672
    v_mfma_f32_16x16x32_bf16 v[52:55], v[132:135], a[236:239], v[52:55]
    ds_read_b64_tr_b16 v[122:123], v17 offset:29696
    v_mfma_f32_16x16x32_bf16 v[56:59], v[136:139], a[236:239], v[56:59]
    ds_read_b64_tr_b16 v[124:125], v20 offset:28672
    buffer_load_dwordx4 v25, s[12:15], s21 offen offset:2048 lds
    v_mfma_f32_16x16x32_bf16 v[60:63], v[140:143], a[236:239], v[60:63]
    ds_read_b64_tr_b16 v[126:127], v20 offset:29696
    s_waitcnt vmcnt(21) lgkmcnt(8)
    v_mfma_f32_16x16x32_bf16 v[32:35], v[96:99], a[0:3], v[32:35]
    v_mfma_f32_16x16x32_bf16 v[36:39], v[100:103], a[0:3], v[36:39]
    v_mfma_f32_16x16x32_bf16 v[40:43], v[104:107], a[0:3], v[40:43]
    s_add_u32 s17, s17, 28672
    v_mfma_f32_16x16x32_bf16 v[44:47], v[108:111], a[0:3], v[44:47]
    v_mfma_f32_16x16x32_bf16 v[48:51], v[96:99], a[4:7], v[48:51]
    v_mfma_f32_16x16x32_bf16 v[52:55], v[100:103], a[4:7], v[52:55]
    v_mfma_f32_16x16x32_bf16 v[56:59], v[104:107], a[4:7], v[56:59]
    s_add_u32 s21, s21, 28672
    v_mfma_f32_16x16x32_bf16 v[60:63], v[108:111], a[4:7], v[60:63]
    s_waitcnt vmcnt(16) lgkmcnt(0)
    v_and_b32 v2, 15, v1
    v_lshrrev_b32 v3, 4, v1
    v_lshlrev_b32 v6, 4, v2
    v_lshl_add_u32 v5, v3, 18, v6
    s_lshl_b32 s59, s32, 4
    s_add_u32 s59, s59, s33
    s_lshl_b32 s60, s59, 2
    s_add_u32 s60, s60, s3
    s_lshl_b32 s60, s60, 8
    s_add_u32 s60, s60, 655360
    s_lshl_b32 s59, s59, 9
    s_lshl_b32 s4, s36, 8
    s_add_u32 s59, s59, s4
    s_lshl_b32 s4, s37, 3
    s_add_u32 s59, s59, s4
    v_mfma_f32_16x16x32_bf16 v[32:35], v[112:115], a[8:11], v[32:35]
    v_mfma_f32_16x16x32_bf16 v[36:39], v[116:119], a[8:11], v[36:39]
    v_mfma_f32_16x16x32_bf16 v[40:43], v[120:123], a[8:11], v[40:43]
    v_mfma_f32_16x16x32_bf16 v[44:47], v[124:127], a[8:11], v[44:47]
    v_mfma_f32_16x16x32_bf16 v[48:51], v[112:115], a[12:15], v[48:51]
    v_mfma_f32_16x16x32_bf16 v[52:55], v[116:119], a[12:15], v[52:55]
    v_mfma_f32_16x16x32_bf16 v[56:59], v[120:123], a[12:15], v[56:59]
    v_mfma_f32_16x16x32_bf16 v[60:63], v[124:127], a[12:15], v[60:63]
    s_nop 7
    v_cvt_pk_bf16_f32 v64, v32, v33
    v_cvt_pk_bf16_f32 v65, v34, v35
    v_cvt_pk_bf16_f32 v66, v36, v37
    v_cvt_pk_bf16_f32 v67, v38, v39
    buffer_store_dwordx4 v[64:67], v24, s[48:51], s57 offen offset:0 sc1
    v_cvt_pk_bf16_f32 v68, v40, v41
    v_cvt_pk_bf16_f32 v69, v42, v43
    v_cvt_pk_bf16_f32 v70, v44, v45
    v_cvt_pk_bf16_f32 v71, v46, v47
    buffer_store_dwordx4 v[68:71], v24, s[48:51], s58 offen offset:0 sc1
    v_cvt_pk_bf16_f32 v72, v48, v49
    v_cvt_pk_bf16_f32 v73, v50, v51
    v_cvt_pk_bf16_f32 v74, v52, v53
    v_cvt_pk_bf16_f32 v75, v54, v55
    buffer_store_dwordx4 v[72:75], v24, s[48:51], s57 offen offset:1024 sc1
    v_cvt_pk_bf16_f32 v76, v56, v57
    v_cvt_pk_bf16_f32 v77, v58, v59
    v_cvt_pk_bf16_f32 v78, v60, v61
    v_cvt_pk_bf16_f32 v79, v62, v63
    buffer_store_dwordx4 v[76:79], v24, s[48:51], s58 offen offset:1024 sc1
    v_pk_add_f32 v[14:15], v[32:33], v[34:35]
    v_pk_mul_f32 v[16:17], v[32:33], v[32:33]
    v_pk_fma_f32 v[16:17], v[34:35], v[34:35], v[16:17]
    v_pk_add_f32 v[14:15], v[14:15], v[36:37]
    v_pk_fma_f32 v[16:17], v[36:37], v[36:37], v[16:17]
    v_pk_add_f32 v[14:15], v[14:15], v[38:39]
    v_pk_fma_f32 v[16:17], v[38:39], v[38:39], v[16:17]
    v_pk_add_f32 v[14:15], v[14:15], v[40:41]
    v_pk_fma_f32 v[16:17], v[40:41], v[40:41], v[16:17]
    v_pk_add_f32 v[14:15], v[14:15], v[42:43]
    v_pk_fma_f32 v[16:17], v[42:43], v[42:43], v[16:17]
    v_pk_add_f32 v[14:15], v[14:15], v[44:45]
    v_pk_fma_f32 v[16:17], v[44:45], v[44:45], v[16:17]
    v_pk_add_f32 v[14:15], v[14:15], v[46:47]
    v_pk_fma_f32 v[16:17], v[46:47], v[46:47], v[16:17]
    v_add_f32 v84, v14, v15
    v_add_f32 v12, v16, v17
    v_pk_add_f32 v[14:15], v[48:49], v[50:51]
    v_pk_mul_f32 v[16:17], v[48:49], v[48:49]
    v_pk_fma_f32 v[16:17], v[50:51], v[50:51], v[16:17]
    v_pk_add_f32 v[14:15], v[14:15], v[52:53]
    v_pk_fma_f32 v[16:17], v[52:53], v[52:53], v[16:17]
    v_pk_add_f32 v[14:15], v[14:15], v[54:55]
    v_pk_fma_f32 v[16:17], v[54:55], v[54:55], v[16:17]
    v_pk_add_f32 v[14:15], v[14:15], v[56:57]
    v_pk_fma_f32 v[16:17], v[56:57], v[56:57], v[16:17]
    v_pk_add_f32 v[14:15], v[14:15], v[58:59]
    v_pk_fma_f32 v[16:17], v[58:59], v[58:59], v[16:17]
    v_pk_add_f32 v[14:15], v[14:15], v[60:61]
    v_pk_fma_f32 v[16:17], v[60:61], v[60:61], v[16:17]
    v_pk_add_f32 v[14:15], v[14:15], v[62:63]
    v_pk_fma_f32 v[16:17], v[62:63], v[62:63], v[16:17]
    v_add_f32 v85, v14, v15
    v_add_f32 v13, v16, v17
    s_nop 0
    v_permlane16_swap_b32 v84, v12
    v_permlane16_swap_b32 v85, v13
    v_pk_add_f32 v[84:85], v[84:85], v[12:13]
    v_mov_b32 v12, v84
    v_mov_b32 v13, v85
    s_nop 1
    v_permlane32_swap_b32 v84, v12
    v_permlane32_swap_b32 v85, v13
    v_pk_add_f32 v[84:85], v[84:85], v[12:13]
    s_mov_b64 exec, 0xffffffff
    buffer_store_dwordx2 v[84:85], v5, s[52:55], s59 offen sc1
    s_mov_b64 exec, -1
    v_mov_b32 v83, v6
    v_mov_b32 v86, s88
    v_mov_b32 v87, s88
    s_add_u32 s8, s82, 0x1400000
    s_addc_u32 s9, s83, 0
    s_mov_b32 s10, 0x400000
    s_mov_b32 s11, 0x20000
    s_add_u32 s44, s82, 0x2800000
    s_addc_u32 s45, s83, 0
    s_mov_b32 s46, 0x80000
    s_mov_b32 s47, 0x20000
    s_add_u32 s48, s82, 0x1800000
    s_addc_u32 s49, s83, 0
    s_mov_b32 s50, 0xe00000
    s_mov_b32 s51, 0x20000
    v_lshlrev_b32 v24, 4, v1
    s_lshl_b32 s40, s94, 1
    s_add_u32 s40, s40, s36
    s_lshl_b32 s16, s40, 18
    s_lshl_b32 s4, s37, 12
    s_add_u32 s16, s16, s4
    v_lshrrev_b32 v2, 5, v1
    v_lshlrev_b32 v8, 8, v2
    v_bfe_u32 v2, v1, 2, 3
    v_lshl_add_u32 v8, v2, 5, v8
    v_and_b32 v2, 1, v1
    v_lshl_add_u32 v10, v2, 4, v8
    v_bfe_u32 v2, v1, 1, 1
    v_lshl_add_u32 v10, v2, 3, v10
    v_and_b32 v2, 3, v1
    v_lshl_add_u32 v8, v2, 3, v8
    v_add_u32 v9, 57344, v8
    v_add_u32 v11, 57344, v10
    v_and_b32 v2, 15, v1
    v_lshrrev_b32 v3, 4, v1
    v_lshlrev_b32 v6, 4, v2
    v_lshl_add_u32 v6, v3, 11, v6
    s_lshl_b32 s52, s40, 13
    s_lshl_b32 s4, s37, 8
    s_add_u32 s52, s52, s4
    s_mov_b64 exec, 0xffff
    s_waitcnt vmcnt(0)
    buffer_store_dwordx4 v[84:87], v83, s[84:87], s60 offen sc1
    s_mov_b64 exec, -1
    s_barrier
    s_add_u32 m0, s20, 86016
    s_nop 0
    buffer_load_dwordx4 v25, s[12:15], s17 offen lds
    buffer_load_dwordx4 v25, s[12:15], s17 offen offset:1024 lds
    buffer_load_dwordx4 v25, s[12:15], s17 offen offset:2048 lds
    buffer_load_dwordx4 v25, s[12:15], s17 offen offset:3072 lds
    s_add_u32 m0, s20, 90112
    s_nop 0
    buffer_load_dwordx4 v25, s[12:15], s21 offen lds
    buffer_load_dwordx4 v25, s[12:15], s21 offen offset:1024 lds
    buffer_load_dwordx4 v25, s[12:15], s21 offen offset:2048 lds
    s_add_u32 s17, s17, 28672
    s_add_u32 s21, s21, 28672
    ds_read_b64_tr_b16 a[0:1], v8 offset:0
    ds_read_b64_tr_b16 a[2:3], v8 offset:512
    ds_read_b64_tr_b16 a[4:5], v8 offset:1024
    ds_read_b64_tr_b16 a[6:7], v8 offset:1536
    ds_read_b64_tr_b16 a[8:9], v8 offset:2048
    ds_read_b64_tr_b16 a[10:11], v8 offset:2560
    ds_read_b64_tr_b16 a[12:13], v8 offset:3072
    ds_read_b64_tr_b16 a[14:15], v8 offset:3584
    ds_read_b64_tr_b16 a[16:17], v8 offset:4096
    ds_read_b64_tr_b16 a[18:19], v8 offset:4608
    ds_read_b64_tr_b16 a[20:21], v8 offset:5120
    ds_read_b64_tr_b16 a[22:23], v8 offset:5632
    ds_read_b64_tr_b16 a[24:25], v10 offset:6144
    ds_read_b64_tr_b16 a[26:27], v10 offset:6656
    ds_read_b64_tr_b16 a[28:29], v8 offset:7168
    ds_read_b64_tr_b16 a[30:31], v8 offset:7680
    ds_read_b64_tr_b16 a[32:33], v8 offset:8192
    ds_read_b64_tr_b16 a[34:35], v8 offset:8704
    ds_read_b64_tr_b16 a[36:37], v8 offset:9216
    ds_read_b64_tr_b16 a[38:39], v8 offset:9728
    ds_read_b64_tr_b16 a[40:41], v8 offset:10240
    ds_read_b64_tr_b16 a[42:43], v8 offset:10752
    ds_read_b64_tr_b16 a[44:45], v8 offset:11264
    ds_read_b64_tr_b16 a[46:47], v8 offset:11776
    ds_read_b64_tr_b16 a[48:49], v8 offset:12288
    ds_read_b64_tr_b16 a[50:51], v8 offset:12800
    ds_read_b64_tr_b16 a[52:53], v10 offset:13312
    ds_read_b64_tr_b16 a[54:55], v10 offset:13824
    s_add_u32 s24, s82, 0x2900000
    s_addc_u32 s25, s83, 0
    s_mov_b32 s26, 0xe000
    s_mov_b32 s27, 0x20000
    v_lshrrev_b32 v7, 4, v1
    v_lshlrev_b32 v7, 4, v7
    s_lshr_b32 s4, s95, 1
    s_mul_i32 s5, s4, 896
    s_and_b32 s4, s95, 1
    s_lshl_b32 s6, s4, 9
    s_add_u32 s6, s6, s5
    s_lshl_b32 s7, s4, 5
    s_add_u32 s7, s7, s5
    s_add_u32 s7, s7, 384
    v_bfe_u32 v5, v1, 4, 1
    v_lshlrev_b32 v5, 6, v5
    v_lshrrev_b32 v4, 5, v1
    v_lshl_add_u32 v5, v4, 4, v5
    s_add_u32 s4, s6, 0
    s_add_u32 s5, s7, 0
    buffer_load_dwordx4 v[200:203], v7, s[24:27], s4 offen offset:0
    buffer_load_dwordx4 v[204:207], v7, s[24:27], s4 offen offset:64
    buffer_load_dwordx4 v[208:211], v7, s[24:27], s4 offen offset:128
    buffer_load_dwordx4 v[212:215], v7, s[24:27], s4 offen offset:192
    buffer_load_dwordx4 v[216:219], v7, s[24:27], s4 offen offset:256
    buffer_load_dwordx4 v[220:223], v7, s[24:27], s4 offen offset:320
    buffer_load_dwordx4 v[224:227], v5, s[24:27], s5 offen
    s_add_u32 s4, s6, 14336
    s_add_u32 s5, s7, 14336
    buffer_load_dwordx4 v[228:231], v7, s[24:27], s4 offen offset:0
    buffer_load_dwordx4 v[232:235], v7, s[24:27], s4 offen offset:64
    buffer_load_dwordx4 v[236:239], v7, s[24:27], s4 offen offset:128
    buffer_load_dwordx4 v[240:243], v7, s[24:27], s4 offen offset:192
    buffer_load_dwordx4 v[244:247], v7, s[24:27], s4 offen offset:256
    buffer_load_dwordx4 v[248:251], v7, s[24:27], s4 offen offset:320
    buffer_load_dwordx4 v[252:255], v5, s[24:27], s5 offen
    s_add_u32 s4, s6, 28672
    s_add_u32 s5, s7, 28672
    buffer_load_dwordx4 v[144:147], v7, s[24:27], s4 offen offset:0
    buffer_load_dwordx4 v[148:151], v7, s[24:27], s4 offen offset:64
    buffer_load_dwordx4 v[152:155], v7, s[24:27], s4 offen offset:128
    buffer_load_dwordx4 v[156:159], v7, s[24:27], s4 offen offset:192
    buffer_load_dwordx4 v[160:163], v7, s[24:27], s4 offen offset:256
    buffer_load_dwordx4 v[164:167], v7, s[24:27], s4 offen offset:320
    buffer_load_dwordx4 v[168:171], v5, s[24:27], s5 offen
    s_add_u32 s4, s6, 43008
    s_add_u32 s5, s7, 43008
    buffer_load_dwordx4 v[172:175], v7, s[24:27], s4 offen offset:0
    buffer_load_dwordx4 v[176:179], v7, s[24:27], s4 offen offset:64
    buffer_load_dwordx4 v[180:183], v7, s[24:27], s4 offen offset:128
    buffer_load_dwordx4 v[184:187], v7, s[24:27], s4 offen offset:192
    buffer_load_dwordx4 v[188:191], v7, s[24:27], s4 offen offset:256
    buffer_load_dwordx4 v[192:195], v7, s[24:27], s4 offen offset:320
    buffer_load_dwordx4 v[196:199], v5, s[24:27], s5 offen
    v_and_b32 v2, 15, v1
    v_lshrrev_b32 v3, 4, v1
    v_lshlrev_b32 v6, 4, v2
    v_lshl_add_u32 v6, v3, 12, v6
    s_lshl_b32 s52, s40, 14
    s_lshl_b32 s5, s37, 9
    s_add_u32 s52, s52, s5
    s_add_u32 s52, s52, 655360
    s_mov_b32 s4, 0x20000
L_spin_19:
    buffer_load_dwordx4 v[32:35], v6, s[84:87], s52 offen offset:0 sc1
    buffer_load_dwordx4 v[36:39], v6, s[84:87], s52 offen offset:256 sc1
    buffer_load_dwordx4 v[40:43], v6, s[84:87], s52 offen offset:1024 sc1
    buffer_load_dwordx4 v[44:47], v6, s[84:87], s52 offen offset:1280 sc1
    buffer_load_dwordx4 v[48:51], v6, s[84:87], s52 offen offset:2048 sc1
    buffer_load_dwordx4 v[52:55], v6, s[84:87], s52 offen offset:2304 sc1
    buffer_load_dwordx4 v[56:59], v6, s[84:87], s52 offen offset:3072 sc1
    buffer_load_dwordx4 v[60:63], v6, s[84:87], s52 offen offset:3328 sc1
    s_waitcnt vmcnt(0)
    v_xor_b32 v2, s88, v34
    v_xor_b32 v3, s88, v38
    v_or_b32 v2, v2, v3
    v_xor_b32 v3, s88, v42
    v_or_b32 v2, v2, v3
    v_xor_b32 v3, s88, v46
    v_or_b32 v2, v2, v3
    v_xor_b32 v3, s88, v50
    v_or_b32 v2, v2, v3
    v_xor_b32 v3, s88, v54
    v_or_b32 v2, v2, v3
    v_xor_b32 v3, s88, v58
    v_or_b32 v2, v2, v3
    v_xor_b32 v3, s88, v62
    v_or_b32 v2, v2, v3
    v_cmp_ne_u32 vcc, 0, v2
    s_sub_u32 s4, s4, 1
    s_nop 3
    s_cbranch_vccz L_spin_19_ok
    s_cmp_eq_u32 s4, 0
    s_cbranch_scc0 L_spin_19
L_spin_19_ok:
    buffer_load_dwordx4 a[112:115], v24, s[8:11], s16 offen offset:0
    buffer_load_dwordx4 a[116:119], v24, s[8:11], s16 offen offset:1024
    buffer_load_dwordx4 a[120:123], v24, s[8:11], s16 offen offset:2048
    buffer_load_dwordx4 a[124:127], v24, s[8:11], s16 offen offset:3072
    s_add_u32 s16, s16, 8192
    buffer_load_dwordx4 a[128:131], v24, s[8:11], s16 offen offset:0
    buffer_load_dwordx4 a[132:135], v24, s[8:11], s16 offen offset:1024
    buffer_load_dwordx4 a[136:139], v24, s[8:11], s16 offen offset:2048
    buffer_load_dwordx4 a[140:143], v24, s[8:11], s16 offen offset:3072
    s_add_u32 s16, s16, 8192
    buffer_load_dwordx4 a[144:147], v24, s[8:11], s16 offen offset:0
    buffer_load_dwordx4 a[148:151], v24, s[8:11], s16 offen offset:1024
    buffer_load_dwordx4 a[152:155], v24, s[8:11], s16 offen offset:2048
    buffer_load_dwordx4 a[156:159], v24, s[8:11], s16 offen offset:3072
    s_add_u32 s16, s16, 8192
    v_pk_add_f32 v[32:33], v[32:33], v[40:41]
    v_pk_add_f32 v[48:49], v[48:49], v[56:57]
    v_pk_add_f32 v[4:5], v[32:33], v[48:49]
    v_pk_add_f32 v[36:37], v[36:37], v[44:45]
    v_pk_add_f32 v[52:53], v[52:53], v[60:61]
    v_pk_add_f32 v[6:7], v[36:37], v[52:53]
    v_mov_b32 v32, v4
    v_mov_b32 v33, v5
    v_mov_b32 v34, v6
    v_mov_b32 v35, v7
    s_nop 0
    v_permlane16_swap_b32 v4, v32
    v_permlane16_swap_b32 v5, v33
    v_permlane16_swap_b32 v6, v34
    v_permlane16_swap_b32 v7, v35
    v_pk_add_f32 v[4:5], v[4:5], v[32:33]
    v_pk_add_f32 v[6:7], v[6:7], v[34:35]
    v_mov_b32 v32, v4
    v_mov_b32 v33, v5
    v_mov_b32 v34, v6
    v_mov_b32 v35, v7
    s_nop 0
    v_permlane32_swap_b32 v4, v32
    v_permlane32_swap_b32 v5, v33
    v_permlane32_swap_b32 v6, v34
    v_permlane32_swap_b32 v7, v35
    v_pk_add_f32 v[4:5], v[4:5], v[32:33]
    v_pk_add_f32 v[6:7], v[6:7], v[34:35]
    v_mul_f32 v4, 0xba800000, v4
    v_mul_f32 v5, 0xba800000, v5
    v_mul_f32 v6, 0xba800000, v6
    v_mul_f32 v7, 0xba800000, v7
    v_pk_add_f32 v[200:201], v[200:201], v[144:145]
    v_pk_add_f32 v[202:203], v[202:203], v[146:147]
    v_pk_add_f32 v[204:205], v[204:205], v[148:149]
    v_pk_add_f32 v[206:207], v[206:207], v[150:151]
    v_pk_add_f32 v[208:209], v[208:209], v[152:153]
    v_pk_add_f32 v[210:211], v[210:211], v[154:155]
    v_pk_add_f32 v[212:213], v[212:213], v[156:157]
    v_pk_add_f32 v[214:215], v[214:215], v[158:159]
    v_pk_add_f32 v[216:217], v[216:217], v[160:161]
    v_pk_add_f32 v[218:219], v[218:219], v[162:163]
    v_pk_add_f32 v[220:221], v[220:221], v[164:165]
    v_pk_add_f32 v[222:223], v[222:223], v[166:167]
    v_pk_add_f32 v[224:225], v[224:225], v[168:169]
    v_pk_add_f32 v[226:227], v[226:227], v[170:171]
    v_pk_add_f32 v[228:229], v[228:229], v[172:173]
    v_pk_add_f32 v[230:231], v[230:231], v[174:175]
    v_pk_add_f32 v[232:233], v[232:233], v[176:177]
    v_pk_add_f32 v[234:235], v[234:235], v[178:179]
    v_pk_add_f32 v[236:237], v[236:237], v[180:181]
    v_pk_add_f32 v[238:239], v[238:239], v[182:183]
    v_pk_add_f32 v[240:241], v[240:241], v[184:185]
    v_pk_add_f32 v[242:243], v[242:243], v[186:187]
    v_pk_add_f32 v[244:245], v[244:245], v[188:189]
    v_pk_add_f32 v[246:247], v[246:247], v[190:191]
    v_pk_add_f32 v[248:249], v[248:249], v[192:193]
    v_pk_add_f32 v[250:251], v[250:251], v[194:195]
    v_pk_add_f32 v[252:253], v[252:253], v[196:197]
    v_pk_add_f32 v[254:255], v[254:255], v[198:199]
    v_pk_mul_f32 v[32:33], v[200:201], v[4:5] op_sel:[0,0] op_sel_hi:[1,0]
    v_pk_mul_f32 v[34:35], v[202:203], v[4:5] op_sel:[0,0] op_sel_hi:[1,0]
    v_pk_mul_f32 v[36:37], v[204:205], v[4:5] op_sel:[0,0] op_sel_hi:[1,0]
    v_pk_mul_f32 v[38:39], v[206:207], v[4:5] op_sel:[0,0] op_sel_hi:[1,0]
    v_pk_mul_f32 v[40:41], v[208:209], v[4:5] op_sel:[0,0] op_sel_hi:[1,0]
    v_pk_mul_f32 v[42:43], v[210:211], v[4:5] op_sel:[0,0] op_sel_hi:[1,0]
    v_pk_mul_f32 v[44:45], v[212:213], v[4:5] op_sel:[0,0] op_sel_hi:[1,0]
    v_pk_mul_f32 v[46:47], v[214:215], v[4:5] op_sel:[0,0] op_sel_hi:[1,0]
    v_pk_mul_f32 v[48:49], v[216:217], v[4:5] op_sel:[0,0] op_sel_hi:[1,0]
    v_pk_mul_f32 v[50:51], v[218:219], v[4:5] op_sel:[0,0] op_sel_hi:[1,0]
    v_pk_mul_f32 v[52:53], v[220:221], v[4:5] op_sel:[0,0] op_sel_hi:[1,0]
    v_pk_mul_f32 v[54:55], v[222:223], v[4:5] op_sel:[0,0] op_sel_hi:[1,0]
    v_pk_mul_f32 v[56:57], v[224:225], v[4:5] op_sel:[0,0] op_sel_hi:[1,0]
    v_pk_mul_f32 v[58:59], v[226:227], v[4:5] op_sel:[0,0] op_sel_hi:[1,0]
    v_pk_mul_f32 v[60:61], v[228:229], v[4:5] op_sel:[0,0] op_sel_hi:[1,0]
    v_pk_mul_f32 v[62:63], v[230:231], v[4:5] op_sel:[0,0] op_sel_hi:[1,0]
    v_pk_mul_f32 v[64:65], v[232:233], v[4:5] op_sel:[0,0] op_sel_hi:[1,0]
    v_pk_mul_f32 v[66:67], v[234:235], v[4:5] op_sel:[0,0] op_sel_hi:[1,0]
    v_pk_mul_f32 v[68:69], v[236:237], v[4:5] op_sel:[0,0] op_sel_hi:[1,0]
    v_pk_mul_f32 v[70:71], v[238:239], v[4:5] op_sel:[0,0] op_sel_hi:[1,0]
    v_pk_mul_f32 v[72:73], v[240:241], v[4:5] op_sel:[0,0] op_sel_hi:[1,0]
    v_pk_mul_f32 v[74:75], v[242:243], v[4:5] op_sel:[0,0] op_sel_hi:[1,0]
    v_pk_mul_f32 v[76:77], v[244:245], v[4:5] op_sel:[0,0] op_sel_hi:[1,0]
    v_pk_mul_f32 v[78:79], v[246:247], v[4:5] op_sel:[0,0] op_sel_hi:[1,0]
    v_pk_mul_f32 v[80:81], v[248:249], v[4:5] op_sel:[0,0] op_sel_hi:[1,0]
    v_pk_mul_f32 v[82:83], v[250:251], v[4:5] op_sel:[0,0] op_sel_hi:[1,0]
    v_pk_mul_f32 v[84:85], v[252:253], v[4:5] op_sel:[0,0] op_sel_hi:[1,0]
    v_pk_mul_f32 v[86:87], v[254:255], v[4:5] op_sel:[0,0] op_sel_hi:[1,0]
    v_pk_mul_f32 v[88:89], v[200:201], v[4:5] op_sel:[0,1] op_sel_hi:[1,1]
    v_pk_mul_f32 v[90:91], v[202:203], v[4:5] op_sel:[0,1] op_sel_hi:[1,1]
    v_pk_mul_f32 v[92:93], v[204:205], v[4:5] op_sel:[0,1] op_sel_hi:[1,1]
    v_pk_mul_f32 v[94:95], v[206:207], v[4:5] op_sel:[0,1] op_sel_hi:[1,1]
    v_pk_mul_f32 v[96:97], v[208:209], v[4:5] op_sel:[0,1] op_sel_hi:[1,1]
    v_pk_mul_f32 v[98:99], v[210:211], v[4:5] op_sel:[0,1] op_sel_hi:[1,1]
    v_pk_mul_f32 v[100:101], v[212:213], v[4:5] op_sel:[0,1] op_sel_hi:[1,1]
    v_pk_mul_f32 v[102:103], v[214:215], v[4:5] op_sel:[0,1] op_sel_hi:[1,1]
    v_pk_mul_f32 v[104:105], v[216:217], v[4:5] op_sel:[0,1] op_sel_hi:[1,1]
    v_pk_mul_f32 v[106:107], v[218:219], v[4:5] op_sel:[0,1] op_sel_hi:[1,1]
    v_pk_mul_f32 v[108:109], v[220:221], v[4:5] op_sel:[0,1] op_sel_hi:[1,1]
    v_pk_mul_f32 v[110:111], v[222:223], v[4:5] op_sel:[0,1] op_sel_hi:[1,1]
    v_pk_mul_f32 v[112:113], v[224:225], v[4:5] op_sel:[0,1] op_sel_hi:[1,1]
    v_pk_mul_f32 v[114:115], v[226:227], v[4:5] op_sel:[0,1] op_sel_hi:[1,1]
    v_pk_mul_f32 v[116:117], v[228:229], v[4:5] op_sel:[0,1] op_sel_hi:[1,1]
    v_pk_mul_f32 v[118:119], v[230:231], v[4:5] op_sel:[0,1] op_sel_hi:[1,1]
    v_pk_mul_f32 v[120:121], v[232:233], v[4:5] op_sel:[0,1] op_sel_hi:[1,1]
    v_pk_mul_f32 v[122:123], v[234:235], v[4:5] op_sel:[0,1] op_sel_hi:[1,1]
    v_pk_mul_f32 v[124:125], v[236:237], v[4:5] op_sel:[0,1] op_sel_hi:[1,1]
    v_pk_mul_f32 v[126:127], v[238:239], v[4:5] op_sel:[0,1] op_sel_hi:[1,1]
    v_pk_mul_f32 v[128:129], v[240:241], v[4:5] op_sel:[0,1] op_sel_hi:[1,1]
    v_pk_mul_f32 v[130:131], v[242:243], v[4:5] op_sel:[0,1] op_sel_hi:[1,1]
    v_pk_mul_f32 v[132:133], v[244:245], v[4:5] op_sel:[0,1] op_sel_hi:[1,1]
    v_pk_mul_f32 v[134:135], v[246:247], v[4:5] op_sel:[0,1] op_sel_hi:[1,1]
    v_pk_mul_f32 v[136:137], v[248:249], v[4:5] op_sel:[0,1] op_sel_hi:[1,1]
    v_pk_mul_f32 v[138:139], v[250:251], v[4:5] op_sel:[0,1] op_sel_hi:[1,1]
    v_pk_mul_f32 v[140:141], v[252:253], v[4:5] op_sel:[0,1] op_sel_hi:[1,1]
    v_pk_mul_f32 v[142:143], v[254:255], v[4:5] op_sel:[0,1] op_sel_hi:[1,1]
    v_pk_mul_f32 v[144:145], v[200:201], v[6:7] op_sel:[0,0] op_sel_hi:[1,0]
    v_pk_mul_f32 v[146:147], v[202:203], v[6:7] op_sel:[0,0] op_sel_hi:[1,0]
    v_pk_mul_f32 v[148:149], v[204:205], v[6:7] op_sel:[0,0] op_sel_hi:[1,0]
    v_pk_mul_f32 v[150:151], v[206:207], v[6:7] op_sel:[0,0] op_sel_hi:[1,0]
    v_pk_mul_f32 v[152:153], v[208:209], v[6:7] op_sel:[0,0] op_sel_hi:[1,0]
    v_pk_mul_f32 v[154:155], v[210:211], v[6:7] op_sel:[0,0] op_sel_hi:[1,0]
    v_pk_mul_f32 v[156:157], v[212:213], v[6:7] op_sel:[0,0] op_sel_hi:[1,0]
    v_pk_mul_f32 v[158:159], v[214:215], v[6:7] op_sel:[0,0] op_sel_hi:[1,0]
    v_pk_mul_f32 v[160:161], v[216:217], v[6:7] op_sel:[0,0] op_sel_hi:[1,0]
    v_pk_mul_f32 v[162:163], v[218:219], v[6:7] op_sel:[0,0] op_sel_hi:[1,0]
    v_pk_mul_f32 v[164:165], v[220:221], v[6:7] op_sel:[0,0] op_sel_hi:[1,0]
    v_pk_mul_f32 v[166:167], v[222:223], v[6:7] op_sel:[0,0] op_sel_hi:[1,0]
    v_pk_mul_f32 v[168:169], v[224:225], v[6:7] op_sel:[0,0] op_sel_hi:[1,0]
    v_pk_mul_f32 v[170:171], v[226:227], v[6:7] op_sel:[0,0] op_sel_hi:[1,0]
    v_pk_mul_f32 v[172:173], v[228:229], v[6:7] op_sel:[0,0] op_sel_hi:[1,0]
    v_pk_mul_f32 v[174:175], v[230:231], v[6:7] op_sel:[0,0] op_sel_hi:[1,0]
    v_pk_mul_f32 v[176:177], v[232:233], v[6:7] op_sel:[0,0] op_sel_hi:[1,0]
    v_pk_mul_f32 v[178:179], v[234:235], v[6:7] op_sel:[0,0] op_sel_hi:[1,0]
    v_pk_mul_f32 v[180:181], v[236:237], v[6:7] op_sel:[0,0] op_sel_hi:[1,0]
    v_pk_mul_f32 v[182:183], v[238:239], v[6:7] op_sel:[0,0] op_sel_hi:[1,0]
    v_pk_mul_f32 v[184:185], v[240:241], v[6:7] op_sel:[0,0] op_sel_hi:[1,0]
    v_pk_mul_f32 v[186:187], v[242:243], v[6:7] op_sel:[0,0] op_sel_hi:[1,0]
    v_pk_mul_f32 v[188:189], v[244:245], v[6:7] op_sel:[0,0] op_sel_hi:[1,0]
    v_pk_mul_f32 v[190:191], v[246:247], v[6:7] op_sel:[0,0] op_sel_hi:[1,0]
    v_pk_mul_f32 v[192:193], v[248:249], v[6:7] op_sel:[0,0] op_sel_hi:[1,0]
    v_pk_mul_f32 v[194:195], v[250:251], v[6:7] op_sel:[0,0] op_sel_hi:[1,0]
    v_pk_mul_f32 v[196:197], v[252:253], v[6:7] op_sel:[0,0] op_sel_hi:[1,0]
    v_pk_mul_f32 v[198:199], v[254:255], v[6:7] op_sel:[0,0] op_sel_hi:[1,0]
    v_pk_mul_f32 v[200:201], v[200:201], v[6:7] op_sel:[0,1] op_sel_hi:[1,1]
    v_pk_mul_f32 v[202:203], v[202:203], v[6:7] op_sel:[0,1] op_sel_hi:[1,1]
    v_pk_mul_f32 v[204:205], v[204:205], v[6:7] op_sel:[0,1] op_sel_hi:[1,1]
    v_pk_mul_f32 v[206:207], v[206:207], v[6:7] op_sel:[0,1] op_sel_hi:[1,1]
    v_pk_mul_f32 v[208:209], v[208:209], v[6:7] op_sel:[0,1] op_sel_hi:[1,1]
    v_pk_mul_f32 v[210:211], v[210:211], v[6:7] op_sel:[0,1] op_sel_hi:[1,1]
    v_pk_mul_f32 v[212:213], v[212:213], v[6:7] op_sel:[0,1] op_sel_hi:[1,1]
    v_pk_mul_f32 v[214:215], v[214:215], v[6:7] op_sel:[0,1] op_sel_hi:[1,1]
    v_pk_mul_f32 v[216:217], v[216:217], v[6:7] op_sel:[0,1] op_sel_hi:[1,1]
    v_pk_mul_f32 v[218:219], v[218:219], v[6:7] op_sel:[0,1] op_sel_hi:[1,1]
    v_pk_mul_f32 v[220:221], v[220:221], v[6:7] op_sel:[0,1] op_sel_hi:[1,1]
    v_pk_mul_f32 v[222:223], v[222:223], v[6:7] op_sel:[0,1] op_sel_hi:[1,1]
    v_pk_mul_f32 v[224:225], v[224:225], v[6:7] op_sel:[0,1] op_sel_hi:[1,1]
    v_pk_mul_f32 v[226:227], v[226:227], v[6:7] op_sel:[0,1] op_sel_hi:[1,1]
    v_pk_mul_f32 v[228:229], v[228:229], v[6:7] op_sel:[0,1] op_sel_hi:[1,1]
    v_pk_mul_f32 v[230:231], v[230:231], v[6:7] op_sel:[0,1] op_sel_hi:[1,1]
    v_pk_mul_f32 v[232:233], v[232:233], v[6:7] op_sel:[0,1] op_sel_hi:[1,1]
    v_pk_mul_f32 v[234:235], v[234:235], v[6:7] op_sel:[0,1] op_sel_hi:[1,1]
    v_pk_mul_f32 v[236:237], v[236:237], v[6:7] op_sel:[0,1] op_sel_hi:[1,1]
    v_pk_mul_f32 v[238:239], v[238:239], v[6:7] op_sel:[0,1] op_sel_hi:[1,1]
    v_pk_mul_f32 v[240:241], v[240:241], v[6:7] op_sel:[0,1] op_sel_hi:[1,1]
    v_pk_mul_f32 v[242:243], v[242:243], v[6:7] op_sel:[0,1] op_sel_hi:[1,1]
    v_pk_mul_f32 v[244:245], v[244:245], v[6:7] op_sel:[0,1] op_sel_hi:[1,1]
    v_pk_mul_f32 v[246:247], v[246:247], v[6:7] op_sel:[0,1] op_sel_hi:[1,1]
    v_pk_mul_f32 v[248:249], v[248:249], v[6:7] op_sel:[0,1] op_sel_hi:[1,1]
    v_pk_mul_f32 v[250:251], v[250:251], v[6:7] op_sel:[0,1] op_sel_hi:[1,1]
    v_pk_mul_f32 v[252:253], v[252:253], v[6:7] op_sel:[0,1] op_sel_hi:[1,1]
    v_pk_mul_f32 v[254:255], v[254:255], v[6:7] op_sel:[0,1] op_sel_hi:[1,1]
    s_waitcnt vmcnt(8) lgkmcnt(0)
    v_mfma_f32_16x16x32_bf16 v[32:35], a[0:3], a[112:115], v[32:35]
    ds_read_b64_tr_b16 a[56:57], v8 offset:14336
    v_mfma_f32_16x16x32_bf16 v[88:91], a[0:3], a[116:119], v[88:91]
    ds_read_b64_tr_b16 a[58:59], v8 offset:14848
    v_mfma_f32_16x16x32_bf16 v[144:147], a[0:3], a[120:123], v[144:147]
    v_mfma_f32_16x16x32_bf16 v[200:203], a[0:3], a[124:127], v[200:203]
    ds_read_b64_tr_b16 a[60:61], v8 offset:15360
    v_mfma_f32_16x16x32_bf16 v[36:39], a[4:7], a[112:115], v[36:39]
    ds_read_b64_tr_b16 a[62:63], v8 offset:15872
    v_mfma_f32_16x16x32_bf16 v[92:95], a[4:7], a[116:119], v[92:95]
    buffer_load_dwordx4 a[160:163], v24, s[8:11], s16 offen offset:0
    v_mfma_f32_16x16x32_bf16 v[148:151], a[4:7], a[120:123], v[148:151]
    v_mfma_f32_16x16x32_bf16 v[204:207], a[4:7], a[124:127], v[204:207]
    ds_read_b64_tr_b16 a[64:65], v8 offset:16384
    v_mfma_f32_16x16x32_bf16 v[40:43], a[8:11], a[112:115], v[40:43]
    ds_read_b64_tr_b16 a[66:67], v8 offset:16896
    v_mfma_f32_16x16x32_bf16 v[96:99], a[8:11], a[116:119], v[96:99]
    v_mfma_f32_16x16x32_bf16 v[152:155], a[8:11], a[120:123], v[152:155]
    ds_read_b64_tr_b16 a[68:69], v8 offset:17408
    v_mfma_f32_16x16x32_bf16 v[208:211], a[8:11], a[124:127], v[208:211]
    ds_read_b64_tr_b16 a[70:71], v8 offset:17920
    v_mfma_f32_16x16x32_bf16 v[44:47], a[12:15], a[112:115], v[44:47]
    v_mfma_f32_16x16x32_bf16 v[100:103], a[12:15], a[116:119], v[100:103]
    ds_read_b64_tr_b16 a[72:73], v8 offset:18432
    v_mfma_f32_16x16x32_bf16 v[156:159], a[12:15], a[120:123], v[156:159]
    ds_read_b64_tr_b16 a[74:75], v8 offset:18944
    v_mfma_f32_16x16x32_bf16 v[212:215], a[12:15], a[124:127], v[212:215]
    v_mfma_f32_16x16x32_bf16 v[48:51], a[16:19], a[112:115], v[48:51]
    buffer_load_dwordx4 a[164:167], v24, s[8:11], s16 offen offset:1024
    v_mfma_f32_16x16x32_bf16 v[104:107], a[16:19], a[116:119], v[104:107]
    ds_read_b64_tr_b16 a[76:77], v8 offset:19456
    v_mfma_f32_16x16x32_bf16 v[160:163], a[16:19], a[120:123], v[160:163]
    ds_read_b64_tr_b16 a[78:79], v8 offset:19968
    v_mfma_f32_16x16x32_bf16 v[216:219], a[16:19], a[124:127], v[216:219]
    v_mfma_f32_16x16x32_bf16 v[52:55], a[20:23], a[112:115], v[52:55]
    ds_read_b64_tr_b16 a[80:81], v10 offset:20480
    v_mfma_f32_16x16x32_bf16 v[108:111], a[20:23], a[116:119], v[108:111]
    ds_read_b64_tr_b16 a[82:83], v10 offset:20992
    v_mfma_f32_16x16x32_bf16 v[164:167], a[20:23], a[120:123], v[164:167]
    v_mfma_f32_16x16x32_bf16 v[220:223], a[20:23], a[124:127], v[220:223]
    ds_read_b64_tr_b16 a[84:85], v8 offset:21504
    v_mfma_f32_16x16x32_bf16 v[56:59], a[24:27], a[112:115], v[56:59]
    ds_read_b64_tr_b16 a[86:87], v8 offset:22016
    v_mfma_f32_16x16x32_bf16 v[112:115], a[24:27], a[116:119], v[112:115]
    v_mfma_f32_16x16x32_bf16 v[168:171], a[24:27], a[120:123], v[168:171]
    ds_read_b64_tr_b16 a[88:89], v8 offset:22528
    v_mfma_f32_16x16x32_bf16 v[224:227], a[24:27], a[124:127], v[224:227]
    ds_read_b64_tr_b16 a[90:91], v8 offset:23040
    v_mfma_f32_16x16x32_bf16 v[60:63], a[28:31], a[112:115], v[60:63]
    buffer_load_dwordx4 a[168:171], v24, s[8:11], s16 offen offset:2048
    v_mfma_f32_16x16x32_bf16 v[116:119], a[28:31], a[116:119], v[116:119]
    v_mfma_f32_16x16x32_bf16 v[172:175], a[28:31], a[120:123], v[172:175]
    ds_read_b64_tr_b16 a[92:93], v8 offset:23552
    v_mfma_f32_16x16x32_bf16 v[228:231], a[28:31], a[124:127], v[228:231]
    ds_read_b64_tr_b16 a[94:95], v8 offset:24064
    v_mfma_f32_16x16x32_bf16 v[64:67], a[32:35], a[112:115], v[64:67]
    v_mfma_f32_16x16x32_bf16 v[120:123], a[32:35], a[116:119], v[120:123]
    ds_read_b64_tr_b16 a[96:97], v8 offset:24576
    v_mfma_f32_16x16x32_bf16 v[176:179], a[32:35], a[120:123], v[176:179]
    ds_read_b64_tr_b16 a[98:99], v8 offset:25088
    v_mfma_f32_16x16x32_bf16 v[232:235], a[32:35], a[124:127], v[232:235]
    v_mfma_f32_16x16x32_bf16 v[68:71], a[36:39], a[112:115], v[68:71]
    ds_read_b64_tr_b16 a[100:101], v8 offset:25600
    v_mfma_f32_16x16x32_bf16 v[124:127], a[36:39], a[116:119], v[124:127]
    ds_read_b64_tr_b16 a[102:103], v8 offset:26112
    v_mfma_f32_16x16x32_bf16 v[180:183], a[36:39], a[120:123], v[180:183]
    v_mfma_f32_16x16x32_bf16 v[236:239], a[36:39], a[124:127], v[236:239]
    buffer_load_dwordx4 a[172:175], v24, s[8:11], s16 offen offset:3072
    v_mfma_f32_16x16x32_bf16 v[72:75], a[40:43], a[112:115], v[72:75]
    ds_read_b64_tr_b16 a[104:105], v8 offset:26624
    v_mfma_f32_16x16x32_bf16 v[128:131], a[40:43], a[116:119], v[128:131]
    ds_read_b64_tr_b16 a[106:107], v8 offset:27136
    v_mfma_f32_16x16x32_bf16 v[184:187], a[40:43], a[120:123], v[184:187]
    v_mfma_f32_16x16x32_bf16 v[240:243], a[40:43], a[124:127], v[240:243]
    ds_read_b64_tr_b16 a[108:109], v10 offset:27648
    v_mfma_f32_16x16x32_bf16 v[76:79], a[44:47], a[112:115], v[76:79]
    ds_read_b64_tr_b16 a[110:111], v10 offset:28160
    v_mfma_f32_16x16x32_bf16 v[132:135], a[44:47], a[116:119], v[132:135]
    v_mfma_f32_16x16x32_bf16 v[188:191], a[44:47], a[120:123], v[188:191]
    v_mfma_f32_16x16x32_bf16 v[244:247], a[44:47], a[124:127], v[244:247]
    v_mfma_f32_16x16x32_bf16 v[80:83], a[48:51], a[112:115], v[80:83]
    v_mfma_f32_16x16x32_bf16 v[136:139], a[48:51], a[116:119], v[136:139]
    v_mfma_f32_16x16x32_bf16 v[192:195], a[48:51], a[120:123], v[192:195]
    s_add_u32 s16, s16, 8192
    v_mfma_f32_16x16x32_bf16 v[248:251], a[48:51], a[124:127], v[248:251]
    v_mfma_f32_16x16x32_bf16 v[84:87], a[52:55], a[112:115], v[84:87]
    v_mfma_f32_16x16x32_bf16 v[140:143], a[52:55], a[116:119], v[140:143]
    v_mfma_f32_16x16x32_bf16 v[196:199], a[52:55], a[120:123], v[196:199]
    v_mfma_f32_16x16x32_bf16 v[252:255], a[52:55], a[124:127], v[252:255]
    s_waitcnt vmcnt(8) lgkmcnt(0)
    v_mfma_f32_16x16x32_bf16 v[32:35], a[56:59], a[128:131], v[32:35]
    ds_read_b64_tr_b16 a[0:1], v8 offset:28672
    v_mfma_f32_16x16x32_bf16 v[88:91], a[56:59], a[132:135], v[88:91]
    ds_read_b64_tr_b16 a[2:3], v8 offset:29184
    v_mfma_f32_16x16x32_bf16 v[144:147], a[56:59], a[136:139], v[144:147]
    v_mfma_f32_16x16x32_bf16 v[200:203], a[56:59], a[140:143], v[200:203]
    ds_read_b64_tr_b16 a[4:5], v8 offset:29696
    v_mfma_f32_16x16x32_bf16 v[36:39], a[60:63], a[128:131], v[36:39]
    ds_read_b64_tr_b16 a[6:7], v8 offset:30208
    v_mfma_f32_16x16x32_bf16 v[92:95], a[60:63], a[132:135], v[92:95]
    buffer_load_dwordx4 a[112:115], v24, s[8:11], s16 offen offset:0
    v_mfma_f32_16x16x32_bf16 v[148:151], a[60:63], a[136:139], v[148:151]
    v_mfma_f32_16x16x32_bf16 v[204:207], a[60:63], a[140:143], v[204:207]
    ds_read_b64_tr_b16 a[8:9], v8 offset:30720
    v_mfma_f32_16x16x32_bf16 v[40:43], a[64:67], a[128:131], v[40:43]
    ds_read_b64_tr_b16 a[10:11], v8 offset:31232
    v_mfma_f32_16x16x32_bf16 v[96:99], a[64:67], a[132:135], v[96:99]
    v_mfma_f32_16x16x32_bf16 v[152:155], a[64:67], a[136:139], v[152:155]
    ds_read_b64_tr_b16 a[12:13], v8 offset:31744
    v_mfma_f32_16x16x32_bf16 v[208:211], a[64:67], a[140:143], v[208:211]
    ds_read_b64_tr_b16 a[14:15], v8 offset:32256
    v_mfma_f32_16x16x32_bf16 v[44:47], a[68:71], a[128:131], v[44:47]
    v_mfma_f32_16x16x32_bf16 v[100:103], a[68:71], a[132:135], v[100:103]
    ds_read_b64_tr_b16 a[16:17], v8 offset:32768
    v_mfma_f32_16x16x32_bf16 v[156:159], a[68:71], a[136:139], v[156:159]
    ds_read_b64_tr_b16 a[18:19], v8 offset:33280
    v_mfma_f32_16x16x32_bf16 v[212:215], a[68:71], a[140:143], v[212:215]
    v_mfma_f32_16x16x32_bf16 v[48:51], a[72:75], a[128:131], v[48:51]
    buffer_load_dwordx4 a[116:119], v24, s[8:11], s16 offen offset:1024
    v_mfma_f32_16x16x32_bf16 v[104:107], a[72:75], a[132:135], v[104:107]
    ds_read_b64_tr_b16 a[20:21], v8 offset:33792
    v_mfma_f32_16x16x32_bf16 v[160:163], a[72:75], a[136:139], v[160:163]
    ds_read_b64_tr_b16 a[22:23], v8 offset:34304
    v_mfma_f32_16x16x32_bf16 v[216:219], a[72:75], a[140:143], v[216:219]
    v_mfma_f32_16x16x32_bf16 v[52:55], a[76:79], a[128:131], v[52:55]
    ds_read_b64_tr_b16 a[24:25], v10 offset:34816
    v_mfma_f32_16x16x32_bf16 v[108:111], a[76:79], a[132:135], v[108:111]
    ds_read_b64_tr_b16 a[26:27], v10 offset:35328
    v_mfma_f32_16x16x32_bf16 v[164:167], a[76:79], a[136:139], v[164:167]
    v_mfma_f32_16x16x32_bf16 v[220:223], a[76:79], a[140:143], v[220:223]
    ds_read_b64_tr_b16 a[28:29], v8 offset:35840
    v_mfma_f32_16x16x32_bf16 v[56:59], a[80:83], a[128:131], v[56:59]
    ds_read_b64_tr_b16 a[30:31], v8 offset:36352
    v_mfma_f32_16x16x32_bf16 v[112:115], a[80:83], a[132:135], v[112:115]
    v_mfma_f32_16x16x32_bf16 v[168:171], a[80:83], a[136:139], v[168:171]
    ds_read_b64_tr_b16 a[32:33], v8 offset:36864
    v_mfma_f32_16x16x32_bf16 v[224:227], a[80:83], a[140:143], v[224:227]
    ds_read_b64_tr_b16 a[34:35], v8 offset:37376
    v_mfma_f32_16x16x32_bf16 v[60:63], a[84:87], a[128:131], v[60:63]
    buffer_load_dwordx4 a[120:123], v24, s[8:11], s16 offen offset:2048
    v_mfma_f32_16x16x32_bf16 v[116:119], a[84:87], a[132:135], v[116:119]
    v_mfma_f32_16x16x32_bf16 v[172:175], a[84:87], a[136:139], v[172:175]
    ds_read_b64_tr_b16 a[36:37], v8 offset:37888
    v_mfma_f32_16x16x32_bf16 v[228:231], a[84:87], a[140:143], v[228:231]
    ds_read_b64_tr_b16 a[38:39], v8 offset:38400
    v_mfma_f32_16x16x32_bf16 v[64:67], a[88:91], a[128:131], v[64:67]
    v_mfma_f32_16x16x32_bf16 v[120:123], a[88:91], a[132:135], v[120:123]
    ds_read_b64_tr_b16 a[40:41], v8 offset:38912
    v_mfma_f32_16x16x32_bf16 v[176:179], a[88:91], a[136:139], v[176:179]
    ds_read_b64_tr_b16 a[42:43], v8 offset:39424
    v_mfma_f32_16x16x32_bf16 v[232:235], a[88:91], a[140:143], v[232:235]
    v_mfma_f32_16x16x32_bf16 v[68:71], a[92:95], a[128:131], v[68:71]
    ds_read_b64_tr_b16 a[44:45], v8 offset:39936
    v_mfma_f32_16x16x32_bf16 v[124:127], a[92:95], a[132:135], v[124:127]
    ds_read_b64_tr_b16 a[46:47], v8 offset:40448
    v_mfma_f32_16x16x32_bf16 v[180:183], a[92:95], a[136:139], v[180:183]
    v_mfma_f32_16x16x32_bf16 v[236:239], a[92:95], a[140:143], v[236:239]
    buffer_load_dwordx4 a[124:127], v24, s[8:11], s16 offen offset:3072
    v_mfma_f32_16x16x32_bf16 v[72:75], a[96:99], a[128:131], v[72:75]
    ds_read_b64_tr_b16 a[48:49], v8 offset:40960
    v_mfma_f32_16x16x32_bf16 v[128:131], a[96:99], a[132:135], v[128:131]
    ds_read_b64_tr_b16 a[50:51], v8 offset:41472
    v_mfma_f32_16x16x32_bf16 v[184:187], a[96:99], a[136:139], v[184:187]
    v_mfma_f32_16x16x32_bf16 v[240:243], a[96:99], a[140:143], v[240:243]
    ds_read_b64_tr_b16 a[52:53], v10 offset:41984
    v_mfma_f32_16x16x32_bf16 v[76:79], a[100:103], a[128:131], v[76:79]
    ds_read_b64_tr_b16 a[54:55], v10 offset:42496
    v_mfma_f32_16x16x32_bf16 v[132:135], a[100:103], a[132:135], v[132:135]
    v_mfma_f32_16x16x32_bf16 v[188:191], a[100:103], a[136:139], v[188:191]
    v_mfma_f32_16x16x32_bf16 v[244:247], a[100:103], a[140:143], v[244:247]
    v_mfma_f32_16x16x32_bf16 v[80:83], a[104:107], a[128:131], v[80:83]
    v_mfma_f32_16x16x32_bf16 v[136:139], a[104:107], a[132:135], v[136:139]
    v_mfma_f32_16x16x32_bf16 v[192:195], a[104:107], a[136:139], v[192:195]
    s_add_u32 s16, s16, 8192
    v_mfma_f32_16x16x32_bf16 v[248:251], a[104:107], a[140:143], v[248:251]
    v_mfma_f32_16x16x32_bf16 v[84:87], a[108:111], a[128:131], v[84:87]
    v_mfma_f32_16x16x32_bf16 v[140:143], a[108:111], a[132:135], v[140:143]
    v_mfma_f32_16x16x32_bf16 v[196:199], a[108:111], a[136:139], v[196:199]
    v_mfma_f32_16x16x32_bf16 v[252:255], a[108:111], a[140:143], v[252:255]
    s_waitcnt vmcnt(8) lgkmcnt(0)
    v_mfma_f32_16x16x32_bf16 v[32:35], a[0:3], a[144:147], v[32:35]
    ds_read_b64_tr_b16 a[56:57], v8 offset:43008
    v_mfma_f32_16x16x32_bf16 v[88:91], a[0:3], a[148:151], v[88:91]
    ds_read_b64_tr_b16 a[58:59], v8 offset:43520
    v_mfma_f32_16x16x32_bf16 v[144:147], a[0:3], a[152:155], v[144:147]
    v_mfma_f32_16x16x32_bf16 v[200:203], a[0:3], a[156:159], v[200:203]
    ds_read_b64_tr_b16 a[60:61], v8 offset:44032
    v_mfma_f32_16x16x32_bf16 v[36:39], a[4:7], a[144:147], v[36:39]
    ds_read_b64_tr_b16 a[62:63], v8 offset:44544
    v_mfma_f32_16x16x32_bf16 v[92:95], a[4:7], a[148:151], v[92:95]
    buffer_load_dwordx4 a[128:131], v24, s[8:11], s16 offen offset:0
    v_mfma_f32_16x16x32_bf16 v[148:151], a[4:7], a[152:155], v[148:151]
    v_mfma_f32_16x16x32_bf16 v[204:207], a[4:7], a[156:159], v[204:207]
    ds_read_b64_tr_b16 a[64:65], v8 offset:45056
    v_mfma_f32_16x16x32_bf16 v[40:43], a[8:11], a[144:147], v[40:43]
    ds_read_b64_tr_b16 a[66:67], v8 offset:45568
    v_mfma_f32_16x16x32_bf16 v[96:99], a[8:11], a[148:151], v[96:99]
    v_mfma_f32_16x16x32_bf16 v[152:155], a[8:11], a[152:155], v[152:155]
    ds_read_b64_tr_b16 a[68:69], v8 offset:46080
    v_mfma_f32_16x16x32_bf16 v[208:211], a[8:11], a[156:159], v[208:211]
    ds_read_b64_tr_b16 a[70:71], v8 offset:46592
    v_mfma_f32_16x16x32_bf16 v[44:47], a[12:15], a[144:147], v[44:47]
    v_mfma_f32_16x16x32_bf16 v[100:103], a[12:15], a[148:151], v[100:103]
    ds_read_b64_tr_b16 a[72:73], v8 offset:47104
    v_mfma_f32_16x16x32_bf16 v[156:159], a[12:15], a[152:155], v[156:159]
    ds_read_b64_tr_b16 a[74:75], v8 offset:47616
    v_mfma_f32_16x16x32_bf16 v[212:215], a[12:15], a[156:159], v[212:215]
    v_mfma_f32_16x16x32_bf16 v[48:51], a[16:19], a[144:147], v[48:51]
    buffer_load_dwordx4 a[132:135], v24, s[8:11], s16 offen offset:1024
    v_mfma_f32_16x16x32_bf16 v[104:107], a[16:19], a[148:151], v[104:107]
    ds_read_b64_tr_b16 a[76:77], v8 offset:48128
    v_mfma_f32_16x16x32_bf16 v[160:163], a[16:19], a[152:155], v[160:163]
    ds_read_b64_tr_b16 a[78:79], v8 offset:48640
    v_mfma_f32_16x16x32_bf16 v[216:219], a[16:19], a[156:159], v[216:219]
    v_mfma_f32_16x16x32_bf16 v[52:55], a[20:23], a[144:147], v[52:55]
    ds_read_b64_tr_b16 a[80:81], v10 offset:49152
    v_mfma_f32_16x16x32_bf16 v[108:111], a[20:23], a[148:151], v[108:111]
    ds_read_b64_tr_b16 a[82:83], v10 offset:49664
    v_mfma_f32_16x16x32_bf16 v[164:167], a[20:23], a[152:155], v[164:167]
    v_mfma_f32_16x16x32_bf16 v[220:223], a[20:23], a[156:159], v[220:223]
    ds_read_b64_tr_b16 a[84:85], v8 offset:50176
    v_mfma_f32_16x16x32_bf16 v[56:59], a[24:27], a[144:147], v[56:59]
    ds_read_b64_tr_b16 a[86:87], v8 offset:50688
    v_mfma_f32_16x16x32_bf16 v[112:115], a[24:27], a[148:151], v[112:115]
    v_mfma_f32_16x16x32_bf16 v[168:171], a[24:27], a[152:155], v[168:171]
    ds_read_b64_tr_b16 a[88:89], v8 offset:51200
    v_mfma_f32_16x16x32_bf16 v[224:227], a[24:27], a[156:159], v[224:227]
    ds_read_b64_tr_b16 a[90:91], v8 offset:51712
    v_mfma_f32_16x16x32_bf16 v[60:63], a[28:31], a[144:147], v[60:63]
    buffer_load_dwordx4 a[136:139], v24, s[8:11], s16 offen offset:2048
    v_mfma_f32_16x16x32_bf16 v[116:119], a[28:31], a[148:151], v[116:119]
    v_mfma_f32_16x16x32_bf16 v[172:175], a[28:31], a[152:155], v[172:175]
    ds_read_b64_tr_b16 a[92:93], v8 offset:52224
    v_mfma_f32_16x16x32_bf16 v[228:231], a[28:31], a[156:159], v[228:231]
    ds_read_b64_tr_b16 a[94:95], v8 offset:52736
    v_mfma_f32_16x16x32_bf16 v[64:67], a[32:35], a[144:147], v[64:67]
    v_mfma_f32_16x16x32_bf16 v[120:123], a[32:35], a[148:151], v[120:123]
    ds_read_b64_tr_b16 a[96:97], v8 offset:53248
    v_mfma_f32_16x16x32_bf16 v[176:179], a[32:35], a[152:155], v[176:179]
    ds_read_b64_tr_b16 a[98:99], v8 offset:53760
    v_mfma_f32_16x16x32_bf16 v[232:235], a[32:35], a[156:159], v[232:235]
    v_mfma_f32_16x16x32_bf16 v[68:71], a[36:39], a[144:147], v[68:71]
    ds_read_b64_tr_b16 a[100:101], v8 offset:54272
    v_mfma_f32_16x16x32_bf16 v[124:127], a[36:39], a[148:151], v[124:127]
    ds_read_b64_tr_b16 a[102:103], v8 offset:54784
    v_mfma_f32_16x16x32_bf16 v[180:183], a[36:39], a[152:155], v[180:183]
    v_mfma_f32_16x16x32_bf16 v[236:239], a[36:39], a[156:159], v[236:239]
    buffer_load_dwordx4 a[140:143], v24, s[8:11], s16 offen offset:3072
    v_mfma_f32_16x16x32_bf16 v[72:75], a[40:43], a[144:147], v[72:75]
    ds_read_b64_tr_b16 a[104:105], v8 offset:55296
    v_mfma_f32_16x16x32_bf16 v[128:131], a[40:43], a[148:151], v[128:131]
    ds_read_b64_tr_b16 a[106:107], v8 offset:55808
    v_mfma_f32_16x16x32_bf16 v[184:187], a[40:43], a[152:155], v[184:187]
    v_mfma_f32_16x16x32_bf16 v[240:243], a[40:43], a[156:159], v[240:243]
    ds_read_b64_tr_b16 a[108:109], v10 offset:56320
    v_mfma_f32_16x16x32_bf16 v[76:79], a[44:47], a[144:147], v[76:79]
    ds_read_b64_tr_b16 a[110:111], v10 offset:56832
    v_mfma_f32_16x16x32_bf16 v[132:135], a[44:47], a[148:151], v[132:135]
    v_mfma_f32_16x16x32_bf16 v[188:191], a[44:47], a[152:155], v[188:191]
    v_mfma_f32_16x16x32_bf16 v[244:247], a[44:47], a[156:159], v[244:247]
    v_mfma_f32_16x16x32_bf16 v[80:83], a[48:51], a[144:147], v[80:83]
    v_mfma_f32_16x16x32_bf16 v[136:139], a[48:51], a[148:151], v[136:139]
    v_mfma_f32_16x16x32_bf16 v[192:195], a[48:51], a[152:155], v[192:195]
    s_add_u32 s16, s16, 8192
    v_mfma_f32_16x16x32_bf16 v[248:251], a[48:51], a[156:159], v[248:251]
    v_mfma_f32_16x16x32_bf16 v[84:87], a[52:55], a[144:147], v[84:87]
    v_mfma_f32_16x16x32_bf16 v[140:143], a[52:55], a[148:151], v[140:143]
    v_mfma_f32_16x16x32_bf16 v[196:199], a[52:55], a[152:155], v[196:199]
    v_mfma_f32_16x16x32_bf16 v[252:255], a[52:55], a[156:159], v[252:255]
    s_waitcnt vmcnt(8) lgkmcnt(0)
    s_barrier
    v_mfma_f32_16x16x32_bf16 v[32:35], a[56:59], a[160:163], v[32:35]
    ds_read_b64_tr_b16 a[0:1], v9 offset:0
    v_mfma_f32_16x16x32_bf16 v[88:91], a[56:59], a[164:167], v[88:91]
    buffer_load_dwordx4 a[144:147], v24, s[8:11], s16 offen offset:0
    v_mfma_f32_16x16x32_bf16 v[144:147], a[56:59], a[168:171], v[144:147]
    ds_read_b64_tr_b16 a[2:3], v9 offset:512
    v_mfma_f32_16x16x32_bf16 v[200:203], a[56:59], a[172:175], v[200:203]
    ds_read_b64_tr_b16 a[4:5], v9 offset:1024
    v_mfma_f32_16x16x32_bf16 v[36:39], a[60:63], a[160:163], v[36:39]
    ds_read_b64_tr_b16 a[6:7], v9 offset:1536
    v_mfma_f32_16x16x32_bf16 v[92:95], a[60:63], a[164:167], v[92:95]
    s_add_u32 m0, s20, 0
    v_mfma_f32_16x16x32_bf16 v[148:151], a[60:63], a[168:171], v[148:151]
    ds_read_b64_tr_b16 a[8:9], v9 offset:2048
    v_mfma_f32_16x16x32_bf16 v[204:207], a[60:63], a[172:175], v[204:207]
    ds_read_b64_tr_b16 a[10:11], v9 offset:2560
    v_mfma_f32_16x16x32_bf16 v[40:43], a[64:67], a[160:163], v[40:43]
    buffer_load_dwordx4 v25, s[12:15], s17 offen lds
    v_mfma_f32_16x16x32_bf16 v[96:99], a[64:67], a[164:167], v[96:99]
    v_mfma_f32_16x16x32_bf16 v[152:155], a[64:67], a[168:171], v[152:155]
    ds_read_b64_tr_b16 a[12:13], v9 offset:3072
    v_mfma_f32_16x16x32_bf16 v[208:211], a[64:67], a[172:175], v[208:211]
    ds_read_b64_tr_b16 a[14:15], v9 offset:3584
    v_mfma_f32_16x16x32_bf16 v[44:47], a[68:71], a[160:163], v[44:47]
    buffer_load_dwordx4 a[148:151], v24, s[8:11], s16 offen offset:1024
    v_mfma_f32_16x16x32_bf16 v[100:103], a[68:71], a[164:167], v[100:103]
    ds_read_b64_tr_b16 a[16:17], v9 offset:4096
    v_mfma_f32_16x16x32_bf16 v[156:159], a[68:71], a[168:171], v[156:159]
    ds_read_b64_tr_b16 a[18:19], v9 offset:4608
    v_mfma_f32_16x16x32_bf16 v[212:215], a[68:71], a[172:175], v[212:215]
    buffer_load_dwordx4 v25, s[12:15], s17 offen offset:1024 lds
    v_mfma_f32_16x16x32_bf16 v[48:51], a[72:75], a[160:163], v[48:51]
    ds_read_b64_tr_b16 a[20:21], v9 offset:5120
    v_mfma_f32_16x16x32_bf16 v[104:107], a[72:75], a[164:167], v[104:107]
    ds_read_b64_tr_b16 a[22:23], v9 offset:5632
    v_mfma_f32_16x16x32_bf16 v[160:163], a[72:75], a[168:171], v[160:163]
    v_mfma_f32_16x16x32_bf16 v[216:219], a[72:75], a[172:175], v[216:219]
    buffer_load_dwordx4 a[152:155], v24, s[8:11], s16 offen offset:2048
    v_mfma_f32_16x16x32_bf16 v[52:55], a[76:79], a[160:163], v[52:55]
    ds_read_b64_tr_b16 a[24:25], v11 offset:6144
    v_mfma_f32_16x16x32_bf16 v[108:111], a[76:79], a[164:167], v[108:111]
    ds_read_b64_tr_b16 a[26:27], v11 offset:6656
    v_mfma_f32_16x16x32_bf16 v[164:167], a[76:79], a[168:171], v[164:167]
    buffer_load_dwordx4 v25, s[12:15], s17 offen offset:2048 lds
    v_mfma_f32_16x16x32_bf16 v[220:223], a[76:79], a[172:175], v[220:223]
    ds_read_b64_tr_b16 a[28:29], v9 offset:7168
    v_mfma_f32_16x16x32_bf16 v[56:59], a[80:83], a[160:163], v[56:59]
    ds_read_b64_tr_b16 a[30:31], v9 offset:7680
    v_mfma_f32_16x16x32_bf16 v[112:115], a[80:83], a[164:167], v[112:115]
    ds_read_b64_tr_b16 a[32:33], v9 offset:8192
    v_mfma_f32_16x16x32_bf16 v[168:171], a[80:83], a[168:171], v[168:171]
    buffer_load_dwordx4 a[156:159], v24, s[8:11], s16 offen offset:3072
    v_mfma_f32_16x16x32_bf16 v[224:227], a[80:83], a[172:175], v[224:227]
    v_mfma_f32_16x16x32_bf16 v[60:63], a[84:87], a[160:163], v[60:63]
    ds_read_b64_tr_b16 a[34:35], v9 offset:8704
    v_mfma_f32_16x16x32_bf16 v[116:119], a[84:87], a[164:167], v[116:119]
    buffer_load_dwordx4 v25, s[12:15], s17 offen offset:3072 lds
    v_mfma_f32_16x16x32_bf16 v[172:175], a[84:87], a[168:171], v[172:175]
    ds_read_b64_tr_b16 a[36:37], v9 offset:9216
    v_mfma_f32_16x16x32_bf16 v[228:231], a[84:87], a[172:175], v[228:231]
    ds_read_b64_tr_b16 a[38:39], v9 offset:9728
    v_mfma_f32_16x16x32_bf16 v[64:67], a[88:91], a[160:163], v[64:67]
    ds_read_b64_tr_b16 a[40:41], v9 offset:10240
    v_mfma_f32_16x16x32_bf16 v[120:123], a[88:91], a[164:167], v[120:123]
    s_add_u32 s16, s16, 8192
    v_mfma_f32_16x16x32_bf16 v[176:179], a[88:91], a[168:171], v[176:179]
    ds_read_b64_tr_b16 a[42:43], v9 offset:10752
    v_mfma_f32_16x16x32_bf16 v[232:235], a[88:91], a[172:175], v[232:235]
    ds_read_b64_tr_b16 a[44:45], v9 offset:11264
    v_mfma_f32_16x16x32_bf16 v[68:71], a[92:95], a[160:163], v[68:71]
    s_add_u32 m0, s20, 4096
    v_mfma_f32_16x16x32_bf16 v[124:127], a[92:95], a[164:167], v[124:127]
    v_mfma_f32_16x16x32_bf16 v[180:183], a[92:95], a[168:171], v[180:183]
    ds_read_b64_tr_b16 a[46:47], v9 offset:11776
    v_mfma_f32_16x16x32_bf16 v[236:239], a[92:95], a[172:175], v[236:239]
    ds_read_b64_tr_b16 a[48:49], v9 offset:12288
    v_mfma_f32_16x16x32_bf16 v[72:75], a[96:99], a[160:163], v[72:75]
    buffer_load_dwordx4 v25, s[12:15], s21 offen lds
    v_mfma_f32_16x16x32_bf16 v[128:131], a[96:99], a[164:167], v[128:131]
    ds_read_b64_tr_b16 a[50:51], v9 offset:12800
    v_mfma_f32_16x16x32_bf16 v[184:187], a[96:99], a[168:171], v[184:187]
    ds_read_b64_tr_b16 a[52:53], v11 offset:13312
    v_mfma_f32_16x16x32_bf16 v[240:243], a[96:99], a[172:175], v[240:243]
    buffer_load_dwordx4 v25, s[12:15], s21 offen offset:1024 lds
    v_mfma_f32_16x16x32_bf16 v[76:79], a[100:103], a[160:163], v[76:79]
    ds_read_b64_tr_b16 a[54:55], v11 offset:13824
    v_mfma_f32_16x16x32_bf16 v[132:135], a[100:103], a[164:167], v[132:135]
    v_mfma_f32_16x16x32_bf16 v[188:191], a[100:103], a[168:171], v[188:191]
    v_mfma_f32_16x16x32_bf16 v[244:247], a[100:103], a[172:175], v[244:247]
    buffer_load_dwordx4 v25, s[12:15], s21 offen offset:2048 lds
    v_mfma_f32_16x16x32_bf16 v[80:83], a[104:107], a[160:163], v[80:83]
    v_mfma_f32_16x16x32_bf16 v[136:139], a[104:107], a[164:167], v[136:139]
    v_mfma_f32_16x16x32_bf16 v[192:195], a[104:107], a[168:171], v[192:195]
    s_add_u32 s17, s17, 28672
    v_mfma_f32_16x16x32_bf16 v[248:251], a[104:107], a[172:175], v[248:251]
    v_mfma_f32_16x16x32_bf16 v[84:87], a[108:111], a[160:163], v[84:87]
    v_mfma_f32_16x16x32_bf16 v[140:143], a[108:111], a[164:167], v[140:143]
    v_mfma_f32_16x16x32_bf16 v[196:199], a[108:111], a[168:171], v[196:199]
    s_add_u32 s21, s21, 28672
    v_mfma_f32_16x16x32_bf16 v[252:255], a[108:111], a[172:175], v[252:255]
    s_waitcnt vmcnt(15) lgkmcnt(0)
    v_mfma_f32_16x16x32_bf16 v[32:35], a[0:3], a[112:115], v[32:35]
    ds_read_b64_tr_b16 a[56:57], v9 offset:14336
    v_mfma_f32_16x16x32_bf16 v[88:91], a[0:3], a[116:119], v[88:91]
    buffer_load_dwordx4 a[160:163], v24, s[8:11], s16 offen offset:0
    v_mfma_f32_16x16x32_bf16 v[144:147], a[0:3], a[120:123], v[144:147]
    ds_read_b64_tr_b16 a[58:59], v9 offset:14848
    v_mfma_f32_16x16x32_bf16 v[200:203], a[0:3], a[124:127], v[200:203]
    ds_read_b64_tr_b16 a[60:61], v9 offset:15360
    v_mfma_f32_16x16x32_bf16 v[36:39], a[4:7], a[112:115], v[36:39]
    ds_read_b64_tr_b16 a[62:63], v9 offset:15872
    v_mfma_f32_16x16x32_bf16 v[92:95], a[4:7], a[116:119], v[92:95]
    s_add_u32 m0, s20, 28672
    v_mfma_f32_16x16x32_bf16 v[148:151], a[4:7], a[120:123], v[148:151]
    ds_read_b64_tr_b16 a[64:65], v9 offset:16384
    v_mfma_f32_16x16x32_bf16 v[204:207], a[4:7], a[124:127], v[204:207]
    ds_read_b64_tr_b16 a[66:67], v9 offset:16896
    v_mfma_f32_16x16x32_bf16 v[40:43], a[8:11], a[112:115], v[40:43]
    buffer_load_dwordx4 v25, s[12:15], s17 offen lds
    v_mfma_f32_16x16x32_bf16 v[96:99], a[8:11], a[116:119], v[96:99]
    v_mfma_f32_16x16x32_bf16 v[152:155], a[8:11], a[120:123], v[152:155]
    ds_read_b64_tr_b16 a[68:69], v9 offset:17408
    v_mfma_f32_16x16x32_bf16 v[208:211], a[8:11], a[124:127], v[208:211]
    ds_read_b64_tr_b16 a[70:71], v9 offset:17920
    v_mfma_f32_16x16x32_bf16 v[44:47], a[12:15], a[112:115], v[44:47]
    buffer_load_dwordx4 a[164:167], v24, s[8:11], s16 offen offset:1024
    v_mfma_f32_16x16x32_bf16 v[100:103], a[12:15], a[116:119], v[100:103]
    ds_read_b64_tr_b16 a[72:73], v9 offset:18432
    v_mfma_f32_16x16x32_bf16 v[156:159], a[12:15], a[120:123], v[156:159]
    ds_read_b64_tr_b16 a[74:75], v9 offset:18944
    v_mfma_f32_16x16x32_bf16 v[212:215], a[12:15], a[124:127], v[212:215]
    buffer_load_dwordx4 v25, s[12:15], s17 offen offset:1024 lds
    v_mfma_f32_16x16x32_bf16 v[48:51], a[16:19], a[112:115], v[48:51]
    ds_read_b64_tr_b16 a[76:77], v9 offset:19456
    v_mfma_f32_16x16x32_bf16 v[104:107], a[16:19], a[116:119], v[104:107]
    ds_read_b64_tr_b16 a[78:79], v9 offset:19968
    v_mfma_f32_16x16x32_bf16 v[160:163], a[16:19], a[120:123], v[160:163]
    v_mfma_f32_16x16x32_bf16 v[216:219], a[16:19], a[124:127], v[216:219]
    buffer_load_dwordx4 a[168:171], v24, s[8:11], s16 offen offset:2048
    v_mfma_f32_16x16x32_bf16 v[52:55], a[20:23], a[112:115], v[52:55]
    ds_read_b64_tr_b16 a[80:81], v11 offset:20480
    v_mfma_f32_16x16x32_bf16 v[108:111], a[20:23], a[116:119], v[108:111]
    ds_read_b64_tr_b16 a[82:83], v11 offset:20992
    v_mfma_f32_16x16x32_bf16 v[164:167], a[20:23], a[120:123], v[164:167]
    buffer_load_dwordx4 v25, s[12:15], s17 offen offset:2048 lds
    v_mfma_f32_16x16x32_bf16 v[220:223], a[20:23], a[124:127], v[220:223]
    ds_read_b64_tr_b16 a[84:85], v9 offset:21504
    v_mfma_f32_16x16x32_bf16 v[56:59], a[24:27], a[112:115], v[56:59]
    ds_read_b64_tr_b16 a[86:87], v9 offset:22016
    v_mfma_f32_16x16x32_bf16 v[112:115], a[24:27], a[116:119], v[112:115]
    ds_read_b64_tr_b16 a[88:89], v9 offset:22528
    v_mfma_f32_16x16x32_bf16 v[168:171], a[24:27], a[120:123], v[168:171]
    buffer_load_dwordx4 a[172:175], v24, s[8:11], s16 offen offset:3072
    v_mfma_f32_16x16x32_bf16 v[224:227], a[24:27], a[124:127], v[224:227]
    v_mfma_f32_16x16x32_bf16 v[60:63], a[28:31], a[112:115], v[60:63]
    ds_read_b64_tr_b16 a[90:91], v9 offset:23040
    v_mfma_f32_16x16x32_bf16 v[116:119], a[28:31], a[116:119], v[116:119]
    buffer_load_dwordx4 v25, s[12:15], s17 offen offset:3072 lds
    v_mfma_f32_16x16x32_bf16 v[172:175], a[28:31], a[120:123], v[172:175]
    ds_read_b64_tr_b16 a[92:93], v9 offset:23552
    v_mfma_f32_16x16x32_bf16 v[228:231], a[28:31], a[124:127], v[228:231]
    ds_read_b64_tr_b16 a[94:95], v9 offset:24064
    v_mfma_f32_16x16x32_bf16 v[64:67], a[32:35], a[112:115], v[64:67]
    ds_read_b64_tr_b16 a[96:97], v9 offset:24576
    v_mfma_f32_16x16x32_bf16 v[120:123], a[32:35], a[116:119], v[120:123]
    s_add_u32 s16, s16, 8192
    v_mfma_f32_16x16x32_bf16 v[176:179], a[32:35], a[120:123], v[176:179]
    ds_read_b64_tr_b16 a[98:99], v9 offset:25088
    v_mfma_f32_16x16x32_bf16 v[232:235], a[32:35], a[124:127], v[232:235]
    ds_read_b64_tr_b16 a[100:101], v9 offset:25600
    v_mfma_f32_16x16x32_bf16 v[68:71], a[36:39], a[112:115], v[68:71]
    s_add_u32 m0, s20, 32768
    v_mfma_f32_16x16x32_bf16 v[124:127], a[36:39], a[116:119], v[124:127]
    v_mfma_f32_16x16x32_bf16 v[180:183], a[36:39], a[120:123], v[180:183]
    ds_read_b64_tr_b16 a[102:103], v9 offset:26112
    v_mfma_f32_16x16x32_bf16 v[236:239], a[36:39], a[124:127], v[236:239]
    ds_read_b64_tr_b16 a[104:105], v9 offset:26624
    v_mfma_f32_16x16x32_bf16 v[72:75], a[40:43], a[112:115], v[72:75]
    buffer_load_dwordx4 v25, s[12:15], s21 offen lds
    v_mfma_f32_16x16x32_bf16 v[128:131], a[40:43], a[116:119], v[128:131]
    ds_read_b64_tr_b16 a[106:107], v9 offset:27136
    v_mfma_f32_16x16x32_bf16 v[184:187], a[40:43], a[120:123], v[184:187]
    ds_read_b64_tr_b16 a[108:109], v11 offset:27648
    v_mfma_f32_16x16x32_bf16 v[240:243], a[40:43], a[124:127], v[240:243]
    buffer_load_dwordx4 v25, s[12:15], s21 offen offset:1024 lds
    v_mfma_f32_16x16x32_bf16 v[76:79], a[44:47], a[112:115], v[76:79]
    ds_read_b64_tr_b16 a[110:111], v11 offset:28160
    v_mfma_f32_16x16x32_bf16 v[132:135], a[44:47], a[116:119], v[132:135]
    v_mfma_f32_16x16x32_bf16 v[188:191], a[44:47], a[120:123], v[188:191]
    v_mfma_f32_16x16x32_bf16 v[244:247], a[44:47], a[124:127], v[244:247]
    buffer_load_dwordx4 v25, s[12:15], s21 offen offset:2048 lds
    v_mfma_f32_16x16x32_bf16 v[80:83], a[48:51], a[112:115], v[80:83]
    v_mfma_f32_16x16x32_bf16 v[136:139], a[48:51], a[116:119], v[136:139]
    v_mfma_f32_16x16x32_bf16 v[192:195], a[48:51], a[120:123], v[192:195]
    s_add_u32 s17, s17, 28672
    v_mfma_f32_16x16x32_bf16 v[248:251], a[48:51], a[124:127], v[248:251]
    v_mfma_f32_16x16x32_bf16 v[84:87], a[52:55], a[112:115], v[84:87]
    v_mfma_f32_16x16x32_bf16 v[140:143], a[52:55], a[116:119], v[140:143]
    v_mfma_f32_16x16x32_bf16 v[196:199], a[52:55], a[120:123], v[196:199]
    s_add_u32 s21, s21, 28672
    v_mfma_f32_16x16x32_bf16 v[252:255], a[52:55], a[124:127], v[252:255]
    s_waitcnt vmcnt(22) lgkmcnt(0)
    v_mfma_f32_16x16x32_bf16 v[32:35], a[56:59], a[128:131], v[32:35]
    ds_read_b64_tr_b16 a[0:1], v9 offset:28672
    v_mfma_f32_16x16x32_bf16 v[88:91], a[56:59], a[132:135], v[88:91]
    ds_read_b64_tr_b16 a[2:3], v9 offset:29184
    v_mfma_f32_16x16x32_bf16 v[144:147], a[56:59], a[136:139], v[144:147]
    v_mfma_f32_16x16x32_bf16 v[200:203], a[56:59], a[140:143], v[200:203]
    ds_read_b64_tr_b16 a[4:5], v9 offset:29696
    v_mfma_f32_16x16x32_bf16 v[36:39], a[60:63], a[128:131], v[36:39]
    ds_read_b64_tr_b16 a[6:7], v9 offset:30208
    v_mfma_f32_16x16x32_bf16 v[92:95], a[60:63], a[132:135], v[92:95]
    buffer_load_dwordx4 a[112:115], v24, s[8:11], s16 offen offset:0
    v_mfma_f32_16x16x32_bf16 v[148:151], a[60:63], a[136:139], v[148:151]
    v_mfma_f32_16x16x32_bf16 v[204:207], a[60:63], a[140:143], v[204:207]
    ds_read_b64_tr_b16 a[8:9], v9 offset:30720
    v_mfma_f32_16x16x32_bf16 v[40:43], a[64:67], a[128:131], v[40:43]
    ds_read_b64_tr_b16 a[10:11], v9 offset:31232
    v_mfma_f32_16x16x32_bf16 v[96:99], a[64:67], a[132:135], v[96:99]
    v_mfma_f32_16x16x32_bf16 v[152:155], a[64:67], a[136:139], v[152:155]
    ds_read_b64_tr_b16 a[12:13], v9 offset:31744
    v_mfma_f32_16x16x32_bf16 v[208:211], a[64:67], a[140:143], v[208:211]
    ds_read_b64_tr_b16 a[14:15], v9 offset:32256
    v_mfma_f32_16x16x32_bf16 v[44:47], a[68:71], a[128:131], v[44:47]
    v_mfma_f32_16x16x32_bf16 v[100:103], a[68:71], a[132:135], v[100:103]
    ds_read_b64_tr_b16 a[16:17], v9 offset:32768
    v_mfma_f32_16x16x32_bf16 v[156:159], a[68:71], a[136:139], v[156:159]
    ds_read_b64_tr_b16 a[18:19], v9 offset:33280
    v_mfma_f32_16x16x32_bf16 v[212:215], a[68:71], a[140:143], v[212:215]
    v_mfma_f32_16x16x32_bf16 v[48:51], a[72:75], a[128:131], v[48:51]
    buffer_load_dwordx4 a[116:119], v24, s[8:11], s16 offen offset:1024
    v_mfma_f32_16x16x32_bf16 v[104:107], a[72:75], a[132:135], v[104:107]
    ds_read_b64_tr_b16 a[20:21], v9 offset:33792
    v_mfma_f32_16x16x32_bf16 v[160:163], a[72:75], a[136:139], v[160:163]
    ds_read_b64_tr_b16 a[22:23], v9 offset:34304
    v_mfma_f32_16x16x32_bf16 v[216:219], a[72:75], a[140:143], v[216:219]
    v_mfma_f32_16x16x32_bf16 v[52:55], a[76:79], a[128:131], v[52:55]
    ds_read_b64_tr_b16 a[24:25], v11 offset:34816
    v_mfma_f32_16x16x32_bf16 v[108:111], a[76:79], a[132:135], v[108:111]
    ds_read_b64_tr_b16 a[26:27], v11 offset:35328
    v_mfma_f32_16x16x32_bf16 v[164:167], a[76:79], a[136:139], v[164:167]
    v_mfma_f32_16x16x32_bf16 v[220:223], a[76:79], a[140:143], v[220:223]
    ds_read_b64_tr_b16 a[28:29], v9 offset:35840
    v_mfma_f32_16x16x32_bf16 v[56:59], a[80:83], a[128:131], v[56:59]
    ds_read_b64_tr_b16 a[30:31], v9 offset:36352
    v_mfma_f32_16x16x32_bf16 v[112:115], a[80:83], a[132:135], v[112:115]
    v_mfma_f32_16x16x32_bf16 v[168:171], a[80:83], a[136:139], v[168:171]
    ds_read_b64_tr_b16 a[32:33], v9 offset:36864
    v_mfma_f32_16x16x32_bf16 v[224:227], a[80:83], a[140:143], v[224:227]
    ds_read_b64_tr_b16 a[34:35], v9 offset:37376
    v_mfma_f32_16x16x32_bf16 v[60:63], a[84:87], a[128:131], v[60:63]
    buffer_load_dwordx4 a[120:123], v24, s[8:11], s16 offen offset:2048
    v_mfma_f32_16x16x32_bf16 v[116:119], a[84:87], a[132:135], v[116:119]
    v_mfma_f32_16x16x32_bf16 v[172:175], a[84:87], a[136:139], v[172:175]
    ds_read_b64_tr_b16 a[36:37], v9 offset:37888
    v_mfma_f32_16x16x32_bf16 v[228:231], a[84:87], a[140:143], v[228:231]
    ds_read_b64_tr_b16 a[38:39], v9 offset:38400
    v_mfma_f32_16x16x32_bf16 v[64:67], a[88:91], a[128:131], v[64:67]
    v_mfma_f32_16x16x32_bf16 v[120:123], a[88:91], a[132:135], v[120:123]
    ds_read_b64_tr_b16 a[40:41], v9 offset:38912
    v_mfma_f32_16x16x32_bf16 v[176:179], a[88:91], a[136:139], v[176:179]
    ds_read_b64_tr_b16 a[42:43], v9 offset:39424
    v_mfma_f32_16x16x32_bf16 v[232:235], a[88:91], a[140:143], v[232:235]
    v_mfma_f32_16x16x32_bf16 v[68:71], a[92:95], a[128:131], v[68:71]
    ds_read_b64_tr_b16 a[44:45], v9 offset:39936
    v_mfma_f32_16x16x32_bf16 v[124:127], a[92:95], a[132:135], v[124:127]
    ds_read_b64_tr_b16 a[46:47], v9 offset:40448
    v_mfma_f32_16x16x32_bf16 v[180:183], a[92:95], a[136:139], v[180:183]
    v_mfma_f32_16x16x32_bf16 v[236:239], a[92:95], a[140:143], v[236:239]
    buffer_load_dwordx4 a[124:127], v24, s[8:11], s16 offen offset:3072
    v_mfma_f32_16x16x32_bf16 v[72:75], a[96:99], a[128:131], v[72:75]
    ds_read_b64_tr_b16 a[48:49], v9 offset:40960
    v_mfma_f32_16x16x32_bf16 v[128:131], a[96:99], a[132:135], v[128:131]
    ds_read_b64_tr_b16 a[50:51], v9 offset:41472
    v_mfma_f32_16x16x32_bf16 v[184:187], a[96:99], a[136:139], v[184:187]
    v_mfma_f32_16x16x32_bf16 v[240:243], a[96:99], a[140:143], v[240:243]
    ds_read_b64_tr_b16 a[52:53], v11 offset:41984
    v_mfma_f32_16x16x32_bf16 v[76:79], a[100:103], a[128:131], v[76:79]
    ds_read_b64_tr_b16 a[54:55], v11 offset:42496
    v_mfma_f32_16x16x32_bf16 v[132:135], a[100:103], a[132:135], v[132:135]
    v_mfma_f32_16x16x32_bf16 v[188:191], a[100:103], a[136:139], v[188:191]
    v_mfma_f32_16x16x32_bf16 v[244:247], a[100:103], a[140:143], v[244:247]
    v_mfma_f32_16x16x32_bf16 v[80:83], a[104:107], a[128:131], v[80:83]
    v_mfma_f32_16x16x32_bf16 v[136:139], a[104:107], a[132:135], v[136:139]
    v_mfma_f32_16x16x32_bf16 v[192:195], a[104:107], a[136:139], v[192:195]
    s_add_u32 s16, s16, 8192
    v_mfma_f32_16x16x32_bf16 v[248:251], a[104:107], a[140:143], v[248:251]
    v_mfma_f32_16x16x32_bf16 v[84:87], a[108:111], a[128:131], v[84:87]
    v_mfma_f32_16x16x32_bf16 v[140:143], a[108:111], a[132:135], v[140:143]
    v_mfma_f32_16x16x32_bf16 v[196:199], a[108:111], a[136:139], v[196:199]
    v_mfma_f32_16x16x32_bf16 v[252:255], a[108:111], a[140:143], v[252:255]
    s_waitcnt vmcnt(19) lgkmcnt(0)
    v_mfma_f32_16x16x32_bf16 v[32:35], a[0:3], a[144:147], v[32:35]
    ds_read_b64_tr_b16 a[56:57], v9 offset:43008
    v_mfma_f32_16x16x32_bf16 v[88:91], a[0:3], a[148:151], v[88:91]
    ds_read_b64_tr_b16 a[58:59], v9 offset:43520
    v_mfma_f32_16x16x32_bf16 v[144:147], a[0:3], a[152:155], v[144:147]
    v_mfma_f32_16x16x32_bf16 v[200:203], a[0:3], a[156:159], v[200:203]
    ds_read_b64_tr_b16 a[60:61], v9 offset:44032
    v_mfma_f32_16x16x32_bf16 v[36:39], a[4:7], a[144:147], v[36:39]
    ds_read_b64_tr_b16 a[62:63], v9 offset:44544
    v_mfma_f32_16x16x32_bf16 v[92:95], a[4:7], a[148:151], v[92:95]
    buffer_load_dwordx4 a[128:131], v24, s[8:11], s16 offen offset:0
    v_mfma_f32_16x16x32_bf16 v[148:151], a[4:7], a[152:155], v[148:151]
    v_mfma_f32_16x16x32_bf16 v[204:207], a[4:7], a[156:159], v[204:207]
    ds_read_b64_tr_b16 a[64:65], v9 offset:45056
    v_mfma_f32_16x16x32_bf16 v[40:43], a[8:11], a[144:147], v[40:43]
    ds_read_b64_tr_b16 a[66:67], v9 offset:45568
    v_mfma_f32_16x16x32_bf16 v[96:99], a[8:11], a[148:151], v[96:99]
    v_mfma_f32_16x16x32_bf16 v[152:155], a[8:11], a[152:155], v[152:155]
    ds_read_b64_tr_b16 a[68:69], v9 offset:46080
    v_mfma_f32_16x16x32_bf16 v[208:211], a[8:11], a[156:159], v[208:211]
    ds_read_b64_tr_b16 a[70:71], v9 offset:46592
    v_mfma_f32_16x16x32_bf16 v[44:47], a[12:15], a[144:147], v[44:47]
    v_mfma_f32_16x16x32_bf16 v[100:103], a[12:15], a[148:151], v[100:103]
    ds_read_b64_tr_b16 a[72:73], v9 offset:47104
    v_mfma_f32_16x16x32_bf16 v[156:159], a[12:15], a[152:155], v[156:159]
    ds_read_b64_tr_b16 a[74:75], v9 offset:47616
    v_mfma_f32_16x16x32_bf16 v[212:215], a[12:15], a[156:159], v[212:215]
    v_mfma_f32_16x16x32_bf16 v[48:51], a[16:19], a[144:147], v[48:51]
    buffer_load_dwordx4 a[132:135], v24, s[8:11], s16 offen offset:1024
    v_mfma_f32_16x16x32_bf16 v[104:107], a[16:19], a[148:151], v[104:107]
    ds_read_b64_tr_b16 a[76:77], v9 offset:48128
    v_mfma_f32_16x16x32_bf16 v[160:163], a[16:19], a[152:155], v[160:163]
    ds_read_b64_tr_b16 a[78:79], v9 offset:48640
    v_mfma_f32_16x16x32_bf16 v[216:219], a[16:19], a[156:159], v[216:219]
    v_mfma_f32_16x16x32_bf16 v[52:55], a[20:23], a[144:147], v[52:55]
    ds_read_b64_tr_b16 a[80:81], v11 offset:49152
    v_mfma_f32_16x16x32_bf16 v[108:111], a[20:23], a[148:151], v[108:111]
    ds_read_b64_tr_b16 a[82:83], v11 offset:49664
    v_mfma_f32_16x16x32_bf16 v[164:167], a[20:23], a[152:155], v[164:167]
    v_mfma_f32_16x16x32_bf16 v[220:223], a[20:23], a[156:159], v[220:223]
    ds_read_b64_tr_b16 a[84:85], v9 offset:50176
    v_mfma_f32_16x16x32_bf16 v[56:59], a[24:27], a[144:147], v[56:59]
    ds_read_b64_tr_b16 a[86:87], v9 offset:50688
    v_mfma_f32_16x16x32_bf16 v[112:115], a[24:27], a[148:151], v[112:115]
    v_mfma_f32_16x16x32_bf16 v[168:171], a[24:27], a[152:155], v[168:171]
    ds_read_b64_tr_b16 a[88:89], v9 offset:51200
    v_mfma_f32_16x16x32_bf16 v[224:227], a[24:27], a[156:159], v[224:227]
    ds_read_b64_tr_b16 a[90:91], v9 offset:51712
    v_mfma_f32_16x16x32_bf16 v[60:63], a[28:31], a[144:147], v[60:63]
    buffer_load_dwordx4 a[136:139], v24, s[8:11], s16 offen offset:2048
    v_mfma_f32_16x16x32_bf16 v[116:119], a[28:31], a[148:151], v[116:119]
    v_mfma_f32_16x16x32_bf16 v[172:175], a[28:31], a[152:155], v[172:175]
    ds_read_b64_tr_b16 a[92:93], v9 offset:52224
    v_mfma_f32_16x16x32_bf16 v[228:231], a[28:31], a[156:159], v[228:231]
    ds_read_b64_tr_b16 a[94:95], v9 offset:52736
    v_mfma_f32_16x16x32_bf16 v[64:67], a[32:35], a[144:147], v[64:67]
    v_mfma_f32_16x16x32_bf16 v[120:123], a[32:35], a[148:151], v[120:123]
    ds_read_b64_tr_b16 a[96:97], v9 offset:53248
    v_mfma_f32_16x16x32_bf16 v[176:179], a[32:35], a[152:155], v[176:179]
    ds_read_b64_tr_b16 a[98:99], v9 offset:53760
    v_mfma_f32_16x16x32_bf16 v[232:235], a[32:35], a[156:159], v[232:235]
    v_mfma_f32_16x16x32_bf16 v[68:71], a[36:39], a[144:147], v[68:71]
    ds_read_b64_tr_b16 a[100:101], v9 offset:54272
    v_mfma_f32_16x16x32_bf16 v[124:127], a[36:39], a[148:151], v[124:127]
    ds_read_b64_tr_b16 a[102:103], v9 offset:54784
    v_mfma_f32_16x16x32_bf16 v[180:183], a[36:39], a[152:155], v[180:183]
    v_mfma_f32_16x16x32_bf16 v[236:239], a[36:39], a[156:159], v[236:239]
    buffer_load_dwordx4 a[140:143], v24, s[8:11], s16 offen offset:3072
    v_mfma_f32_16x16x32_bf16 v[72:75], a[40:43], a[144:147], v[72:75]
    ds_read_b64_tr_b16 a[104:105], v9 offset:55296
    v_mfma_f32_16x16x32_bf16 v[128:131], a[40:43], a[148:151], v[128:131]
    ds_read_b64_tr_b16 a[106:107], v9 offset:55808
    v_mfma_f32_16x16x32_bf16 v[184:187], a[40:43], a[152:155], v[184:187]
    v_mfma_f32_16x16x32_bf16 v[240:243], a[40:43], a[156:159], v[240:243]
    ds_read_b64_tr_b16 a[108:109], v11 offset:56320
    v_mfma_f32_16x16x32_bf16 v[76:79], a[44:47], a[144:147], v[76:79]
    ds_read_b64_tr_b16 a[110:111], v11 offset:56832
    v_mfma_f32_16x16x32_bf16 v[132:135], a[44:47], a[148:151], v[132:135]
    v_mfma_f32_16x16x32_bf16 v[188:191], a[44:47], a[152:155], v[188:191]
    v_mfma_f32_16x16x32_bf16 v[244:247], a[44:47], a[156:159], v[244:247]
    v_mfma_f32_16x16x32_bf16 v[80:83], a[48:51], a[144:147], v[80:83]
    v_mfma_f32_16x16x32_bf16 v[136:139], a[48:51], a[148:151], v[136:139]
    v_mfma_f32_16x16x32_bf16 v[192:195], a[48:51], a[152:155], v[192:195]
    s_add_u32 s16, s16, 8192
    v_mfma_f32_16x16x32_bf16 v[248:251], a[48:51], a[156:159], v[248:251]
    v_mfma_f32_16x16x32_bf16 v[84:87], a[52:55], a[144:147], v[84:87]
    v_mfma_f32_16x16x32_bf16 v[140:143], a[52:55], a[148:151], v[140:143]
    v_mfma_f32_16x16x32_bf16 v[196:199], a[52:55], a[152:155], v[196:199]
    v_mfma_f32_16x16x32_bf16 v[252:255], a[52:55], a[156:159], v[252:255]
    s_mov_b32 s18, 2
.p2align 6
L_loop_20:
    s_waitcnt vmcnt(8) lgkmcnt(0)
    s_barrier
    v_mfma_f32_16x16x32_bf16 v[32:35], a[56:59], a[160:163], v[32:35]
    ds_read_b64_tr_b16 a[0:1], v8 offset:0
    v_mfma_f32_16x16x32_bf16 v[88:91], a[56:59], a[164:167], v[88:91]
    buffer_load_dwordx4 a[144:147], v24, s[8:11], s16 offen offset:0
    v_mfma_f32_16x16x32_bf16 v[144:147], a[56:59], a[168:171], v[144:147]
    ds_read_b64_tr_b16 a[2:3], v8 offset:512
    v_mfma_f32_16x16x32_bf16 v[200:203], a[56:59], a[172:175], v[200:203]
    ds_read_b64_tr_b16 a[4:5], v8 offset:1024
    v_mfma_f32_16x16x32_bf16 v[36:39], a[60:63], a[160:163], v[36:39]
    ds_read_b64_tr_b16 a[6:7], v8 offset:1536
    v_mfma_f32_16x16x32_bf16 v[92:95], a[60:63], a[164:167], v[92:95]
    s_add_u32 m0, s20, 57344
    v_mfma_f32_16x16x32_bf16 v[148:151], a[60:63], a[168:171], v[148:151]
    ds_read_b64_tr_b16 a[8:9], v8 offset:2048
    v_mfma_f32_16x16x32_bf16 v[204:207], a[60:63], a[172:175], v[204:207]
    ds_read_b64_tr_b16 a[10:11], v8 offset:2560
    v_mfma_f32_16x16x32_bf16 v[40:43], a[64:67], a[160:163], v[40:43]
    buffer_load_dwordx4 v25, s[12:15], s17 offen lds
    v_mfma_f32_16x16x32_bf16 v[96:99], a[64:67], a[164:167], v[96:99]
    v_mfma_f32_16x16x32_bf16 v[152:155], a[64:67], a[168:171], v[152:155]
    ds_read_b64_tr_b16 a[12:13], v8 offset:3072
    v_mfma_f32_16x16x32_bf16 v[208:211], a[64:67], a[172:175], v[208:211]
    ds_read_b64_tr_b16 a[14:15], v8 offset:3584
    v_mfma_f32_16x16x32_bf16 v[44:47], a[68:71], a[160:163], v[44:47]
    buffer_load_dwordx4 a[148:151], v24, s[8:11], s16 offen offset:1024
    v_mfma_f32_16x16x32_bf16 v[100:103], a[68:71], a[164:167], v[100:103]
    ds_read_b64_tr_b16 a[16:17], v8 offset:4096
    v_mfma_f32_16x16x32_bf16 v[156:159], a[68:71], a[168:171], v[156:159]
    ds_read_b64_tr_b16 a[18:19], v8 offset:4608
    v_mfma_f32_16x16x32_bf16 v[212:215], a[68:71], a[172:175], v[212:215]
    buffer_load_dwordx4 v25, s[12:15], s17 offen offset:1024 lds
    v_mfma_f32_16x16x32_bf16 v[48:51], a[72:75], a[160:163], v[48:51]
    ds_read_b64_tr_b16 a[20:21], v8 offset:5120
    v_mfma_f32_16x16x32_bf16 v[104:107], a[72:75], a[164:167], v[104:107]
    ds_read_b64_tr_b16 a[22:23], v8 offset:5632
    v_mfma_f32_16x16x32_bf16 v[160:163], a[72:75], a[168:171], v[160:163]
    v_mfma_f32_16x16x32_bf16 v[216:219], a[72:75], a[172:175], v[216:219]
    buffer_load_dwordx4 a[152:155], v24, s[8:11], s16 offen offset:2048
    v_mfma_f32_16x16x32_bf16 v[52:55], a[76:79], a[160:163], v[52:55]
    ds_read_b64_tr_b16 a[24:25], v10 offset:6144
    v_mfma_f32_16x16x32_bf16 v[108:111], a[76:79], a[164:167], v[108:111]
    ds_read_b64_tr_b16 a[26:27], v10 offset:6656
    v_mfma_f32_16x16x32_bf16 v[164:167], a[76:79], a[168:171], v[164:167]
    buffer_load_dwordx4 v25, s[12:15], s17 offen offset:2048 lds
    v_mfma_f32_16x16x32_bf16 v[220:223], a[76:79], a[172:175], v[220:223]
    ds_read_b64_tr_b16 a[28:29], v8 offset:7168
    v_mfma_f32_16x16x32_bf16 v[56:59], a[80:83], a[160:163], v[56:59]
    ds_read_b64_tr_b16 a[30:31], v8 offset:7680
    v_mfma_f32_16x16x32_bf16 v[112:115], a[80:83], a[164:167], v[112:115]
    ds_read_b64_tr_b16 a[32:33], v8 offset:8192
    v_mfma_f32_16x16x32_bf16 v[168:171], a[80:83], a[168:171], v[168:171]
    buffer_load_dwordx4 a[156:159], v24, s[8:11], s16 offen offset:3072
    v_mfma_f32_16x16x32_bf16 v[224:227], a[80:83], a[172:175], v[224:227]
    v_mfma_f32_16x16x32_bf16 v[60:63], a[84:87], a[160:163], v[60:63]
    ds_read_b64_tr_b16 a[34:35], v8 offset:8704
    v_mfma_f32_16x16x32_bf16 v[116:119], a[84:87], a[164:167], v[116:119]
    buffer_load_dwordx4 v25, s[12:15], s17 offen offset:3072 lds
    v_mfma_f32_16x16x32_bf16 v[172:175], a[84:87], a[168:171], v[172:175]
    ds_read_b64_tr_b16 a[36:37], v8 offset:9216
    v_mfma_f32_16x16x32_bf16 v[228:231], a[84:87], a[172:175], v[228:231]
    ds_read_b64_tr_b16 a[38:39], v8 offset:9728
    v_mfma_f32_16x16x32_bf16 v[64:67], a[88:91], a[160:163], v[64:67]
    ds_read_b64_tr_b16 a[40:41], v8 offset:10240
    v_mfma_f32_16x16x32_bf16 v[120:123], a[88:91], a[164:167], v[120:123]
    s_add_u32 s16, s16, 8192
    v_mfma_f32_16x16x32_bf16 v[176:179], a[88:91], a[168:171], v[176:179]
    ds_read_b64_tr_b16 a[42:43], v8 offset:10752
    v_mfma_f32_16x16x32_bf16 v[232:235], a[88:91], a[172:175], v[232:235]
    ds_read_b64_tr_b16 a[44:45], v8 offset:11264
    v_mfma_f32_16x16x32_bf16 v[68:71], a[92:95], a[160:163], v[68:71]
    s_add_u32 m0, s20, 61440
    v_mfma_f32_16x16x32_bf16 v[124:127], a[92:95], a[164:167], v[124:127]
    v_mfma_f32_16x16x32_bf16 v[180:183], a[92:95], a[168:171], v[180:183]
    ds_read_b64_tr_b16 a[46:47], v8 offset:11776
    v_mfma_f32_16x16x32_bf16 v[236:239], a[92:95], a[172:175], v[236:239]
    ds_read_b64_tr_b16 a[48:49], v8 offset:12288
    v_mfma_f32_16x16x32_bf16 v[72:75], a[96:99], a[160:163], v[72:75]
    buffer_load_dwordx4 v25, s[12:15], s21 offen lds
    v_mfma_f32_16x16x32_bf16 v[128:131], a[96:99], a[164:167], v[128:131]
    ds_read_b64_tr_b16 a[50:51], v8 offset:12800
    v_mfma_f32_16x16x32_bf16 v[184:187], a[96:99], a[168:171], v[184:187]
    ds_read_b64_tr_b16 a[52:53], v10 offset:13312
    v_mfma_f32_16x16x32_bf16 v[240:243], a[96:99], a[172:175], v[240:243]
    buffer_load_dwordx4 v25, s[12:15], s21 offen offset:1024 lds
    v_mfma_f32_16x16x32_bf16 v[76:79], a[100:103], a[160:163], v[76:79]
    ds_read_b64_tr_b16 a[54:55], v10 offset:13824
    v_mfma_f32_16x16x32_bf16 v[132:135], a[100:103], a[164:167], v[132:135]
    v_mfma_f32_16x16x32_bf16 v[188:191], a[100:103], a[168:171], v[188:191]
    v_mfma_f32_16x16x32_bf16 v[244:247], a[100:103], a[172:175], v[244:247]
    buffer_load_dwordx4 v25, s[12:15], s21 offen offset:2048 lds
    v_mfma_f32_16x16x32_bf16 v[80:83], a[104:107], a[160:163], v[80:83]
    v_mfma_f32_16x16x32_bf16 v[136:139], a[104:107], a[164:167], v[136:139]
    v_mfma_f32_16x16x32_bf16 v[192:195], a[104:107], a[168:171], v[192:195]
    s_add_u32 s17, s17, 28672
    v_mfma_f32_16x16x32_bf16 v[248:251], a[104:107], a[172:175], v[248:251]
    v_mfma_f32_16x16x32_bf16 v[84:87], a[108:111], a[160:163], v[84:87]
    v_mfma_f32_16x16x32_bf16 v[140:143], a[108:111], a[164:167], v[140:143]
    v_mfma_f32_16x16x32_bf16 v[196:199], a[108:111], a[168:171], v[196:199]
    s_add_u32 s21, s21, 28672
    v_mfma_f32_16x16x32_bf16 v[252:255], a[108:111], a[172:175], v[252:255]
    s_waitcnt vmcnt(15) lgkmcnt(0)
    v_mfma_f32_16x16x32_bf16 v[32:35], a[0:3], a[112:115], v[32:35]
    ds_read_b64_tr_b16 a[56:57], v8 offset:14336
    v_mfma_f32_16x16x32_bf16 v[88:91], a[0:3], a[116:119], v[88:91]
    buffer_load_dwordx4 a[160:163], v24, s[8:11], s16 offen offset:0
    v_mfma_f32_16x16x32_bf16 v[144:147], a[0:3], a[120:123], v[144:147]
    ds_read_b64_tr_b16 a[58:59], v8 offset:14848
    v_mfma_f32_16x16x32_bf16 v[200:203], a[0:3], a[124:127], v[200:203]
    ds_read_b64_tr_b16 a[60:61], v8 offset:15360
    v_mfma_f32_16x16x32_bf16 v[36:39], a[4:7], a[112:115], v[36:39]
    ds_read_b64_tr_b16 a[62:63], v8 offset:15872
    v_mfma_f32_16x16x32_bf16 v[92:95], a[4:7], a[116:119], v[92:95]
    s_add_u32 m0, s20, 86016
    v_mfma_f32_16x16x32_bf16 v[148:151], a[4:7], a[120:123], v[148:151]
    ds_read_b64_tr_b16 a[64:65], v8 offset:16384
    v_mfma_f32_16x16x32_bf16 v[204:207], a[4:7], a[124:127], v[204:207]
    ds_read_b64_tr_b16 a[66:67], v8 offset:16896
    v_mfma_f32_16x16x32_bf16 v[40:43], a[8:11], a[112:115], v[40:43]
    buffer_load_dwordx4 v25, s[12:15], s17 offen lds
    v_mfma_f32_16x16x32_bf16 v[96:99], a[8:11], a[116:119], v[96:99]
    v_mfma_f32_16x16x32_bf16 v[152:155], a[8:11], a[120:123], v[152:155]
    ds_read_b64_tr_b16 a[68:69], v8 offset:17408
    v_mfma_f32_16x16x32_bf16 v[208:211], a[8:11], a[124:127], v[208:211]
    ds_read_b64_tr_b16 a[70:71], v8 offset:17920
    v_mfma_f32_16x16x32_bf16 v[44:47], a[12:15], a[112:115], v[44:47]
    buffer_load_dwordx4 a[164:167], v24, s[8:11], s16 offen offset:1024
    v_mfma_f32_16x16x32_bf16 v[100:103], a[12:15], a[116:119], v[100:103]
    ds_read_b64_tr_b16 a[72:73], v8 offset:18432
    v_mfma_f32_16x16x32_bf16 v[156:159], a[12:15], a[120:123], v[156:159]
    ds_read_b64_tr_b16 a[74:75], v8 offset:18944
    v_mfma_f32_16x16x32_bf16 v[212:215], a[12:15], a[124:127], v[212:215]
    buffer_load_dwordx4 v25, s[12:15], s17 offen offset:1024 lds
    v_mfma_f32_16x16x32_bf16 v[48:51], a[16:19], a[112:115], v[48:51]
    ds_read_b64_tr_b16 a[76:77], v8 offset:19456
    v_mfma_f32_16x16x32_bf16 v[104:107], a[16:19], a[116:119], v[104:107]
    ds_read_b64_tr_b16 a[78:79], v8 offset:19968
    v_mfma_f32_16x16x32_bf16 v[160:163], a[16:19], a[120:123], v[160:163]
    v_mfma_f32_16x16x32_bf16 v[216:219], a[16:19], a[124:127], v[216:219]
    buffer_load_dwordx4 a[168:171], v24, s[8:11], s16 offen offset:2048
    v_mfma_f32_16x16x32_bf16 v[52:55], a[20:23], a[112:115], v[52:55]
    ds_read_b64_tr_b16 a[80:81], v10 offset:20480
    v_mfma_f32_16x16x32_bf16 v[108:111], a[20:23], a[116:119], v[108:111]
    ds_read_b64_tr_b16 a[82:83], v10 offset:20992
    v_mfma_f32_16x16x32_bf16 v[164:167], a[20:23], a[120:123], v[164:167]
    buffer_load_dwordx4 v25, s[12:15], s17 offen offset:2048 lds
    v_mfma_f32_16x16x32_bf16 v[220:223], a[20:23], a[124:127], v[220:223]
    ds_read_b64_tr_b16 a[84:85], v8 offset:21504
    v_mfma_f32_16x16x32_bf16 v[56:59], a[24:27], a[112:115], v[56:59]
    ds_read_b64_tr_b16 a[86:87], v8 offset:22016
    v_mfma_f32_16x16x32_bf16 v[112:115], a[24:27], a[116:119], v[112:115]
    ds_read_b64_tr_b16 a[88:89], v8 offset:22528
    v_mfma_f32_16x16x32_bf16 v[168:171], a[24:27], a[120:123], v[168:171]
    buffer_load_dwordx4 a[172:175], v24, s[8:11], s16 offen offset:3072
    v_mfma_f32_16x16x32_bf16 v[224:227], a[24:27], a[124:127], v[224:227]
    v_mfma_f32_16x16x32_bf16 v[60:63], a[28:31], a[112:115], v[60:63]
    ds_read_b64_tr_b16 a[90:91], v8 offset:23040
    v_mfma_f32_16x16x32_bf16 v[116:119], a[28:31], a[116:119], v[116:119]
    buffer_load_dwordx4 v25, s[12:15], s17 offen offset:3072 lds
    v_mfma_f32_16x16x32_bf16 v[172:175], a[28:31], a[120:123], v[172:175]
    ds_read_b64_tr_b16 a[92:93], v8 offset:23552
    v_mfma_f32_16x16x32_bf16 v[228:231], a[28:31], a[124:127], v[228:231]
    ds_read_b64_tr_b16 a[94:95], v8 offset:24064
    v_mfma_f32_16x16x32_bf16 v[64:67], a[32:35], a[112:115], v[64:67]
    ds_read_b64_tr_b16 a[96:97], v8 offset:24576
    v_mfma_f32_16x16x32_bf16 v[120:123], a[32:35], a[116:119], v[120:123]
    s_add_u32 s16, s16, 8192
    v_mfma_f32_16x16x32_bf16 v[176:179], a[32:35], a[120:123], v[176:179]
    ds_read_b64_tr_b16 a[98:99], v8 offset:25088
    v_mfma_f32_16x16x32_bf16 v[232:235], a[32:35], a[124:127], v[232:235]
    ds_read_b64_tr_b16 a[100:101], v8 offset:25600
    v_mfma_f32_16x16x32_bf16 v[68:71], a[36:39], a[112:115], v[68:71]
    s_add_u32 m0, s20, 90112
    v_mfma_f32_16x16x32_bf16 v[124:127], a[36:39], a[116:119], v[124:127]
    v_mfma_f32_16x16x32_bf16 v[180:183], a[36:39], a[120:123], v[180:183]
    ds_read_b64_tr_b16 a[102:103], v8 offset:26112
    v_mfma_f32_16x16x32_bf16 v[236:239], a[36:39], a[124:127], v[236:239]
    ds_read_b64_tr_b16 a[104:105], v8 offset:26624
    v_mfma_f32_16x16x32_bf16 v[72:75], a[40:43], a[112:115], v[72:75]
    buffer_load_dwordx4 v25, s[12:15], s21 offen lds
    v_mfma_f32_16x16x32_bf16 v[128:131], a[40:43], a[116:119], v[128:131]
    ds_read_b64_tr_b16 a[106:107], v8 offset:27136
    v_mfma_f32_16x16x32_bf16 v[184:187], a[40:43], a[120:123], v[184:187]
    ds_read_b64_tr_b16 a[108:109], v10 offset:27648
    v_mfma_f32_16x16x32_bf16 v[240:243], a[40:43], a[124:127], v[240:243]
    buffer_load_dwordx4 v25, s[12:15], s21 offen offset:1024 lds
    v_mfma_f32_16x16x32_bf16 v[76:79], a[44:47], a[112:115], v[76:79]
    ds_read_b64_tr_b16 a[110:111], v10 offset:28160
    v_mfma_f32_16x16x32_bf16 v[132:135], a[44:47], a[116:119], v[132:135]
    v_mfma_f32_16x16x32_bf16 v[188:191], a[44:47], a[120:123], v[188:191]
    v_mfma_f32_16x16x32_bf16 v[244:247], a[44:47], a[124:127], v[244:247]
    buffer_load_dwordx4 v25, s[12:15], s21 offen offset:2048 lds
    v_mfma_f32_16x16x32_bf16 v[80:83], a[48:51], a[112:115], v[80:83]
    v_mfma_f32_16x16x32_bf16 v[136:139], a[48:51], a[116:119], v[136:139]
    v_mfma_f32_16x16x32_bf16 v[192:195], a[48:51], a[120:123], v[192:195]
    s_add_u32 s17, s17, 28672
    v_mfma_f32_16x16x32_bf16 v[248:251], a[48:51], a[124:127], v[248:251]
    v_mfma_f32_16x16x32_bf16 v[84:87], a[52:55], a[112:115], v[84:87]
    v_mfma_f32_16x16x32_bf16 v[140:143], a[52:55], a[116:119], v[140:143]
    v_mfma_f32_16x16x32_bf16 v[196:199], a[52:55], a[120:123], v[196:199]
    s_add_u32 s21, s21, 28672
    v_mfma_f32_16x16x32_bf16 v[252:255], a[52:55], a[124:127], v[252:255]
    s_waitcnt vmcnt(22) lgkmcnt(0)
    v_mfma_f32_16x16x32_bf16 v[32:35], a[56:59], a[128:131], v[32:35]
    ds_read_b64_tr_b16 a[0:1], v8 offset:28672
    v_mfma_f32_16x16x32_bf16 v[88:91], a[56:59], a[132:135], v[88:91]
    ds_read_b64_tr_b16 a[2:3], v8 offset:29184
    v_mfma_f32_16x16x32_bf16 v[144:147], a[56:59], a[136:139], v[144:147]
    v_mfma_f32_16x16x32_bf16 v[200:203], a[56:59], a[140:143], v[200:203]
    ds_read_b64_tr_b16 a[4:5], v8 offset:29696
    v_mfma_f32_16x16x32_bf16 v[36:39], a[60:63], a[128:131], v[36:39]
    ds_read_b64_tr_b16 a[6:7], v8 offset:30208
    v_mfma_f32_16x16x32_bf16 v[92:95], a[60:63], a[132:135], v[92:95]
    buffer_load_dwordx4 a[112:115], v24, s[8:11], s16 offen offset:0
    v_mfma_f32_16x16x32_bf16 v[148:151], a[60:63], a[136:139], v[148:151]
    v_mfma_f32_16x16x32_bf16 v[204:207], a[60:63], a[140:143], v[204:207]
    ds_read_b64_tr_b16 a[8:9], v8 offset:30720
    v_mfma_f32_16x16x32_bf16 v[40:43], a[64:67], a[128:131], v[40:43]
    ds_read_b64_tr_b16 a[10:11], v8 offset:31232
    v_mfma_f32_16x16x32_bf16 v[96:99], a[64:67], a[132:135], v[96:99]
    v_mfma_f32_16x16x32_bf16 v[152:155], a[64:67], a[136:139], v[152:155]
    ds_read_b64_tr_b16 a[12:13], v8 offset:31744
    v_mfma_f32_16x16x32_bf16 v[208:211], a[64:67], a[140:143], v[208:211]
    ds_read_b64_tr_b16 a[14:15], v8 offset:32256
    v_mfma_f32_16x16x32_bf16 v[44:47], a[68:71], a[128:131], v[44:47]
    v_mfma_f32_16x16x32_bf16 v[100:103], a[68:71], a[132:135], v[100:103]
    ds_read_b64_tr_b16 a[16:17], v8 offset:32768
    v_mfma_f32_16x16x32_bf16 v[156:159], a[68:71], a[136:139], v[156:159]
    ds_read_b64_tr_b16 a[18:19], v8 offset:33280
    v_mfma_f32_16x16x32_bf16 v[212:215], a[68:71], a[140:143], v[212:215]
    v_mfma_f32_16x16x32_bf16 v[48:51], a[72:75], a[128:131], v[48:51]
    buffer_load_dwordx4 a[116:119], v24, s[8:11], s16 offen offset:1024
    v_mfma_f32_16x16x32_bf16 v[104:107], a[72:75], a[132:135], v[104:107]
    ds_read_b64_tr_b16 a[20:21], v8 offset:33792
    v_mfma_f32_16x16x32_bf16 v[160:163], a[72:75], a[136:139], v[160:163]
    ds_read_b64_tr_b16 a[22:23], v8 offset:34304
    v_mfma_f32_16x16x32_bf16 v[216:219], a[72:75], a[140:143], v[216:219]
    v_mfma_f32_16x16x32_bf16 v[52:55], a[76:79], a[128:131], v[52:55]
    ds_read_b64_tr_b16 a[24:25], v10 offset:34816
    v_mfma_f32_16x16x32_bf16 v[108:111], a[76:79], a[132:135], v[108:111]
    ds_read_b64_tr_b16 a[26:27], v10 offset:35328
    v_mfma_f32_16x16x32_bf16 v[164:167], a[76:79], a[136:139], v[164:167]
    v_mfma_f32_16x16x32_bf16 v[220:223], a[76:79], a[140:143], v[220:223]
    ds_read_b64_tr_b16 a[28:29], v8 offset:35840
    v_mfma_f32_16x16x32_bf16 v[56:59], a[80:83], a[128:131], v[56:59]
    ds_read_b64_tr_b16 a[30:31], v8 offset:36352
    v_mfma_f32_16x16x32_bf16 v[112:115], a[80:83], a[132:135], v[112:115]
    v_mfma_f32_16x16x32_bf16 v[168:171], a[80:83], a[136:139], v[168:171]
    ds_read_b64_tr_b16 a[32:33], v8 offset:36864
    v_mfma_f32_16x16x32_bf16 v[224:227], a[80:83], a[140:143], v[224:227]
    ds_read_b64_tr_b16 a[34:35], v8 offset:37376
    v_mfma_f32_16x16x32_bf16 v[60:63], a[84:87], a[128:131], v[60:63]
    buffer_load_dwordx4 a[120:123], v24, s[8:11], s16 offen offset:2048
    v_mfma_f32_16x16x32_bf16 v[116:119], a[84:87], a[132:135], v[116:119]
    v_mfma_f32_16x16x32_bf16 v[172:175], a[84:87], a[136:139], v[172:175]
    ds_read_b64_tr_b16 a[36:37], v8 offset:37888
    v_mfma_f32_16x16x32_bf16 v[228:231], a[84:87], a[140:143], v[228:231]
    ds_read_b64_tr_b16 a[38:39], v8 offset:38400
    v_mfma_f32_16x16x32_bf16 v[64:67], a[88:91], a[128:131], v[64:67]
    v_mfma_f32_16x16x32_bf16 v[120:123], a[88:91], a[132:135], v[120:123]
    ds_read_b64_tr_b16 a[40:41], v8 offset:38912
    v_mfma_f32_16x16x32_bf16 v[176:179], a[88:91], a[136:139], v[176:179]
    ds_read_b64_tr_b16 a[42:43], v8 offset:39424
    v_mfma_f32_16x16x32_bf16 v[232:235], a[88:91], a[140:143], v[232:235]
    v_mfma_f32_16x16x32_bf16 v[68:71], a[92:95], a[128:131], v[68:71]
    ds_read_b64_tr_b16 a[44:45], v8 offset:39936
    v_mfma_f32_16x16x32_bf16 v[124:127], a[92:95], a[132:135], v[124:127]
    ds_read_b64_tr_b16 a[46:47], v8 offset:40448
    v_mfma_f32_16x16x32_bf16 v[180:183], a[92:95], a[136:139], v[180:183]
    v_mfma_f32_16x16x32_bf16 v[236:239], a[92:95], a[140:143], v[236:239]
    buffer_load_dwordx4 a[124:127], v24, s[8:11], s16 offen offset:3072
    v_mfma_f32_16x16x32_bf16 v[72:75], a[96:99], a[128:131], v[72:75]
    ds_read_b64_tr_b16 a[48:49], v8 offset:40960
    v_mfma_f32_16x16x32_bf16 v[128:131], a[96:99], a[132:135], v[128:131]
    ds_read_b64_tr_b16 a[50:51], v8 offset:41472
    v_mfma_f32_16x16x32_bf16 v[184:187], a[96:99], a[136:139], v[184:187]
    v_mfma_f32_16x16x32_bf16 v[240:243], a[96:99], a[140:143], v[240:243]
    ds_read_b64_tr_b16 a[52:53], v10 offset:41984
    v_mfma_f32_16x16x32_bf16 v[76:79], a[100:103], a[128:131], v[76:79]
    ds_read_b64_tr_b16 a[54:55], v10 offset:42496
    v_mfma_f32_16x16x32_bf16 v[132:135], a[100:103], a[132:135], v[132:135]
    v_mfma_f32_16x16x32_bf16 v[188:191], a[100:103], a[136:139], v[188:191]
    v_mfma_f32_16x16x32_bf16 v[244:247], a[100:103], a[140:143], v[244:247]
    v_mfma_f32_16x16x32_bf16 v[80:83], a[104:107], a[128:131], v[80:83]
    v_mfma_f32_16x16x32_bf16 v[136:139], a[104:107], a[132:135], v[136:139]
    v_mfma_f32_16x16x32_bf16 v[192:195], a[104:107], a[136:139], v[192:195]
    s_add_u32 s16, s16, 8192
    v_mfma_f32_16x16x32_bf16 v[248:251], a[104:107], a[140:143], v[248:251]
    v_mfma_f32_16x16x32_bf16 v[84:87], a[108:111], a[128:131], v[84:87]
    v_mfma_f32_16x16x32_bf16 v[140:143], a[108:111], a[132:135], v[140:143]
    v_mfma_f32_16x16x32_bf16 v[196:199], a[108:111], a[136:139], v[196:199]
    v_mfma_f32_16x16x32_bf16 v[252:255], a[108:111], a[140:143], v[252:255]
    s_waitcnt vmcnt(19) lgkmcnt(0)
    v_mfma_f32_16x16x32_bf16 v[32:35], a[0:3], a[144:147], v[32:35]
    ds_read_b64_tr_b16 a[56:57], v8 offset:43008
    v_mfma_f32_16x16x32_bf16 v[88:91], a[0:3], a[148:151], v[88:91]
    ds_read_b64_tr_b16 a[58:59], v8 offset:43520
    v_mfma_f32_16x16x32_bf16 v[144:147], a[0:3], a[152:155], v[144:147]
    v_mfma_f32_16x16x32_bf16 v[200:203], a[0:3], a[156:159], v[200:203]
    ds_read_b64_tr_b16 a[60:61], v8 offset:44032
    v_mfma_f32_16x16x32_bf16 v[36:39], a[4:7], a[144:147], v[36:39]
    ds_read_b64_tr_b16 a[62:63], v8 offset:44544
    v_mfma_f32_16x16x32_bf16 v[92:95], a[4:7], a[148:151], v[92:95]
    buffer_load_dwordx4 a[128:131], v24, s[8:11], s16 offen offset:0
    v_mfma_f32_16x16x32_bf16 v[148:151], a[4:7], a[152:155], v[148:151]
    v_mfma_f32_16x16x32_bf16 v[204:207], a[4:7], a[156:159], v[204:207]
    ds_read_b64_tr_b16 a[64:65], v8 offset:45056
    v_mfma_f32_16x16x32_bf16 v[40:43], a[8:11], a[144:147], v[40:43]
    ds_read_b64_tr_b16 a[66:67], v8 offset:45568
    v_mfma_f32_16x16x32_bf16 v[96:99], a[8:11], a[148:151], v[96:99]
    v_mfma_f32_16x16x32_bf16 v[152:155], a[8:11], a[152:155], v[152:155]
    ds_read_b64_tr_b16 a[68:69], v8 offset:46080
    v_mfma_f32_16x16x32_bf16 v[208:211], a[8:11], a[156:159], v[208:211]
    ds_read_b64_tr_b16 a[70:71], v8 offset:46592
    v_mfma_f32_16x16x32_bf16 v[44:47], a[12:15], a[144:147], v[44:47]
    v_mfma_f32_16x16x32_bf16 v[100:103], a[12:15], a[148:151], v[100:103]
    ds_read_b64_tr_b16 a[72:73], v8 offset:47104
    v_mfma_f32_16x16x32_bf16 v[156:159], a[12:15], a[152:155], v[156:159]
    ds_read_b64_tr_b16 a[74:75], v8 offset:47616
    v_mfma_f32_16x16x32_bf16 v[212:215], a[12:15], a[156:159], v[212:215]
    v_mfma_f32_16x16x32_bf16 v[48:51], a[16:19], a[144:147], v[48:51]
    buffer_load_dwordx4 a[132:135], v24, s[8:11], s16 offen offset:1024
    v_mfma_f32_16x16x32_bf16 v[104:107], a[16:19], a[148:151], v[104:107]
    ds_read_b64_tr_b16 a[76:77], v8 offset:48128
    v_mfma_f32_16x16x32_bf16 v[160:163], a[16:19], a[152:155], v[160:163]
    ds_read_b64_tr_b16 a[78:79], v8 offset:48640
    v_mfma_f32_16x16x32_bf16 v[216:219], a[16:19], a[156:159], v[216:219]
    v_mfma_f32_16x16x32_bf16 v[52:55], a[20:23], a[144:147], v[52:55]
    ds_read_b64_tr_b16 a[80:81], v10 offset:49152
    v_mfma_f32_16x16x32_bf16 v[108:111], a[20:23], a[148:151], v[108:111]
    ds_read_b64_tr_b16 a[82:83], v10 offset:49664
    v_mfma_f32_16x16x32_bf16 v[164:167], a[20:23], a[152:155], v[164:167]
    v_mfma_f32_16x16x32_bf16 v[220:223], a[20:23], a[156:159], v[220:223]
    ds_read_b64_tr_b16 a[84:85], v8 offset:50176
    v_mfma_f32_16x16x32_bf16 v[56:59], a[24:27], a[144:147], v[56:59]
    ds_read_b64_tr_b16 a[86:87], v8 offset:50688
    v_mfma_f32_16x16x32_bf16 v[112:115], a[24:27], a[148:151], v[112:115]
    v_mfma_f32_16x16x32_bf16 v[168:171], a[24:27], a[152:155], v[168:171]
    ds_read_b64_tr_b16 a[88:89], v8 offset:51200
    v_mfma_f32_16x16x32_bf16 v[224:227], a[24:27], a[156:159], v[224:227]
    ds_read_b64_tr_b16 a[90:91], v8 offset:51712
    v_mfma_f32_16x16x32_bf16 v[60:63], a[28:31], a[144:147], v[60:63]
    buffer_load_dwordx4 a[136:139], v24, s[8:11], s16 offen offset:2048
    v_mfma_f32_16x16x32_bf16 v[116:119], a[28:31], a[148:151], v[116:119]
    v_mfma_f32_16x16x32_bf16 v[172:175], a[28:31], a[152:155], v[172:175]
    ds_read_b64_tr_b16 a[92:93], v8 offset:52224
    v_mfma_f32_16x16x32_bf16 v[228:231], a[28:31], a[156:159], v[228:231]
    ds_read_b64_tr_b16 a[94:95], v8 offset:52736
    v_mfma_f32_16x16x32_bf16 v[64:67], a[32:35], a[144:147], v[64:67]
    v_mfma_f32_16x16x32_bf16 v[120:123], a[32:35], a[148:151], v[120:123]
    ds_read_b64_tr_b16 a[96:97], v8 offset:53248
    v_mfma_f32_16x16x32_bf16 v[176:179], a[32:35], a[152:155], v[176:179]
    ds_read_b64_tr_b16 a[98:99], v8 offset:53760
    v_mfma_f32_16x16x32_bf16 v[232:235], a[32:35], a[156:159], v[232:235]
    v_mfma_f32_16x16x32_bf16 v[68:71], a[36:39], a[144:147], v[68:71]
    ds_read_b64_tr_b16 a[100:101], v8 offset:54272
    v_mfma_f32_16x16x32_bf16 v[124:127], a[36:39], a[148:151], v[124:127]
    ds_read_b64_tr_b16 a[102:103], v8 offset:54784
    v_mfma_f32_16x16x32_bf16 v[180:183], a[36:39], a[152:155], v[180:183]
    v_mfma_f32_16x16x32_bf16 v[236:239], a[36:39], a[156:159], v[236:239]
    buffer_load_dwordx4 a[140:143], v24, s[8:11], s16 offen offset:3072
    v_mfma_f32_16x16x32_bf16 v[72:75], a[40:43], a[144:147], v[72:75]
    ds_read_b64_tr_b16 a[104:105], v8 offset:55296
    v_mfma_f32_16x16x32_bf16 v[128:131], a[40:43], a[148:151], v[128:131]
    ds_read_b64_tr_b16 a[106:107], v8 offset:55808
    v_mfma_f32_16x16x32_bf16 v[184:187], a[40:43], a[152:155], v[184:187]
    v_mfma_f32_16x16x32_bf16 v[240:243], a[40:43], a[156:159], v[240:243]
    ds_read_b64_tr_b16 a[108:109], v10 offset:56320
    v_mfma_f32_16x16x32_bf16 v[76:79], a[44:47], a[144:147], v[76:79]
    ds_read_b64_tr_b16 a[110:111], v10 offset:56832
    v_mfma_f32_16x16x32_bf16 v[132:135], a[44:47], a[148:151], v[132:135]
    v_mfma_f32_16x16x32_bf16 v[188:191], a[44:47], a[152:155], v[188:191]
    v_mfma_f32_16x16x32_bf16 v[244:247], a[44:47], a[156:159], v[244:247]
    v_mfma_f32_16x16x32_bf16 v[80:83], a[48:51], a[144:147], v[80:83]
    v_mfma_f32_16x16x32_bf16 v[136:139], a[48:51], a[148:151], v[136:139]
    v_mfma_f32_16x16x32_bf16 v[192:195], a[48:51], a[152:155], v[192:195]
    s_add_u32 s16, s16, 8192
    v_mfma_f32_16x16x32_bf16 v[248:251], a[48:51], a[156:159], v[248:251]
    v_mfma_f32_16x16x32_bf16 v[84:87], a[52:55], a[144:147], v[84:87]
    v_mfma_f32_16x16x32_bf16 v[140:143], a[52:55], a[148:151], v[140:143]
    v_mfma_f32_16x16x32_bf16 v[196:199], a[52:55], a[152:155], v[196:199]
    v_mfma_f32_16x16x32_bf16 v[252:255], a[52:55], a[156:159], v[252:255]
    s_waitcnt vmcnt(8) lgkmcnt(0)
    s_barrier
    v_mfma_f32_16x16x32_bf16 v[32:35], a[56:59], a[160:163], v[32:35]
    ds_read_b64_tr_b16 a[0:1], v9 offset:0
    v_mfma_f32_16x16x32_bf16 v[88:91], a[56:59], a[164:167], v[88:91]
    buffer_load_dwordx4 a[144:147], v24, s[8:11], s16 offen offset:0
    v_mfma_f32_16x16x32_bf16 v[144:147], a[56:59], a[168:171], v[144:147]
    ds_read_b64_tr_b16 a[2:3], v9 offset:512
    v_mfma_f32_16x16x32_bf16 v[200:203], a[56:59], a[172:175], v[200:203]
    ds_read_b64_tr_b16 a[4:5], v9 offset:1024
    v_mfma_f32_16x16x32_bf16 v[36:39], a[60:63], a[160:163], v[36:39]
    ds_read_b64_tr_b16 a[6:7], v9 offset:1536
    v_mfma_f32_16x16x32_bf16 v[92:95], a[60:63], a[164:167], v[92:95]
    s_add_u32 m0, s20, 0
    v_mfma_f32_16x16x32_bf16 v[148:151], a[60:63], a[168:171], v[148:151]
    ds_read_b64_tr_b16 a[8:9], v9 offset:2048
    v_mfma_f32_16x16x32_bf16 v[204:207], a[60:63], a[172:175], v[204:207]
    ds_read_b64_tr_b16 a[10:11], v9 offset:2560
    v_mfma_f32_16x16x32_bf16 v[40:43], a[64:67], a[160:163], v[40:43]
    buffer_load_dwordx4 v25, s[12:15], s17 offen lds
    v_mfma_f32_16x16x32_bf16 v[96:99], a[64:67], a[164:167], v[96:99]
    v_mfma_f32_16x16x32_bf16 v[152:155], a[64:67], a[168:171], v[152:155]
    ds_read_b64_tr_b16 a[12:13], v9 offset:3072
    v_mfma_f32_16x16x32_bf16 v[208:211], a[64:67], a[172:175], v[208:211]
    ds_read_b64_tr_b16 a[14:15], v9 offset:3584
    v_mfma_f32_16x16x32_bf16 v[44:47], a[68:71], a[160:163], v[44:47]
    buffer_load_dwordx4 a[148:151], v24, s[8:11], s16 offen offset:1024
    v_mfma_f32_16x16x32_bf16 v[100:103], a[68:71], a[164:167], v[100:103]
    ds_read_b64_tr_b16 a[16:17], v9 offset:4096
    v_mfma_f32_16x16x32_bf16 v[156:159], a[68:71], a[168:171], v[156:159]
    ds_read_b64_tr_b16 a[18:19], v9 offset:4608
    v_mfma_f32_16x16x32_bf16 v[212:215], a[68:71], a[172:175], v[212:215]
    buffer_load_dwordx4 v25, s[12:15], s17 offen offset:1024 lds
    v_mfma_f32_16x16x32_bf16 v[48:51], a[72:75], a[160:163], v[48:51]
    ds_read_b64_tr_b16 a[20:21], v9 offset:5120
    v_mfma_f32_16x16x32_bf16 v[104:107], a[72:75], a[164:167], v[104:107]
    ds_read_b64_tr_b16 a[22:23], v9 offset:5632
    v_mfma_f32_16x16x32_bf16 v[160:163], a[72:75], a[168:171], v[160:163]
    v_mfma_f32_16x16x32_bf16 v[216:219], a[72:75], a[172:175], v[216:219]
    buffer_load_dwordx4 a[152:155], v24, s[8:11], s16 offen offset:2048
    v_mfma_f32_16x16x32_bf16 v[52:55], a[76:79], a[160:163], v[52:55]
    ds_read_b64_tr_b16 a[24:25], v11 offset:6144
    v_mfma_f32_16x16x32_bf16 v[108:111], a[76:79], a[164:167], v[108:111]
    ds_read_b64_tr_b16 a[26:27], v11 offset:6656
    v_mfma_f32_16x16x32_bf16 v[164:167], a[76:79], a[168:171], v[164:167]
    buffer_load_dwordx4 v25, s[12:15], s17 offen offset:2048 lds
    v_mfma_f32_16x16x32_bf16 v[220:223], a[76:79], a[172:175], v[220:223]
    ds_read_b64_tr_b16 a[28:29], v9 offset:7168
    v_mfma_f32_16x16x32_bf16 v[56:59], a[80:83], a[160:163], v[56:59]
    ds_read_b64_tr_b16 a[30:31], v9 offset:7680
    v_mfma_f32_16x16x32_bf16 v[112:115], a[80:83], a[164:167], v[112:115]
    ds_read_b64_tr_b16 a[32:33], v9 offset:8192
    v_mfma_f32_16x16x32_bf16 v[168:171], a[80:83], a[168:171], v[168:171]
    buffer_load_dwordx4 a[156:159], v24, s[8:11], s16 offen offset:3072
    v_mfma_f32_16x16x32_bf16 v[224:227], a[80:83], a[172:175], v[224:227]
    v_mfma_f32_16x16x32_bf16 v[60:63], a[84:87], a[160:163], v[60:63]
    ds_read_b64_tr_b16 a[34:35], v9 offset:8704
    v_mfma_f32_16x16x32_bf16 v[116:119], a[84:87], a[164:167], v[116:119]
    buffer_load_dwordx4 v25, s[12:15], s17 offen offset:3072 lds
    v_mfma_f32_16x16x32_bf16 v[172:175], a[84:87], a[168:171], v[172:175]
    ds_read_b64_tr_b16 a[36:37], v9 offset:9216
    v_mfma_f32_16x16x32_bf16 v[228:231], a[84:87], a[172:175], v[228:231]
    ds_read_b64_tr_b16 a[38:39], v9 offset:9728
    v_mfma_f32_16x16x32_bf16 v[64:67], a[88:91], a[160:163], v[64:67]
    ds_read_b64_tr_b16 a[40:41], v9 offset:10240
    v_mfma_f32_16x16x32_bf16 v[120:123], a[88:91], a[164:167], v[120:123]
    s_add_u32 s16, s16, 8192
    v_mfma_f32_16x16x32_bf16 v[176:179], a[88:91], a[168:171], v[176:179]
    ds_read_b64_tr_b16 a[42:43], v9 offset:10752
    v_mfma_f32_16x16x32_bf16 v[232:235], a[88:91], a[172:175], v[232:235]
    ds_read_b64_tr_b16 a[44:45], v9 offset:11264
    v_mfma_f32_16x16x32_bf16 v[68:71], a[92:95], a[160:163], v[68:71]
    s_add_u32 m0, s20, 4096
    v_mfma_f32_16x16x32_bf16 v[124:127], a[92:95], a[164:167], v[124:127]
    v_mfma_f32_16x16x32_bf16 v[180:183], a[92:95], a[168:171], v[180:183]
    ds_read_b64_tr_b16 a[46:47], v9 offset:11776
    v_mfma_f32_16x16x32_bf16 v[236:239], a[92:95], a[172:175], v[236:239]
    ds_read_b64_tr_b16 a[48:49], v9 offset:12288
    v_mfma_f32_16x16x32_bf16 v[72:75], a[96:99], a[160:163], v[72:75]
    buffer_load_dwordx4 v25, s[12:15], s21 offen lds
    v_mfma_f32_16x16x32_bf16 v[128:131], a[96:99], a[164:167], v[128:131]
    ds_read_b64_tr_b16 a[50:51], v9 offset:12800
    v_mfma_f32_16x16x32_bf16 v[184:187], a[96:99], a[168:171], v[184:187]
    ds_read_b64_tr_b16 a[52:53], v11 offset:13312
    v_mfma_f32_16x16x32_bf16 v[240:243], a[96:99], a[172:175], v[240:243]
    buffer_load_dwordx4 v25, s[12:15], s21 offen offset:1024 lds
    v_mfma_f32_16x16x32_bf16 v[76:79], a[100:103], a[160:163], v[76:79]
    ds_read_b64_tr_b16 a[54:55], v11 offset:13824
    v_mfma_f32_16x16x32_bf16 v[132:135], a[100:103], a[164:167], v[132:135]
    v_mfma_f32_16x16x32_bf16 v[188:191], a[100:103], a[168:171], v[188:191]
    v_mfma_f32_16x16x32_bf16 v[244:247], a[100:103], a[172:175], v[244:247]
    buffer_load_dwordx4 v25, s[12:15], s21 offen offset:2048 lds
    v_mfma_f32_16x16x32_bf16 v[80:83], a[104:107], a[160:163], v[80:83]
    v_mfma_f32_16x16x32_bf16 v[136:139], a[104:107], a[164:167], v[136:139]
    v_mfma_f32_16x16x32_bf16 v[192:195], a[104:107], a[168:171], v[192:195]
    s_add_u32 s17, s17, 28672
    v_mfma_f32_16x16x32_bf16 v[248:251], a[104:107], a[172:175], v[248:251]
    v_mfma_f32_16x16x32_bf16 v[84:87], a[108:111], a[160:163], v[84:87]
    v_mfma_f32_16x16x32_bf16 v[140:143], a[108:111], a[164:167], v[140:143]
    v_mfma_f32_16x16x32_bf16 v[196:199], a[108:111], a[168:171], v[196:199]
    s_add_u32 s21, s21, 28672
    v_mfma_f32_16x16x32_bf16 v[252:255], a[108:111], a[172:175], v[252:255]
    s_waitcnt vmcnt(15) lgkmcnt(0)
    v_mfma_f32_16x16x32_bf16 v[32:35], a[0:3], a[112:115], v[32:35]
    ds_read_b64_tr_b16 a[56:57], v9 offset:14336
    v_mfma_f32_16x16x32_bf16 v[88:91], a[0:3], a[116:119], v[88:91]
    buffer_load_dwordx4 a[160:163], v24, s[8:11], s16 offen offset:0
    v_mfma_f32_16x16x32_bf16 v[144:147], a[0:3], a[120:123], v[144:147]
    ds_read_b64_tr_b16 a[58:59], v9 offset:14848
    v_mfma_f32_16x16x32_bf16 v[200:203], a[0:3], a[124:127], v[200:203]
    ds_read_b64_tr_b16 a[60:61], v9 offset:15360
    v_mfma_f32_16x16x32_bf16 v[36:39], a[4:7], a[112:115], v[36:39]
    ds_read_b64_tr_b16 a[62:63], v9 offset:15872
    v_mfma_f32_16x16x32_bf16 v[92:95], a[4:7], a[116:119], v[92:95]
    s_add_u32 m0, s20, 28672
    v_mfma_f32_16x16x32_bf16 v[148:151], a[4:7], a[120:123], v[148:151]
    ds_read_b64_tr_b16 a[64:65], v9 offset:16384
    v_mfma_f32_16x16x32_bf16 v[204:207], a[4:7], a[124:127], v[204:207]
    ds_read_b64_tr_b16 a[66:67], v9 offset:16896
    v_mfma_f32_16x16x32_bf16 v[40:43], a[8:11], a[112:115], v[40:43]
    buffer_load_dwordx4 v25, s[12:15], s17 offen lds
    v_mfma_f32_16x16x32_bf16 v[96:99], a[8:11], a[116:119], v[96:99]
    v_mfma_f32_16x16x32_bf16 v[152:155], a[8:11], a[120:123], v[152:155]
    ds_read_b64_tr_b16 a[68:69], v9 offset:17408
    v_mfma_f32_16x16x32_bf16 v[208:211], a[8:11], a[124:127], v[208:211]
    ds_read_b64_tr_b16 a[70:71], v9 offset:17920
    v_mfma_f32_16x16x32_bf16 v[44:47], a[12:15], a[112:115], v[44:47]
    buffer_load_dwordx4 a[164:167], v24, s[8:11], s16 offen offset:1024
    v_mfma_f32_16x16x32_bf16 v[100:103], a[12:15], a[116:119], v[100:103]
    ds_read_b64_tr_b16 a[72:73], v9 offset:18432
    v_mfma_f32_16x16x32_bf16 v[156:159], a[12:15], a[120:123], v[156:159]
    ds_read_b64_tr_b16 a[74:75], v9 offset:18944
    v_mfma_f32_16x16x32_bf16 v[212:215], a[12:15], a[124:127], v[212:215]
    buffer_load_dwordx4 v25, s[12:15], s17 offen offset:1024 lds
    v_mfma_f32_16x16x32_bf16 v[48:51], a[16:19], a[112:115], v[48:51]
    ds_read_b64_tr_b16 a[76:77], v9 offset:19456
    v_mfma_f32_16x16x32_bf16 v[104:107], a[16:19], a[116:119], v[104:107]
    ds_read_b64_tr_b16 a[78:79], v9 offset:19968
    v_mfma_f32_16x16x32_bf16 v[160:163], a[16:19], a[120:123], v[160:163]
    v_mfma_f32_16x16x32_bf16 v[216:219], a[16:19], a[124:127], v[216:219]
    buffer_load_dwordx4 a[168:171], v24, s[8:11], s16 offen offset:2048
    v_mfma_f32_16x16x32_bf16 v[52:55], a[20:23], a[112:115], v[52:55]
    ds_read_b64_tr_b16 a[80:81], v11 offset:20480
    v_mfma_f32_16x16x32_bf16 v[108:111], a[20:23], a[116:119], v[108:111]
    ds_read_b64_tr_b16 a[82:83], v11 offset:20992
    v_mfma_f32_16x16x32_bf16 v[164:167], a[20:23], a[120:123], v[164:167]
    buffer_load_dwordx4 v25, s[12:15], s17 offen offset:2048 lds
    v_mfma_f32_16x16x32_bf16 v[220:223], a[20:23], a[124:127], v[220:223]
    ds_read_b64_tr_b16 a[84:85], v9 offset:21504
    v_mfma_f32_16x16x32_bf16 v[56:59], a[24:27], a[112:115], v[56:59]
    ds_read_b64_tr_b16 a[86:87], v9 offset:22016
    v_mfma_f32_16x16x32_bf16 v[112:115], a[24:27], a[116:119], v[112:115]
    ds_read_b64_tr_b16 a[88:89], v9 offset:22528
    v_mfma_f32_16x16x32_bf16 v[168:171], a[24:27], a[120:123], v[168:171]
    buffer_load_dwordx4 a[172:175], v24, s[8:11], s16 offen offset:3072
    v_mfma_f32_16x16x32_bf16 v[224:227], a[24:27], a[124:127], v[224:227]
    v_mfma_f32_16x16x32_bf16 v[60:63], a[28:31], a[112:115], v[60:63]
    ds_read_b64_tr_b16 a[90:91], v9 offset:23040
    v_mfma_f32_16x16x32_bf16 v[116:119], a[28:31], a[116:119], v[116:119]
    buffer_load_dwordx4 v25, s[12:15], s17 offen offset:3072 lds
    v_mfma_f32_16x16x32_bf16 v[172:175], a[28:31], a[120:123], v[172:175]
    ds_read_b64_tr_b16 a[92:93], v9 offset:23552
    v_mfma_f32_16x16x32_bf16 v[228:231], a[28:31], a[124:127], v[228:231]
    ds_read_b64_tr_b16 a[94:95], v9 offset:24064
    v_mfma_f32_16x16x32_bf16 v[64:67], a[32:35], a[112:115], v[64:67]
    ds_read_b64_tr_b16 a[96:97], v9 offset:24576
    v_mfma_f32_16x16x32_bf16 v[120:123], a[32:35], a[116:119], v[120:123]
    s_add_u32 s16, s16, 8192
    v_mfma_f32_16x16x32_bf16 v[176:179], a[32:35], a[120:123], v[176:179]
    ds_read_b64_tr_b16 a[98:99], v9 offset:25088
    v_mfma_f32_16x16x32_bf16 v[232:235], a[32:35], a[124:127], v[232:235]
    ds_read_b64_tr_b16 a[100:101], v9 offset:25600
    v_mfma_f32_16x16x32_bf16 v[68:71], a[36:39], a[112:115], v[68:71]
    s_add_u32 m0, s20, 32768
    v_mfma_f32_16x16x32_bf16 v[124:127], a[36:39], a[116:119], v[124:127]
    v_mfma_f32_16x16x32_bf16 v[180:183], a[36:39], a[120:123], v[180:183]
    ds_read_b64_tr_b16 a[102:103], v9 offset:26112
    v_mfma_f32_16x16x32_bf16 v[236:239], a[36:39], a[124:127], v[236:239]
    ds_read_b64_tr_b16 a[104:105], v9 offset:26624
    v_mfma_f32_16x16x32_bf16 v[72:75], a[40:43], a[112:115], v[72:75]
    buffer_load_dwordx4 v25, s[12:15], s21 offen lds
    v_mfma_f32_16x16x32_bf16 v[128:131], a[40:43], a[116:119], v[128:131]
    ds_read_b64_tr_b16 a[106:107], v9 offset:27136
    v_mfma_f32_16x16x32_bf16 v[184:187], a[40:43], a[120:123], v[184:187]
    ds_read_b64_tr_b16 a[108:109], v11 offset:27648
    v_mfma_f32_16x16x32_bf16 v[240:243], a[40:43], a[124:127], v[240:243]
    buffer_load_dwordx4 v25, s[12:15], s21 offen offset:1024 lds
    v_mfma_f32_16x16x32_bf16 v[76:79], a[44:47], a[112:115], v[76:79]
    ds_read_b64_tr_b16 a[110:111], v11 offset:28160
    v_mfma_f32_16x16x32_bf16 v[132:135], a[44:47], a[116:119], v[132:135]
    v_mfma_f32_16x16x32_bf16 v[188:191], a[44:47], a[120:123], v[188:191]
    v_mfma_f32_16x16x32_bf16 v[244:247], a[44:47], a[124:127], v[244:247]
    buffer_load_dwordx4 v25, s[12:15], s21 offen offset:2048 lds
    v_mfma_f32_16x16x32_bf16 v[80:83], a[48:51], a[112:115], v[80:83]
    v_mfma_f32_16x16x32_bf16 v[136:139], a[48:51], a[116:119], v[136:139]
    v_mfma_f32_16x16x32_bf16 v[192:195], a[48:51], a[120:123], v[192:195]
    s_add_u32 s17, s17, 28672
    v_mfma_f32_16x16x32_bf16 v[248:251], a[48:51], a[124:127], v[248:251]
    v_mfma_f32_16x16x32_bf16 v[84:87], a[52:55], a[112:115], v[84:87]
    v_mfma_f32_16x16x32_bf16 v[140:143], a[52:55], a[116:119], v[140:143]
    v_mfma_f32_16x16x32_bf16 v[196:199], a[52:55], a[120:123], v[196:199]
    s_add_u32 s21, s21, 28672
    v_mfma_f32_16x16x32_bf16 v[252:255], a[52:55], a[124:127], v[252:255]
    s_waitcnt vmcnt(22) lgkmcnt(0)
    v_mfma_f32_16x16x32_bf16 v[32:35], a[56:59], a[128:131], v[32:35]
    ds_read_b64_tr_b16 a[0:1], v9 offset:28672
    v_mfma_f32_16x16x32_bf16 v[88:91], a[56:59], a[132:135], v[88:91]
    ds_read_b64_tr_b16 a[2:3], v9 offset:29184
    v_mfma_f32_16x16x32_bf16 v[144:147], a[56:59], a[136:139], v[144:147]
    v_mfma_f32_16x16x32_bf16 v[200:203], a[56:59], a[140:143], v[200:203]
    ds_read_b64_tr_b16 a[4:5], v9 offset:29696
    v_mfma_f32_16x16x32_bf16 v[36:39], a[60:63], a[128:131], v[36:39]
    ds_read_b64_tr_b16 a[6:7], v9 offset:30208
    v_mfma_f32_16x16x32_bf16 v[92:95], a[60:63], a[132:135], v[92:95]
    buffer_load_dwordx4 a[112:115], v24, s[8:11], s16 offen offset:0
    v_mfma_f32_16x16x32_bf16 v[148:151], a[60:63], a[136:139], v[148:151]
    v_mfma_f32_16x16x32_bf16 v[204:207], a[60:63], a[140:143], v[204:207]
    ds_read_b64_tr_b16 a[8:9], v9 offset:30720
    v_mfma_f32_16x16x32_bf16 v[40:43], a[64:67], a[128:131], v[40:43]
    ds_read_b64_tr_b16 a[10:11], v9 offset:31232
    v_mfma_f32_16x16x32_bf16 v[96:99], a[64:67], a[132:135], v[96:99]
    v_mfma_f32_16x16x32_bf16 v[152:155], a[64:67], a[136:139], v[152:155]
    ds_read_b64_tr_b16 a[12:13], v9 offset:31744
    v_mfma_f32_16x16x32_bf16 v[208:211], a[64:67], a[140:143], v[208:211]
    ds_read_b64_tr_b16 a[14:15], v9 offset:32256
    v_mfma_f32_16x16x32_bf16 v[44:47], a[68:71], a[128:131], v[44:47]
    v_mfma_f32_16x16x32_bf16 v[100:103], a[68:71], a[132:135], v[100:103]
    ds_read_b64_tr_b16 a[16:17], v9 offset:32768
    v_mfma_f32_16x16x32_bf16 v[156:159], a[68:71], a[136:139], v[156:159]
    ds_read_b64_tr_b16 a[18:19], v9 offset:33280
    v_mfma_f32_16x16x32_bf16 v[212:215], a[68:71], a[140:143], v[212:215]
    v_mfma_f32_16x16x32_bf16 v[48:51], a[72:75], a[128:131], v[48:51]
    buffer_load_dwordx4 a[116:119], v24, s[8:11], s16 offen offset:1024
    v_mfma_f32_16x16x32_bf16 v[104:107], a[72:75], a[132:135], v[104:107]
    ds_read_b64_tr_b16 a[20:21], v9 offset:33792
    v_mfma_f32_16x16x32_bf16 v[160:163], a[72:75], a[136:139], v[160:163]
    ds_read_b64_tr_b16 a[22:23], v9 offset:34304
    v_mfma_f32_16x16x32_bf16 v[216:219], a[72:75], a[140:143], v[216:219]
    v_mfma_f32_16x16x32_bf16 v[52:55], a[76:79], a[128:131], v[52:55]
    ds_read_b64_tr_b16 a[24:25], v11 offset:34816
    v_mfma_f32_16x16x32_bf16 v[108:111], a[76:79], a[132:135], v[108:111]
    ds_read_b64_tr_b16 a[26:27], v11 offset:35328
    v_mfma_f32_16x16x32_bf16 v[164:167], a[76:79], a[136:139], v[164:167]
    v_mfma_f32_16x16x32_bf16 v[220:223], a[76:79], a[140:143], v[220:223]
    ds_read_b64_tr_b16 a[28:29], v9 offset:35840
    v_mfma_f32_16x16x32_bf16 v[56:59], a[80:83], a[128:131], v[56:59]
    ds_read_b64_tr_b16 a[30:31], v9 offset:36352
    v_mfma_f32_16x16x32_bf16 v[112:115], a[80:83], a[132:135], v[112:115]
    v_mfma_f32_16x16x32_bf16 v[168:171], a[80:83], a[136:139], v[168:171]
    ds_read_b64_tr_b16 a[32:33], v9 offset:36864
    v_mfma_f32_16x16x32_bf16 v[224:227], a[80:83], a[140:143], v[224:227]
    ds_read_b64_tr_b16 a[34:35], v9 offset:37376
    v_mfma_f32_16x16x32_bf16 v[60:63], a[84:87], a[128:131], v[60:63]
    buffer_load_dwordx4 a[120:123], v24, s[8:11], s16 offen offset:2048
    v_mfma_f32_16x16x32_bf16 v[116:119], a[84:87], a[132:135], v[116:119]
    v_mfma_f32_16x16x32_bf16 v[172:175], a[84:87], a[136:139], v[172:175]
    ds_read_b64_tr_b16 a[36:37], v9 offset:37888
    v_mfma_f32_16x16x32_bf16 v[228:231], a[84:87], a[140:143], v[228:231]
    ds_read_b64_tr_b16 a[38:39], v9 offset:38400
    v_mfma_f32_16x16x32_bf16 v[64:67], a[88:91], a[128:131], v[64:67]
    v_mfma_f32_16x16x32_bf16 v[120:123], a[88:91], a[132:135], v[120:123]
    ds_read_b64_tr_b16 a[40:41], v9 offset:38912
    v_mfma_f32_16x16x32_bf16 v[176:179], a[88:91], a[136:139], v[176:179]
    ds_read_b64_tr_b16 a[42:43], v9 offset:39424
    v_mfma_f32_16x16x32_bf16 v[232:235], a[88:91], a[140:143], v[232:235]
    v_mfma_f32_16x16x32_bf16 v[68:71], a[92:95], a[128:131], v[68:71]
    ds_read_b64_tr_b16 a[44:45], v9 offset:39936
    v_mfma_f32_16x16x32_bf16 v[124:127], a[92:95], a[132:135], v[124:127]
    ds_read_b64_tr_b16 a[46:47], v9 offset:40448
    v_mfma_f32_16x16x32_bf16 v[180:183], a[92:95], a[136:139], v[180:183]
    v_mfma_f32_16x16x32_bf16 v[236:239], a[92:95], a[140:143], v[236:239]
    buffer_load_dwordx4 a[124:127], v24, s[8:11], s16 offen offset:3072
    v_mfma_f32_16x16x32_bf16 v[72:75], a[96:99], a[128:131], v[72:75]
    ds_read_b64_tr_b16 a[48:49], v9 offset:40960
    v_mfma_f32_16x16x32_bf16 v[128:131], a[96:99], a[132:135], v[128:131]
    ds_read_b64_tr_b16 a[50:51], v9 offset:41472
    v_mfma_f32_16x16x32_bf16 v[184:187], a[96:99], a[136:139], v[184:187]
    v_mfma_f32_16x16x32_bf16 v[240:243], a[96:99], a[140:143], v[240:243]
    ds_read_b64_tr_b16 a[52:53], v11 offset:41984
    v_mfma_f32_16x16x32_bf16 v[76:79], a[100:103], a[128:131], v[76:79]
    ds_read_b64_tr_b16 a[54:55], v11 offset:42496
    v_mfma_f32_16x16x32_bf16 v[132:135], a[100:103], a[132:135], v[132:135]
    v_mfma_f32_16x16x32_bf16 v[188:191], a[100:103], a[136:139], v[188:191]
    v_mfma_f32_16x16x32_bf16 v[244:247], a[100:103], a[140:143], v[244:247]
    v_mfma_f32_16x16x32_bf16 v[80:83], a[104:107], a[128:131], v[80:83]
    v_mfma_f32_16x16x32_bf16 v[136:139], a[104:107], a[132:135], v[136:139]
    v_mfma_f32_16x16x32_bf16 v[192:195], a[104:107], a[136:139], v[192:195]
    s_add_u32 s16, s16, 8192
    v_mfma_f32_16x16x32_bf16 v[248:251], a[104:107], a[140:143], v[248:251]
    v_mfma_f32_16x16x32_bf16 v[84:87], a[108:111], a[128:131], v[84:87]
    v_mfma_f32_16x16x32_bf16 v[140:143], a[108:111], a[132:135], v[140:143]
    v_mfma_f32_16x16x32_bf16 v[196:199], a[108:111], a[136:139], v[196:199]
    v_mfma_f32_16x16x32_bf16 v[252:255], a[108:111], a[140:143], v[252:255]
    s_waitcnt vmcnt(19) lgkmcnt(0)
    v_mfma_f32_16x16x32_bf16 v[32:35], a[0:3], a[144:147], v[32:35]
    ds_read_b64_tr_b16 a[56:57], v9 offset:43008
    v_mfma_f32_16x16x32_bf16 v[88:91], a[0:3], a[148:151], v[88:91]
    ds_read_b64_tr_b16 a[58:59], v9 offset:43520
    v_mfma_f32_16x16x32_bf16 v[144:147], a[0:3], a[152:155], v[144:147]
    v_mfma_f32_16x16x32_bf16 v[200:203], a[0:3], a[156:159], v[200:203]
    ds_read_b64_tr_b16 a[60:61], v9 offset:44032
    v_mfma_f32_16x16x32_bf16 v[36:39], a[4:7], a[144:147], v[36:39]
    ds_read_b64_tr_b16 a[62:63], v9 offset:44544
    v_mfma_f32_16x16x32_bf16 v[92:95], a[4:7], a[148:151], v[92:95]
    buffer_load_dwordx4 a[128:131], v24, s[8:11], s16 offen offset:0
    v_mfma_f32_16x16x32_bf16 v[148:151], a[4:7], a[152:155], v[148:151]
    v_mfma_f32_16x16x32_bf16 v[204:207], a[4:7], a[156:159], v[204:207]
    ds_read_b64_tr_b16 a[64:65], v9 offset:45056
    v_mfma_f32_16x16x32_bf16 v[40:43], a[8:11], a[144:147], v[40:43]
    ds_read_b64_tr_b16 a[66:67], v9 offset:45568
    v_mfma_f32_16x16x32_bf16 v[96:99], a[8:11], a[148:151], v[96:99]
    v_mfma_f32_16x16x32_bf16 v[152:155], a[8:11], a[152:155], v[152:155]
    ds_read_b64_tr_b16 a[68:69], v9 offset:46080
    v_mfma_f32_16x16x32_bf16 v[208:211], a[8:11], a[156:159], v[208:211]
    ds_read_b64_tr_b16 a[70:71], v9 offset:46592
    v_mfma_f32_16x16x32_bf16 v[44:47], a[12:15], a[144:147], v[44:47]
    v_mfma_f32_16x16x32_bf16 v[100:103], a[12:15], a[148:151], v[100:103]
    ds_read_b64_tr_b16 a[72:73], v9 offset:47104
    v_mfma_f32_16x16x32_bf16 v[156:159], a[12:15], a[152:155], v[156:159]
    ds_read_b64_tr_b16 a[74:75], v9 offset:47616
    v_mfma_f32_16x16x32_bf16 v[212:215], a[12:15], a[156:159], v[212:215]
    v_mfma_f32_16x16x32_bf16 v[48:51], a[16:19], a[144:147], v[48:51]
    buffer_load_dwordx4 a[132:135], v24, s[8:11], s16 offen offset:1024
    v_mfma_f32_16x16x32_bf16 v[104:107], a[16:19], a[148:151], v[104:107]
    ds_read_b64_tr_b16 a[76:77], v9 offset:48128
    v_mfma_f32_16x16x32_bf16 v[160:163], a[16:19], a[152:155], v[160:163]
    ds_read_b64_tr_b16 a[78:79], v9 offset:48640
    v_mfma_f32_16x16x32_bf16 v[216:219], a[16:19], a[156:159], v[216:219]
    v_mfma_f32_16x16x32_bf16 v[52:55], a[20:23], a[144:147], v[52:55]
    ds_read_b64_tr_b16 a[80:81], v11 offset:49152
    v_mfma_f32_16x16x32_bf16 v[108:111], a[20:23], a[148:151], v[108:111]
    ds_read_b64_tr_b16 a[82:83], v11 offset:49664
    v_mfma_f32_16x16x32_bf16 v[164:167], a[20:23], a[152:155], v[164:167]
    v_mfma_f32_16x16x32_bf16 v[220:223], a[20:23], a[156:159], v[220:223]
    ds_read_b64_tr_b16 a[84:85], v9 offset:50176
    v_mfma_f32_16x16x32_bf16 v[56:59], a[24:27], a[144:147], v[56:59]
    ds_read_b64_tr_b16 a[86:87], v9 offset:50688
    v_mfma_f32_16x16x32_bf16 v[112:115], a[24:27], a[148:151], v[112:115]
    v_mfma_f32_16x16x32_bf16 v[168:171], a[24:27], a[152:155], v[168:171]
    ds_read_b64_tr_b16 a[88:89], v9 offset:51200
    v_mfma_f32_16x16x32_bf16 v[224:227], a[24:27], a[156:159], v[224:227]
    ds_read_b64_tr_b16 a[90:91], v9 offset:51712
    v_mfma_f32_16x16x32_bf16 v[60:63], a[28:31], a[144:147], v[60:63]
    buffer_load_dwordx4 a[136:139], v24, s[8:11], s16 offen offset:2048
    v_mfma_f32_16x16x32_bf16 v[116:119], a[28:31], a[148:151], v[116:119]
    v_mfma_f32_16x16x32_bf16 v[172:175], a[28:31], a[152:155], v[172:175]
    ds_read_b64_tr_b16 a[92:93], v9 offset:52224
    v_mfma_f32_16x16x32_bf16 v[228:231], a[28:31], a[156:159], v[228:231]
    ds_read_b64_tr_b16 a[94:95], v9 offset:52736
    v_mfma_f32_16x16x32_bf16 v[64:67], a[32:35], a[144:147], v[64:67]
    v_mfma_f32_16x16x32_bf16 v[120:123], a[32:35], a[148:151], v[120:123]
    ds_read_b64_tr_b16 a[96:97], v9 offset:53248
    v_mfma_f32_16x16x32_bf16 v[176:179], a[32:35], a[152:155], v[176:179]
    ds_read_b64_tr_b16 a[98:99], v9 offset:53760
    v_mfma_f32_16x16x32_bf16 v[232:235], a[32:35], a[156:159], v[232:235]
    v_mfma_f32_16x16x32_bf16 v[68:71], a[36:39], a[144:147], v[68:71]
    ds_read_b64_tr_b16 a[100:101], v9 offset:54272
    v_mfma_f32_16x16x32_bf16 v[124:127], a[36:39], a[148:151], v[124:127]
    ds_read_b64_tr_b16 a[102:103], v9 offset:54784
    v_mfma_f32_16x16x32_bf16 v[180:183], a[36:39], a[152:155], v[180:183]
    v_mfma_f32_16x16x32_bf16 v[236:239], a[36:39], a[156:159], v[236:239]
    buffer_load_dwordx4 a[140:143], v24, s[8:11], s16 offen offset:3072
    v_mfma_f32_16x16x32_bf16 v[72:75], a[40:43], a[144:147], v[72:75]
    ds_read_b64_tr_b16 a[104:105], v9 offset:55296
    v_mfma_f32_16x16x32_bf16 v[128:131], a[40:43], a[148:151], v[128:131]
    ds_read_b64_tr_b16 a[106:107], v9 offset:55808
    v_mfma_f32_16x16x32_bf16 v[184:187], a[40:43], a[152:155], v[184:187]
    v_mfma_f32_16x16x32_bf16 v[240:243], a[40:43], a[156:159], v[240:243]
    ds_read_b64_tr_b16 a[108:109], v11 offset:56320
    v_mfma_f32_16x16x32_bf16 v[76:79], a[44:47], a[144:147], v[76:79]
    ds_read_b64_tr_b16 a[110:111], v11 offset:56832
    v_mfma_f32_16x16x32_bf16 v[132:135], a[44:47], a[148:151], v[132:135]
    v_mfma_f32_16x16x32_bf16 v[188:191], a[44:47], a[152:155], v[188:191]
    v_mfma_f32_16x16x32_bf16 v[244:247], a[44:47], a[156:159], v[244:247]
    v_mfma_f32_16x16x32_bf16 v[80:83], a[48:51], a[144:147], v[80:83]
    v_mfma_f32_16x16x32_bf16 v[136:139], a[48:51], a[148:151], v[136:139]
    v_mfma_f32_16x16x32_bf16 v[192:195], a[48:51], a[152:155], v[192:195]
    s_add_u32 s16, s16, 8192
    v_mfma_f32_16x16x32_bf16 v[248:251], a[48:51], a[156:159], v[248:251]
    v_mfma_f32_16x16x32_bf16 v[84:87], a[52:55], a[144:147], v[84:87]
    v_mfma_f32_16x16x32_bf16 v[140:143], a[52:55], a[148:151], v[140:143]
    v_mfma_f32_16x16x32_bf16 v[196:199], a[52:55], a[152:155], v[196:199]
    v_mfma_f32_16x16x32_bf16 v[252:255], a[52:55], a[156:159], v[252:255]
    s_sub_u32 s18, s18, 1
    s_cmp_lg_u32 s18, 0
    s_cbranch_scc1 L_loop_20
    s_waitcnt vmcnt(8) lgkmcnt(0)
    s_barrier
    v_mfma_f32_16x16x32_bf16 v[32:35], a[56:59], a[160:163], v[32:35]
    ds_read_b64_tr_b16 a[0:1], v8 offset:0
    v_mfma_f32_16x16x32_bf16 v[88:91], a[56:59], a[164:167], v[88:91]
    buffer_load_dwordx4 a[144:147], v24, s[8:11], s16 offen offset:0
    v_mfma_f32_16x16x32_bf16 v[144:147], a[56:59], a[168:171], v[144:147]
    ds_read_b64_tr_b16 a[2:3], v8 offset:512
    v_mfma_f32_16x16x32_bf16 v[200:203], a[56:59], a[172:175], v[200:203]
    ds_read_b64_tr_b16 a[4:5], v8 offset:1024
    v_mfma_f32_16x16x32_bf16 v[36:39], a[60:63], a[160:163], v[36:39]
    ds_read_b64_tr_b16 a[6:7], v8 offset:1536
    v_mfma_f32_16x16x32_bf16 v[92:95], a[60:63], a[164:167], v[92:95]
    s_add_u32 m0, s20, 57344
    v_mfma_f32_16x16x32_bf16 v[148:151], a[60:63], a[168:171], v[148:151]
    ds_read_b64_tr_b16 a[8:9], v8 offset:2048
    v_mfma_f32_16x16x32_bf16 v[204:207], a[60:63], a[172:175], v[204:207]
    ds_read_b64_tr_b16 a[10:11], v8 offset:2560
    v_mfma_f32_16x16x32_bf16 v[40:43], a[64:67], a[160:163], v[40:43]
    buffer_load_dwordx4 v25, s[12:15], s17 offen lds
    v_mfma_f32_16x16x32_bf16 v[96:99], a[64:67], a[164:167], v[96:99]
    v_mfma_f32_16x16x32_bf16 v[152:155], a[64:67], a[168:171], v[152:155]
    ds_read_b64_tr_b16 a[12:13], v8 offset:3072
    v_mfma_f32_16x16x32_bf16 v[208:211], a[64:67], a[172:175], v[208:211]
    ds_read_b64_tr_b16 a[14:15], v8 offset:3584
    v_mfma_f32_16x16x32_bf16 v[44:47], a[68:71], a[160:163], v[44:47]
    buffer_load_dwordx4 a[148:151], v24, s[8:11], s16 offen offset:1024
    v_mfma_f32_16x16x32_bf16 v[100:103], a[68:71], a[164:167], v[100:103]
    ds_read_b64_tr_b16 a[16:17], v8 offset:4096
    v_mfma_f32_16x16x32_bf16 v[156:159], a[68:71], a[168:171], v[156:159]
    ds_read_b64_tr_b16 a[18:19], v8 offset:4608
    v_mfma_f32_16x16x32_bf16 v[212:215], a[68:71], a[172:175], v[212:215]
    buffer_load_dwordx4 v25, s[12:15], s17 offen offset:1024 lds
    v_mfma_f32_16x16x32_bf16 v[48:51], a[72:75], a[160:163], v[48:51]
    ds_read_b64_tr_b16 a[20:21], v8 offset:5120
    v_mfma_f32_16x16x32_bf16 v[104:107], a[72:75], a[164:167], v[104:107]
    ds_read_b64_tr_b16 a[22:23], v8 offset:5632
    v_mfma_f32_16x16x32_bf16 v[160:163], a[72:75], a[168:171], v[160:163]
    v_mfma_f32_16x16x32_bf16 v[216:219], a[72:75], a[172:175], v[216:219]
    buffer_load_dwordx4 a[152:155], v24, s[8:11], s16 offen offset:2048
    v_mfma_f32_16x16x32_bf16 v[52:55], a[76:79], a[160:163], v[52:55]
    ds_read_b64_tr_b16 a[24:25], v10 offset:6144
    v_mfma_f32_16x16x32_bf16 v[108:111], a[76:79], a[164:167], v[108:111]
    ds_read_b64_tr_b16 a[26:27], v10 offset:6656
    v_mfma_f32_16x16x32_bf16 v[164:167], a[76:79], a[168:171], v[164:167]
    buffer_load_dwordx4 v25, s[12:15], s17 offen offset:2048 lds
    v_mfma_f32_16x16x32_bf16 v[220:223], a[76:79], a[172:175], v[220:223]
    ds_read_b64_tr_b16 a[28:29], v8 offset:7168
    v_mfma_f32_16x16x32_bf16 v[56:59], a[80:83], a[160:163], v[56:59]
    ds_read_b64_tr_b16 a[30:31], v8 offset:7680
    v_mfma_f32_16x16x32_bf16 v[112:115], a[80:83], a[164:167], v[112:115]
    ds_read_b64_tr_b16 a[32:33], v8 offset:8192
    v_mfma_f32_16x16x32_bf16 v[168:171], a[80:83], a[168:171], v[168:171]
    buffer_load_dwordx4 a[156:159], v24, s[8:11], s16 offen offset:3072
    v_mfma_f32_16x16x32_bf16 v[224:227], a[80:83], a[172:175], v[224:227]
    v_mfma_f32_16x16x32_bf16 v[60:63], a[84:87], a[160:163], v[60:63]
    ds_read_b64_tr_b16 a[34:35], v8 offset:8704
    v_mfma_f32_16x16x32_bf16 v[116:119], a[84:87], a[164:167], v[116:119]
    buffer_load_dwordx4 v25, s[12:15], s17 offen offset:3072 lds
    v_mfma_f32_16x16x32_bf16 v[172:175], a[84:87], a[168:171], v[172:175]
    ds_read_b64_tr_b16 a[36:37], v8 offset:9216
    v_mfma_f32_16x16x32_bf16 v[228:231], a[84:87], a[172:175], v[228:231]
    ds_read_b64_tr_b16 a[38:39], v8 offset:9728
    v_mfma_f32_16x16x32_bf16 v[64:67], a[88:91], a[160:163], v[64:67]
    ds_read_b64_tr_b16 a[40:41], v8 offset:10240
    v_mfma_f32_16x16x32_bf16 v[120:123], a[88:91], a[164:167], v[120:123]
    s_add_u32 s16, s16, 8192
    v_mfma_f32_16x16x32_bf16 v[176:179], a[88:91], a[168:171], v[176:179]
    ds_read_b64_tr_b16 a[42:43], v8 offset:10752
    v_mfma_f32_16x16x32_bf16 v[232:235], a[88:91], a[172:175], v[232:235]
    ds_read_b64_tr_b16 a[44:45], v8 offset:11264
    v_mfma_f32_16x16x32_bf16 v[68:71], a[92:95], a[160:163], v[68:71]
    s_add_u32 m0, s20, 61440
    v_mfma_f32_16x16x32_bf16 v[124:127], a[92:95], a[164:167], v[124:127]
    v_mfma_f32_16x16x32_bf16 v[180:183], a[92:95], a[168:171], v[180:183]
    ds_read_b64_tr_b16 a[46:47], v8 offset:11776
    v_mfma_f32_16x16x32_bf16 v[236:239], a[92:95], a[172:175], v[236:239]
    ds_read_b64_tr_b16 a[48:49], v8 offset:12288
    v_mfma_f32_16x16x32_bf16 v[72:75], a[96:99], a[160:163], v[72:75]
    buffer_load_dwordx4 v25, s[12:15], s21 offen lds
    v_mfma_f32_16x16x32_bf16 v[128:131], a[96:99], a[164:167], v[128:131]
    ds_read_b64_tr_b16 a[50:51], v8 offset:12800
    v_mfma_f32_16x16x32_bf16 v[184:187], a[96:99], a[168:171], v[184:187]
    ds_read_b64_tr_b16 a[52:53], v10 offset:13312
    v_mfma_f32_16x16x32_bf16 v[240:243], a[96:99], a[172:175], v[240:243]
    buffer_load_dwordx4 v25, s[12:15], s21 offen offset:1024 lds
    v_mfma_f32_16x16x32_bf16 v[76:79], a[100:103], a[160:163], v[76:79]
    ds_read_b64_tr_b16 a[54:55], v10 offset:13824
    v_mfma_f32_16x16x32_bf16 v[132:135], a[100:103], a[164:167], v[132:135]
    v_mfma_f32_16x16x32_bf16 v[188:191], a[100:103], a[168:171], v[188:191]
    v_mfma_f32_16x16x32_bf16 v[244:247], a[100:103], a[172:175], v[244:247]
    buffer_load_dwordx4 v25, s[12:15], s21 offen offset:2048 lds
    v_mfma_f32_16x16x32_bf16 v[80:83], a[104:107], a[160:163], v[80:83]
    v_mfma_f32_16x16x32_bf16 v[136:139], a[104:107], a[164:167], v[136:139]
    v_mfma_f32_16x16x32_bf16 v[192:195], a[104:107], a[168:171], v[192:195]
    s_add_u32 s17, s17, 28672
    v_mfma_f32_16x16x32_bf16 v[248:251], a[104:107], a[172:175], v[248:251]
    v_mfma_f32_16x16x32_bf16 v[84:87], a[108:111], a[160:163], v[84:87]
    v_mfma_f32_16x16x32_bf16 v[140:143], a[108:111], a[164:167], v[140:143]
    v_mfma_f32_16x16x32_bf16 v[196:199], a[108:111], a[168:171], v[196:199]
    s_add_u32 s21, s21, 28672
    v_mfma_f32_16x16x32_bf16 v[252:255], a[108:111], a[172:175], v[252:255]
    s_waitcnt vmcnt(15) lgkmcnt(0)
    v_mfma_f32_16x16x32_bf16 v[32:35], a[0:3], a[112:115], v[32:35]
    ds_read_b64_tr_b16 a[56:57], v8 offset:14336
    v_mfma_f32_16x16x32_bf16 v[88:91], a[0:3], a[116:119], v[88:91]
    buffer_load_dwordx4 a[160:163], v24, s[8:11], s16 offen offset:0
    v_mfma_f32_16x16x32_bf16 v[144:147], a[0:3], a[120:123], v[144:147]
    ds_read_b64_tr_b16 a[58:59], v8 offset:14848
    v_mfma_f32_16x16x32_bf16 v[200:203], a[0:3], a[124:127], v[200:203]
    ds_read_b64_tr_b16 a[60:61], v8 offset:15360
    v_mfma_f32_16x16x32_bf16 v[36:39], a[4:7], a[112:115], v[36:39]
    ds_read_b64_tr_b16 a[62:63], v8 offset:15872
    v_mfma_f32_16x16x32_bf16 v[92:95], a[4:7], a[116:119], v[92:95]
    s_add_u32 m0, s20, 86016
    v_mfma_f32_16x16x32_bf16 v[148:151], a[4:7], a[120:123], v[148:151]
    ds_read_b64_tr_b16 a[64:65], v8 offset:16384
    v_mfma_f32_16x16x32_bf16 v[204:207], a[4:7], a[124:127], v[204:207]
    ds_read_b64_tr_b16 a[66:67], v8 offset:16896
    v_mfma_f32_16x16x32_bf16 v[40:43], a[8:11], a[112:115], v[40:43]
    buffer_load_dwordx4 v25, s[12:15], s17 offen lds
    v_mfma_f32_16x16x32_bf16 v[96:99], a[8:11], a[116:119], v[96:99]
    v_mfma_f32_16x16x32_bf16 v[152:155], a[8:11], a[120:123], v[152:155]
    ds_read_b64_tr_b16 a[68:69], v8 offset:17408
    v_mfma_f32_16x16x32_bf16 v[208:211], a[8:11], a[124:127], v[208:211]
    ds_read_b64_tr_b16 a[70:71], v8 offset:17920
    v_mfma_f32_16x16x32_bf16 v[44:47], a[12:15], a[112:115], v[44:47]
    buffer_load_dwordx4 a[164:167], v24, s[8:11], s16 offen offset:1024
    v_mfma_f32_16x16x32_bf16 v[100:103], a[12:15], a[116:119], v[100:103]
    ds_read_b64_tr_b16 a[72:73], v8 offset:18432
    v_mfma_f32_16x16x32_bf16 v[156:159], a[12:15], a[120:123], v[156:159]
    ds_read_b64_tr_b16 a[74:75], v8 offset:18944
    v_mfma_f32_16x16x32_bf16 v[212:215], a[12:15], a[124:127], v[212:215]
    buffer_load_dwordx4 v25, s[12:15], s17 offen offset:1024 lds
    v_mfma_f32_16x16x32_bf16 v[48:51], a[16:19], a[112:115], v[48:51]
    ds_read_b64_tr_b16 a[76:77], v8 offset:19456
    v_mfma_f32_16x16x32_bf16 v[104:107], a[16:19], a[116:119], v[104:107]
    ds_read_b64_tr_b16 a[78:79], v8 offset:19968
    v_mfma_f32_16x16x32_bf16 v[160:163], a[16:19], a[120:123], v[160:163]
    v_mfma_f32_16x16x32_bf16 v[216:219], a[16:19], a[124:127], v[216:219]
    buffer_load_dwordx4 a[168:171], v24, s[8:11], s16 offen offset:2048
    v_mfma_f32_16x16x32_bf16 v[52:55], a[20:23], a[112:115], v[52:55]
    ds_read_b64_tr_b16 a[80:81], v10 offset:20480
    v_mfma_f32_16x16x32_bf16 v[108:111], a[20:23], a[116:119], v[108:111]
    ds_read_b64_tr_b16 a[82:83], v10 offset:20992
    v_mfma_f32_16x16x32_bf16 v[164:167], a[20:23], a[120:123], v[164:167]
    buffer_load_dwordx4 v25, s[12:15], s17 offen offset:2048 lds
    v_mfma_f32_16x16x32_bf16 v[220:223], a[20:23], a[124:127], v[220:223]
    ds_read_b64_tr_b16 a[84:85], v8 offset:21504
    v_mfma_f32_16x16x32_bf16 v[56:59], a[24:27], a[112:115], v[56:59]
    ds_read_b64_tr_b16 a[86:87], v8 offset:22016
    v_mfma_f32_16x16x32_bf16 v[112:115], a[24:27], a[116:119], v[112:115]
    ds_read_b64_tr_b16 a[88:89], v8 offset:22528
    v_mfma_f32_16x16x32_bf16 v[168:171], a[24:27], a[120:123], v[168:171]
    buffer_load_dwordx4 a[172:175], v24, s[8:11], s16 offen offset:3072
    v_mfma_f32_16x16x32_bf16 v[224:227], a[24:27], a[124:127], v[224:227]
    v_mfma_f32_16x16x32_bf16 v[60:63], a[28:31], a[112:115], v[60:63]
    ds_read_b64_tr_b16 a[90:91], v8 offset:23040
    v_mfma_f32_16x16x32_bf16 v[116:119], a[28:31], a[116:119], v[116:119]
    buffer_load_dwordx4 v25, s[12:15], s17 offen offset:3072 lds
    v_mfma_f32_16x16x32_bf16 v[172:175], a[28:31], a[120:123], v[172:175]
    ds_read_b64_tr_b16 a[92:93], v8 offset:23552
    v_mfma_f32_16x16x32_bf16 v[228:231], a[28:31], a[124:127], v[228:231]
    ds_read_b64_tr_b16 a[94:95], v8 offset:24064
    v_mfma_f32_16x16x32_bf16 v[64:67], a[32:35], a[112:115], v[64:67]
    ds_read_b64_tr_b16 a[96:97], v8 offset:24576
    v_mfma_f32_16x16x32_bf16 v[120:123], a[32:35], a[116:119], v[120:123]
    s_add_u32 s16, s16, 8192
    v_mfma_f32_16x16x32_bf16 v[176:179], a[32:35], a[120:123], v[176:179]
    ds_read_b64_tr_b16 a[98:99], v8 offset:25088
    v_mfma_f32_16x16x32_bf16 v[232:235], a[32:35], a[124:127], v[232:235]
    ds_read_b64_tr_b16 a[100:101], v8 offset:25600
    v_mfma_f32_16x16x32_bf16 v[68:71], a[36:39], a[112:115], v[68:71]
    s_add_u32 m0, s20, 90112
    v_mfma_f32_16x16x32_bf16 v[124:127], a[36:39], a[116:119], v[124:127]
    v_mfma_f32_16x16x32_bf16 v[180:183], a[36:39], a[120:123], v[180:183]
    ds_read_b64_tr_b16 a[102:103], v8 offset:26112
    v_mfma_f32_16x16x32_bf16 v[236:239], a[36:39], a[124:127], v[236:239]
    ds_read_b64_tr_b16 a[104:105], v8 offset:26624
    v_mfma_f32_16x16x32_bf16 v[72:75], a[40:43], a[112:115], v[72:75]
    buffer_load_dwordx4 v25, s[12:15], s21 offen lds
    v_mfma_f32_16x16x32_bf16 v[128:131], a[40:43], a[116:119], v[128:131]
    ds_read_b64_tr_b16 a[106:107], v8 offset:27136
    v_mfma_f32_16x16x32_bf16 v[184:187], a[40:43], a[120:123], v[184:187]
    ds_read_b64_tr_b16 a[108:109], v10 offset:27648
    v_mfma_f32_16x16x32_bf16 v[240:243], a[40:43], a[124:127], v[240:243]
    buffer_load_dwordx4 v25, s[12:15], s21 offen offset:1024 lds
    v_mfma_f32_16x16x32_bf16 v[76:79], a[44:47], a[112:115], v[76:79]
    ds_read_b64_tr_b16 a[110:111], v10 offset:28160
    v_mfma_f32_16x16x32_bf16 v[132:135], a[44:47], a[116:119], v[132:135]
    v_mfma_f32_16x16x32_bf16 v[188:191], a[44:47], a[120:123], v[188:191]
    v_mfma_f32_16x16x32_bf16 v[244:247], a[44:47], a[124:127], v[244:247]
    buffer_load_dwordx4 v25, s[12:15], s21 offen offset:2048 lds
    v_mfma_f32_16x16x32_bf16 v[80:83], a[48:51], a[112:115], v[80:83]
    v_mfma_f32_16x16x32_bf16 v[136:139], a[48:51], a[116:119], v[136:139]
    v_mfma_f32_16x16x32_bf16 v[192:195], a[48:51], a[120:123], v[192:195]
    s_add_u32 s17, s17, 28672
    v_mfma_f32_16x16x32_bf16 v[248:251], a[48:51], a[124:127], v[248:251]
    v_mfma_f32_16x16x32_bf16 v[84:87], a[52:55], a[112:115], v[84:87]
    v_mfma_f32_16x16x32_bf16 v[140:143], a[52:55], a[116:119], v[140:143]
    v_mfma_f32_16x16x32_bf16 v[196:199], a[52:55], a[120:123], v[196:199]
    s_add_u32 s21, s21, 28672
    v_mfma_f32_16x16x32_bf16 v[252:255], a[52:55], a[124:127], v[252:255]
    s_waitcnt vmcnt(22) lgkmcnt(0)
    v_mfma_f32_16x16x32_bf16 v[32:35], a[56:59], a[128:131], v[32:35]
    ds_read_b64_tr_b16 a[0:1], v8 offset:28672
    v_mfma_f32_16x16x32_bf16 v[88:91], a[56:59], a[132:135], v[88:91]
    ds_read_b64_tr_b16 a[2:3], v8 offset:29184
    v_mfma_f32_16x16x32_bf16 v[144:147], a[56:59], a[136:139], v[144:147]
    v_mfma_f32_16x16x32_bf16 v[200:203], a[56:59], a[140:143], v[200:203]
    ds_read_b64_tr_b16 a[4:5], v8 offset:29696
    v_mfma_f32_16x16x32_bf16 v[36:39], a[60:63], a[128:131], v[36:39]
    ds_read_b64_tr_b16 a[6:7], v8 offset:30208
    v_mfma_f32_16x16x32_bf16 v[92:95], a[60:63], a[132:135], v[92:95]
    buffer_load_dwordx4 a[112:115], v24, s[8:11], s16 offen offset:0
    v_mfma_f32_16x16x32_bf16 v[148:151], a[60:63], a[136:139], v[148:151]
    v_mfma_f32_16x16x32_bf16 v[204:207], a[60:63], a[140:143], v[204:207]
    ds_read_b64_tr_b16 a[8:9], v8 offset:30720
    v_mfma_f32_16x16x32_bf16 v[40:43], a[64:67], a[128:131], v[40:43]
    ds_read_b64_tr_b16 a[10:11], v8 offset:31232
    v_mfma_f32_16x16x32_bf16 v[96:99], a[64:67], a[132:135], v[96:99]
    v_mfma_f32_16x16x32_bf16 v[152:155], a[64:67], a[136:139], v[152:155]
    ds_read_b64_tr_b16 a[12:13], v8 offset:31744
    v_mfma_f32_16x16x32_bf16 v[208:211], a[64:67], a[140:143], v[208:211]
    ds_read_b64_tr_b16 a[14:15], v8 offset:32256
    v_mfma_f32_16x16x32_bf16 v[44:47], a[68:71], a[128:131], v[44:47]
    v_mfma_f32_16x16x32_bf16 v[100:103], a[68:71], a[132:135], v[100:103]
    ds_read_b64_tr_b16 a[16:17], v8 offset:32768
    v_mfma_f32_16x16x32_bf16 v[156:159], a[68:71], a[136:139], v[156:159]
    ds_read_b64_tr_b16 a[18:19], v8 offset:33280
    v_mfma_f32_16x16x32_bf16 v[212:215], a[68:71], a[140:143], v[212:215]
    v_mfma_f32_16x16x32_bf16 v[48:51], a[72:75], a[128:131], v[48:51]
    buffer_load_dwordx4 a[116:119], v24, s[8:11], s16 offen offset:1024
    v_mfma_f32_16x16x32_bf16 v[104:107], a[72:75], a[132:135], v[104:107]
    ds_read_b64_tr_b16 a[20:21], v8 offset:33792
    v_mfma_f32_16x16x32_bf16 v[160:163], a[72:75], a[136:139], v[160:163]
    ds_read_b64_tr_b16 a[22:23], v8 offset:34304
    v_mfma_f32_16x16x32_bf16 v[216:219], a[72:75], a[140:143], v[216:219]
    v_mfma_f32_16x16x32_bf16 v[52:55], a[76:79], a[128:131], v[52:55]
    ds_read_b64_tr_b16 a[24:25], v10 offset:34816
    v_mfma_f32_16x16x32_bf16 v[108:111], a[76:79], a[132:135], v[108:111]
    ds_read_b64_tr_b16 a[26:27], v10 offset:35328
    v_mfma_f32_16x16x32_bf16 v[164:167], a[76:79], a[136:139], v[164:167]
    v_mfma_f32_16x16x32_bf16 v[220:223], a[76:79], a[140:143], v[220:223]
    ds_read_b64_tr_b16 a[28:29], v8 offset:35840
    v_mfma_f32_16x16x32_bf16 v[56:59], a[80:83], a[128:131], v[56:59]
    ds_read_b64_tr_b16 a[30:31], v8 offset:36352
    v_mfma_f32_16x16x32_bf16 v[112:115], a[80:83], a[132:135], v[112:115]
    v_mfma_f32_16x16x32_bf16 v[168:171], a[80:83], a[136:139], v[168:171]
    ds_read_b64_tr_b16 a[32:33], v8 offset:36864
    v_mfma_f32_16x16x32_bf16 v[224:227], a[80:83], a[140:143], v[224:227]
    ds_read_b64_tr_b16 a[34:35], v8 offset:37376
    v_mfma_f32_16x16x32_bf16 v[60:63], a[84:87], a[128:131], v[60:63]
    buffer_load_dwordx4 a[120:123], v24, s[8:11], s16 offen offset:2048
    v_mfma_f32_16x16x32_bf16 v[116:119], a[84:87], a[132:135], v[116:119]
    v_mfma_f32_16x16x32_bf16 v[172:175], a[84:87], a[136:139], v[172:175]
    ds_read_b64_tr_b16 a[36:37], v8 offset:37888
    v_mfma_f32_16x16x32_bf16 v[228:231], a[84:87], a[140:143], v[228:231]
    ds_read_b64_tr_b16 a[38:39], v8 offset:38400
    v_mfma_f32_16x16x32_bf16 v[64:67], a[88:91], a[128:131], v[64:67]
    v_mfma_f32_16x16x32_bf16 v[120:123], a[88:91], a[132:135], v[120:123]
    ds_read_b64_tr_b16 a[40:41], v8 offset:38912
    v_mfma_f32_16x16x32_bf16 v[176:179], a[88:91], a[136:139], v[176:179]
    ds_read_b64_tr_b16 a[42:43], v8 offset:39424
    v_mfma_f32_16x16x32_bf16 v[232:235], a[88:91], a[140:143], v[232:235]
    v_mfma_f32_16x16x32_bf16 v[68:71], a[92:95], a[128:131], v[68:71]
    ds_read_b64_tr_b16 a[44:45], v8 offset:39936
    v_mfma_f32_16x16x32_bf16 v[124:127], a[92:95], a[132:135], v[124:127]
    ds_read_b64_tr_b16 a[46:47], v8 offset:40448
    v_mfma_f32_16x16x32_bf16 v[180:183], a[92:95], a[136:139], v[180:183]
    v_mfma_f32_16x16x32_bf16 v[236:239], a[92:95], a[140:143], v[236:239]
    buffer_load_dwordx4 a[124:127], v24, s[8:11], s16 offen offset:3072
    v_mfma_f32_16x16x32_bf16 v[72:75], a[96:99], a[128:131], v[72:75]
    ds_read_b64_tr_b16 a[48:49], v8 offset:40960
    v_mfma_f32_16x16x32_bf16 v[128:131], a[96:99], a[132:135], v[128:131]
    ds_read_b64_tr_b16 a[50:51], v8 offset:41472
    v_mfma_f32_16x16x32_bf16 v[184:187], a[96:99], a[136:139], v[184:187]
    v_mfma_f32_16x16x32_bf16 v[240:243], a[96:99], a[140:143], v[240:243]
    ds_read_b64_tr_b16 a[52:53], v10 offset:41984
    v_mfma_f32_16x16x32_bf16 v[76:79], a[100:103], a[128:131], v[76:79]
    ds_read_b64_tr_b16 a[54:55], v10 offset:42496
    v_mfma_f32_16x16x32_bf16 v[132:135], a[100:103], a[132:135], v[132:135]
    v_mfma_f32_16x16x32_bf16 v[188:191], a[100:103], a[136:139], v[188:191]
    v_mfma_f32_16x16x32_bf16 v[244:247], a[100:103], a[140:143], v[244:247]
    v_mfma_f32_16x16x32_bf16 v[80:83], a[104:107], a[128:131], v[80:83]
    v_mfma_f32_16x16x32_bf16 v[136:139], a[104:107], a[132:135], v[136:139]
    v_mfma_f32_16x16x32_bf16 v[192:195], a[104:107], a[136:139], v[192:195]
    s_add_u32 s16, s16, 8192
    v_mfma_f32_16x16x32_bf16 v[248:251], a[104:107], a[140:143], v[248:251]
    v_mfma_f32_16x16x32_bf16 v[84:87], a[108:111], a[128:131], v[84:87]
    v_mfma_f32_16x16x32_bf16 v[140:143], a[108:111], a[132:135], v[140:143]
    v_mfma_f32_16x16x32_bf16 v[196:199], a[108:111], a[136:139], v[196:199]
    v_mfma_f32_16x16x32_bf16 v[252:255], a[108:111], a[140:143], v[252:255]
    s_waitcnt vmcnt(19) lgkmcnt(0)
    v_mfma_f32_16x16x32_bf16 v[32:35], a[0:3], a[144:147], v[32:35]
    ds_read_b64_tr_b16 a[56:57], v8 offset:43008
    v_mfma_f32_16x16x32_bf16 v[88:91], a[0:3], a[148:151], v[88:91]
    ds_read_b64_tr_b16 a[58:59], v8 offset:43520
    v_mfma_f32_16x16x32_bf16 v[144:147], a[0:3], a[152:155], v[144:147]
    v_mfma_f32_16x16x32_bf16 v[200:203], a[0:3], a[156:159], v[200:203]
    ds_read_b64_tr_b16 a[60:61], v8 offset:44032
    v_mfma_f32_16x16x32_bf16 v[36:39], a[4:7], a[144:147], v[36:39]
    ds_read_b64_tr_b16 a[62:63], v8 offset:44544
    v_mfma_f32_16x16x32_bf16 v[92:95], a[4:7], a[148:151], v[92:95]
    buffer_load_dwordx4 a[128:131], v24, s[8:11], s16 offen offset:0
    v_mfma_f32_16x16x32_bf16 v[148:151], a[4:7], a[152:155], v[148:151]
    v_mfma_f32_16x16x32_bf16 v[204:207], a[4:7], a[156:159], v[204:207]
    ds_read_b64_tr_b16 a[64:65], v8 offset:45056
    v_mfma_f32_16x16x32_bf16 v[40:43], a[8:11], a[144:147], v[40:43]
    ds_read_b64_tr_b16 a[66:67], v8 offset:45568
    v_mfma_f32_16x16x32_bf16 v[96:99], a[8:11], a[148:151], v[96:99]
    v_mfma_f32_16x16x32_bf16 v[152:155], a[8:11], a[152:155], v[152:155]
    ds_read_b64_tr_b16 a[68:69], v8 offset:46080
    v_mfma_f32_16x16x32_bf16 v[208:211], a[8:11], a[156:159], v[208:211]
    ds_read_b64_tr_b16 a[70:71], v8 offset:46592
    v_mfma_f32_16x16x32_bf16 v[44:47], a[12:15], a[144:147], v[44:47]
    v_mfma_f32_16x16x32_bf16 v[100:103], a[12:15], a[148:151], v[100:103]
    ds_read_b64_tr_b16 a[72:73], v8 offset:47104
    v_mfma_f32_16x16x32_bf16 v[156:159], a[12:15], a[152:155], v[156:159]
    ds_read_b64_tr_b16 a[74:75], v8 offset:47616
    v_mfma_f32_16x16x32_bf16 v[212:215], a[12:15], a[156:159], v[212:215]
    v_mfma_f32_16x16x32_bf16 v[48:51], a[16:19], a[144:147], v[48:51]
    buffer_load_dwordx4 a[132:135], v24, s[8:11], s16 offen offset:1024
    v_mfma_f32_16x16x32_bf16 v[104:107], a[16:19], a[148:151], v[104:107]
    ds_read_b64_tr_b16 a[76:77], v8 offset:48128
    v_mfma_f32_16x16x32_bf16 v[160:163], a[16:19], a[152:155], v[160:163]
    ds_read_b64_tr_b16 a[78:79], v8 offset:48640
    v_mfma_f32_16x16x32_bf16 v[216:219], a[16:19], a[156:159], v[216:219]
    v_mfma_f32_16x16x32_bf16 v[52:55], a[20:23], a[144:147], v[52:55]
    ds_read_b64_tr_b16 a[80:81], v10 offset:49152
    v_mfma_f32_16x16x32_bf16 v[108:111], a[20:23], a[148:151], v[108:111]
    ds_read_b64_tr_b16 a[82:83], v10 offset:49664
    v_mfma_f32_16x16x32_bf16 v[164:167], a[20:23], a[152:155], v[164:167]
    v_mfma_f32_16x16x32_bf16 v[220:223], a[20:23], a[156:159], v[220:223]
    ds_read_b64_tr_b16 a[84:85], v8 offset:50176
    v_mfma_f32_16x16x32_bf16 v[56:59], a[24:27], a[144:147], v[56:59]
    ds_read_b64_tr_b16 a[86:87], v8 offset:50688
    v_mfma_f32_16x16x32_bf16 v[112:115], a[24:27], a[148:151], v[112:115]
    v_mfma_f32_16x16x32_bf16 v[168:171], a[24:27], a[152:155], v[168:171]
    ds_read_b64_tr_b16 a[88:89], v8 offset:51200
    v_mfma_f32_16x16x32_bf16 v[224:227], a[24:27], a[156:159], v[224:227]
    ds_read_b64_tr_b16 a[90:91], v8 offset:51712
    v_mfma_f32_16x16x32_bf16 v[60:63], a[28:31], a[144:147], v[60:63]
    buffer_load_dwordx4 a[136:139], v24, s[8:11], s16 offen offset:2048
    v_mfma_f32_16x16x32_bf16 v[116:119], a[28:31], a[148:151], v[116:119]
    v_mfma_f32_16x16x32_bf16 v[172:175], a[28:31], a[152:155], v[172:175]
    ds_read_b64_tr_b16 a[92:93], v8 offset:52224
    v_mfma_f32_16x16x32_bf16 v[228:231], a[28:31], a[156:159], v[228:231]
    ds_read_b64_tr_b16 a[94:95], v8 offset:52736
    v_mfma_f32_16x16x32_bf16 v[64:67], a[32:35], a[144:147], v[64:67]
    v_mfma_f32_16x16x32_bf16 v[120:123], a[32:35], a[148:151], v[120:123]
    ds_read_b64_tr_b16 a[96:97], v8 offset:53248
    v_mfma_f32_16x16x32_bf16 v[176:179], a[32:35], a[152:155], v[176:179]
    ds_read_b64_tr_b16 a[98:99], v8 offset:53760
    v_mfma_f32_16x16x32_bf16 v[232:235], a[32:35], a[156:159], v[232:235]
    v_mfma_f32_16x16x32_bf16 v[68:71], a[36:39], a[144:147], v[68:71]
    ds_read_b64_tr_b16 a[100:101], v8 offset:54272
    v_mfma_f32_16x16x32_bf16 v[124:127], a[36:39], a[148:151], v[124:127]
    ds_read_b64_tr_b16 a[102:103], v8 offset:54784
    v_mfma_f32_16x16x32_bf16 v[180:183], a[36:39], a[152:155], v[180:183]
    v_mfma_f32_16x16x32_bf16 v[236:239], a[36:39], a[156:159], v[236:239]
    buffer_load_dwordx4 a[140:143], v24, s[8:11], s16 offen offset:3072
    v_mfma_f32_16x16x32_bf16 v[72:75], a[40:43], a[144:147], v[72:75]
    ds_read_b64_tr_b16 a[104:105], v8 offset:55296
    v_mfma_f32_16x16x32_bf16 v[128:131], a[40:43], a[148:151], v[128:131]
    ds_read_b64_tr_b16 a[106:107], v8 offset:55808
    v_mfma_f32_16x16x32_bf16 v[184:187], a[40:43], a[152:155], v[184:187]
    v_mfma_f32_16x16x32_bf16 v[240:243], a[40:43], a[156:159], v[240:243]
    ds_read_b64_tr_b16 a[108:109], v10 offset:56320
    v_mfma_f32_16x16x32_bf16 v[76:79], a[44:47], a[144:147], v[76:79]
    ds_read_b64_tr_b16 a[110:111], v10 offset:56832
    v_mfma_f32_16x16x32_bf16 v[132:135], a[44:47], a[148:151], v[132:135]
    v_mfma_f32_16x16x32_bf16 v[188:191], a[44:47], a[152:155], v[188:191]
    v_mfma_f32_16x16x32_bf16 v[244:247], a[44:47], a[156:159], v[244:247]
    v_mfma_f32_16x16x32_bf16 v[80:83], a[48:51], a[144:147], v[80:83]
    v_mfma_f32_16x16x32_bf16 v[136:139], a[48:51], a[148:151], v[136:139]
    v_mfma_f32_16x16x32_bf16 v[192:195], a[48:51], a[152:155], v[192:195]
    s_add_u32 s16, s16, 8192
    v_mfma_f32_16x16x32_bf16 v[248:251], a[48:51], a[156:159], v[248:251]
    v_mfma_f32_16x16x32_bf16 v[84:87], a[52:55], a[144:147], v[84:87]
    v_mfma_f32_16x16x32_bf16 v[140:143], a[52:55], a[148:151], v[140:143]
    v_mfma_f32_16x16x32_bf16 v[196:199], a[52:55], a[152:155], v[196:199]
    v_mfma_f32_16x16x32_bf16 v[252:255], a[52:55], a[156:159], v[252:255]
    s_waitcnt vmcnt(8) lgkmcnt(0)
    s_barrier
    v_mfma_f32_16x16x32_bf16 v[32:35], a[56:59], a[160:163], v[32:35]
    ds_read_b64_tr_b16 a[0:1], v9 offset:0
    buffer_load_dwordx4 a[144:147], v24, s[8:11], s16 offen offset:0
    v_mfma_f32_16x16x32_bf16 v[88:91], a[56:59], a[164:167], v[88:91]
    ds_read_b64_tr_b16 a[2:3], v9 offset:512
    v_mfma_f32_16x16x32_bf16 v[144:147], a[56:59], a[168:171], v[144:147]
    s_mov_b32 s12, s76
    v_mfma_f32_16x16x32_bf16 v[200:203], a[56:59], a[172:175], v[200:203]
    ds_read_b64_tr_b16 a[4:5], v9 offset:1024
    v_mfma_f32_16x16x32_bf16 v[36:39], a[60:63], a[160:163], v[36:39]
    ds_read_b64_tr_b16 a[6:7], v9 offset:1536
    buffer_load_dwordx4 a[148:151], v24, s[8:11], s16 offen offset:1024
    v_mfma_f32_16x16x32_bf16 v[92:95], a[60:63], a[164:167], v[92:95]
    v_mfma_f32_16x16x32_bf16 v[148:151], a[60:63], a[168:171], v[148:151]
    ds_read_b64_tr_b16 a[8:9], v9 offset:2048
    s_mov_b32 s13, s77
    v_mfma_f32_16x16x32_bf16 v[204:207], a[60:63], a[172:175], v[204:207]
    buffer_load_dwordx4 a[152:155], v24, s[8:11], s16 offen offset:2048
    v_mfma_f32_16x16x32_bf16 v[40:43], a[64:67], a[160:163], v[40:43]
    ds_read_b64_tr_b16 a[10:11], v9 offset:2560
    v_mfma_f32_16x16x32_bf16 v[96:99], a[64:67], a[164:167], v[96:99]
    ds_read_b64_tr_b16 a[12:13], v9 offset:3072
    s_mov_b32 s14, 0x700000
    v_mfma_f32_16x16x32_bf16 v[152:155], a[64:67], a[168:171], v[152:155]
    v_mfma_f32_16x16x32_bf16 v[208:211], a[64:67], a[172:175], v[208:211]
    ds_read_b64_tr_b16 a[14:15], v9 offset:3584
    buffer_load_dwordx4 a[156:159], v24, s[8:11], s16 offen offset:3072
    v_mfma_f32_16x16x32_bf16 v[44:47], a[68:71], a[160:163], v[44:47]
    v_mfma_f32_16x16x32_bf16 v[100:103], a[68:71], a[164:167], v[100:103]
    ds_read_b64_tr_b16 a[16:17], v9 offset:4096
    s_mov_b32 s15, 0x20000
    v_mfma_f32_16x16x32_bf16 v[156:159], a[68:71], a[168:171], v[156:159]
    ds_read_b64_tr_b16 a[18:19], v9 offset:4608
    s_add_u32 s16, s16, 8192
    v_mfma_f32_16x16x32_bf16 v[212:215], a[68:71], a[172:175], v[212:215]
    v_mfma_f32_16x16x32_bf16 v[48:51], a[72:75], a[160:163], v[48:51]
    ds_read_b64_tr_b16 a[20:21], v9 offset:5120
    v_lshrrev_b32 v2, 3, v1
    v_mfma_f32_16x16x32_bf16 v[104:107], a[72:75], a[164:167], v[104:107]
    v_mfma_f32_16x16x32_bf16 v[160:163], a[72:75], a[168:171], v[160:163]
    ds_read_b64_tr_b16 a[22:23], v9 offset:5632
    v_mul_u32_u24 v4, 2048, v2
    v_mfma_f32_16x16x32_bf16 v[216:219], a[72:75], a[172:175], v[216:219]
    ds_read_b64_tr_b16 a[24:25], v11 offset:6144
    v_mfma_f32_16x16x32_bf16 v[52:55], a[76:79], a[160:163], v[52:55]
    v_bfe_u32 v2, v1, 4, 2
    v_mfma_f32_16x16x32_bf16 v[108:111], a[76:79], a[164:167], v[108:111]
    ds_read_b64_tr_b16 a[26:27], v11 offset:6656
    v_lshlrev_b32 v2, 1, v2
    v_mfma_f32_16x16x32_bf16 v[164:167], a[76:79], a[168:171], v[164:167]
    v_mfma_f32_16x16x32_bf16 v[220:223], a[76:79], a[172:175], v[220:223]
    ds_read_b64_tr_b16 a[28:29], v9 offset:7168
    v_and_b32 v3, 7, v1
    v_mfma_f32_16x16x32_bf16 v[56:59], a[80:83], a[160:163], v[56:59]
    ds_read_b64_tr_b16 a[30:31], v9 offset:7680
    v_mfma_f32_16x16x32_bf16 v[112:115], a[80:83], a[164:167], v[112:115]
    v_xor_b32 v2, v2, v3
    v_mfma_f32_16x16x32_bf16 v[168:171], a[80:83], a[168:171], v[168:171]
    ds_read_b64_tr_b16 a[32:33], v9 offset:8192
    v_mfma_f32_16x16x32_bf16 v[224:227], a[80:83], a[172:175], v[224:227]
    ds_read_b64_tr_b16 a[34:35], v9 offset:8704
    v_lshl_add_u32 v4, v2, 4, v4
    v_mfma_f32_16x16x32_bf16 v[60:63], a[84:87], a[160:163], v[60:63]
    s_mul_i32 s5, s3, 16384
    v_mfma_f32_16x16x32_bf16 v[116:119], a[84:87], a[164:167], v[116:119]
    ds_read_b64_tr_b16 a[36:37], v9 offset:9216
    v_mfma_f32_16x16x32_bf16 v[172:175], a[84:87], a[168:171], v[172:175]
    s_lshr_b32 s6, s29, 2
    v_mfma_f32_16x16x32_bf16 v[228:231], a[84:87], a[172:175], v[228:231]
    ds_read_b64_tr_b16 a[38:39], v9 offset:9728
    v_mfma_f32_16x16x32_bf16 v[64:67], a[88:91], a[160:163], v[64:67]
    ds_read_b64_tr_b16 a[40:41], v9 offset:10240
    s_lshl_b32 s6, s6, 8
    v_mfma_f32_16x16x32_bf16 v[120:123], a[88:91], a[164:167], v[120:123]
    v_mfma_f32_16x16x32_bf16 v[176:179], a[88:91], a[168:171], v[176:179]
    ds_read_b64_tr_b16 a[42:43], v9 offset:10752
    s_add_u32 s5, s5, s6
    v_mfma_f32_16x16x32_bf16 v[232:235], a[88:91], a[172:175], v[232:235]
    v_add_u32 v26, s5, v4
    v_mfma_f32_16x16x32_bf16 v[68:71], a[92:95], a[160:163], v[68:71]
    ds_read_b64_tr_b16 a[44:45], v9 offset:11264
    v_mfma_f32_16x16x32_bf16 v[124:127], a[92:95], a[164:167], v[124:127]
    ds_read_b64_tr_b16 a[46:47], v9 offset:11776
    v_add_u32 v27, 128, v26
    v_mfma_f32_16x16x32_bf16 v[180:183], a[92:95], a[168:171], v[180:183]
    v_mfma_f32_16x16x32_bf16 v[236:239], a[92:95], a[172:175], v[236:239]
    ds_read_b64_tr_b16 a[48:49], v9 offset:12288
    v_add_u32 v28, 65536, v26
    v_mfma_f32_16x16x32_bf16 v[72:75], a[96:99], a[160:163], v[72:75]
    v_mfma_f32_16x16x32_bf16 v[128:131], a[96:99], a[164:167], v[128:131]
    ds_read_b64_tr_b16 a[50:51], v9 offset:12800
    v_add_u32 v29, 65536, v27
    v_mfma_f32_16x16x32_bf16 v[184:187], a[96:99], a[168:171], v[184:187]
    ds_read_b64_tr_b16 a[52:53], v11 offset:13312
    s_lshr_b32 s17, s28, 1
    v_mfma_f32_16x16x32_bf16 v[240:243], a[96:99], a[172:175], v[240:243]
    v_mfma_f32_16x16x32_bf16 v[76:79], a[100:103], a[160:163], v[76:79]
    ds_read_b64_tr_b16 a[54:55], v11 offset:13824
    s_mul_i32 s17, s17, 1835008
    v_mfma_f32_16x16x32_bf16 v[132:135], a[100:103], a[164:167], v[132:135]
    v_mfma_f32_16x16x32_bf16 v[188:191], a[100:103], a[168:171], v[188:191]
    s_lshl_b32 s20, s3, 10
    v_mfma_f32_16x16x32_bf16 v[244:247], a[100:103], a[172:175], v[244:247]
    s_add_u32 m0, s20, 114688
    v_mfma_f32_16x16x32_bf16 v[80:83], a[104:107], a[160:163], v[80:83]
    buffer_load_dwordx4 v26, s[12:15], s17 offen lds
    s_add_u32 m0, s20, 118784
    v_mfma_f32_16x16x32_bf16 v[136:139], a[104:107], a[164:167], v[136:139]
    buffer_load_dwordx4 v27, s[12:15], s17 offen lds
    v_mfma_f32_16x16x32_bf16 v[192:195], a[104:107], a[168:171], v[192:195]
    s_add_u32 m0, s20, 122880
    v_mfma_f32_16x16x32_bf16 v[248:251], a[104:107], a[172:175], v[248:251]
    buffer_load_dwordx4 v28, s[12:15], s17 offen lds
    v_mfma_f32_16x16x32_bf16 v[84:87], a[108:111], a[160:163], v[84:87]
    s_add_u32 m0, s20, 126976
    v_mfma_f32_16x16x32_bf16 v[140:143], a[108:111], a[164:167], v[140:143]
    buffer_load_dwordx4 v29, s[12:15], s17 offen lds
    v_mfma_f32_16x16x32_bf16 v[196:199], a[108:111], a[168:171], v[196:199]
    v_mfma_f32_16x16x32_bf16 v[252:255], a[108:111], a[172:175], v[252:255]
    s_add_u32 s17, s17, 131072
    s_waitcnt vmcnt(12) lgkmcnt(0)
    v_mfma_f32_16x16x32_bf16 v[32:35], a[0:3], a[112:115], v[32:35]
    ds_read_b64_tr_b16 a[56:57], v9 offset:14336
    buffer_load_dwordx4 a[160:163], v24, s[8:11], s16 offen offset:0
    v_mfma_f32_16x16x32_bf16 v[88:91], a[0:3], a[116:119], v[88:91]
    ds_read_b64_tr_b16 a[58:59], v9 offset:14848
    s_add_u32 m0, s20, 131072
    v_mfma_f32_16x16x32_bf16 v[144:147], a[0:3], a[120:123], v[144:147]
    buffer_load_dwordx4 v26, s[12:15], s17 offen lds
    v_mfma_f32_16x16x32_bf16 v[200:203], a[0:3], a[124:127], v[200:203]
    ds_read_b64_tr_b16 a[60:61], v9 offset:15360
    v_mfma_f32_16x16x32_bf16 v[36:39], a[4:7], a[112:115], v[36:39]
    ds_read_b64_tr_b16 a[62:63], v9 offset:15872
    buffer_load_dwordx4 a[164:167], v24, s[8:11], s16 offen offset:1024
    v_mfma_f32_16x16x32_bf16 v[92:95], a[4:7], a[116:119], v[92:95]
    s_add_u32 m0, s20, 135168
    v_mfma_f32_16x16x32_bf16 v[148:151], a[4:7], a[120:123], v[148:151]
    ds_read_b64_tr_b16 a[64:65], v9 offset:16384
    buffer_load_dwordx4 v27, s[12:15], s17 offen lds
    v_mfma_f32_16x16x32_bf16 v[204:207], a[4:7], a[124:127], v[204:207]
    v_mfma_f32_16x16x32_bf16 v[40:43], a[8:11], a[112:115], v[40:43]
    ds_read_b64_tr_b16 a[66:67], v9 offset:16896
    buffer_load_dwordx4 a[168:171], v24, s[8:11], s16 offen offset:2048
    s_add_u32 m0, s20, 139264
    v_mfma_f32_16x16x32_bf16 v[96:99], a[8:11], a[116:119], v[96:99]
    ds_read_b64_tr_b16 a[68:69], v9 offset:17408
    buffer_load_dwordx4 v28, s[12:15], s17 offen lds
    v_mfma_f32_16x16x32_bf16 v[152:155], a[8:11], a[120:123], v[152:155]
    v_mfma_f32_16x16x32_bf16 v[208:211], a[8:11], a[124:127], v[208:211]
    ds_read_b64_tr_b16 a[70:71], v9 offset:17920
    buffer_load_dwordx4 a[172:175], v24, s[8:11], s16 offen offset:3072
    v_mfma_f32_16x16x32_bf16 v[44:47], a[12:15], a[112:115], v[44:47]
    s_add_u32 m0, s20, 143360
    v_mfma_f32_16x16x32_bf16 v[100:103], a[12:15], a[116:119], v[100:103]
    ds_read_b64_tr_b16 a[72:73], v9 offset:18432
    buffer_load_dwordx4 v29, s[12:15], s17 offen lds
    v_mfma_f32_16x16x32_bf16 v[156:159], a[12:15], a[120:123], v[156:159]
    ds_read_b64_tr_b16 a[74:75], v9 offset:18944
    v_mfma_f32_16x16x32_bf16 v[212:215], a[12:15], a[124:127], v[212:215]
    s_add_u32 s16, s16, 8192
    v_mfma_f32_16x16x32_bf16 v[48:51], a[16:19], a[112:115], v[48:51]
    ds_read_b64_tr_b16 a[76:77], v9 offset:19456
    v_mfma_f32_16x16x32_bf16 v[104:107], a[16:19], a[116:119], v[104:107]
    s_add_u32 s17, s17, 131072
    s_add_u32 m0, s20, 147456
    v_mfma_f32_16x16x32_bf16 v[160:163], a[16:19], a[120:123], v[160:163]
    ds_read_b64_tr_b16 a[78:79], v9 offset:19968
    buffer_load_dwordx4 v26, s[12:15], s17 offen lds
    v_mfma_f32_16x16x32_bf16 v[216:219], a[16:19], a[124:127], v[216:219]
    ds_read_b64_tr_b16 a[80:81], v11 offset:20480
    s_add_u32 m0, s20, 151552
    v_mfma_f32_16x16x32_bf16 v[52:55], a[20:23], a[112:115], v[52:55]
    buffer_load_dwordx4 v27, s[12:15], s17 offen lds
    v_mfma_f32_16x16x32_bf16 v[108:111], a[20:23], a[116:119], v[108:111]
    ds_read_b64_tr_b16 a[82:83], v11 offset:20992
    s_add_u32 m0, s20, 155648
    v_mfma_f32_16x16x32_bf16 v[164:167], a[20:23], a[120:123], v[164:167]
    buffer_load_dwordx4 v28, s[12:15], s17 offen lds
    v_mfma_f32_16x16x32_bf16 v[220:223], a[20:23], a[124:127], v[220:223]
    ds_read_b64_tr_b16 a[84:85], v9 offset:21504
    s_add_u32 m0, s20, 159744
    v_mfma_f32_16x16x32_bf16 v[56:59], a[24:27], a[112:115], v[56:59]
    ds_read_b64_tr_b16 a[86:87], v9 offset:22016
    buffer_load_dwordx4 v29, s[12:15], s17 offen lds
    v_mfma_f32_16x16x32_bf16 v[112:115], a[24:27], a[116:119], v[112:115]
    v_mfma_f32_16x16x32_bf16 v[168:171], a[24:27], a[120:123], v[168:171]
    ds_read_b64_tr_b16 a[88:89], v9 offset:22528
    s_add_u32 s17, s17, 131072
    v_mfma_f32_16x16x32_bf16 v[224:227], a[24:27], a[124:127], v[224:227]
    ds_read_b64_tr_b16 a[90:91], v9 offset:23040
    s_add_u32 m0, s20, 0
    v_mfma_f32_16x16x32_bf16 v[60:63], a[28:31], a[112:115], v[60:63]
    buffer_load_dwordx4 v26, s[12:15], s17 offen lds
    s_add_u32 m0, s20, 4096
    v_mfma_f32_16x16x32_bf16 v[116:119], a[28:31], a[116:119], v[116:119]
    ds_read_b64_tr_b16 a[92:93], v9 offset:23552
    buffer_load_dwordx4 v27, s[12:15], s17 offen lds
    v_mfma_f32_16x16x32_bf16 v[172:175], a[28:31], a[120:123], v[172:175]
    s_add_u32 m0, s20, 8192
    v_mfma_f32_16x16x32_bf16 v[228:231], a[28:31], a[124:127], v[228:231]
    ds_read_b64_tr_b16 a[94:95], v9 offset:24064
    buffer_load_dwordx4 v28, s[12:15], s17 offen lds
    v_mfma_f32_16x16x32_bf16 v[64:67], a[32:35], a[112:115], v[64:67]
    ds_read_b64_tr_b16 a[96:97], v9 offset:24576
    s_add_u32 m0, s20, 12288
    v_mfma_f32_16x16x32_bf16 v[120:123], a[32:35], a[116:119], v[120:123]
    buffer_load_dwordx4 v29, s[12:15], s17 offen lds
    v_mfma_f32_16x16x32_bf16 v[176:179], a[32:35], a[120:123], v[176:179]
    ds_read_b64_tr_b16 a[98:99], v9 offset:25088
    v_mfma_f32_16x16x32_bf16 v[232:235], a[32:35], a[124:127], v[232:235]
    s_add_u32 s17, s17, 131072
    v_mfma_f32_16x16x32_bf16 v[68:71], a[36:39], a[112:115], v[68:71]
    ds_read_b64_tr_b16 a[100:101], v9 offset:25600
    s_add_u32 m0, s20, 16384
    v_mfma_f32_16x16x32_bf16 v[124:127], a[36:39], a[116:119], v[124:127]
    ds_read_b64_tr_b16 a[102:103], v9 offset:26112
    buffer_load_dwordx4 v26, s[12:15], s17 offen lds
    s_add_u32 m0, s20, 20480
    v_mfma_f32_16x16x32_bf16 v[180:183], a[36:39], a[120:123], v[180:183]
    buffer_load_dwordx4 v27, s[12:15], s17 offen lds
    v_mfma_f32_16x16x32_bf16 v[236:239], a[36:39], a[124:127], v[236:239]
    ds_read_b64_tr_b16 a[104:105], v9 offset:26624
    s_add_u32 m0, s20, 24576
    v_mfma_f32_16x16x32_bf16 v[72:75], a[40:43], a[112:115], v[72:75]
    buffer_load_dwordx4 v28, s[12:15], s17 offen lds
    v_mfma_f32_16x16x32_bf16 v[128:131], a[40:43], a[116:119], v[128:131]
    ds_read_b64_tr_b16 a[106:107], v9 offset:27136
    s_add_u32 m0, s20, 28672
    v_mfma_f32_16x16x32_bf16 v[184:187], a[40:43], a[120:123], v[184:187]
    ds_read_b64_tr_b16 a[108:109], v11 offset:27648
    buffer_load_dwordx4 v29, s[12:15], s17 offen lds
    v_mfma_f32_16x16x32_bf16 v[240:243], a[40:43], a[124:127], v[240:243]
    v_mfma_f32_16x16x32_bf16 v[76:79], a[44:47], a[112:115], v[76:79]
    ds_read_b64_tr_b16 a[110:111], v11 offset:28160
    s_add_u32 s17, s17, 131072
    v_mfma_f32_16x16x32_bf16 v[132:135], a[44:47], a[116:119], v[132:135]
    s_add_u32 m0, s20, 32768
    v_mfma_f32_16x16x32_bf16 v[188:191], a[44:47], a[120:123], v[188:191]
    buffer_load_dwordx4 v26, s[12:15], s17 offen lds
    s_add_u32 m0, s20, 36864
    v_mfma_f32_16x16x32_bf16 v[244:247], a[44:47], a[124:127], v[244:247]
    buffer_load_dwordx4 v27, s[12:15], s17 offen lds
    v_mfma_f32_16x16x32_bf16 v[80:83], a[48:51], a[112:115], v[80:83]
    s_add_u32 m0, s20, 40960
    v_mfma_f32_16x16x32_bf16 v[136:139], a[48:51], a[116:119], v[136:139]
    buffer_load_dwordx4 v28, s[12:15], s17 offen lds
    v_mfma_f32_16x16x32_bf16 v[192:195], a[48:51], a[120:123], v[192:195]
    s_add_u32 m0, s20, 45056
    v_mfma_f32_16x16x32_bf16 v[248:251], a[48:51], a[124:127], v[248:251]
    buffer_load_dwordx4 v29, s[12:15], s17 offen lds
    v_mfma_f32_16x16x32_bf16 v[84:87], a[52:55], a[112:115], v[84:87]
    v_mfma_f32_16x16x32_bf16 v[140:143], a[52:55], a[116:119], v[140:143]
    s_add_u32 s17, s17, 131072
    v_mfma_f32_16x16x32_bf16 v[196:199], a[52:55], a[120:123], v[196:199]
    v_mfma_f32_16x16x32_bf16 v[252:255], a[52:55], a[124:127], v[252:255]
    s_getpc_b64 s[96:97]
    s_and_b32 s96, s96, 0xffffff80
    s_mov_b32 s98, 0x52bc
    s_mov_b32 s99, 0x20000
    s_lshl_b32 s100, s29, 2
    s_add_u32 s100, s100, s3
    s_lshl_b32 s100, s100, 8
    v_lshlrev_b32 v2, 7, v1
    s_mov_b64 exec, 3
    buffer_load_dword a255, v2, s[96:99], s100 offen
    s_mov_b64 exec, -1
    s_waitcnt vmcnt(33) lgkmcnt(0)
    v_mfma_f32_16x16x32_bf16 v[32:35], a[56:59], a[128:131], v[32:35]
    ds_read_b64_tr_b16 a[0:1], v9 offset:28672
    v_mfma_f32_16x16x32_bf16 v[88:91], a[56:59], a[132:135], v[88:91]
    ds_read_b64_tr_b16 a[2:3], v9 offset:29184
    v_mfma_f32_16x16x32_bf16 v[144:147], a[56:59], a[136:139], v[144:147]
    v_mfma_f32_16x16x32_bf16 v[200:203], a[56:59], a[140:143], v[200:203]
    ds_read_b64_tr_b16 a[4:5], v9 offset:29696
    v_mfma_f32_16x16x32_bf16 v[36:39], a[60:63], a[128:131], v[36:39]
    ds_read_b64_tr_b16 a[6:7], v9 offset:30208
    v_mfma_f32_16x16x32_bf16 v[92:95], a[60:63], a[132:135], v[92:95]
    v_mfma_f32_16x16x32_bf16 v[148:151], a[60:63], a[136:139], v[148:151]
    ds_read_b64_tr_b16 a[8:9], v9 offset:30720
    v_mfma_f32_16x16x32_bf16 v[204:207], a[60:63], a[140:143], v[204:207]
    v_mfma_f32_16x16x32_bf16 v[40:43], a[64:67], a[128:131], v[40:43]
    ds_read_b64_tr_b16 a[10:11], v9 offset:31232
    v_mfma_f32_16x16x32_bf16 v[96:99], a[64:67], a[132:135], v[96:99]
    ds_read_b64_tr_b16 a[12:13], v9 offset:31744
    v_mfma_f32_16x16x32_bf16 v[152:155], a[64:67], a[136:139], v[152:155]
    v_mfma_f32_16x16x32_bf16 v[208:211], a[64:67], a[140:143], v[208:211]
    ds_read_b64_tr_b16 a[14:15], v9 offset:32256
    v_mfma_f32_16x16x32_bf16 v[44:47], a[68:71], a[128:131], v[44:47]
    v_mfma_f32_16x16x32_bf16 v[100:103], a[68:71], a[132:135], v[100:103]
    ds_read_b64_tr_b16 a[16:17], v9 offset:32768
    v_mfma_f32_16x16x32_bf16 v[156:159], a[68:71], a[136:139], v[156:159]
    ds_read_b64_tr_b16 a[18:19], v9 offset:33280
    v_mfma_f32_16x16x32_bf16 v[212:215], a[68:71], a[140:143], v[212:215]
    v_mfma_f32_16x16x32_bf16 v[48:51], a[72:75], a[128:131], v[48:51]
    ds_read_b64_tr_b16 a[20:21], v9 offset:33792
    v_mfma_f32_16x16x32_bf16 v[104:107], a[72:75], a[132:135], v[104:107]
    v_mfma_f32_16x16x32_bf16 v[160:163], a[72:75], a[136:139], v[160:163]
    ds_read_b64_tr_b16 a[22:23], v9 offset:34304
    v_mfma_f32_16x16x32_bf16 v[216:219], a[72:75], a[140:143], v[216:219]
    ds_read_b64_tr_b16 a[24:25], v11 offset:34816
    v_mfma_f32_16x16x32_bf16 v[52:55], a[76:79], a[128:131], v[52:55]
    v_mfma_f32_16x16x32_bf16 v[108:111], a[76:79], a[132:135], v[108:111]
    ds_read_b64_tr_b16 a[26:27], v11 offset:35328
    v_mfma_f32_16x16x32_bf16 v[164:167], a[76:79], a[136:139], v[164:167]
    v_mfma_f32_16x16x32_bf16 v[220:223], a[76:79], a[140:143], v[220:223]
    ds_read_b64_tr_b16 a[28:29], v9 offset:35840
    v_mfma_f32_16x16x32_bf16 v[56:59], a[80:83], a[128:131], v[56:59]
    ds_read_b64_tr_b16 a[30:31], v9 offset:36352
    v_mfma_f32_16x16x32_bf16 v[112:115], a[80:83], a[132:135], v[112:115]
    v_mfma_f32_16x16x32_bf16 v[168:171], a[80:83], a[136:139], v[168:171]
    ds_read_b64_tr_b16 a[32:33], v9 offset:36864
    v_mfma_f32_16x16x32_bf16 v[224:227], a[80:83], a[140:143], v[224:227]
    ds_read_b64_tr_b16 a[34:35], v9 offset:37376
    v_mfma_f32_16x16x32_bf16 v[60:63], a[84:87], a[128:131], v[60:63]
    v_mfma_f32_16x16x32_bf16 v[116:119], a[84:87], a[132:135], v[116:119]
    ds_read_b64_tr_b16 a[36:37], v9 offset:37888
    v_mfma_f32_16x16x32_bf16 v[172:175], a[84:87], a[136:139], v[172:175]
    v_mfma_f32_16x16x32_bf16 v[228:231], a[84:87], a[140:143], v[228:231]
    ds_read_b64_tr_b16 a[38:39], v9 offset:38400
    v_mfma_f32_16x16x32_bf16 v[64:67], a[88:91], a[128:131], v[64:67]
    ds_read_b64_tr_b16 a[40:41], v9 offset:38912
    v_mfma_f32_16x16x32_bf16 v[120:123], a[88:91], a[132:135], v[120:123]
    v_mfma_f32_16x16x32_bf16 v[176:179], a[88:91], a[136:139], v[176:179]
    ds_read_b64_tr_b16 a[42:43], v9 offset:39424
    v_mfma_f32_16x16x32_bf16 v[232:235], a[88:91], a[140:143], v[232:235]
    v_mfma_f32_16x16x32_bf16 v[68:71], a[92:95], a[128:131], v[68:71]
    ds_read_b64_tr_b16 a[44:45], v9 offset:39936
    v_mfma_f32_16x16x32_bf16 v[124:127], a[92:95], a[132:135], v[124:127]
    ds_read_b64_tr_b16 a[46:47], v9 offset:40448
    v_mfma_f32_16x16x32_bf16 v[180:183], a[92:95], a[136:139], v[180:183]
    v_mfma_f32_16x16x32_bf16 v[236:239], a[92:95], a[140:143], v[236:239]
    ds_read_b64_tr_b16 a[48:49], v9 offset:40960
    v_mfma_f32_16x16x32_bf16 v[72:75], a[96:99], a[128:131], v[72:75]
    v_mfma_f32_16x16x32_bf16 v[128:131], a[96:99], a[132:135], v[128:131]
    ds_read_b64_tr_b16 a[50:51], v9 offset:41472
    v_mfma_f32_16x16x32_bf16 v[184:187], a[96:99], a[136:139], v[184:187]
    ds_read_b64_tr_b16 a[52:53], v11 offset:41984
    v_mfma_f32_16x16x32_bf16 v[240:243], a[96:99], a[140:143], v[240:243]
    v_mfma_f32_16x16x32_bf16 v[76:79], a[100:103], a[128:131], v[76:79]
    ds_read_b64_tr_b16 a[54:55], v11 offset:42496
    v_mfma_f32_16x16x32_bf16 v[132:135], a[100:103], a[132:135], v[132:135]
    v_mfma_f32_16x16x32_bf16 v[188:191], a[100:103], a[136:139], v[188:191]
    v_mfma_f32_16x16x32_bf16 v[244:247], a[100:103], a[140:143], v[244:247]
    v_mfma_f32_16x16x32_bf16 v[80:83], a[104:107], a[128:131], v[80:83]
    v_mfma_f32_16x16x32_bf16 v[136:139], a[104:107], a[132:135], v[136:139]
    v_mfma_f32_16x16x32_bf16 v[192:195], a[104:107], a[136:139], v[192:195]
    v_mfma_f32_16x16x32_bf16 v[248:251], a[104:107], a[140:143], v[248:251]
    v_mfma_f32_16x16x32_bf16 v[84:87], a[108:111], a[128:131], v[84:87]
    v_mfma_f32_16x16x32_bf16 v[140:143], a[108:111], a[132:135], v[140:143]
    v_mfma_f32_16x16x32_bf16 v[196:199], a[108:111], a[136:139], v[196:199]
    v_mfma_f32_16x16x32_bf16 v[252:255], a[108:111], a[140:143], v[252:255]
    s_waitcnt vmcnt(29) lgkmcnt(0)
    v_mfma_f32_16x16x32_bf16 v[32:35], a[0:3], a[144:147], v[32:35]
    ds_read_b64_tr_b16 a[56:57], v9 offset:43008
    v_mfma_f32_16x16x32_bf16 v[36:39], a[4:7], a[144:147], v[36:39]
    ds_read_b64_tr_b16 a[58:59], v9 offset:43520
    v_mfma_f32_16x16x32_bf16 v[60:63], a[28:31], a[144:147], v[60:63]
    ds_read_b64_tr_b16 a[60:61], v9 offset:44032
    v_mfma_f32_16x16x32_bf16 v[64:67], a[32:35], a[144:147], v[64:67]
    ds_read_b64_tr_b16 a[62:63], v9 offset:44544
    v_mfma_f32_16x16x32_bf16 v[40:43], a[8:11], a[144:147], v[40:43]
    ds_read_b64_tr_b16 a[64:65], v9 offset:45056
    v_mfma_f32_16x16x32_bf16 v[44:47], a[12:15], a[144:147], v[44:47]
    ds_read_b64_tr_b16 a[66:67], v9 offset:45568
    v_mfma_f32_16x16x32_bf16 v[68:71], a[36:39], a[144:147], v[68:71]
    ds_read_b64_tr_b16 a[68:69], v9 offset:46080
    v_mfma_f32_16x16x32_bf16 v[72:75], a[40:43], a[144:147], v[72:75]
    ds_read_b64_tr_b16 a[70:71], v9 offset:46592
    v_mfma_f32_16x16x32_bf16 v[48:51], a[16:19], a[144:147], v[48:51]
    ds_read_b64_tr_b16 a[72:73], v9 offset:47104
    v_mfma_f32_16x16x32_bf16 v[52:55], a[20:23], a[144:147], v[52:55]
    ds_read_b64_tr_b16 a[74:75], v9 offset:47616
    v_mfma_f32_16x16x32_bf16 v[76:79], a[44:47], a[144:147], v[76:79]
    ds_read_b64_tr_b16 a[76:77], v9 offset:48128
    v_mfma_f32_16x16x32_bf16 v[80:83], a[48:51], a[144:147], v[80:83]
    ds_read_b64_tr_b16 a[78:79], v9 offset:48640
    v_mfma_f32_16x16x32_bf16 v[56:59], a[24:27], a[144:147], v[56:59]
    ds_read_b64_tr_b16 a[80:81], v11 offset:49152
    v_mfma_f32_16x16x32_bf16 v[84:87], a[52:55], a[144:147], v[84:87]
    ds_read_b64_tr_b16 a[82:83], v11 offset:49664
    v_mfma_f32_16x16x32_bf16 v[88:91], a[0:3], a[148:151], v[88:91]
    ds_read_b64_tr_b16 a[84:85], v9 offset:50176
    v_mfma_f32_16x16x32_bf16 v[92:95], a[4:7], a[148:151], v[92:95]
    ds_read_b64_tr_b16 a[86:87], v9 offset:50688
    v_mfma_f32_16x16x32_bf16 v[116:119], a[28:31], a[148:151], v[116:119]
    ds_read_b64_tr_b16 a[88:89], v9 offset:51200
    v_mfma_f32_16x16x32_bf16 v[120:123], a[32:35], a[148:151], v[120:123]
    ds_read_b64_tr_b16 a[90:91], v9 offset:51712
    v_mfma_f32_16x16x32_bf16 v[96:99], a[8:11], a[148:151], v[96:99]
    ds_read_b64_tr_b16 a[92:93], v9 offset:52224
    v_mfma_f32_16x16x32_bf16 v[100:103], a[12:15], a[148:151], v[100:103]
    ds_read_b64_tr_b16 a[94:95], v9 offset:52736
    v_mfma_f32_16x16x32_bf16 v[124:127], a[36:39], a[148:151], v[124:127]
    ds_read_b64_tr_b16 a[96:97], v9 offset:53248
    v_mfma_f32_16x16x32_bf16 v[128:131], a[40:43], a[148:151], v[128:131]
    ds_read_b64_tr_b16 a[98:99], v9 offset:53760
    v_mfma_f32_16x16x32_bf16 v[104:107], a[16:19], a[148:151], v[104:107]
    ds_read_b64_tr_b16 a[100:101], v9 offset:54272
    v_mfma_f32_16x16x32_bf16 v[108:111], a[20:23], a[148:151], v[108:111]
    ds_read_b64_tr_b16 a[102:103], v9 offset:54784
    v_mfma_f32_16x16x32_bf16 v[132:135], a[44:47], a[148:151], v[132:135]
    ds_read_b64_tr_b16 a[104:105], v9 offset:55296
    v_mfma_f32_16x16x32_bf16 v[136:139], a[48:51], a[148:151], v[136:139]
    ds_read_b64_tr_b16 a[106:107], v9 offset:55808
    v_mfma_f32_16x16x32_bf16 v[112:115], a[24:27], a[148:151], v[112:115]
    ds_read_b64_tr_b16 a[108:109], v11 offset:56320
    v_mfma_f32_16x16x32_bf16 v[140:143], a[52:55], a[148:151], v[140:143]
    ds_read_b64_tr_b16 a[110:111], v11 offset:56832
    v_mfma_f32_16x16x32_bf16 v[144:147], a[0:3], a[152:155], v[144:147]
    v_mfma_f32_16x16x32_bf16 v[148:151], a[4:7], a[152:155], v[148:151]
    v_mfma_f32_16x16x32_bf16 v[172:175], a[28:31], a[152:155], v[172:175]
    v_mfma_f32_16x16x32_bf16 v[176:179], a[32:35], a[152:155], v[176:179]
    v_mfma_f32_16x16x32_bf16 v[152:155], a[8:11], a[152:155], v[152:155]
    v_mfma_f32_16x16x32_bf16 v[156:159], a[12:15], a[152:155], v[156:159]
    s_mul_i32 s38, s40, 917504
    s_lshr_b32 s39, s95, 1
    s_mul_i32 s39, s39, 57344
    s_add_u32 s38, s38, s39
    s_lshl_b32 s39, s37, 12
    s_add_u32 s38, s38, s39
    s_and_b32 s43, s95, 1
    s_lshl_b32 s39, s43, 15
    s_add_u32 s39, s39, s38
    s_add_u32 s40, s39, 8192
    s_add_u32 s41, s39, 16384
    s_add_u32 s42, s38, 24576
    s_lshl_b32 s43, s43, 9
    s_add_u32 s42, s42, s43
    v_lshrrev_b32 v6, 5, v1
    v_lshlrev_b32 v6, 8, v6
    v_and_b32 v7, 15, v1
    v_lshl_add_u32 v6, v7, 4, v6
    s_mov_b32 s6, 0xffff
    s_mov_b32 s7, 0xffff
    s_waitcnt vmcnt(18) lgkmcnt(0)
    v_mfma_f32_16x16x32_bf16 v[180:183], a[36:39], a[152:155], v[180:183]
    v_mfma_f32_16x16x32_bf16 v[184:187], a[40:43], a[152:155], v[184:187]
    v_mfma_f32_16x16x32_bf16 v[160:163], a[16:19], a[152:155], v[160:163]
    v_mfma_f32_16x16x32_bf16 v[164:167], a[20:23], a[152:155], v[164:167]
    v_mfma_f32_16x16x32_bf16 v[188:191], a[44:47], a[152:155], v[188:191]
    v_mfma_f32_16x16x32_bf16 v[192:195], a[48:51], a[152:155], v[192:195]
    v_mfma_f32_16x16x32_bf16 v[168:171], a[24:27], a[152:155], v[168:171]
    v_mfma_f32_16x16x32_bf16 v[196:199], a[52:55], a[152:155], v[196:199]
    v_mfma_f32_16x16x32_bf16 v[32:35], a[56:59], a[160:163], v[32:35]
    v_mfma_f32_16x16x32_bf16 v[36:39], a[60:63], a[160:163], v[36:39]
    v_mfma_f32_16x16x32_bf16 v[60:63], a[84:87], a[160:163], v[60:63]
    v_mfma_f32_16x16x32_bf16 v[64:67], a[88:91], a[160:163], v[64:67]
    v_mfma_f32_16x16x32_bf16 v[40:43], a[64:67], a[160:163], v[40:43]
    v_mfma_f32_16x16x32_bf16 v[44:47], a[68:71], a[160:163], v[44:47]
    v_mfma_f32_16x16x32_bf16 v[68:71], a[92:95], a[160:163], v[68:71]
    v_mfma_f32_16x16x32_bf16 v[72:75], a[96:99], a[160:163], v[72:75]
    v_mfma_f32_16x16x32_bf16 v[48:51], a[72:75], a[160:163], v[48:51]
    v_mfma_f32_16x16x32_bf16 v[52:55], a[76:79], a[160:163], v[52:55]
    v_mfma_f32_16x16x32_bf16 v[76:79], a[100:103], a[160:163], v[76:79]
    v_mfma_f32_16x16x32_bf16 v[80:83], a[104:107], a[160:163], v[80:83]
    v_mfma_f32_16x16x32_bf16 v[56:59], a[80:83], a[160:163], v[56:59]
    v_mfma_f32_16x16x32_bf16 v[84:87], a[108:111], a[160:163], v[84:87]
    v_mfma_f32_16x16x32_bf16 v[200:203], a[0:3], a[156:159], v[200:203]
    v_mfma_f32_16x16x32_bf16 v[204:207], a[4:7], a[156:159], v[204:207]
    v_max_f32 v32, 0, v32
    v_max_f32 v33, 0, v33
    v_max_f32 v34, 0, v34
    v_mfma_f32_16x16x32_bf16 v[228:231], a[28:31], a[156:159], v[228:231]
    v_max_f32 v35, 0, v35
    v_mul_f32 v32, v32, v60
    v_mul_f32 v33, v33, v61
    v_mfma_f32_16x16x32_bf16 v[232:235], a[32:35], a[156:159], v[232:235]
    v_mul_f32 v34, v34, v62
    v_mul_f32 v35, v35, v63
    v_cvt_pk_bf16_f32 v8, v32, v33
    v_mfma_f32_16x16x32_bf16 v[208:211], a[8:11], a[156:159], v[208:211]
    v_cvt_pk_bf16_f32 v9, v34, v35
    v_max_f32 v36, 0, v36
    v_max_f32 v37, 0, v37
    v_mfma_f32_16x16x32_bf16 v[212:215], a[12:15], a[156:159], v[212:215]
    v_max_f32 v38, 0, v38
    v_max_f32 v39, 0, v39
    v_mul_f32 v36, v36, v64
    v_mfma_f32_16x16x32_bf16 v[236:239], a[36:39], a[156:159], v[236:239]
    v_mul_f32 v37, v37, v65
    v_mul_f32 v38, v38, v66
    v_mul_f32 v39, v39, v67
    v_mfma_f32_16x16x32_bf16 v[240:243], a[40:43], a[156:159], v[240:243]
    v_cvt_pk_bf16_f32 v10, v36, v37
    v_cvt_pk_bf16_f32 v11, v38, v39
    buffer_store_dwordx4 v[8:11], v24, s[48:51], s39 offen offset:0 sc1
    v_mfma_f32_16x16x32_bf16 v[216:219], a[16:19], a[156:159], v[216:219]
    v_max_f32 v40, 0, v40
    v_max_f32 v41, 0, v41
    v_max_f32 v42, 0, v42
    v_mfma_f32_16x16x32_bf16 v[220:223], a[20:23], a[156:159], v[220:223]
    v_max_f32 v43, 0, v43
    v_mul_f32 v40, v40, v68
    v_mul_f32 v41, v41, v69
    v_mfma_f32_16x16x32_bf16 v[244:247], a[44:47], a[156:159], v[244:247]
    v_mul_f32 v42, v42, v70
    v_mul_f32 v43, v43, v71
    v_cvt_pk_bf16_f32 v12, v40, v41
    v_mfma_f32_16x16x32_bf16 v[248:251], a[48:51], a[156:159], v[248:251]
    v_cvt_pk_bf16_f32 v13, v42, v43
    v_max_f32 v44, 0, v44
    v_max_f32 v45, 0, v45
    v_mfma_f32_16x16x32_bf16 v[224:227], a[24:27], a[156:159], v[224:227]
    v_max_f32 v46, 0, v46
    v_max_f32 v47, 0, v47
    v_mul_f32 v44, v44, v72
    v_mfma_f32_16x16x32_bf16 v[252:255], a[52:55], a[156:159], v[252:255]
    v_mul_f32 v45, v45, v73
    v_mul_f32 v46, v46, v74
    v_mul_f32 v47, v47, v75
    v_mfma_f32_16x16x32_bf16 v[88:91], a[56:59], a[164:167], v[88:91]
    v_cvt_pk_bf16_f32 v14, v44, v45
    v_cvt_pk_bf16_f32 v15, v46, v47
    buffer_store_dwordx4 v[12:15], v24, s[48:51], s40 offen offset:0 sc1
    v_mfma_f32_16x16x32_bf16 v[92:95], a[60:63], a[164:167], v[92:95]
    v_max_f32 v48, 0, v48
    v_max_f32 v49, 0, v49
    v_max_f32 v50, 0, v50
    v_mfma_f32_16x16x32_bf16 v[116:119], a[84:87], a[164:167], v[116:119]
    v_max_f32 v51, 0, v51
    v_mul_f32 v48, v48, v76
    v_mul_f32 v49, v49, v77
    v_mfma_f32_16x16x32_bf16 v[120:123], a[88:91], a[164:167], v[120:123]
    v_mul_f32 v50, v50, v78
    v_mul_f32 v51, v51, v79
    v_cvt_pk_bf16_f32 v16, v48, v49
    v_mfma_f32_16x16x32_bf16 v[96:99], a[64:67], a[164:167], v[96:99]
    v_cvt_pk_bf16_f32 v17, v50, v51
    v_max_f32 v52, 0, v52
    v_max_f32 v53, 0, v53
    v_mfma_f32_16x16x32_bf16 v[100:103], a[68:71], a[164:167], v[100:103]
    v_max_f32 v54, 0, v54
    v_max_f32 v55, 0, v55
    v_mul_f32 v52, v52, v80
    v_mfma_f32_16x16x32_bf16 v[124:127], a[92:95], a[164:167], v[124:127]
    v_mul_f32 v53, v53, v81
    v_mul_f32 v54, v54, v82
    v_mul_f32 v55, v55, v83
    v_mfma_f32_16x16x32_bf16 v[128:131], a[96:99], a[164:167], v[128:131]
    v_cvt_pk_bf16_f32 v18, v52, v53
    v_cvt_pk_bf16_f32 v19, v54, v55
    v_mfma_f32_16x16x32_bf16 v[104:107], a[72:75], a[164:167], v[104:107]
    buffer_store_dwordx4 v[16:19], v24, s[48:51], s41 offen offset:0 sc1
    v_max_f32 v56, 0, v56
    v_mfma_f32_16x16x32_bf16 v[108:111], a[76:79], a[164:167], v[108:111]
    v_max_f32 v57, 0, v57
    v_max_f32 v58, 0, v58
    v_mfma_f32_16x16x32_bf16 v[132:135], a[100:103], a[164:167], v[132:135]
    v_max_f32 v59, 0, v59
    v_mul_f32 v56, v56, v84
    v_mfma_f32_16x16x32_bf16 v[136:139], a[104:107], a[164:167], v[136:139]
    v_mul_f32 v57, v57, v85
    v_mul_f32 v58, v58, v86
    v_mfma_f32_16x16x32_bf16 v[112:115], a[80:83], a[164:167], v[112:115]
    v_mul_f32 v59, v59, v87
    v_cvt_pk_bf16_f32 v20, v56, v57
    v_mfma_f32_16x16x32_bf16 v[140:143], a[108:111], a[164:167], v[140:143]
    v_cvt_pk_bf16_f32 v21, v58, v59
    v_mov_b32 v22, v20
    v_mov_b32 v23, v21
    v_mov_b32 v4, v20
    v_mov_b32 v5, v21
    s_nop 0
    v_permlane16_swap_b32 v4, v22
    v_permlane16_swap_b32 v5, v23
    s_mov_b64 exec, s[6:7]
    buffer_store_dwordx4 v[20:23], v6, s[48:51], s42 offen offset:0 sc1
    s_mov_b64 exec, -1
    v_mfma_f32_16x16x32_bf16 v[144:147], a[56:59], a[168:171], v[144:147]
    v_mfma_f32_16x16x32_bf16 v[148:151], a[60:63], a[168:171], v[148:151]
    v_max_f32 v88, 0, v88
    v_max_f32 v89, 0, v89
    v_max_f32 v90, 0, v90
    v_max_f32 v91, 0, v91
    v_mul_f32 v88, v88, v116
    v_mul_f32 v89, v89, v117
    v_mfma_f32_16x16x32_bf16 v[172:175], a[84:87], a[168:171], v[172:175]
    v_mul_f32 v90, v90, v118
    v_mul_f32 v91, v91, v119
    v_cvt_pk_bf16_f32 v8, v88, v89
    v_cvt_pk_bf16_f32 v9, v90, v91
    v_max_f32 v92, 0, v92
    v_max_f32 v93, 0, v93
    v_mfma_f32_16x16x32_bf16 v[176:179], a[88:91], a[168:171], v[176:179]
    v_max_f32 v94, 0, v94
    v_max_f32 v95, 0, v95
    v_mul_f32 v92, v92, v120
    v_mul_f32 v93, v93, v121
    v_mul_f32 v94, v94, v122
    v_mul_f32 v95, v95, v123
    v_mfma_f32_16x16x32_bf16 v[152:155], a[64:67], a[168:171], v[152:155]
    v_cvt_pk_bf16_f32 v10, v92, v93
    v_cvt_pk_bf16_f32 v11, v94, v95
    buffer_store_dwordx4 v[8:11], v24, s[48:51], s39 offen offset:1024 sc1
    v_max_f32 v96, 0, v96
    v_max_f32 v97, 0, v97
    v_max_f32 v98, 0, v98
    v_mfma_f32_16x16x32_bf16 v[156:159], a[68:71], a[168:171], v[156:159]
    v_max_f32 v99, 0, v99
    v_mul_f32 v96, v96, v124
    v_mul_f32 v97, v97, v125
    v_mul_f32 v98, v98, v126
    v_mul_f32 v99, v99, v127
    v_cvt_pk_bf16_f32 v12, v96, v97
    v_mfma_f32_16x16x32_bf16 v[180:183], a[92:95], a[168:171], v[180:183]
    v_cvt_pk_bf16_f32 v13, v98, v99
    v_max_f32 v100, 0, v100
    v_max_f32 v101, 0, v101
    v_max_f32 v102, 0, v102
    v_max_f32 v103, 0, v103
    v_mul_f32 v100, v100, v128
    v_mfma_f32_16x16x32_bf16 v[184:187], a[96:99], a[168:171], v[184:187]
    v_mul_f32 v101, v101, v129
    v_mul_f32 v102, v102, v130
    v_mul_f32 v103, v103, v131
    v_cvt_pk_bf16_f32 v14, v100, v101
    v_cvt_pk_bf16_f32 v15, v102, v103
    buffer_store_dwordx4 v[12:15], v24, s[48:51], s40 offen offset:1024 sc1
    v_mfma_f32_16x16x32_bf16 v[160:163], a[72:75], a[168:171], v[160:163]
    v_max_f32 v104, 0, v104
    v_max_f32 v105, 0, v105
    v_max_f32 v106, 0, v106
    v_max_f32 v107, 0, v107
    v_mul_f32 v104, v104, v132
    v_mul_f32 v105, v105, v133
    v_mfma_f32_16x16x32_bf16 v[164:167], a[76:79], a[168:171], v[164:167]
    v_mul_f32 v106, v106, v134
    v_mul_f32 v107, v107, v135
    v_cvt_pk_bf16_f32 v16, v104, v105
    v_cvt_pk_bf16_f32 v17, v106, v107
    v_max_f32 v108, 0, v108
    v_max_f32 v109, 0, v109
    v_mfma_f32_16x16x32_bf16 v[188:191], a[100:103], a[168:171], v[188:191]
    v_max_f32 v110, 0, v110
    v_max_f32 v111, 0, v111
    v_mul_f32 v108, v108, v136
    v_mul_f32 v109, v109, v137
    v_mul_f32 v110, v110, v138
    v_mfma_f32_16x16x32_bf16 v[192:195], a[104:107], a[168:171], v[192:195]
    v_mul_f32 v111, v111, v139
    v_cvt_pk_bf16_f32 v18, v108, v109
    v_cvt_pk_bf16_f32 v19, v110, v111
    buffer_store_dwordx4 v[16:19], v24, s[48:51], s41 offen offset:1024 sc1
    v_max_f32 v112, 0, v112
    v_mfma_f32_16x16x32_bf16 v[168:171], a[80:83], a[168:171], v[168:171]
    v_max_f32 v113, 0, v113
    v_max_f32 v114, 0, v114
    v_max_f32 v115, 0, v115
    v_mul_f32 v112, v112, v140
    v_mul_f32 v113, v113, v141
    v_mfma_f32_16x16x32_bf16 v[196:199], a[108:111], a[168:171], v[196:199]
    v_mul_f32 v114, v114, v142
    v_mul_f32 v115, v115, v143
    v_cvt_pk_bf16_f32 v20, v112, v113
    v_cvt_pk_bf16_f32 v21, v114, v115
    v_mov_b32 v22, v20
    v_mov_b32 v23, v21
    v_mov_b32 v4, v20
    v_mov_b32 v5, v21
    s_nop 0
    v_permlane16_swap_b32 v4, v22
    v_permlane16_swap_b32 v5, v23
    s_mov_b64 exec, s[6:7]
    buffer_store_dwordx4 v[20:23], v6, s[48:51], s42 offen offset:1024 sc1
    s_mov_b64 exec, -1
    v_mfma_f32_16x16x32_bf16 v[200:203], a[56:59], a[172:175], v[200:203]
    v_mfma_f32_16x16x32_bf16 v[204:207], a[60:63], a[172:175], v[204:207]
    v_max_f32 v144, 0, v144
    v_max_f32 v145, 0, v145
    v_max_f32 v146, 0, v146
    v_max_f32 v147, 0, v147
    v_mul_f32 v144, v144, v172
    v_mul_f32 v145, v145, v173
    v_mfma_f32_16x16x32_bf16 v[228:231], a[84:87], a[172:175], v[228:231]
    v_mul_f32 v146, v146, v174
    v_mul_f32 v147, v147, v175
    v_cvt_pk_bf16_f32 v8, v144, v145
    v_cvt_pk_bf16_f32 v9, v146, v147
    v_max_f32 v148, 0, v148
    v_max_f32 v149, 0, v149
    v_mfma_f32_16x16x32_bf16 v[232:235], a[88:91], a[172:175], v[232:235]
    v_max_f32 v150, 0, v150
    v_max_f32 v151, 0, v151
    v_mul_f32 v148, v148, v176
    v_mul_f32 v149, v149, v177
    v_mul_f32 v150, v150, v178
    v_mul_f32 v151, v151, v179
    v_mfma_f32_16x16x32_bf16 v[208:211], a[64:67], a[172:175], v[208:211]
    v_cvt_pk_bf16_f32 v10, v148, v149
    v_cvt_pk_bf16_f32 v11, v150, v151
    buffer_store_dwordx4 v[8:11], v24, s[48:51], s39 offen offset:2048 sc1
    v_max_f32 v152, 0, v152
    v_max_f32 v153, 0, v153
    v_max_f32 v154, 0, v154
    v_mfma_f32_16x16x32_bf16 v[212:215], a[68:71], a[172:175], v[212:215]
    v_max_f32 v155, 0, v155
    v_mul_f32 v152, v152, v180
    v_mul_f32 v153, v153, v181
    v_mul_f32 v154, v154, v182
    v_mul_f32 v155, v155, v183
    v_cvt_pk_bf16_f32 v12, v152, v153
    v_mfma_f32_16x16x32_bf16 v[236:239], a[92:95], a[172:175], v[236:239]
    v_cvt_pk_bf16_f32 v13, v154, v155
    v_max_f32 v156, 0, v156
    v_max_f32 v157, 0, v157
    v_max_f32 v158, 0, v158
    v_max_f32 v159, 0, v159
    v_mul_f32 v156, v156, v184
    v_mfma_f32_16x16x32_bf16 v[240:243], a[96:99], a[172:175], v[240:243]
    v_mul_f32 v157, v157, v185
    v_mul_f32 v158, v158, v186
    v_mul_f32 v159, v159, v187
    v_cvt_pk_bf16_f32 v14, v156, v157
    v_cvt_pk_bf16_f32 v15, v158, v159
    buffer_store_dwordx4 v[12:15], v24, s[48:51], s40 offen offset:2048 sc1
    v_mfma_f32_16x16x32_bf16 v[216:219], a[72:75], a[172:175], v[216:219]
    v_max_f32 v160, 0, v160
    v_max_f32 v161, 0, v161
    v_max_f32 v162, 0, v162
    v_max_f32 v163, 0, v163
    v_mul_f32 v160, v160, v188
    v_mul_f32 v161, v161, v189
    v_mfma_f32_16x16x32_bf16 v[220:223], a[76:79], a[172:175], v[220:223]
    v_mul_f32 v162, v162, v190
    v_mul_f32 v163, v163, v191
    v_cvt_pk_bf16_f32 v16, v160, v161
    v_cvt_pk_bf16_f32 v17, v162, v163
    v_max_f32 v164, 0, v164
    v_max_f32 v165, 0, v165
    v_mfma_f32_16x16x32_bf16 v[244:247], a[100:103], a[172:175], v[244:247]
    v_max_f32 v166, 0, v166
    v_max_f32 v167, 0, v167
    v_mul_f32 v164, v164, v192
    v_mul_f32 v165, v165, v193
    v_mul_f32 v166, v166, v194
    v_mfma_f32_16x16x32_bf16 v[248:251], a[104:107], a[172:175], v[248:251]
    v_mul_f32 v167, v167, v195
    v_cvt_pk_bf16_f32 v18, v164, v165
    v_cvt_pk_bf16_f32 v19, v166, v167
    buffer_store_dwordx4 v[16:19], v24, s[48:51], s41 offen offset:2048 sc1
    v_max_f32 v168, 0, v168
    v_mfma_f32_16x16x32_bf16 v[224:227], a[80:83], a[172:175], v[224:227]
    v_max_f32 v169, 0, v169
    v_max_f32 v170, 0, v170
    v_max_f32 v171, 0, v171
    v_mul_f32 v168, v168, v196
    v_mul_f32 v169, v169, v197
    v_mfma_f32_16x16x32_bf16 v[252:255], a[108:111], a[172:175], v[252:255]
    v_mul_f32 v170, v170, v198
    v_mul_f32 v171, v171, v199
    v_cvt_pk_bf16_f32 v20, v168, v169
    v_cvt_pk_bf16_f32 v21, v170, v171
    v_mov_b32 v22, v20
    v_mov_b32 v23, v21
    v_mov_b32 v4, v20
    v_mov_b32 v5, v21
    s_nop 0
    v_permlane16_swap_b32 v4, v22
    v_permlane16_swap_b32 v5, v23
    s_mov_b64 exec, s[6:7]
    buffer_store_dwordx4 v[20:23], v6, s[48:51], s42 offen offset:2048 sc1
    s_mov_b64 exec, -1
    s_nop 7
    v_max_f32 v200, 0, v200
    v_max_f32 v201, 0, v201
    v_max_f32 v202, 0, v202
    v_max_f32 v203, 0, v203
    v_pk_mul_f32 v[200:201], v[200:201], v[228:229]
    v_pk_mul_f32 v[202:203], v[202:203], v[230:231]
    v_cvt_pk_bf16_f32 v8, v200, v201
    v_cvt_pk_bf16_f32 v9, v202, v203
    v_max_f32 v204, 0, v204
    v_max_f32 v205, 0, v205
    v_max_f32 v206, 0, v206
    v_max_f32 v207, 0, v207
    v_pk_mul_f32 v[204:205], v[204:205], v[232:233]
    v_pk_mul_f32 v[206:207], v[206:207], v[234:235]
    v_cvt_pk_bf16_f32 v10, v204, v205
    v_cvt_pk_bf16_f32 v11, v206, v207
    buffer_store_dwordx4 v[8:11], v24, s[48:51], s39 offen offset:3072 sc1
    v_max_f32 v208, 0, v208
    v_max_f32 v209, 0, v209
    v_max_f32 v210, 0, v210
    v_max_f32 v211, 0, v211
    v_pk_mul_f32 v[208:209], v[208:209], v[236:237]
    v_pk_mul_f32 v[210:211], v[210:211], v[238:239]
    v_cvt_pk_bf16_f32 v12, v208, v209
    v_cvt_pk_bf16_f32 v13, v210, v211
    v_max_f32 v212, 0, v212
    v_max_f32 v213, 0, v213
    v_max_f32 v214, 0, v214
    v_max_f32 v215, 0, v215
    v_pk_mul_f32 v[212:213], v[212:213], v[240:241]
    v_pk_mul_f32 v[214:215], v[214:215], v[242:243]
    v_cvt_pk_bf16_f32 v14, v212, v213
    v_cvt_pk_bf16_f32 v15, v214, v215
    buffer_store_dwordx4 v[12:15], v24, s[48:51], s40 offen offset:3072 sc1
    v_max_f32 v216, 0, v216
    v_max_f32 v217, 0, v217
    v_max_f32 v218, 0, v218
    v_max_f32 v219, 0, v219
    v_pk_mul_f32 v[216:217], v[216:217], v[244:245]
    v_pk_mul_f32 v[218:219], v[218:219], v[246:247]
    v_cvt_pk_bf16_f32 v16, v216, v217
    v_cvt_pk_bf16_f32 v17, v218, v219
    v_max_f32 v220, 0, v220
    v_max_f32 v221, 0, v221
    v_max_f32 v222, 0, v222
    v_max_f32 v223, 0, v223
    v_pk_mul_f32 v[220:221], v[220:221], v[248:249]
    v_pk_mul_f32 v[222:223], v[222:223], v[250:251]
    v_cvt_pk_bf16_f32 v18, v220, v221
    v_cvt_pk_bf16_f32 v19, v222, v223
    buffer_store_dwordx4 v[16:19], v24, s[48:51], s41 offen offset:3072 sc1
    v_max_f32 v224, 0, v224
    v_max_f32 v225, 0, v225
    v_max_f32 v226, 0, v226
    v_max_f32 v227, 0, v227
    v_pk_mul_f32 v[224:225], v[224:225], v[252:253]
    v_pk_mul_f32 v[226:227], v[226:227], v[254:255]
    v_cvt_pk_bf16_f32 v20, v224, v225
    v_cvt_pk_bf16_f32 v21, v226, v227
    v_mov_b32 v22, v20
    v_mov_b32 v23, v21
    v_mov_b32 v4, v20
    v_mov_b32 v5, v21
    s_nop 0
    v_permlane16_swap_b32 v4, v22
    v_permlane16_swap_b32 v5, v23
    s_mov_b64 exec, s[6:7]
    buffer_store_dwordx4 v[20:23], v6, s[48:51], s42 offen offset:3072 sc1
    s_mov_b64 exec, -1
    s_mov_b32 s44, s78
    s_mov_b32 s45, s79
    s_mov_b32 s46, 0x400000
    s_mov_b32 s47, 0x20000
    s_add_u32 s48, s82, 0x1400000
    s_addc_u32 s49, s83, 0
    s_mov_b32 s50, 0x400000
    s_mov_b32 s51, 0x20000
    s_add_u32 s52, s82, 0x2800000
    s_addc_u32 s53, s83, 0
    s_mov_b32 s54, 0x80000
    s_mov_b32 s55, 0x20000
    s_add_u32 s24, s82, 0x4000000
    s_addc_u32 s25, s83, 0
    s_mov_b32 s26, 0x1000000
    s_mov_b32 s27, 0x20000
    s_lshr_b32 s62, s28, 1
    s_and_b32 s41, s28, 1
    s_lshl_b32 s41, s41, 2
    s_and_b32 s5, s29, 3
    s_add_u32 s41, s41, s5
    s_lshr_b32 s5, s29, 2
    s_lshl_b32 s40, s41, 1
    s_add_u32 s40, s40, s36
    s_lshl_b32 s6, s37, 2
    s_add_u32 s6, s6, s62
    s_lshl_b32 s42, s40, 3
    s_add_u32 s42, s42, s6
    s_lshl_b32 s42, s42, 15
    s_lshl_b32 s43, s5, 8
    s_add_u32 s42, s42, s43
    s_lshl_b32 s57, s40, 18
    s_lshl_b32 s58, s5, 15
    s_add_u32 s57, s57, s58
    s_lshl_b32 s58, s6, 10
    s_add_u32 s57, s57, s58
    s_lshl_b32 s59, s40, 13
    s_lshl_b32 s60, s37, 8
    s_add_u32 s59, s59, s60
    s_lshl_b32 s60, s62, 2
    s_add_u32 s59, s59, s60
    s_add_u32 s60, s59, 262144
    s_lshl_b32 s61, s2, 2
    s_add_u32 s61, s61, s3
    s_lshl_b32 s61, s61, 14
    v_and_b32 v2, 15, v1
    v_lshrrev_b32 v3, 4, v1
    v_lshlrev_b32 v6, 4, v2
    v_lshl_add_u32 v6, v3, 11, v6
    v_lshlrev_b32 v24, 4, v1
    s_add_u32 s8, s82, 0x1800000
    s_addc_u32 s9, s83, 0
    s_mov_b32 s10, 0xe00000
    s_mov_b32 s11, 0x20000
    s_mul_i32 s16, s40, 917504
    s_mul_i32 s4, s62, 229376
    s_add_u32 s16, s16, s4
    s_lshl_b32 s4, s37, 12
    s_add_u32 s16, s16, s4
    s_lshl_b32 s4, s62, 10
    v_add_u32 v216, s4, v24
    v_xor_b32 v217, 1024, v216
    v_xor_b32 v218, 2048, v216
    v_xor_b32 v219, 3072, v216
    v_bfe_u32 v2, v1, 3, 2
    v_xor_b32 v2, 0, v2
    v_lshlrev_b32 v200, 5, v2
    v_and_b32 v2, 3, v1
    v_lshl_add_u32 v200, v2, 3, v200
    v_bfe_u32 v2, v1, 2, 3
    v_lshl_add_u32 v200, v2, 7, v200
    v_lshrrev_b32 v2, 5, v1
    v_lshl_add_u32 v200, v2, 10, v200
    v_add_u32 v201, 49152, v200
    v_add_u32 v202, 98304, v200
    v_add_u32 v203, 147456, v200
    v_bfe_u32 v2, v1, 3, 2
    v_xor_b32 v2, 1, v2
    v_lshlrev_b32 v204, 5, v2
    v_and_b32 v2, 3, v1
    v_lshl_add_u32 v204, v2, 3, v204
    v_bfe_u32 v2, v1, 2, 3
    v_lshl_add_u32 v204, v2, 7, v204
    v_lshrrev_b32 v2, 5, v1
    v_lshl_add_u32 v204, v2, 10, v204
    v_add_u32 v205, 49152, v204
    v_add_u32 v206, 98304, v204
    v_add_u32 v207, 147456, v204
    v_bfe_u32 v2, v1, 3, 2
    v_xor_b32 v2, 2, v2
    v_lshlrev_b32 v208, 5, v2
    v_and_b32 v2, 3, v1
    v_lshl_add_u32 v208, v2, 3, v208
    v_bfe_u32 v2, v1, 2, 3
    v_lshl_add_u32 v208, v2, 7, v208
    v_lshrrev_b32 v2, 5, v1
    v_lshl_add_u32 v208, v2, 10, v208
    v_add_u32 v209, 49152, v208
    v_add_u32 v210, 98304, v208
    v_add_u32 v211, 147456, v208
    v_bfe_u32 v2, v1, 3, 2
    v_xor_b32 v2, 3, v2
    v_lshlrev_b32 v212, 5, v2
    v_and_b32 v2, 3, v1
    v_lshl_add_u32 v212, v2, 3, v212
    v_bfe_u32 v2, v1, 2, 3
    v_lshl_add_u32 v212, v2, 7, v212
    v_lshrrev_b32 v2, 5, v1
    v_lshl_add_u32 v212, v2, 10, v212
    v_add_u32 v213, 49152, v212
    v_add_u32 v214, 98304, v212
    v_add_u32 v215, 147456, v212
    v_mov_b32 v32, 0
    v_mov_b32 v33, 0
    v_mov_b32 v34, 0
    v_mov_b32 v35, 0
    v_mov_b32 v36, 0
    v_mov_b32 v37, 0
    v_mov_b32 v38, 0
    v_mov_b32 v39, 0
    v_mov_b32 v40, 0
    v_mov_b32 v41, 0
    v_mov_b32 v42, 0
    v_mov_b32 v43, 0
    v_mov_b32 v44, 0
    v_mov_b32 v45, 0
    v_mov_b32 v46, 0
    v_mov_b32 v47, 0
    v_mov_b32 v48, 0
    v_mov_b32 v49, 0
    v_mov_b32 v50, 0
    v_mov_b32 v51, 0
    v_mov_b32 v52, 0
    v_mov_b32 v53, 0
    v_mov_b32 v54, 0
    v_mov_b32 v55, 0
    v_mov_b32 v56, 0
    v_mov_b32 v57, 0
    v_mov_b32 v58, 0
    v_mov_b32 v59, 0
    v_mov_b32 v60, 0
    v_mov_b32 v61, 0
    v_mov_b32 v62, 0
    v_mov_b32 v63, 0
    v_mov_b32 v64, 0
    v_mov_b32 v65, 0
    v_mov_b32 v66, 0
    v_mov_b32 v67, 0
    v_mov_b32 v68, 0
    v_mov_b32 v69, 0
    v_mov_b32 v70, 0
    v_mov_b32 v71, 0
    v_mov_b32 v72, 0
    v_mov_b32 v73, 0
    v_mov_b32 v74, 0
    v_mov_b32 v75, 0
    v_mov_b32 v76, 0
    v_mov_b32 v77, 0
    v_mov_b32 v78, 0
    v_mov_b32 v79, 0
    v_mov_b32 v80, 0
    v_mov_b32 v81, 0
    v_mov_b32 v82, 0
    v_mov_b32 v83, 0
    v_mov_b32 v84, 0
    v_mov_b32 v85, 0
    v_mov_b32 v86, 0
    v_mov_b32 v87, 0
    v_mov_b32 v88, 0
    v_mov_b32 v89, 0
    v_mov_b32 v90, 0
    v_mov_b32 v91, 0
    v_mov_b32 v92, 0
    v_mov_b32 v93, 0
    v_mov_b32 v94, 0
    v_mov_b32 v95, 0
    v_mov_b32 v96, 0
    v_mov_b32 v97, 0
    v_mov_b32 v98, 0
    v_mov_b32 v99, 0
    v_mov_b32 v100, 0
    v_mov_b32 v101, 0
    v_mov_b32 v102, 0
    v_mov_b32 v103, 0
    v_mov_b32 v104, 0
    v_mov_b32 v105, 0
    v_mov_b32 v106, 0
    v_mov_b32 v107, 0
    v_mov_b32 v108, 0
    v_mov_b32 v109, 0
    v_mov_b32 v110, 0
    v_mov_b32 v111, 0
    v_mov_b32 v112, 0
    v_mov_b32 v113, 0
    v_mov_b32 v114, 0
    v_mov_b32 v115, 0
    v_mov_b32 v116, 0
    v_mov_b32 v117, 0
    v_mov_b32 v118, 0
    v_mov_b32 v119, 0
    v_mov_b32 v120, 0
    v_mov_b32 v121, 0
    v_mov_b32 v122, 0
    v_mov_b32 v123, 0
    v_mov_b32 v124, 0
    v_mov_b32 v125, 0
    v_mov_b32 v126, 0
    v_mov_b32 v127, 0
    v_mov_b32 v128, 0
    v_mov_b32 v129, 0
    v_mov_b32 v130, 0
    v_mov_b32 v131, 0
    v_mov_b32 v132, 0
    v_mov_b32 v133, 0
    v_mov_b32 v134, 0
    v_mov_b32 v135, 0
    v_mov_b32 v136, 0
    v_mov_b32 v137, 0
    v_mov_b32 v138, 0
    v_mov_b32 v139, 0
    v_mov_b32 v140, 0
    v_mov_b32 v141, 0
    v_mov_b32 v142, 0
    v_mov_b32 v143, 0
    v_mov_b32 v144, 0
    v_mov_b32 v145, 0
    v_mov_b32 v146, 0
    v_mov_b32 v147, 0
    v_mov_b32 v148, 0
    v_mov_b32 v149, 0
    v_mov_b32 v150, 0
    v_mov_b32 v151, 0
    v_mov_b32 v152, 0
    v_mov_b32 v153, 0
    v_mov_b32 v154, 0
    v_mov_b32 v155, 0
    v_mov_b32 v156, 0
    v_mov_b32 v157, 0
    v_mov_b32 v158, 0
    v_mov_b32 v159, 0
    s_lshl_b32 s4, s94, 2
    s_add_u32 s4, s4, s3
    s_lshl_b32 s5, s4, 5
    s_add_u32 s4, s5, s95
    s_lshl_b32 s4, s4, 2
    s_add_u32 s4, s4, 8192
    v_mov_b32 v2, s88
    v_mov_b32 v3, 0
    s_mov_b64 exec, 1
    s_cmp_eq_u32 s89, 0
    s_waitcnt vmcnt(0)
    s_cbranch_scc1 L_s4_21_g
    buffer_store_dword v2, v3, s[84:87], s4 offen
    s_branch L_s4_21
L_s4_21_g:
    buffer_store_dword v2, v3, s[84:87], s4 offen sc1
L_s4_21:
    s_mov_b64 exec, -1
    s_barrier
    ds_read_b64_tr_b16 a[0:1], v202 offset:16384
    ds_read_b64_tr_b16 a[2:3], v202 offset:18432
    ds_read_b64_tr_b16 a[4:5], v206 offset:16384
    ds_read_b64_tr_b16 a[6:7], v206 offset:18432
    ds_read_b64_tr_b16 a[8:9], v210 offset:16384
    ds_read_b64_tr_b16 a[10:11], v210 offset:18432
    ds_read_b64_tr_b16 a[12:13], v214 offset:16384
    ds_read_b64_tr_b16 a[14:15], v214 offset:18432
    ds_read_b64_tr_b16 a[16:17], v202 offset:20480
    ds_read_b64_tr_b16 a[18:19], v202 offset:22528
    ds_read_b64_tr_b16 a[20:21], v206 offset:20480
    ds_read_b64_tr_b16 a[22:23], v206 offset:22528
    ds_read_b64_tr_b16 a[24:25], v210 offset:20480
    ds_read_b64_tr_b16 a[26:27], v210 offset:22528
    ds_read_b64_tr_b16 a[28:29], v214 offset:20480
    ds_read_b64_tr_b16 a[30:31], v214 offset:22528
    s_lshl_b32 s5, s5, 2
    s_lshl_b32 s6, s62, 5
    s_add_u32 s5, s5, s6
    s_add_u32 s5, s5, 8192
    v_lshlrev_b32 v2, 2, v1
    s_mov_b64 exec, 0xff
    s_mov_b32 s4, 0x20000
L_spin_22:
    buffer_load_dword v4, v2, s[84:87], s5 offen sc1
    s_waitcnt vmcnt(0)
    v_cmp_ne_u32 vcc, s88, v4
    s_sub_u32 s4, s4, 1
    s_nop 3
    s_cbranch_vccz L_spin_22_ok
    s_cmp_eq_u32 s4, 0
    s_cbranch_scc0 L_spin_22
L_spin_22_ok:
    s_mov_b64 exec, -1
    buffer_load_dwordx4 a[64:67], v216, s[8:11], s16 offen
    buffer_load_dwordx4 a[68:71], v217, s[8:11], s16 offen
    buffer_load_dwordx4 a[72:75], v218, s[8:11], s16 offen
    buffer_load_dwordx4 a[76:79], v219, s[8:11], s16 offen
    s_add_u32 s16, s16, 8192
    buffer_load_dwordx4 a[80:83], v216, s[8:11], s16 offen
    buffer_load_dwordx4 a[84:87], v217, s[8:11], s16 offen
    buffer_load_dwordx4 a[88:91], v218, s[8:11], s16 offen
    buffer_load_dwordx4 a[92:95], v219, s[8:11], s16 offen
    s_add_u32 s16, s16, 8192
    buffer_load_dwordx4 a[96:99], v216, s[8:11], s16 offen
    buffer_load_dwordx4 a[100:103], v217, s[8:11], s16 offen
    buffer_load_dwordx4 a[104:107], v218, s[8:11], s16 offen
    buffer_load_dwordx4 a[108:111], v219, s[8:11], s16 offen
    s_add_u32 s16, s16, 8192
    s_waitcnt vmcnt(8) lgkmcnt(0)
    v_mfma_f32_16x16x32_bf16 v[32:35], a[0:3], a[64:67], v[32:35]
    ds_read_b64_tr_b16 a[32:33], v202 offset:24576
    v_mfma_f32_16x16x32_bf16 v[64:67], a[0:3], a[68:71], v[64:67]
    buffer_load_dwordx4 a[112:115], v216, s[8:11], s16 offen
    v_mfma_f32_16x16x32_bf16 v[96:99], a[0:3], a[72:75], v[96:99]
    ds_read_b64_tr_b16 a[34:35], v202 offset:26624
    v_mfma_f32_16x16x32_bf16 v[128:131], a[0:3], a[76:79], v[128:131]
    s_add_u32 m0, s20, 49152
    v_mfma_f32_16x16x32_bf16 v[36:39], a[4:7], a[64:67], v[36:39]
    ds_read_b64_tr_b16 a[36:37], v206 offset:24576
    v_mfma_f32_16x16x32_bf16 v[68:71], a[4:7], a[68:71], v[68:71]
    ds_read_b64_tr_b16 a[38:39], v206 offset:26624
    v_mfma_f32_16x16x32_bf16 v[100:103], a[4:7], a[72:75], v[100:103]
    buffer_load_dwordx4 v26, s[12:15], s17 offen lds
    v_mfma_f32_16x16x32_bf16 v[132:135], a[4:7], a[76:79], v[132:135]
    ds_read_b64_tr_b16 a[40:41], v210 offset:24576
    v_mfma_f32_16x16x32_bf16 v[40:43], a[8:11], a[64:67], v[40:43]
    buffer_load_dwordx4 a[116:119], v217, s[8:11], s16 offen
    v_mfma_f32_16x16x32_bf16 v[72:75], a[8:11], a[68:71], v[72:75]
    ds_read_b64_tr_b16 a[42:43], v210 offset:26624
    v_mfma_f32_16x16x32_bf16 v[104:107], a[8:11], a[72:75], v[104:107]
    ds_read_b64_tr_b16 a[44:45], v214 offset:24576
    v_mfma_f32_16x16x32_bf16 v[136:139], a[8:11], a[76:79], v[136:139]
    s_add_u32 m0, s20, 53248
    v_mfma_f32_16x16x32_bf16 v[44:47], a[12:15], a[64:67], v[44:47]
    ds_read_b64_tr_b16 a[46:47], v214 offset:26624
    v_mfma_f32_16x16x32_bf16 v[76:79], a[12:15], a[68:71], v[76:79]
    buffer_load_dwordx4 v27, s[12:15], s17 offen lds
    v_mfma_f32_16x16x32_bf16 v[108:111], a[12:15], a[72:75], v[108:111]
    ds_read_b64_tr_b16 a[48:49], v202 offset:28672
    v_mfma_f32_16x16x32_bf16 v[140:143], a[12:15], a[76:79], v[140:143]
    ds_read_b64_tr_b16 a[50:51], v202 offset:30720
    v_mfma_f32_16x16x32_bf16 v[48:51], a[16:19], a[64:67], v[48:51]
    buffer_load_dwordx4 a[120:123], v218, s[8:11], s16 offen
    v_mfma_f32_16x16x32_bf16 v[80:83], a[16:19], a[68:71], v[80:83]
    ds_read_b64_tr_b16 a[52:53], v206 offset:28672
    v_mfma_f32_16x16x32_bf16 v[112:115], a[16:19], a[72:75], v[112:115]
    s_add_u32 m0, s20, 57344
    v_mfma_f32_16x16x32_bf16 v[144:147], a[16:19], a[76:79], v[144:147]
    ds_read_b64_tr_b16 a[54:55], v206 offset:30720
    v_mfma_f32_16x16x32_bf16 v[52:55], a[20:23], a[64:67], v[52:55]
    buffer_load_dwordx4 v28, s[12:15], s17 offen lds
    v_mfma_f32_16x16x32_bf16 v[84:87], a[20:23], a[68:71], v[84:87]
    ds_read_b64_tr_b16 a[56:57], v210 offset:28672
    v_mfma_f32_16x16x32_bf16 v[116:119], a[20:23], a[72:75], v[116:119]
    ds_read_b64_tr_b16 a[58:59], v210 offset:30720
    v_mfma_f32_16x16x32_bf16 v[148:151], a[20:23], a[76:79], v[148:151]
    buffer_load_dwordx4 a[124:127], v219, s[8:11], s16 offen
    v_mfma_f32_16x16x32_bf16 v[56:59], a[24:27], a[64:67], v[56:59]
    ds_read_b64_tr_b16 a[60:61], v214 offset:28672
    v_mfma_f32_16x16x32_bf16 v[88:91], a[24:27], a[68:71], v[88:91]
    s_add_u32 m0, s20, 61440
    v_mfma_f32_16x16x32_bf16 v[120:123], a[24:27], a[72:75], v[120:123]
    ds_read_b64_tr_b16 a[62:63], v214 offset:30720
    v_mfma_f32_16x16x32_bf16 v[152:155], a[24:27], a[76:79], v[152:155]
    v_mfma_f32_16x16x32_bf16 v[60:63], a[28:31], a[64:67], v[60:63]
    buffer_load_dwordx4 v29, s[12:15], s17 offen lds
    v_mfma_f32_16x16x32_bf16 v[92:95], a[28:31], a[68:71], v[92:95]
    v_mfma_f32_16x16x32_bf16 v[124:127], a[28:31], a[72:75], v[124:127]
    s_add_u32 s16, s16, 8192
    v_mfma_f32_16x16x32_bf16 v[156:159], a[28:31], a[76:79], v[156:159]
    s_waitcnt vmcnt(12) lgkmcnt(0)
    v_mfma_f32_16x16x32_bf16 v[32:35], a[32:35], a[80:83], v[32:35]
    ds_read_b64_tr_b16 a[0:1], v202 offset:32768
    v_mfma_f32_16x16x32_bf16 v[64:67], a[32:35], a[84:87], v[64:67]
    buffer_load_dwordx4 a[64:67], v216, s[8:11], s16 offen
    v_mfma_f32_16x16x32_bf16 v[96:99], a[32:35], a[88:91], v[96:99]
    ds_read_b64_tr_b16 a[2:3], v202 offset:34816
    v_mfma_f32_16x16x32_bf16 v[128:131], a[32:35], a[92:95], v[128:131]
    ds_read_b64_tr_b16 a[4:5], v206 offset:32768
    v_mfma_f32_16x16x32_bf16 v[36:39], a[36:39], a[80:83], v[36:39]
    s_add_u32 s17, s17, 131072
    v_mfma_f32_16x16x32_bf16 v[68:71], a[36:39], a[84:87], v[68:71]
    ds_read_b64_tr_b16 a[6:7], v206 offset:34816
    v_mfma_f32_16x16x32_bf16 v[100:103], a[36:39], a[88:91], v[100:103]
    buffer_load_dwordx4 a[68:71], v217, s[8:11], s16 offen
    v_mfma_f32_16x16x32_bf16 v[132:135], a[36:39], a[92:95], v[132:135]
    ds_read_b64_tr_b16 a[8:9], v210 offset:32768
    v_mfma_f32_16x16x32_bf16 v[40:43], a[40:43], a[80:83], v[40:43]
    ds_read_b64_tr_b16 a[10:11], v210 offset:34816
    v_mfma_f32_16x16x32_bf16 v[72:75], a[40:43], a[84:87], v[72:75]
    s_add_u32 m0, s20, 65536
    v_mfma_f32_16x16x32_bf16 v[104:107], a[40:43], a[88:91], v[104:107]
    ds_read_b64_tr_b16 a[12:13], v214 offset:32768
    v_mfma_f32_16x16x32_bf16 v[136:139], a[40:43], a[92:95], v[136:139]
    ds_read_b64_tr_b16 a[14:15], v214 offset:34816
    v_mfma_f32_16x16x32_bf16 v[44:47], a[44:47], a[80:83], v[44:47]
    buffer_load_dwordx4 v26, s[12:15], s17 offen lds
    v_mfma_f32_16x16x32_bf16 v[76:79], a[44:47], a[84:87], v[76:79]
    ds_read_b64_tr_b16 a[16:17], v202 offset:36864
    v_mfma_f32_16x16x32_bf16 v[108:111], a[44:47], a[88:91], v[108:111]
    buffer_load_dwordx4 a[72:75], v218, s[8:11], s16 offen
    v_mfma_f32_16x16x32_bf16 v[140:143], a[44:47], a[92:95], v[140:143]
    ds_read_b64_tr_b16 a[18:19], v202 offset:38912
    v_mfma_f32_16x16x32_bf16 v[48:51], a[48:51], a[80:83], v[48:51]
    ds_read_b64_tr_b16 a[20:21], v206 offset:36864
    v_mfma_f32_16x16x32_bf16 v[80:83], a[48:51], a[84:87], v[80:83]
    s_add_u32 m0, s20, 69632
    v_mfma_f32_16x16x32_bf16 v[112:115], a[48:51], a[88:91], v[112:115]
    ds_read_b64_tr_b16 a[22:23], v206 offset:38912
    v_mfma_f32_16x16x32_bf16 v[144:147], a[48:51], a[92:95], v[144:147]
    ds_read_b64_tr_b16 a[24:25], v210 offset:36864
    v_mfma_f32_16x16x32_bf16 v[52:55], a[52:55], a[80:83], v[52:55]
    buffer_load_dwordx4 v27, s[12:15], s17 offen lds
    v_mfma_f32_16x16x32_bf16 v[84:87], a[52:55], a[84:87], v[84:87]
    ds_read_b64_tr_b16 a[26:27], v210 offset:38912
    v_mfma_f32_16x16x32_bf16 v[116:119], a[52:55], a[88:91], v[116:119]
    buffer_load_dwordx4 a[76:79], v219, s[8:11], s16 offen
    v_mfma_f32_16x16x32_bf16 v[148:151], a[52:55], a[92:95], v[148:151]
    ds_read_b64_tr_b16 a[28:29], v214 offset:36864
    v_mfma_f32_16x16x32_bf16 v[56:59], a[56:59], a[80:83], v[56:59]
    ds_read_b64_tr_b16 a[30:31], v214 offset:38912
    v_mfma_f32_16x16x32_bf16 v[88:91], a[56:59], a[84:87], v[88:91]
    s_add_u32 m0, s20, 73728
    v_mfma_f32_16x16x32_bf16 v[120:123], a[56:59], a[88:91], v[120:123]
    v_mfma_f32_16x16x32_bf16 v[152:155], a[56:59], a[92:95], v[152:155]
    v_mfma_f32_16x16x32_bf16 v[60:63], a[60:63], a[80:83], v[60:63]
    buffer_load_dwordx4 v28, s[12:15], s17 offen lds
    v_mfma_f32_16x16x32_bf16 v[92:95], a[60:63], a[84:87], v[92:95]
    v_mfma_f32_16x16x32_bf16 v[124:127], a[60:63], a[88:91], v[124:127]
    s_add_u32 s16, s16, 8192
    v_mfma_f32_16x16x32_bf16 v[156:159], a[60:63], a[92:95], v[156:159]
    s_waitcnt vmcnt(15) lgkmcnt(0)
    v_mfma_f32_16x16x32_bf16 v[32:35], a[0:3], a[96:99], v[32:35]
    ds_read_b64_tr_b16 a[32:33], v202 offset:40960
    v_mfma_f32_16x16x32_bf16 v[64:67], a[0:3], a[100:103], v[64:67]
    buffer_load_dwordx4 a[80:83], v216, s[8:11], s16 offen
    v_mfma_f32_16x16x32_bf16 v[96:99], a[0:3], a[104:107], v[96:99]
    ds_read_b64_tr_b16 a[34:35], v202 offset:43008
    v_mfma_f32_16x16x32_bf16 v[128:131], a[0:3], a[108:111], v[128:131]
    ds_read_b64_tr_b16 a[36:37], v206 offset:40960
    v_mfma_f32_16x16x32_bf16 v[36:39], a[4:7], a[96:99], v[36:39]
    s_add_u32 m0, s20, 77824
    v_mfma_f32_16x16x32_bf16 v[68:71], a[4:7], a[100:103], v[68:71]
    ds_read_b64_tr_b16 a[38:39], v206 offset:43008
    v_mfma_f32_16x16x32_bf16 v[100:103], a[4:7], a[104:107], v[100:103]
    ds_read_b64_tr_b16 a[40:41], v210 offset:40960
    v_mfma_f32_16x16x32_bf16 v[132:135], a[4:7], a[108:111], v[132:135]
    ds_read_b64_tr_b16 a[42:43], v210 offset:43008
    v_mfma_f32_16x16x32_bf16 v[40:43], a[8:11], a[96:99], v[40:43]
    buffer_load_dwordx4 v29, s[12:15], s17 offen lds
    v_mfma_f32_16x16x32_bf16 v[72:75], a[8:11], a[100:103], v[72:75]
    ds_read_b64_tr_b16 a[44:45], v214 offset:40960
    v_mfma_f32_16x16x32_bf16 v[104:107], a[8:11], a[104:107], v[104:107]
    ds_read_b64_tr_b16 a[46:47], v214 offset:43008
    v_mfma_f32_16x16x32_bf16 v[136:139], a[8:11], a[108:111], v[136:139]
    buffer_load_dwordx4 a[84:87], v217, s[8:11], s16 offen
    v_mfma_f32_16x16x32_bf16 v[44:47], a[12:15], a[96:99], v[44:47]
    ds_read_b64_tr_b16 a[48:49], v202 offset:45056
    v_mfma_f32_16x16x32_bf16 v[76:79], a[12:15], a[100:103], v[76:79]
    ds_read_b64_tr_b16 a[50:51], v202 offset:47104
    v_mfma_f32_16x16x32_bf16 v[108:111], a[12:15], a[104:107], v[108:111]
    s_add_u32 s17, s17, 131072
    v_mfma_f32_16x16x32_bf16 v[140:143], a[12:15], a[108:111], v[140:143]
    ds_read_b64_tr_b16 a[52:53], v206 offset:45056
    v_mfma_f32_16x16x32_bf16 v[48:51], a[16:19], a[96:99], v[48:51]
    ds_read_b64_tr_b16 a[54:55], v206 offset:47104
    v_mfma_f32_16x16x32_bf16 v[80:83], a[16:19], a[100:103], v[80:83]
    buffer_load_dwordx4 a[88:91], v218, s[8:11], s16 offen
    v_mfma_f32_16x16x32_bf16 v[112:115], a[16:19], a[104:107], v[112:115]
    ds_read_b64_tr_b16 a[56:57], v210 offset:45056
    v_mfma_f32_16x16x32_bf16 v[144:147], a[16:19], a[108:111], v[144:147]
    ds_read_b64_tr_b16 a[58:59], v210 offset:47104
    v_mfma_f32_16x16x32_bf16 v[52:55], a[20:23], a[96:99], v[52:55]
    s_add_u32 m0, s20, 81920
    v_mfma_f32_16x16x32_bf16 v[84:87], a[20:23], a[100:103], v[84:87]
    ds_read_b64_tr_b16 a[60:61], v214 offset:45056
    v_mfma_f32_16x16x32_bf16 v[116:119], a[20:23], a[104:107], v[116:119]
    ds_read_b64_tr_b16 a[62:63], v214 offset:47104
    v_mfma_f32_16x16x32_bf16 v[148:151], a[20:23], a[108:111], v[148:151]
    v_mfma_f32_16x16x32_bf16 v[56:59], a[24:27], a[96:99], v[56:59]
    buffer_load_dwordx4 v26, s[12:15], s17 offen lds
    v_mfma_f32_16x16x32_bf16 v[88:91], a[24:27], a[100:103], v[88:91]
    v_mfma_f32_16x16x32_bf16 v[120:123], a[24:27], a[104:107], v[120:123]
    v_mfma_f32_16x16x32_bf16 v[152:155], a[24:27], a[108:111], v[152:155]
    buffer_load_dwordx4 a[92:95], v219, s[8:11], s16 offen
    v_mfma_f32_16x16x32_bf16 v[60:63], a[28:31], a[96:99], v[60:63]
    v_mfma_f32_16x16x32_bf16 v[92:95], a[28:31], a[100:103], v[92:95]
    v_mfma_f32_16x16x32_bf16 v[124:127], a[28:31], a[104:107], v[124:127]
    s_add_u32 s16, s16, 8192
    v_mfma_f32_16x16x32_bf16 v[156:159], a[28:31], a[108:111], v[156:159]
    s_waitcnt vmcnt(14) lgkmcnt(0)
    v_mfma_f32_16x16x32_bf16 v[32:35], a[32:35], a[112:115], v[32:35]
    ds_read_b64_tr_b16 a[0:1], v203 offset:0
    v_mfma_f32_16x16x32_bf16 v[64:67], a[32:35], a[116:119], v[64:67]
    buffer_load_dwordx4 a[96:99], v216, s[8:11], s16 offen
    v_mfma_f32_16x16x32_bf16 v[96:99], a[32:35], a[120:123], v[96:99]
    ds_read_b64_tr_b16 a[2:3], v203 offset:2048
    v_mfma_f32_16x16x32_bf16 v[128:131], a[32:35], a[124:127], v[128:131]
    ds_read_b64_tr_b16 a[4:5], v207 offset:0
    v_mfma_f32_16x16x32_bf16 v[36:39], a[36:39], a[112:115], v[36:39]
    s_add_u32 m0, s20, 86016
    v_mfma_f32_16x16x32_bf16 v[68:71], a[36:39], a[116:119], v[68:71]
    ds_read_b64_tr_b16 a[6:7], v207 offset:2048
    v_mfma_f32_16x16x32_bf16 v[100:103], a[36:39], a[120:123], v[100:103]
    ds_read_b64_tr_b16 a[8:9], v211 offset:0
    v_mfma_f32_16x16x32_bf16 v[132:135], a[36:39], a[124:127], v[132:135]
    buffer_load_dwordx4 v27, s[12:15], s17 offen lds
    v_mfma_f32_16x16x32_bf16 v[40:43], a[40:43], a[112:115], v[40:43]
    ds_read_b64_tr_b16 a[10:11], v211 offset:2048
    v_mfma_f32_16x16x32_bf16 v[72:75], a[40:43], a[116:119], v[72:75]
    ds_read_b64_tr_b16 a[12:13], v215 offset:0
    v_mfma_f32_16x16x32_bf16 v[104:107], a[40:43], a[120:123], v[104:107]
    buffer_load_dwordx4 a[100:103], v217, s[8:11], s16 offen
    v_mfma_f32_16x16x32_bf16 v[136:139], a[40:43], a[124:127], v[136:139]
    ds_read_b64_tr_b16 a[14:15], v215 offset:2048
    v_mfma_f32_16x16x32_bf16 v[44:47], a[44:47], a[112:115], v[44:47]
    ds_read_b64_tr_b16 a[16:17], v203 offset:4096
    v_mfma_f32_16x16x32_bf16 v[76:79], a[44:47], a[116:119], v[76:79]
    s_add_u32 m0, s20, 90112
    v_mfma_f32_16x16x32_bf16 v[108:111], a[44:47], a[120:123], v[108:111]
    ds_read_b64_tr_b16 a[18:19], v203 offset:6144
    v_mfma_f32_16x16x32_bf16 v[140:143], a[44:47], a[124:127], v[140:143]
    ds_read_b64_tr_b16 a[20:21], v207 offset:4096
    v_mfma_f32_16x16x32_bf16 v[48:51], a[48:51], a[112:115], v[48:51]
    buffer_load_dwordx4 v28, s[12:15], s17 offen lds
    v_mfma_f32_16x16x32_bf16 v[80:83], a[48:51], a[116:119], v[80:83]
    ds_read_b64_tr_b16 a[22:23], v207 offset:6144
    v_mfma_f32_16x16x32_bf16 v[112:115], a[48:51], a[120:123], v[112:115]
    buffer_load_dwordx4 a[104:107], v218, s[8:11], s16 offen
    v_mfma_f32_16x16x32_bf16 v[144:147], a[48:51], a[124:127], v[144:147]
    ds_read_b64_tr_b16 a[24:25], v211 offset:4096
    v_mfma_f32_16x16x32_bf16 v[52:55], a[52:55], a[112:115], v[52:55]
    ds_read_b64_tr_b16 a[26:27], v211 offset:6144
    v_mfma_f32_16x16x32_bf16 v[84:87], a[52:55], a[116:119], v[84:87]
    s_add_u32 m0, s20, 94208
    v_mfma_f32_16x16x32_bf16 v[116:119], a[52:55], a[120:123], v[116:119]
    ds_read_b64_tr_b16 a[28:29], v215 offset:4096
    v_mfma_f32_16x16x32_bf16 v[148:151], a[52:55], a[124:127], v[148:151]
    ds_read_b64_tr_b16 a[30:31], v215 offset:6144
    v_mfma_f32_16x16x32_bf16 v[56:59], a[56:59], a[112:115], v[56:59]
    buffer_load_dwordx4 v29, s[12:15], s17 offen lds
    v_mfma_f32_16x16x32_bf16 v[88:91], a[56:59], a[116:119], v[88:91]
    v_mfma_f32_16x16x32_bf16 v[120:123], a[56:59], a[120:123], v[120:123]
    v_mfma_f32_16x16x32_bf16 v[152:155], a[56:59], a[124:127], v[152:155]
    buffer_load_dwordx4 a[108:111], v219, s[8:11], s16 offen
    v_mfma_f32_16x16x32_bf16 v[60:63], a[60:63], a[112:115], v[60:63]
    v_mfma_f32_16x16x32_bf16 v[92:95], a[60:63], a[116:119], v[92:95]
    v_mfma_f32_16x16x32_bf16 v[124:127], a[60:63], a[120:123], v[124:127]
    s_add_u32 s16, s16, 8192
    v_mfma_f32_16x16x32_bf16 v[156:159], a[60:63], a[124:127], v[156:159]
    s_waitcnt vmcnt(14) lgkmcnt(0)
    v_mfma_f32_16x16x32_bf16 v[32:35], a[0:3], a[64:67], v[32:35]
    ds_read_b64_tr_b16 a[32:33], v203 offset:8192
    v_mfma_f32_16x16x32_bf16 v[64:67], a[0:3], a[68:71], v[64:67]
    buffer_load_dwordx4 a[112:115], v216, s[8:11], s16 offen
    v_mfma_f32_16x16x32_bf16 v[96:99], a[0:3], a[72:75], v[96:99]
    ds_read_b64_tr_b16 a[34:35], v203 offset:10240
    v_mfma_f32_16x16x32_bf16 v[128:131], a[0:3], a[76:79], v[128:131]
    ds_read_b64_tr_b16 a[36:37], v207 offset:8192
    v_mfma_f32_16x16x32_bf16 v[36:39], a[4:7], a[64:67], v[36:39]
    s_add_u32 s17, s17, 131072
    v_mfma_f32_16x16x32_bf16 v[68:71], a[4:7], a[68:71], v[68:71]
    ds_read_b64_tr_b16 a[38:39], v207 offset:10240
    v_mfma_f32_16x16x32_bf16 v[100:103], a[4:7], a[72:75], v[100:103]
    ds_read_b64_tr_b16 a[40:41], v211 offset:8192
    v_mfma_f32_16x16x32_bf16 v[132:135], a[4:7], a[76:79], v[132:135]
    ds_read_b64_tr_b16 a[42:43], v211 offset:10240
    v_mfma_f32_16x16x32_bf16 v[40:43], a[8:11], a[64:67], v[40:43]
    buffer_load_dwordx4 a[116:119], v217, s[8:11], s16 offen
    v_mfma_f32_16x16x32_bf16 v[72:75], a[8:11], a[68:71], v[72:75]
    ds_read_b64_tr_b16 a[44:45], v215 offset:8192
    v_mfma_f32_16x16x32_bf16 v[104:107], a[8:11], a[72:75], v[104:107]
    ds_read_b64_tr_b16 a[46:47], v215 offset:10240
    v_mfma_f32_16x16x32_bf16 v[136:139], a[8:11], a[76:79], v[136:139]
    s_add_u32 m0, s20, 98304
    v_mfma_f32_16x16x32_bf16 v[44:47], a[12:15], a[64:67], v[44:47]
    ds_read_b64_tr_b16 a[48:49], v203 offset:12288
    v_mfma_f32_16x16x32_bf16 v[76:79], a[12:15], a[68:71], v[76:79]
    ds_read_b64_tr_b16 a[50:51], v203 offset:14336
    v_mfma_f32_16x16x32_bf16 v[108:111], a[12:15], a[72:75], v[108:111]
    buffer_load_dwordx4 v26, s[12:15], s17 offen lds
    v_mfma_f32_16x16x32_bf16 v[140:143], a[12:15], a[76:79], v[140:143]
    ds_read_b64_tr_b16 a[52:53], v207 offset:12288
    v_mfma_f32_16x16x32_bf16 v[48:51], a[16:19], a[64:67], v[48:51]
    ds_read_b64_tr_b16 a[54:55], v207 offset:14336
    v_mfma_f32_16x16x32_bf16 v[80:83], a[16:19], a[68:71], v[80:83]
    buffer_load_dwordx4 a[120:123], v218, s[8:11], s16 offen
    v_mfma_f32_16x16x32_bf16 v[112:115], a[16:19], a[72:75], v[112:115]
    ds_read_b64_tr_b16 a[56:57], v211 offset:12288
    v_mfma_f32_16x16x32_bf16 v[144:147], a[16:19], a[76:79], v[144:147]
    ds_read_b64_tr_b16 a[58:59], v211 offset:14336
    v_mfma_f32_16x16x32_bf16 v[52:55], a[20:23], a[64:67], v[52:55]
    s_add_u32 m0, s20, 102400
    v_mfma_f32_16x16x32_bf16 v[84:87], a[20:23], a[68:71], v[84:87]
    ds_read_b64_tr_b16 a[60:61], v215 offset:12288
    v_mfma_f32_16x16x32_bf16 v[116:119], a[20:23], a[72:75], v[116:119]
    ds_read_b64_tr_b16 a[62:63], v215 offset:14336
    v_mfma_f32_16x16x32_bf16 v[148:151], a[20:23], a[76:79], v[148:151]
    v_mfma_f32_16x16x32_bf16 v[56:59], a[24:27], a[64:67], v[56:59]
    buffer_load_dwordx4 v27, s[12:15], s17 offen lds
    v_mfma_f32_16x16x32_bf16 v[88:91], a[24:27], a[68:71], v[88:91]
    v_mfma_f32_16x16x32_bf16 v[120:123], a[24:27], a[72:75], v[120:123]
    v_mfma_f32_16x16x32_bf16 v[152:155], a[24:27], a[76:79], v[152:155]
    buffer_load_dwordx4 a[124:127], v219, s[8:11], s16 offen
    v_mfma_f32_16x16x32_bf16 v[60:63], a[28:31], a[64:67], v[60:63]
    v_mfma_f32_16x16x32_bf16 v[92:95], a[28:31], a[68:71], v[92:95]
    v_mfma_f32_16x16x32_bf16 v[124:127], a[28:31], a[72:75], v[124:127]
    s_add_u32 s16, s16, 8192
    v_mfma_f32_16x16x32_bf16 v[156:159], a[28:31], a[76:79], v[156:159]
    s_waitcnt vmcnt(13) lgkmcnt(0)
    v_mfma_f32_16x16x32_bf16 v[32:35], a[32:35], a[80:83], v[32:35]
    ds_read_b64_tr_b16 a[0:1], v200 offset:0
    v_mfma_f32_16x16x32_bf16 v[64:67], a[32:35], a[84:87], v[64:67]
    buffer_load_dwordx4 a[64:67], v216, s[8:11], s16 offen
    v_mfma_f32_16x16x32_bf16 v[96:99], a[32:35], a[88:91], v[96:99]
    ds_read_b64_tr_b16 a[2:3], v200 offset:2048
    v_mfma_f32_16x16x32_bf16 v[128:131], a[32:35], a[92:95], v[128:131]
    ds_read_b64_tr_b16 a[4:5], v204 offset:0
    v_mfma_f32_16x16x32_bf16 v[36:39], a[36:39], a[80:83], v[36:39]
    s_add_u32 m0, s20, 106496
    v_mfma_f32_16x16x32_bf16 v[68:71], a[36:39], a[84:87], v[68:71]
    ds_read_b64_tr_b16 a[6:7], v204 offset:2048
    v_mfma_f32_16x16x32_bf16 v[100:103], a[36:39], a[88:91], v[100:103]
    ds_read_b64_tr_b16 a[8:9], v208 offset:0
    v_mfma_f32_16x16x32_bf16 v[132:135], a[36:39], a[92:95], v[132:135]
    ds_read_b64_tr_b16 a[10:11], v208 offset:2048
    v_mfma_f32_16x16x32_bf16 v[40:43], a[40:43], a[80:83], v[40:43]
    buffer_load_dwordx4 v28, s[12:15], s17 offen lds
    v_mfma_f32_16x16x32_bf16 v[72:75], a[40:43], a[84:87], v[72:75]
    ds_read_b64_tr_b16 a[12:13], v212 offset:0
    v_mfma_f32_16x16x32_bf16 v[104:107], a[40:43], a[88:91], v[104:107]
    ds_read_b64_tr_b16 a[14:15], v212 offset:2048
    v_mfma_f32_16x16x32_bf16 v[136:139], a[40:43], a[92:95], v[136:139]
    buffer_load_dwordx4 a[68:71], v217, s[8:11], s16 offen
    v_mfma_f32_16x16x32_bf16 v[44:47], a[44:47], a[80:83], v[44:47]
    ds_read_b64_tr_b16 a[16:17], v200 offset:4096
    v_mfma_f32_16x16x32_bf16 v[76:79], a[44:47], a[84:87], v[76:79]
    ds_read_b64_tr_b16 a[18:19], v200 offset:6144
    v_mfma_f32_16x16x32_bf16 v[108:111], a[44:47], a[88:91], v[108:111]
    s_add_u32 m0, s20, 110592
    v_mfma_f32_16x16x32_bf16 v[140:143], a[44:47], a[92:95], v[140:143]
    ds_read_b64_tr_b16 a[20:21], v204 offset:4096
    v_mfma_f32_16x16x32_bf16 v[48:51], a[48:51], a[80:83], v[48:51]
    ds_read_b64_tr_b16 a[22:23], v204 offset:6144
    v_mfma_f32_16x16x32_bf16 v[80:83], a[48:51], a[84:87], v[80:83]
    buffer_load_dwordx4 v29, s[12:15], s17 offen lds
    v_mfma_f32_16x16x32_bf16 v[112:115], a[48:51], a[88:91], v[112:115]
    ds_read_b64_tr_b16 a[24:25], v208 offset:4096
    v_mfma_f32_16x16x32_bf16 v[144:147], a[48:51], a[92:95], v[144:147]
    ds_read_b64_tr_b16 a[26:27], v208 offset:6144
    v_mfma_f32_16x16x32_bf16 v[52:55], a[52:55], a[80:83], v[52:55]
    buffer_load_dwordx4 a[72:75], v218, s[8:11], s16 offen
    v_mfma_f32_16x16x32_bf16 v[84:87], a[52:55], a[84:87], v[84:87]
    ds_read_b64_tr_b16 a[28:29], v212 offset:4096
    v_mfma_f32_16x16x32_bf16 v[116:119], a[52:55], a[88:91], v[116:119]
    ds_read_b64_tr_b16 a[30:31], v212 offset:6144
    v_mfma_f32_16x16x32_bf16 v[148:151], a[52:55], a[92:95], v[148:151]
    v_mfma_f32_16x16x32_bf16 v[56:59], a[56:59], a[80:83], v[56:59]
    s_add_u32 s17, s17, 131072
    v_mfma_f32_16x16x32_bf16 v[88:91], a[56:59], a[84:87], v[88:91]
    v_mfma_f32_16x16x32_bf16 v[120:123], a[56:59], a[88:91], v[120:123]
    v_mfma_f32_16x16x32_bf16 v[152:155], a[56:59], a[92:95], v[152:155]
    buffer_load_dwordx4 a[76:79], v219, s[8:11], s16 offen
    v_mfma_f32_16x16x32_bf16 v[60:63], a[60:63], a[80:83], v[60:63]
    v_mfma_f32_16x16x32_bf16 v[92:95], a[60:63], a[84:87], v[92:95]
    v_mfma_f32_16x16x32_bf16 v[124:127], a[60:63], a[88:91], v[124:127]
    s_add_u32 s16, s16, 8192
    v_mfma_f32_16x16x32_bf16 v[156:159], a[60:63], a[92:95], v[156:159]
    s_waitcnt vmcnt(12) lgkmcnt(0)
    v_mfma_f32_16x16x32_bf16 v[32:35], a[0:3], a[96:99], v[32:35]
    ds_read_b64_tr_b16 a[32:33], v200 offset:8192
    v_mfma_f32_16x16x32_bf16 v[64:67], a[0:3], a[100:103], v[64:67]
    ds_read_b64_tr_b16 a[34:35], v200 offset:10240
    v_mfma_f32_16x16x32_bf16 v[96:99], a[0:3], a[104:107], v[96:99]
    ds_read_b64_tr_b16 a[36:37], v204 offset:8192
    v_mfma_f32_16x16x32_bf16 v[128:131], a[0:3], a[108:111], v[128:131]
    buffer_load_dwordx4 a[80:83], v216, s[8:11], s16 offen
    v_mfma_f32_16x16x32_bf16 v[36:39], a[4:7], a[96:99], v[36:39]
    ds_read_b64_tr_b16 a[38:39], v204 offset:10240
    v_mfma_f32_16x16x32_bf16 v[68:71], a[4:7], a[100:103], v[68:71]
    v_mfma_f32_16x16x32_bf16 v[100:103], a[4:7], a[104:107], v[100:103]
    ds_read_b64_tr_b16 a[40:41], v208 offset:8192
    v_mfma_f32_16x16x32_bf16 v[132:135], a[4:7], a[108:111], v[132:135]
    ds_read_b64_tr_b16 a[42:43], v208 offset:10240
    v_mfma_f32_16x16x32_bf16 v[40:43], a[8:11], a[96:99], v[40:43]
    ds_read_b64_tr_b16 a[44:45], v212 offset:8192
    v_mfma_f32_16x16x32_bf16 v[72:75], a[8:11], a[100:103], v[72:75]
    buffer_load_dwordx4 a[84:87], v217, s[8:11], s16 offen
    v_mfma_f32_16x16x32_bf16 v[104:107], a[8:11], a[104:107], v[104:107]
    v_mfma_f32_16x16x32_bf16 v[136:139], a[8:11], a[108:111], v[136:139]
    ds_read_b64_tr_b16 a[46:47], v212 offset:10240
    v_mfma_f32_16x16x32_bf16 v[44:47], a[12:15], a[96:99], v[44:47]
    ds_read_b64_tr_b16 a[48:49], v200 offset:12288
    v_mfma_f32_16x16x32_bf16 v[76:79], a[12:15], a[100:103], v[76:79]
    ds_read_b64_tr_b16 a[50:51], v200 offset:14336
    v_mfma_f32_16x16x32_bf16 v[108:111], a[12:15], a[104:107], v[108:111]
    v_mfma_f32_16x16x32_bf16 v[140:143], a[12:15], a[108:111], v[140:143]
    ds_read_b64_tr_b16 a[52:53], v204 offset:12288
    v_mfma_f32_16x16x32_bf16 v[48:51], a[16:19], a[96:99], v[48:51]
    buffer_load_dwordx4 a[88:91], v218, s[8:11], s16 offen
    v_mfma_f32_16x16x32_bf16 v[80:83], a[16:19], a[100:103], v[80:83]
    ds_read_b64_tr_b16 a[54:55], v204 offset:14336
    v_mfma_f32_16x16x32_bf16 v[112:115], a[16:19], a[104:107], v[112:115]
    ds_read_b64_tr_b16 a[56:57], v208 offset:12288
    v_mfma_f32_16x16x32_bf16 v[144:147], a[16:19], a[108:111], v[144:147]
    v_mfma_f32_16x16x32_bf16 v[52:55], a[20:23], a[96:99], v[52:55]
    ds_read_b64_tr_b16 a[58:59], v208 offset:14336
    v_mfma_f32_16x16x32_bf16 v[84:87], a[20:23], a[100:103], v[84:87]
    ds_read_b64_tr_b16 a[60:61], v212 offset:12288
    v_mfma_f32_16x16x32_bf16 v[116:119], a[20:23], a[104:107], v[116:119]
    buffer_load_dwordx4 a[92:95], v219, s[8:11], s16 offen
    v_mfma_f32_16x16x32_bf16 v[148:151], a[20:23], a[108:111], v[148:151]
    ds_read_b64_tr_b16 a[62:63], v212 offset:14336
    v_mfma_f32_16x16x32_bf16 v[56:59], a[24:27], a[96:99], v[56:59]
    v_mfma_f32_16x16x32_bf16 v[88:91], a[24:27], a[100:103], v[88:91]
    v_mfma_f32_16x16x32_bf16 v[120:123], a[24:27], a[104:107], v[120:123]
    v_mfma_f32_16x16x32_bf16 v[152:155], a[24:27], a[108:111], v[152:155]
    v_mfma_f32_16x16x32_bf16 v[60:63], a[28:31], a[96:99], v[60:63]
    s_add_u32 s16, s16, 8192
    v_mfma_f32_16x16x32_bf16 v[92:95], a[28:31], a[100:103], v[92:95]
    v_mfma_f32_16x16x32_bf16 v[124:127], a[28:31], a[104:107], v[124:127]
    v_mfma_f32_16x16x32_bf16 v[156:159], a[28:31], a[108:111], v[156:159]
    s_waitcnt vmcnt(6) lgkmcnt(0)
    s_barrier
    v_mfma_f32_16x16x32_bf16 v[32:35], a[32:35], a[112:115], v[32:35]
    ds_read_b64_tr_b16 a[0:1], v200 offset:16384
    v_mfma_f32_16x16x32_bf16 v[64:67], a[32:35], a[116:119], v[64:67]
    buffer_load_dwordx4 a[96:99], v216, s[8:11], s16 offen
    v_mfma_f32_16x16x32_bf16 v[96:99], a[32:35], a[120:123], v[96:99]
    ds_read_b64_tr_b16 a[2:3], v200 offset:18432
    v_mfma_f32_16x16x32_bf16 v[128:131], a[32:35], a[124:127], v[128:131]
    ds_read_b64_tr_b16 a[4:5], v204 offset:16384
    v_mfma_f32_16x16x32_bf16 v[36:39], a[36:39], a[112:115], v[36:39]
    s_add_u32 m0, s20, 114688
    v_mfma_f32_16x16x32_bf16 v[68:71], a[36:39], a[116:119], v[68:71]
    ds_read_b64_tr_b16 a[6:7], v204 offset:18432
    v_mfma_f32_16x16x32_bf16 v[100:103], a[36:39], a[120:123], v[100:103]
    ds_read_b64_tr_b16 a[8:9], v208 offset:16384
    v_mfma_f32_16x16x32_bf16 v[132:135], a[36:39], a[124:127], v[132:135]
    buffer_load_dwordx4 v26, s[12:15], s17 offen lds
    v_mfma_f32_16x16x32_bf16 v[40:43], a[40:43], a[112:115], v[40:43]
    ds_read_b64_tr_b16 a[10:11], v208 offset:18432
    v_mfma_f32_16x16x32_bf16 v[72:75], a[40:43], a[116:119], v[72:75]
    ds_read_b64_tr_b16 a[12:13], v212 offset:16384
    v_mfma_f32_16x16x32_bf16 v[104:107], a[40:43], a[120:123], v[104:107]
    buffer_load_dwordx4 a[100:103], v217, s[8:11], s16 offen
    v_mfma_f32_16x16x32_bf16 v[136:139], a[40:43], a[124:127], v[136:139]
    ds_read_b64_tr_b16 a[14:15], v212 offset:18432
    v_mfma_f32_16x16x32_bf16 v[44:47], a[44:47], a[112:115], v[44:47]
    ds_read_b64_tr_b16 a[16:17], v200 offset:20480
    v_mfma_f32_16x16x32_bf16 v[76:79], a[44:47], a[116:119], v[76:79]
    s_add_u32 m0, s20, 118784
    v_mfma_f32_16x16x32_bf16 v[108:111], a[44:47], a[120:123], v[108:111]
    ds_read_b64_tr_b16 a[18:19], v200 offset:22528
    v_mfma_f32_16x16x32_bf16 v[140:143], a[44:47], a[124:127], v[140:143]
    ds_read_b64_tr_b16 a[20:21], v204 offset:20480
    v_mfma_f32_16x16x32_bf16 v[48:51], a[48:51], a[112:115], v[48:51]
    buffer_load_dwordx4 v27, s[12:15], s17 offen lds
    v_mfma_f32_16x16x32_bf16 v[80:83], a[48:51], a[116:119], v[80:83]
    ds_read_b64_tr_b16 a[22:23], v204 offset:22528
    v_mfma_f32_16x16x32_bf16 v[112:115], a[48:51], a[120:123], v[112:115]
    buffer_load_dwordx4 a[104:107], v218, s[8:11], s16 offen
    v_mfma_f32_16x16x32_bf16 v[144:147], a[48:51], a[124:127], v[144:147]
    ds_read_b64_tr_b16 a[24:25], v208 offset:20480
    v_mfma_f32_16x16x32_bf16 v[52:55], a[52:55], a[112:115], v[52:55]
    ds_read_b64_tr_b16 a[26:27], v208 offset:22528
    v_mfma_f32_16x16x32_bf16 v[84:87], a[52:55], a[116:119], v[84:87]
    s_add_u32 m0, s20, 122880
    v_mfma_f32_16x16x32_bf16 v[116:119], a[52:55], a[120:123], v[116:119]
    ds_read_b64_tr_b16 a[28:29], v212 offset:20480
    v_mfma_f32_16x16x32_bf16 v[148:151], a[52:55], a[124:127], v[148:151]
    ds_read_b64_tr_b16 a[30:31], v212 offset:22528
    v_mfma_f32_16x16x32_bf16 v[56:59], a[56:59], a[112:115], v[56:59]
    buffer_load_dwordx4 v28, s[12:15], s17 offen lds
    v_mfma_f32_16x16x32_bf16 v[88:91], a[56:59], a[116:119], v[88:91]
    v_mfma_f32_16x16x32_bf16 v[120:123], a[56:59], a[120:123], v[120:123]
    v_mfma_f32_16x16x32_bf16 v[152:155], a[56:59], a[124:127], v[152:155]
    buffer_load_dwordx4 a[108:111], v219, s[8:11], s16 offen
    v_mfma_f32_16x16x32_bf16 v[60:63], a[60:63], a[112:115], v[60:63]
    v_mfma_f32_16x16x32_bf16 v[92:95], a[60:63], a[116:119], v[92:95]
    v_mfma_f32_16x16x32_bf16 v[124:127], a[60:63], a[120:123], v[124:127]
    s_add_u32 s16, s16, 8192
    v_mfma_f32_16x16x32_bf16 v[156:159], a[60:63], a[124:127], v[156:159]
    s_waitcnt vmcnt(11) lgkmcnt(0)
    v_mfma_f32_16x16x32_bf16 v[32:35], a[0:3], a[64:67], v[32:35]
    ds_read_b64_tr_b16 a[32:33], v200 offset:24576
    v_mfma_f32_16x16x32_bf16 v[64:67], a[0:3], a[68:71], v[64:67]
    buffer_load_dwordx4 a[112:115], v216, s[8:11], s16 offen
    v_mfma_f32_16x16x32_bf16 v[96:99], a[0:3], a[72:75], v[96:99]
    ds_read_b64_tr_b16 a[34:35], v200 offset:26624
    v_mfma_f32_16x16x32_bf16 v[128:131], a[0:3], a[76:79], v[128:131]
    ds_read_b64_tr_b16 a[36:37], v204 offset:24576
    v_mfma_f32_16x16x32_bf16 v[36:39], a[4:7], a[64:67], v[36:39]
    s_add_u32 m0, s20, 126976
    v_mfma_f32_16x16x32_bf16 v[68:71], a[4:7], a[68:71], v[68:71]
    ds_read_b64_tr_b16 a[38:39], v204 offset:26624
    v_mfma_f32_16x16x32_bf16 v[100:103], a[4:7], a[72:75], v[100:103]
    ds_read_b64_tr_b16 a[40:41], v208 offset:24576
    v_mfma_f32_16x16x32_bf16 v[132:135], a[4:7], a[76:79], v[132:135]
    ds_read_b64_tr_b16 a[42:43], v208 offset:26624
    v_mfma_f32_16x16x32_bf16 v[40:43], a[8:11], a[64:67], v[40:43]
    buffer_load_dwordx4 v29, s[12:15], s17 offen lds
    v_mfma_f32_16x16x32_bf16 v[72:75], a[8:11], a[68:71], v[72:75]
    ds_read_b64_tr_b16 a[44:45], v212 offset:24576
    v_mfma_f32_16x16x32_bf16 v[104:107], a[8:11], a[72:75], v[104:107]
    ds_read_b64_tr_b16 a[46:47], v212 offset:26624
    v_mfma_f32_16x16x32_bf16 v[136:139], a[8:11], a[76:79], v[136:139]
    buffer_load_dwordx4 a[116:119], v217, s[8:11], s16 offen
    v_mfma_f32_16x16x32_bf16 v[44:47], a[12:15], a[64:67], v[44:47]
    ds_read_b64_tr_b16 a[48:49], v200 offset:28672
    v_mfma_f32_16x16x32_bf16 v[76:79], a[12:15], a[68:71], v[76:79]
    ds_read_b64_tr_b16 a[50:51], v200 offset:30720
    v_mfma_f32_16x16x32_bf16 v[108:111], a[12:15], a[72:75], v[108:111]
    s_add_u32 s17, s17, 131072
    v_mfma_f32_16x16x32_bf16 v[140:143], a[12:15], a[76:79], v[140:143]
    ds_read_b64_tr_b16 a[52:53], v204 offset:28672
    v_mfma_f32_16x16x32_bf16 v[48:51], a[16:19], a[64:67], v[48:51]
    ds_read_b64_tr_b16 a[54:55], v204 offset:30720
    v_mfma_f32_16x16x32_bf16 v[80:83], a[16:19], a[68:71], v[80:83]
    buffer_load_dwordx4 a[120:123], v218, s[8:11], s16 offen
    v_mfma_f32_16x16x32_bf16 v[112:115], a[16:19], a[72:75], v[112:115]
    ds_read_b64_tr_b16 a[56:57], v208 offset:28672
    v_mfma_f32_16x16x32_bf16 v[144:147], a[16:19], a[76:79], v[144:147]
    ds_read_b64_tr_b16 a[58:59], v208 offset:30720
    v_mfma_f32_16x16x32_bf16 v[52:55], a[20:23], a[64:67], v[52:55]
    s_add_u32 m0, s20, 131072
    v_mfma_f32_16x16x32_bf16 v[84:87], a[20:23], a[68:71], v[84:87]
    ds_read_b64_tr_b16 a[60:61], v212 offset:28672
    v_mfma_f32_16x16x32_bf16 v[116:119], a[20:23], a[72:75], v[116:119]
    ds_read_b64_tr_b16 a[62:63], v212 offset:30720
    v_mfma_f32_16x16x32_bf16 v[148:151], a[20:23], a[76:79], v[148:151]
    v_mfma_f32_16x16x32_bf16 v[56:59], a[24:27], a[64:67], v[56:59]
    buffer_load_dwordx4 v26, s[12:15], s17 offen lds
    v_mfma_f32_16x16x32_bf16 v[88:91], a[24:27], a[68:71], v[88:91]
    v_mfma_f32_16x16x32_bf16 v[120:123], a[24:27], a[72:75], v[120:123]
    v_mfma_f32_16x16x32_bf16 v[152:155], a[24:27], a[76:79], v[152:155]
    buffer_load_dwordx4 a[124:127], v219, s[8:11], s16 offen
    v_mfma_f32_16x16x32_bf16 v[60:63], a[28:31], a[64:67], v[60:63]
    v_mfma_f32_16x16x32_bf16 v[92:95], a[28:31], a[68:71], v[92:95]
    v_mfma_f32_16x16x32_bf16 v[124:127], a[28:31], a[72:75], v[124:127]
    s_add_u32 s16, s16, 8192
    v_mfma_f32_16x16x32_bf16 v[156:159], a[28:31], a[76:79], v[156:159]
    s_waitcnt vmcnt(13) lgkmcnt(0)
    v_mfma_f32_16x16x32_bf16 v[32:35], a[32:35], a[80:83], v[32:35]
    ds_read_b64_tr_b16 a[0:1], v200 offset:32768
    v_mfma_f32_16x16x32_bf16 v[64:67], a[32:35], a[84:87], v[64:67]
    buffer_load_dwordx4 a[64:67], v216, s[8:11], s16 offen
    v_mfma_f32_16x16x32_bf16 v[96:99], a[32:35], a[88:91], v[96:99]
    ds_read_b64_tr_b16 a[2:3], v200 offset:34816
    v_mfma_f32_16x16x32_bf16 v[128:131], a[32:35], a[92:95], v[128:131]
    ds_read_b64_tr_b16 a[4:5], v204 offset:32768
    v_mfma_f32_16x16x32_bf16 v[36:39], a[36:39], a[80:83], v[36:39]
    s_add_u32 m0, s20, 135168
    v_mfma_f32_16x16x32_bf16 v[68:71], a[36:39], a[84:87], v[68:71]
    ds_read_b64_tr_b16 a[6:7], v204 offset:34816
    v_mfma_f32_16x16x32_bf16 v[100:103], a[36:39], a[88:91], v[100:103]
    ds_read_b64_tr_b16 a[8:9], v208 offset:32768
    v_mfma_f32_16x16x32_bf16 v[132:135], a[36:39], a[92:95], v[132:135]
    buffer_load_dwordx4 v27, s[12:15], s17 offen lds
    v_mfma_f32_16x16x32_bf16 v[40:43], a[40:43], a[80:83], v[40:43]
    ds_read_b64_tr_b16 a[10:11], v208 offset:34816
    v_mfma_f32_16x16x32_bf16 v[72:75], a[40:43], a[84:87], v[72:75]
    ds_read_b64_tr_b16 a[12:13], v212 offset:32768
    v_mfma_f32_16x16x32_bf16 v[104:107], a[40:43], a[88:91], v[104:107]
    buffer_load_dwordx4 a[68:71], v217, s[8:11], s16 offen
    v_mfma_f32_16x16x32_bf16 v[136:139], a[40:43], a[92:95], v[136:139]
    ds_read_b64_tr_b16 a[14:15], v212 offset:34816
    v_mfma_f32_16x16x32_bf16 v[44:47], a[44:47], a[80:83], v[44:47]
    ds_read_b64_tr_b16 a[16:17], v200 offset:36864
    v_mfma_f32_16x16x32_bf16 v[76:79], a[44:47], a[84:87], v[76:79]
    s_add_u32 m0, s20, 139264
    v_mfma_f32_16x16x32_bf16 v[108:111], a[44:47], a[88:91], v[108:111]
    ds_read_b64_tr_b16 a[18:19], v200 offset:38912
    v_mfma_f32_16x16x32_bf16 v[140:143], a[44:47], a[92:95], v[140:143]
    ds_read_b64_tr_b16 a[20:21], v204 offset:36864
    v_mfma_f32_16x16x32_bf16 v[48:51], a[48:51], a[80:83], v[48:51]
    buffer_load_dwordx4 v28, s[12:15], s17 offen lds
    v_mfma_f32_16x16x32_bf16 v[80:83], a[48:51], a[84:87], v[80:83]
    ds_read_b64_tr_b16 a[22:23], v204 offset:38912
    v_mfma_f32_16x16x32_bf16 v[112:115], a[48:51], a[88:91], v[112:115]
    buffer_load_dwordx4 a[72:75], v218, s[8:11], s16 offen
    v_mfma_f32_16x16x32_bf16 v[144:147], a[48:51], a[92:95], v[144:147]
    ds_read_b64_tr_b16 a[24:25], v208 offset:36864
    v_mfma_f32_16x16x32_bf16 v[52:55], a[52:55], a[80:83], v[52:55]
    ds_read_b64_tr_b16 a[26:27], v208 offset:38912
    v_mfma_f32_16x16x32_bf16 v[84:87], a[52:55], a[84:87], v[84:87]
    s_add_u32 m0, s20, 143360
    v_mfma_f32_16x16x32_bf16 v[116:119], a[52:55], a[88:91], v[116:119]
    ds_read_b64_tr_b16 a[28:29], v212 offset:36864
    v_mfma_f32_16x16x32_bf16 v[148:151], a[52:55], a[92:95], v[148:151]
    ds_read_b64_tr_b16 a[30:31], v212 offset:38912
    v_mfma_f32_16x16x32_bf16 v[56:59], a[56:59], a[80:83], v[56:59]
    buffer_load_dwordx4 v29, s[12:15], s17 offen lds
    v_mfma_f32_16x16x32_bf16 v[88:91], a[56:59], a[84:87], v[88:91]
    v_mfma_f32_16x16x32_bf16 v[120:123], a[56:59], a[88:91], v[120:123]
    v_mfma_f32_16x16x32_bf16 v[152:155], a[56:59], a[92:95], v[152:155]
    buffer_load_dwordx4 a[76:79], v219, s[8:11], s16 offen
    v_mfma_f32_16x16x32_bf16 v[60:63], a[60:63], a[80:83], v[60:63]
    v_mfma_f32_16x16x32_bf16 v[92:95], a[60:63], a[84:87], v[92:95]
    v_mfma_f32_16x16x32_bf16 v[124:127], a[60:63], a[88:91], v[124:127]
    s_add_u32 s16, s16, 8192
    v_mfma_f32_16x16x32_bf16 v[156:159], a[60:63], a[92:95], v[156:159]
    s_waitcnt vmcnt(13) lgkmcnt(0)
    v_mfma_f32_16x16x32_bf16 v[32:35], a[0:3], a[96:99], v[32:35]
    ds_read_b64_tr_b16 a[32:33], v200 offset:40960
    v_mfma_f32_16x16x32_bf16 v[64:67], a[0:3], a[100:103], v[64:67]
    buffer_load_dwordx4 a[80:83], v216, s[8:11], s16 offen
    v_mfma_f32_16x16x32_bf16 v[96:99], a[0:3], a[104:107], v[96:99]
    ds_read_b64_tr_b16 a[34:35], v200 offset:43008
    v_mfma_f32_16x16x32_bf16 v[128:131], a[0:3], a[108:111], v[128:131]
    ds_read_b64_tr_b16 a[36:37], v204 offset:40960
    v_mfma_f32_16x16x32_bf16 v[36:39], a[4:7], a[96:99], v[36:39]
    s_add_u32 s17, s17, 131072
    v_mfma_f32_16x16x32_bf16 v[68:71], a[4:7], a[100:103], v[68:71]
    ds_read_b64_tr_b16 a[38:39], v204 offset:43008
    v_mfma_f32_16x16x32_bf16 v[100:103], a[4:7], a[104:107], v[100:103]
    ds_read_b64_tr_b16 a[40:41], v208 offset:40960
    v_mfma_f32_16x16x32_bf16 v[132:135], a[4:7], a[108:111], v[132:135]
    ds_read_b64_tr_b16 a[42:43], v208 offset:43008
    v_mfma_f32_16x16x32_bf16 v[40:43], a[8:11], a[96:99], v[40:43]
    buffer_load_dwordx4 a[84:87], v217, s[8:11], s16 offen
    v_mfma_f32_16x16x32_bf16 v[72:75], a[8:11], a[100:103], v[72:75]
    ds_read_b64_tr_b16 a[44:45], v212 offset:40960
    v_mfma_f32_16x16x32_bf16 v[104:107], a[8:11], a[104:107], v[104:107]
    ds_read_b64_tr_b16 a[46:47], v212 offset:43008
    v_mfma_f32_16x16x32_bf16 v[136:139], a[8:11], a[108:111], v[136:139]
    s_add_u32 m0, s20, 147456
    v_mfma_f32_16x16x32_bf16 v[44:47], a[12:15], a[96:99], v[44:47]
    ds_read_b64_tr_b16 a[48:49], v200 offset:45056
    v_mfma_f32_16x16x32_bf16 v[76:79], a[12:15], a[100:103], v[76:79]
    ds_read_b64_tr_b16 a[50:51], v200 offset:47104
    v_mfma_f32_16x16x32_bf16 v[108:111], a[12:15], a[104:107], v[108:111]
    buffer_load_dwordx4 v26, s[12:15], s17 offen lds
    v_mfma_f32_16x16x32_bf16 v[140:143], a[12:15], a[108:111], v[140:143]
    ds_read_b64_tr_b16 a[52:53], v204 offset:45056
    v_mfma_f32_16x16x32_bf16 v[48:51], a[16:19], a[96:99], v[48:51]
    ds_read_b64_tr_b16 a[54:55], v204 offset:47104
    v_mfma_f32_16x16x32_bf16 v[80:83], a[16:19], a[100:103], v[80:83]
    buffer_load_dwordx4 a[88:91], v218, s[8:11], s16 offen
    v_mfma_f32_16x16x32_bf16 v[112:115], a[16:19], a[104:107], v[112:115]
    ds_read_b64_tr_b16 a[56:57], v208 offset:45056
    v_mfma_f32_16x16x32_bf16 v[144:147], a[16:19], a[108:111], v[144:147]
    ds_read_b64_tr_b16 a[58:59], v208 offset:47104
    v_mfma_f32_16x16x32_bf16 v[52:55], a[20:23], a[96:99], v[52:55]
    s_add_u32 m0, s20, 151552
    v_mfma_f32_16x16x32_bf16 v[84:87], a[20:23], a[100:103], v[84:87]
    ds_read_b64_tr_b16 a[60:61], v212 offset:45056
    v_mfma_f32_16x16x32_bf16 v[116:119], a[20:23], a[104:107], v[116:119]
    ds_read_b64_tr_b16 a[62:63], v212 offset:47104
    v_mfma_f32_16x16x32_bf16 v[148:151], a[20:23], a[108:111], v[148:151]
    v_mfma_f32_16x16x32_bf16 v[56:59], a[24:27], a[96:99], v[56:59]
    buffer_load_dwordx4 v27, s[12:15], s17 offen lds
    v_mfma_f32_16x16x32_bf16 v[88:91], a[24:27], a[100:103], v[88:91]
    v_mfma_f32_16x16x32_bf16 v[120:123], a[24:27], a[104:107], v[120:123]
    v_mfma_f32_16x16x32_bf16 v[152:155], a[24:27], a[108:111], v[152:155]
    buffer_load_dwordx4 a[92:95], v219, s[8:11], s16 offen
    v_mfma_f32_16x16x32_bf16 v[60:63], a[28:31], a[96:99], v[60:63]
    v_mfma_f32_16x16x32_bf16 v[92:95], a[28:31], a[100:103], v[92:95]
    v_mfma_f32_16x16x32_bf16 v[124:127], a[28:31], a[104:107], v[124:127]
    s_add_u32 s16, s16, 8192
    v_mfma_f32_16x16x32_bf16 v[156:159], a[28:31], a[108:111], v[156:159]
    s_waitcnt vmcnt(13) lgkmcnt(0)
    v_mfma_f32_16x16x32_bf16 v[32:35], a[32:35], a[112:115], v[32:35]
    ds_read_b64_tr_b16 a[0:1], v201 offset:0
    v_mfma_f32_16x16x32_bf16 v[64:67], a[32:35], a[116:119], v[64:67]
    buffer_load_dwordx4 a[96:99], v216, s[8:11], s16 offen
    v_mfma_f32_16x16x32_bf16 v[96:99], a[32:35], a[120:123], v[96:99]
    ds_read_b64_tr_b16 a[2:3], v201 offset:2048
    v_mfma_f32_16x16x32_bf16 v[128:131], a[32:35], a[124:127], v[128:131]
    ds_read_b64_tr_b16 a[4:5], v205 offset:0
    v_mfma_f32_16x16x32_bf16 v[36:39], a[36:39], a[112:115], v[36:39]
    ds_read_b64_tr_b16 a[6:7], v205 offset:2048
    v_mfma_f32_16x16x32_bf16 v[68:71], a[36:39], a[116:119], v[68:71]
    s_add_u32 m0, s20, 155648
    v_mfma_f32_16x16x32_bf16 v[100:103], a[36:39], a[120:123], v[100:103]
    ds_read_b64_tr_b16 a[8:9], v209 offset:0
    v_mfma_f32_16x16x32_bf16 v[132:135], a[36:39], a[124:127], v[132:135]
    ds_read_b64_tr_b16 a[10:11], v209 offset:2048
    v_mfma_f32_16x16x32_bf16 v[40:43], a[40:43], a[112:115], v[40:43]
    buffer_load_dwordx4 v28, s[12:15], s17 offen lds
    v_mfma_f32_16x16x32_bf16 v[72:75], a[40:43], a[116:119], v[72:75]
    ds_read_b64_tr_b16 a[12:13], v213 offset:0
    v_mfma_f32_16x16x32_bf16 v[104:107], a[40:43], a[120:123], v[104:107]
    ds_read_b64_tr_b16 a[14:15], v213 offset:2048
    v_mfma_f32_16x16x32_bf16 v[136:139], a[40:43], a[124:127], v[136:139]
    v_mfma_f32_16x16x32_bf16 v[44:47], a[44:47], a[112:115], v[44:47]
    buffer_load_dwordx4 a[100:103], v217, s[8:11], s16 offen
    v_mfma_f32_16x16x32_bf16 v[76:79], a[44:47], a[116:119], v[76:79]
    ds_read_b64_tr_b16 a[16:17], v201 offset:4096
    v_mfma_f32_16x16x32_bf16 v[108:111], a[44:47], a[120:123], v[108:111]
    ds_read_b64_tr_b16 a[18:19], v201 offset:6144
    v_mfma_f32_16x16x32_bf16 v[140:143], a[44:47], a[124:127], v[140:143]
    ds_read_b64_tr_b16 a[20:21], v205 offset:4096
    v_mfma_f32_16x16x32_bf16 v[48:51], a[48:51], a[112:115], v[48:51]
    s_add_u32 m0, s20, 159744
    v_mfma_f32_16x16x32_bf16 v[80:83], a[48:51], a[116:119], v[80:83]
    ds_read_b64_tr_b16 a[22:23], v205 offset:6144
    v_mfma_f32_16x16x32_bf16 v[112:115], a[48:51], a[120:123], v[112:115]
    ds_read_b64_tr_b16 a[24:25], v209 offset:4096
    v_mfma_f32_16x16x32_bf16 v[144:147], a[48:51], a[124:127], v[144:147]
    buffer_load_dwordx4 v29, s[12:15], s17 offen lds
    v_mfma_f32_16x16x32_bf16 v[52:55], a[52:55], a[112:115], v[52:55]
    ds_read_b64_tr_b16 a[26:27], v209 offset:6144
    v_mfma_f32_16x16x32_bf16 v[84:87], a[52:55], a[116:119], v[84:87]
    ds_read_b64_tr_b16 a[28:29], v213 offset:4096
    v_mfma_f32_16x16x32_bf16 v[116:119], a[52:55], a[120:123], v[116:119]
    ds_read_b64_tr_b16 a[30:31], v213 offset:6144
    v_mfma_f32_16x16x32_bf16 v[148:151], a[52:55], a[124:127], v[148:151]
    buffer_load_dwordx4 a[104:107], v218, s[8:11], s16 offen
    v_mfma_f32_16x16x32_bf16 v[56:59], a[56:59], a[112:115], v[56:59]
    v_mfma_f32_16x16x32_bf16 v[88:91], a[56:59], a[116:119], v[88:91]
    v_mfma_f32_16x16x32_bf16 v[120:123], a[56:59], a[120:123], v[120:123]
    buffer_load_dwordx4 a[108:111], v219, s[8:11], s16 offen
    v_mfma_f32_16x16x32_bf16 v[152:155], a[56:59], a[124:127], v[152:155]
    v_mfma_f32_16x16x32_bf16 v[60:63], a[60:63], a[112:115], v[60:63]
    v_mfma_f32_16x16x32_bf16 v[92:95], a[60:63], a[116:119], v[92:95]
    v_mfma_f32_16x16x32_bf16 v[124:127], a[60:63], a[120:123], v[124:127]
    s_add_u32 s16, s16, 8192
    v_mfma_f32_16x16x32_bf16 v[156:159], a[60:63], a[124:127], v[156:159]
    s_waitcnt vmcnt(12) lgkmcnt(0)
    v_mfma_f32_16x16x32_bf16 v[32:35], a[0:3], a[64:67], v[32:35]
    ds_read_b64_tr_b16 a[32:33], v201 offset:8192
    v_mfma_f32_16x16x32_bf16 v[64:67], a[0:3], a[68:71], v[64:67]
    ds_read_b64_tr_b16 a[34:35], v201 offset:10240
    v_mfma_f32_16x16x32_bf16 v[96:99], a[0:3], a[72:75], v[96:99]
    buffer_load_dwordx4 a[112:115], v216, s[8:11], s16 offen
    v_mfma_f32_16x16x32_bf16 v[128:131], a[0:3], a[76:79], v[128:131]
    ds_read_b64_tr_b16 a[36:37], v205 offset:8192
    v_mfma_f32_16x16x32_bf16 v[36:39], a[4:7], a[64:67], v[36:39]
    ds_read_b64_tr_b16 a[38:39], v205 offset:10240
    v_mfma_f32_16x16x32_bf16 v[68:71], a[4:7], a[68:71], v[68:71]
    ds_read_b64_tr_b16 a[40:41], v209 offset:8192
    v_mfma_f32_16x16x32_bf16 v[100:103], a[4:7], a[72:75], v[100:103]
    s_add_u32 s17, s17, 131072
    v_mfma_f32_16x16x32_bf16 v[132:135], a[4:7], a[76:79], v[132:135]
    ds_read_b64_tr_b16 a[42:43], v209 offset:10240
    v_mfma_f32_16x16x32_bf16 v[40:43], a[8:11], a[64:67], v[40:43]
    v_mfma_f32_16x16x32_bf16 v[72:75], a[8:11], a[68:71], v[72:75]
    ds_read_b64_tr_b16 a[44:45], v213 offset:8192
    v_mfma_f32_16x16x32_bf16 v[104:107], a[8:11], a[72:75], v[104:107]
    buffer_load_dwordx4 a[116:119], v217, s[8:11], s16 offen
    v_mfma_f32_16x16x32_bf16 v[136:139], a[8:11], a[76:79], v[136:139]
    ds_read_b64_tr_b16 a[46:47], v213 offset:10240
    v_mfma_f32_16x16x32_bf16 v[44:47], a[12:15], a[64:67], v[44:47]
    ds_read_b64_tr_b16 a[48:49], v201 offset:12288
    v_mfma_f32_16x16x32_bf16 v[76:79], a[12:15], a[68:71], v[76:79]
    ds_read_b64_tr_b16 a[50:51], v201 offset:14336
    v_mfma_f32_16x16x32_bf16 v[108:111], a[12:15], a[72:75], v[108:111]
    s_add_u32 m0, s20, 0
    v_mfma_f32_16x16x32_bf16 v[140:143], a[12:15], a[76:79], v[140:143]
    ds_read_b64_tr_b16 a[52:53], v205 offset:12288
    v_mfma_f32_16x16x32_bf16 v[48:51], a[16:19], a[64:67], v[48:51]
    v_mfma_f32_16x16x32_bf16 v[80:83], a[16:19], a[68:71], v[80:83]
    ds_read_b64_tr_b16 a[54:55], v205 offset:14336
    v_mfma_f32_16x16x32_bf16 v[112:115], a[16:19], a[72:75], v[112:115]
    buffer_load_dwordx4 v26, s[12:15], s17 offen lds
    v_mfma_f32_16x16x32_bf16 v[144:147], a[16:19], a[76:79], v[144:147]
    ds_read_b64_tr_b16 a[56:57], v209 offset:12288
    v_mfma_f32_16x16x32_bf16 v[52:55], a[20:23], a[64:67], v[52:55]
    ds_read_b64_tr_b16 a[58:59], v209 offset:14336
    v_mfma_f32_16x16x32_bf16 v[84:87], a[20:23], a[68:71], v[84:87]
    ds_read_b64_tr_b16 a[60:61], v213 offset:12288
    v_mfma_f32_16x16x32_bf16 v[116:119], a[20:23], a[72:75], v[116:119]
    buffer_load_dwordx4 a[120:123], v218, s[8:11], s16 offen
    v_mfma_f32_16x16x32_bf16 v[148:151], a[20:23], a[76:79], v[148:151]
    ds_read_b64_tr_b16 a[62:63], v213 offset:14336
    v_mfma_f32_16x16x32_bf16 v[56:59], a[24:27], a[64:67], v[56:59]
    v_mfma_f32_16x16x32_bf16 v[88:91], a[24:27], a[68:71], v[88:91]
    v_mfma_f32_16x16x32_bf16 v[120:123], a[24:27], a[72:75], v[120:123]
    buffer_load_dwordx4 a[124:127], v219, s[8:11], s16 offen
    v_mfma_f32_16x16x32_bf16 v[152:155], a[24:27], a[76:79], v[152:155]
    v_mfma_f32_16x16x32_bf16 v[60:63], a[28:31], a[64:67], v[60:63]
    v_mfma_f32_16x16x32_bf16 v[92:95], a[28:31], a[68:71], v[92:95]
    v_mfma_f32_16x16x32_bf16 v[124:127], a[28:31], a[72:75], v[124:127]
    s_add_u32 s16, s16, 8192
    v_mfma_f32_16x16x32_bf16 v[156:159], a[28:31], a[76:79], v[156:159]
    s_waitcnt vmcnt(11) lgkmcnt(0)
    v_mfma_f32_16x16x32_bf16 v[32:35], a[32:35], a[80:83], v[32:35]
    ds_read_b64_tr_b16 a[0:1], v201 offset:16384
    v_mfma_f32_16x16x32_bf16 v[64:67], a[32:35], a[84:87], v[64:67]
    buffer_load_dwordx4 a[128:131], v216, s[8:11], s16 offen
    v_mfma_f32_16x16x32_bf16 v[96:99], a[32:35], a[88:91], v[96:99]
    ds_read_b64_tr_b16 a[2:3], v201 offset:18432
    v_mfma_f32_16x16x32_bf16 v[128:131], a[32:35], a[92:95], v[128:131]
    ds_read_b64_tr_b16 a[4:5], v205 offset:16384
    v_mfma_f32_16x16x32_bf16 v[36:39], a[36:39], a[80:83], v[36:39]
    ds_read_b64_tr_b16 a[6:7], v205 offset:18432
    v_mfma_f32_16x16x32_bf16 v[68:71], a[36:39], a[84:87], v[68:71]
    s_add_u32 m0, s20, 4096
    v_mfma_f32_16x16x32_bf16 v[100:103], a[36:39], a[88:91], v[100:103]
    ds_read_b64_tr_b16 a[8:9], v209 offset:16384
    v_mfma_f32_16x16x32_bf16 v[132:135], a[36:39], a[92:95], v[132:135]
    ds_read_b64_tr_b16 a[10:11], v209 offset:18432
    v_mfma_f32_16x16x32_bf16 v[40:43], a[40:43], a[80:83], v[40:43]
    buffer_load_dwordx4 v27, s[12:15], s17 offen lds
    v_mfma_f32_16x16x32_bf16 v[72:75], a[40:43], a[84:87], v[72:75]
    ds_read_b64_tr_b16 a[12:13], v213 offset:16384
    v_mfma_f32_16x16x32_bf16 v[104:107], a[40:43], a[88:91], v[104:107]
    ds_read_b64_tr_b16 a[14:15], v213 offset:18432
    v_mfma_f32_16x16x32_bf16 v[136:139], a[40:43], a[92:95], v[136:139]
    v_mfma_f32_16x16x32_bf16 v[44:47], a[44:47], a[80:83], v[44:47]
    buffer_load_dwordx4 a[68:71], v217, s[8:11], s16 offen
    v_mfma_f32_16x16x32_bf16 v[76:79], a[44:47], a[84:87], v[76:79]
    ds_read_b64_tr_b16 a[16:17], v201 offset:20480
    v_mfma_f32_16x16x32_bf16 v[108:111], a[44:47], a[88:91], v[108:111]
    ds_read_b64_tr_b16 a[18:19], v201 offset:22528
    v_mfma_f32_16x16x32_bf16 v[140:143], a[44:47], a[92:95], v[140:143]
    ds_read_b64_tr_b16 a[20:21], v205 offset:20480
    v_mfma_f32_16x16x32_bf16 v[48:51], a[48:51], a[80:83], v[48:51]
    s_add_u32 m0, s20, 8192
    v_mfma_f32_16x16x32_bf16 v[80:83], a[48:51], a[84:87], v[80:83]
    ds_read_b64_tr_b16 a[22:23], v205 offset:22528
    v_mfma_f32_16x16x32_bf16 v[112:115], a[48:51], a[88:91], v[112:115]
    ds_read_b64_tr_b16 a[24:25], v209 offset:20480
    v_mfma_f32_16x16x32_bf16 v[144:147], a[48:51], a[92:95], v[144:147]
    buffer_load_dwordx4 v28, s[12:15], s17 offen lds
    v_mfma_f32_16x16x32_bf16 v[52:55], a[52:55], a[80:83], v[52:55]
    ds_read_b64_tr_b16 a[26:27], v209 offset:22528
    v_mfma_f32_16x16x32_bf16 v[84:87], a[52:55], a[84:87], v[84:87]
    ds_read_b64_tr_b16 a[28:29], v213 offset:20480
    v_mfma_f32_16x16x32_bf16 v[116:119], a[52:55], a[88:91], v[116:119]
    ds_read_b64_tr_b16 a[30:31], v213 offset:22528
    v_mfma_f32_16x16x32_bf16 v[148:151], a[52:55], a[92:95], v[148:151]
    buffer_load_dwordx4 a[72:75], v218, s[8:11], s16 offen
    v_mfma_f32_16x16x32_bf16 v[56:59], a[56:59], a[80:83], v[56:59]
    v_mfma_f32_16x16x32_bf16 v[88:91], a[56:59], a[84:87], v[88:91]
    v_mfma_f32_16x16x32_bf16 v[120:123], a[56:59], a[88:91], v[120:123]
    buffer_load_dwordx4 a[76:79], v219, s[8:11], s16 offen
    v_mfma_f32_16x16x32_bf16 v[152:155], a[56:59], a[92:95], v[152:155]
    v_mfma_f32_16x16x32_bf16 v[60:63], a[60:63], a[80:83], v[60:63]
    v_mfma_f32_16x16x32_bf16 v[92:95], a[60:63], a[84:87], v[92:95]
    v_mfma_f32_16x16x32_bf16 v[124:127], a[60:63], a[88:91], v[124:127]
    s_add_u32 s16, s16, 8192
    v_mfma_f32_16x16x32_bf16 v[156:159], a[60:63], a[92:95], v[156:159]
    s_waitcnt vmcnt(11) lgkmcnt(0)
    v_mfma_f32_16x16x32_bf16 v[32:35], a[0:3], a[96:99], v[32:35]
    ds_read_b64_tr_b16 a[32:33], v201 offset:24576
    v_mfma_f32_16x16x32_bf16 v[64:67], a[0:3], a[100:103], v[64:67]
    ds_read_b64_tr_b16 a[34:35], v201 offset:26624
    v_mfma_f32_16x16x32_bf16 v[96:99], a[0:3], a[104:107], v[96:99]
    buffer_load_dwordx4 a[132:135], v216, s[8:11], s16 offen
    v_mfma_f32_16x16x32_bf16 v[128:131], a[0:3], a[108:111], v[128:131]
    ds_read_b64_tr_b16 a[36:37], v205 offset:24576
    v_mfma_f32_16x16x32_bf16 v[36:39], a[4:7], a[96:99], v[36:39]
    ds_read_b64_tr_b16 a[38:39], v205 offset:26624
    v_mfma_f32_16x16x32_bf16 v[68:71], a[4:7], a[100:103], v[68:71]
    ds_read_b64_tr_b16 a[40:41], v209 offset:24576
    v_mfma_f32_16x16x32_bf16 v[100:103], a[4:7], a[104:107], v[100:103]
    s_add_u32 m0, s20, 12288
    v_mfma_f32_16x16x32_bf16 v[132:135], a[4:7], a[108:111], v[132:135]
    ds_read_b64_tr_b16 a[42:43], v209 offset:26624
    v_mfma_f32_16x16x32_bf16 v[40:43], a[8:11], a[96:99], v[40:43]
    v_mfma_f32_16x16x32_bf16 v[72:75], a[8:11], a[100:103], v[72:75]
    ds_read_b64_tr_b16 a[44:45], v213 offset:24576
    v_mfma_f32_16x16x32_bf16 v[104:107], a[8:11], a[104:107], v[104:107]
    buffer_load_dwordx4 v29, s[12:15], s17 offen lds
    v_mfma_f32_16x16x32_bf16 v[136:139], a[8:11], a[108:111], v[136:139]
    ds_read_b64_tr_b16 a[46:47], v213 offset:26624
    v_mfma_f32_16x16x32_bf16 v[44:47], a[12:15], a[96:99], v[44:47]
    ds_read_b64_tr_b16 a[48:49], v201 offset:28672
    v_mfma_f32_16x16x32_bf16 v[76:79], a[12:15], a[100:103], v[76:79]
    ds_read_b64_tr_b16 a[50:51], v201 offset:30720
    v_mfma_f32_16x16x32_bf16 v[108:111], a[12:15], a[104:107], v[108:111]
    buffer_load_dwordx4 a[84:87], v217, s[8:11], s16 offen
    v_mfma_f32_16x16x32_bf16 v[140:143], a[12:15], a[108:111], v[140:143]
    ds_read_b64_tr_b16 a[52:53], v205 offset:28672
    v_mfma_f32_16x16x32_bf16 v[48:51], a[16:19], a[96:99], v[48:51]
    v_mfma_f32_16x16x32_bf16 v[80:83], a[16:19], a[100:103], v[80:83]
    ds_read_b64_tr_b16 a[54:55], v205 offset:30720
    v_mfma_f32_16x16x32_bf16 v[112:115], a[16:19], a[104:107], v[112:115]
    s_add_u32 s17, s17, 131072
    v_mfma_f32_16x16x32_bf16 v[144:147], a[16:19], a[108:111], v[144:147]
    ds_read_b64_tr_b16 a[56:57], v209 offset:28672
    v_mfma_f32_16x16x32_bf16 v[52:55], a[20:23], a[96:99], v[52:55]
    ds_read_b64_tr_b16 a[58:59], v209 offset:30720
    v_mfma_f32_16x16x32_bf16 v[84:87], a[20:23], a[100:103], v[84:87]
    ds_read_b64_tr_b16 a[60:61], v213 offset:28672
    v_mfma_f32_16x16x32_bf16 v[116:119], a[20:23], a[104:107], v[116:119]
    buffer_load_dwordx4 a[88:91], v218, s[8:11], s16 offen
    v_mfma_f32_16x16x32_bf16 v[148:151], a[20:23], a[108:111], v[148:151]
    ds_read_b64_tr_b16 a[62:63], v213 offset:30720
    v_mfma_f32_16x16x32_bf16 v[56:59], a[24:27], a[96:99], v[56:59]
    v_mfma_f32_16x16x32_bf16 v[88:91], a[24:27], a[100:103], v[88:91]
    v_mfma_f32_16x16x32_bf16 v[120:123], a[24:27], a[104:107], v[120:123]
    buffer_load_dwordx4 a[92:95], v219, s[8:11], s16 offen
    v_mfma_f32_16x16x32_bf16 v[152:155], a[24:27], a[108:111], v[152:155]
    v_mfma_f32_16x16x32_bf16 v[60:63], a[28:31], a[96:99], v[60:63]
    v_mfma_f32_16x16x32_bf16 v[92:95], a[28:31], a[100:103], v[92:95]
    v_mfma_f32_16x16x32_bf16 v[124:127], a[28:31], a[104:107], v[124:127]
    s_add_u32 s16, s16, 8192
    v_mfma_f32_16x16x32_bf16 v[156:159], a[28:31], a[108:111], v[156:159]
    s_waitcnt vmcnt(11) lgkmcnt(0)
    v_mfma_f32_16x16x32_bf16 v[32:35], a[32:35], a[112:115], v[32:35]
    ds_read_b64_tr_b16 a[0:1], v201 offset:32768
    v_mfma_f32_16x16x32_bf16 v[64:67], a[32:35], a[116:119], v[64:67]
    ds_read_b64_tr_b16 a[2:3], v201 offset:34816
    v_mfma_f32_16x16x32_bf16 v[96:99], a[32:35], a[120:123], v[96:99]
    ds_read_b64_tr_b16 a[4:5], v205 offset:32768
    v_mfma_f32_16x16x32_bf16 v[128:131], a[32:35], a[124:127], v[128:131]
    buffer_load_dwordx4 a[136:139], v216, s[8:11], s16 offen
    v_mfma_f32_16x16x32_bf16 v[36:39], a[36:39], a[112:115], v[36:39]
    ds_read_b64_tr_b16 a[6:7], v205 offset:34816
    v_mfma_f32_16x16x32_bf16 v[68:71], a[36:39], a[116:119], v[68:71]
    v_mfma_f32_16x16x32_bf16 v[100:103], a[36:39], a[120:123], v[100:103]
    ds_read_b64_tr_b16 a[8:9], v209 offset:32768
    v_mfma_f32_16x16x32_bf16 v[132:135], a[36:39], a[124:127], v[132:135]
    ds_read_b64_tr_b16 a[10:11], v209 offset:34816
    v_mfma_f32_16x16x32_bf16 v[40:43], a[40:43], a[112:115], v[40:43]
    ds_read_b64_tr_b16 a[12:13], v213 offset:32768
    v_mfma_f32_16x16x32_bf16 v[72:75], a[40:43], a[116:119], v[72:75]
    buffer_load_dwordx4 a[100:103], v217, s[8:11], s16 offen
    v_mfma_f32_16x16x32_bf16 v[104:107], a[40:43], a[120:123], v[104:107]
    v_mfma_f32_16x16x32_bf16 v[136:139], a[40:43], a[124:127], v[136:139]
    ds_read_b64_tr_b16 a[14:15], v213 offset:34816
    v_mfma_f32_16x16x32_bf16 v[44:47], a[44:47], a[112:115], v[44:47]
    ds_read_b64_tr_b16 a[16:17], v201 offset:36864
    v_mfma_f32_16x16x32_bf16 v[76:79], a[44:47], a[116:119], v[76:79]
    ds_read_b64_tr_b16 a[18:19], v201 offset:38912
    v_mfma_f32_16x16x32_bf16 v[108:111], a[44:47], a[120:123], v[108:111]
    v_mfma_f32_16x16x32_bf16 v[140:143], a[44:47], a[124:127], v[140:143]
    ds_read_b64_tr_b16 a[20:21], v205 offset:36864
    v_mfma_f32_16x16x32_bf16 v[48:51], a[48:51], a[112:115], v[48:51]
    buffer_load_dwordx4 a[104:107], v218, s[8:11], s16 offen
    v_mfma_f32_16x16x32_bf16 v[80:83], a[48:51], a[116:119], v[80:83]
    ds_read_b64_tr_b16 a[22:23], v205 offset:38912
    v_mfma_f32_16x16x32_bf16 v[112:115], a[48:51], a[120:123], v[112:115]
    ds_read_b64_tr_b16 a[24:25], v209 offset:36864
    v_mfma_f32_16x16x32_bf16 v[144:147], a[48:51], a[124:127], v[144:147]
    v_mfma_f32_16x16x32_bf16 v[52:55], a[52:55], a[112:115], v[52:55]
    ds_read_b64_tr_b16 a[26:27], v209 offset:38912
    v_mfma_f32_16x16x32_bf16 v[84:87], a[52:55], a[116:119], v[84:87]
    ds_read_b64_tr_b16 a[28:29], v213 offset:36864
    v_mfma_f32_16x16x32_bf16 v[116:119], a[52:55], a[120:123], v[116:119]
    buffer_load_dwordx4 a[108:111], v219, s[8:11], s16 offen
    v_mfma_f32_16x16x32_bf16 v[148:151], a[52:55], a[124:127], v[148:151]
    ds_read_b64_tr_b16 a[30:31], v213 offset:38912
    v_mfma_f32_16x16x32_bf16 v[56:59], a[56:59], a[112:115], v[56:59]
    v_mfma_f32_16x16x32_bf16 v[88:91], a[56:59], a[116:119], v[88:91]
    v_mfma_f32_16x16x32_bf16 v[120:123], a[56:59], a[120:123], v[120:123]
    v_mfma_f32_16x16x32_bf16 v[152:155], a[56:59], a[124:127], v[152:155]
    v_mfma_f32_16x16x32_bf16 v[60:63], a[60:63], a[112:115], v[60:63]
    s_add_u32 s16, s16, 8192
    v_mfma_f32_16x16x32_bf16 v[92:95], a[60:63], a[116:119], v[92:95]
    v_mfma_f32_16x16x32_bf16 v[124:127], a[60:63], a[120:123], v[124:127]
    v_mfma_f32_16x16x32_bf16 v[156:159], a[60:63], a[124:127], v[156:159]
    s_waitcnt vmcnt(9) lgkmcnt(0)
    v_mfma_f32_16x16x32_bf16 v[64:67], a[0:3], a[68:71], v[64:67]
    ds_read_b64_tr_b16 a[32:33], v201 offset:40960
    v_mfma_f32_16x16x32_bf16 v[96:99], a[0:3], a[72:75], v[96:99]
    buffer_load_dwordx4 a[140:143], v216, s[8:11], s16 offen
    v_mfma_f32_16x16x32_bf16 v[128:131], a[0:3], a[76:79], v[128:131]
    ds_read_b64_tr_b16 a[34:35], v201 offset:43008
    v_mfma_f32_16x16x32_bf16 v[68:71], a[4:7], a[68:71], v[68:71]
    ds_read_b64_tr_b16 a[36:37], v205 offset:40960
    v_mfma_f32_16x16x32_bf16 v[100:103], a[4:7], a[72:75], v[100:103]
    ds_read_b64_tr_b16 a[38:39], v205 offset:43008
    v_mfma_f32_16x16x32_bf16 v[132:135], a[4:7], a[76:79], v[132:135]
    buffer_load_dwordx4 v[160:163], v24, s[48:51], s57 offen
    s_add_u32 s57, s57, 8192
    v_mfma_f32_16x16x32_bf16 v[72:75], a[8:11], a[68:71], v[72:75]
    ds_read_b64_tr_b16 a[40:41], v209 offset:40960
    v_mfma_f32_16x16x32_bf16 v[104:107], a[8:11], a[72:75], v[104:107]
    ds_read_b64_tr_b16 a[42:43], v209 offset:43008
    v_mfma_f32_16x16x32_bf16 v[136:139], a[8:11], a[76:79], v[136:139]
    buffer_load_dwordx4 a[116:119], v217, s[8:11], s16 offen
    v_mfma_f32_16x16x32_bf16 v[76:79], a[12:15], a[68:71], v[76:79]
    ds_read_b64_tr_b16 a[44:45], v213 offset:40960
    v_mfma_f32_16x16x32_bf16 v[108:111], a[12:15], a[72:75], v[108:111]
    ds_read_b64_tr_b16 a[46:47], v213 offset:43008
    v_mfma_f32_16x16x32_bf16 v[140:143], a[12:15], a[76:79], v[140:143]
    ds_read_b64_tr_b16 a[48:49], v201 offset:45056
    v_mfma_f32_16x16x32_bf16 v[80:83], a[16:19], a[68:71], v[80:83]
    buffer_load_dwordx4 v[164:167], v24, s[48:51], s57 offen
    s_add_u32 s57, s57, 8192
    v_mfma_f32_16x16x32_bf16 v[112:115], a[16:19], a[72:75], v[112:115]
    ds_read_b64_tr_b16 a[50:51], v201 offset:47104
    v_mfma_f32_16x16x32_bf16 v[144:147], a[16:19], a[76:79], v[144:147]
    ds_read_b64_tr_b16 a[52:53], v205 offset:45056
    v_mfma_f32_16x16x32_bf16 v[84:87], a[20:23], a[68:71], v[84:87]
    buffer_load_dwordx4 a[120:123], v218, s[8:11], s16 offen
    v_mfma_f32_16x16x32_bf16 v[116:119], a[20:23], a[72:75], v[116:119]
    ds_read_b64_tr_b16 a[54:55], v205 offset:47104
    v_mfma_f32_16x16x32_bf16 v[148:151], a[20:23], a[76:79], v[148:151]
    ds_read_b64_tr_b16 a[56:57], v209 offset:45056
    v_mfma_f32_16x16x32_bf16 v[88:91], a[24:27], a[68:71], v[88:91]
    buffer_load_dwordx4 a[124:127], v219, s[8:11], s16 offen
    v_mfma_f32_16x16x32_bf16 v[120:123], a[24:27], a[72:75], v[120:123]
    ds_read_b64_tr_b16 a[58:59], v209 offset:47104
    v_mfma_f32_16x16x32_bf16 v[152:155], a[24:27], a[76:79], v[152:155]
    ds_read_b64_tr_b16 a[60:61], v213 offset:45056
    v_mfma_f32_16x16x32_bf16 v[92:95], a[28:31], a[68:71], v[92:95]
    ds_read_b64_tr_b16 a[62:63], v213 offset:47104
    v_mfma_f32_16x16x32_bf16 v[124:127], a[28:31], a[72:75], v[124:127]
    s_add_u32 s16, s16, 8192
    v_mfma_f32_16x16x32_bf16 v[156:159], a[28:31], a[76:79], v[156:159]
    s_waitcnt vmcnt(10) lgkmcnt(0)
    v_mfma_f32_16x16x32_bf16 v[64:67], a[32:35], a[84:87], v[64:67]
    ds_read_b64_tr_b16 a[0:1], v202 offset:0
    v_mfma_f32_16x16x32_bf16 v[96:99], a[32:35], a[88:91], v[96:99]
    buffer_load_dwordx4 a[144:147], v216, s[8:11], s16 offen
    v_mfma_f32_16x16x32_bf16 v[128:131], a[32:35], a[92:95], v[128:131]
    ds_read_b64_tr_b16 a[2:3], v202 offset:2048
    v_mfma_f32_16x16x32_bf16 v[68:71], a[36:39], a[84:87], v[68:71]
    ds_read_b64_tr_b16 a[4:5], v206 offset:0
    v_mfma_f32_16x16x32_bf16 v[100:103], a[36:39], a[88:91], v[100:103]
    ds_read_b64_tr_b16 a[6:7], v206 offset:2048
    v_mfma_f32_16x16x32_bf16 v[132:135], a[36:39], a[92:95], v[132:135]
    buffer_load_dwordx4 v[168:171], v24, s[48:51], s57 offen
    s_add_u32 s57, s57, 8192
    v_mfma_f32_16x16x32_bf16 v[72:75], a[40:43], a[84:87], v[72:75]
    ds_read_b64_tr_b16 a[8:9], v210 offset:0
    v_mfma_f32_16x16x32_bf16 v[104:107], a[40:43], a[88:91], v[104:107]
    ds_read_b64_tr_b16 a[10:11], v210 offset:2048
    v_mfma_f32_16x16x32_bf16 v[136:139], a[40:43], a[92:95], v[136:139]
    buffer_load_dwordx4 a[68:71], v217, s[8:11], s16 offen
    v_mfma_f32_16x16x32_bf16 v[76:79], a[44:47], a[84:87], v[76:79]
    ds_read_b64_tr_b16 a[12:13], v214 offset:0
    v_mfma_f32_16x16x32_bf16 v[108:111], a[44:47], a[88:91], v[108:111]
    ds_read_b64_tr_b16 a[14:15], v214 offset:2048
    v_mfma_f32_16x16x32_bf16 v[140:143], a[44:47], a[92:95], v[140:143]
    ds_read_b64_tr_b16 a[16:17], v202 offset:4096
    v_mfma_f32_16x16x32_bf16 v[80:83], a[48:51], a[84:87], v[80:83]
    buffer_load_dwordx4 v[172:175], v24, s[48:51], s57 offen
    s_add_u32 s57, s57, 8192
    v_mfma_f32_16x16x32_bf16 v[112:115], a[48:51], a[88:91], v[112:115]
    ds_read_b64_tr_b16 a[18:19], v202 offset:6144
    v_mfma_f32_16x16x32_bf16 v[144:147], a[48:51], a[92:95], v[144:147]
    ds_read_b64_tr_b16 a[20:21], v206 offset:4096
    v_mfma_f32_16x16x32_bf16 v[84:87], a[52:55], a[84:87], v[84:87]
    buffer_load_dwordx4 a[72:75], v218, s[8:11], s16 offen
    v_mfma_f32_16x16x32_bf16 v[116:119], a[52:55], a[88:91], v[116:119]
    ds_read_b64_tr_b16 a[22:23], v206 offset:6144
    v_mfma_f32_16x16x32_bf16 v[148:151], a[52:55], a[92:95], v[148:151]
    ds_read_b64_tr_b16 a[24:25], v210 offset:4096
    v_mfma_f32_16x16x32_bf16 v[88:91], a[56:59], a[84:87], v[88:91]
    buffer_load_dwordx4 a[76:79], v219, s[8:11], s16 offen
    v_mfma_f32_16x16x32_bf16 v[120:123], a[56:59], a[88:91], v[120:123]
    ds_read_b64_tr_b16 a[26:27], v210 offset:6144
    v_mfma_f32_16x16x32_bf16 v[152:155], a[56:59], a[92:95], v[152:155]
    ds_read_b64_tr_b16 a[28:29], v214 offset:4096
    v_mfma_f32_16x16x32_bf16 v[92:95], a[60:63], a[84:87], v[92:95]
    ds_read_b64_tr_b16 a[30:31], v214 offset:6144
    v_mfma_f32_16x16x32_bf16 v[124:127], a[60:63], a[88:91], v[124:127]
    s_add_u32 s16, s16, 8192
    v_mfma_f32_16x16x32_bf16 v[156:159], a[60:63], a[92:95], v[156:159]
    s_waitcnt vmcnt(12) lgkmcnt(0)
    v_mfma_f32_16x16x32_bf16 v[64:67], a[0:3], a[100:103], v[64:67]
    ds_read_b64_tr_b16 a[32:33], v202 offset:8192
    v_mfma_f32_16x16x32_bf16 v[96:99], a[0:3], a[104:107], v[96:99]
    buffer_load_dwordx4 a[148:151], v216, s[8:11], s16 offen
    v_mfma_f32_16x16x32_bf16 v[128:131], a[0:3], a[108:111], v[128:131]
    ds_read_b64_tr_b16 a[34:35], v202 offset:10240
    v_mfma_f32_16x16x32_bf16 v[68:71], a[4:7], a[100:103], v[68:71]
    ds_read_b64_tr_b16 a[36:37], v206 offset:8192
    v_mfma_f32_16x16x32_bf16 v[100:103], a[4:7], a[104:107], v[100:103]
    ds_read_b64_tr_b16 a[38:39], v206 offset:10240
    v_mfma_f32_16x16x32_bf16 v[132:135], a[4:7], a[108:111], v[132:135]
    buffer_load_dword v176, v6, s[52:55], s59 offen offset:0 sc1
    v_mfma_f32_16x16x32_bf16 v[72:75], a[8:11], a[100:103], v[72:75]
    ds_read_b64_tr_b16 a[40:41], v210 offset:8192
    v_mfma_f32_16x16x32_bf16 v[104:107], a[8:11], a[104:107], v[104:107]
    ds_read_b64_tr_b16 a[42:43], v210 offset:10240
    v_mfma_f32_16x16x32_bf16 v[136:139], a[8:11], a[108:111], v[136:139]
    buffer_load_dwordx4 a[84:87], v217, s[8:11], s16 offen
    v_mfma_f32_16x16x32_bf16 v[76:79], a[12:15], a[100:103], v[76:79]
    ds_read_b64_tr_b16 a[44:45], v214 offset:8192
    v_mfma_f32_16x16x32_bf16 v[108:111], a[12:15], a[104:107], v[108:111]
    ds_read_b64_tr_b16 a[46:47], v214 offset:10240
    v_mfma_f32_16x16x32_bf16 v[140:143], a[12:15], a[108:111], v[140:143]
    ds_read_b64_tr_b16 a[48:49], v202 offset:12288
    v_mfma_f32_16x16x32_bf16 v[80:83], a[16:19], a[100:103], v[80:83]
    buffer_load_dword v177, v6, s[52:55], s59 offen offset:512 sc1
    v_mfma_f32_16x16x32_bf16 v[112:115], a[16:19], a[104:107], v[112:115]
    ds_read_b64_tr_b16 a[50:51], v202 offset:14336
    v_mfma_f32_16x16x32_bf16 v[144:147], a[16:19], a[108:111], v[144:147]
    ds_read_b64_tr_b16 a[52:53], v206 offset:12288
    v_mfma_f32_16x16x32_bf16 v[84:87], a[20:23], a[100:103], v[84:87]
    buffer_load_dwordx4 a[88:91], v218, s[8:11], s16 offen
    v_mfma_f32_16x16x32_bf16 v[116:119], a[20:23], a[104:107], v[116:119]
    ds_read_b64_tr_b16 a[54:55], v206 offset:14336
    v_mfma_f32_16x16x32_bf16 v[148:151], a[20:23], a[108:111], v[148:151]
    ds_read_b64_tr_b16 a[56:57], v210 offset:12288
    v_mfma_f32_16x16x32_bf16 v[88:91], a[24:27], a[100:103], v[88:91]
    buffer_load_dwordx4 a[92:95], v219, s[8:11], s16 offen
    v_mfma_f32_16x16x32_bf16 v[120:123], a[24:27], a[104:107], v[120:123]
    ds_read_b64_tr_b16 a[58:59], v210 offset:14336
    v_mfma_f32_16x16x32_bf16 v[152:155], a[24:27], a[108:111], v[152:155]
    ds_read_b64_tr_b16 a[60:61], v214 offset:12288
    v_mfma_f32_16x16x32_bf16 v[92:95], a[28:31], a[100:103], v[92:95]
    ds_read_b64_tr_b16 a[62:63], v214 offset:14336
    v_mfma_f32_16x16x32_bf16 v[124:127], a[28:31], a[104:107], v[124:127]
    s_add_u32 s16, s16, 8192
    v_mfma_f32_16x16x32_bf16 v[156:159], a[28:31], a[108:111], v[156:159]
    s_waitcnt vmcnt(12) lgkmcnt(0)
    s_barrier
    v_mfma_f32_16x16x32_bf16 v[64:67], a[32:35], a[116:119], v[64:67]
    ds_read_b64_tr_b16 a[0:1], v202 offset:16384
    v_mfma_f32_16x16x32_bf16 v[96:99], a[32:35], a[120:123], v[96:99]
    buffer_load_dwordx4 a[152:155], v216, s[8:11], s16 offen
    v_mfma_f32_16x16x32_bf16 v[128:131], a[32:35], a[124:127], v[128:131]
    ds_read_b64_tr_b16 a[2:3], v202 offset:18432
    v_mfma_f32_16x16x32_bf16 v[68:71], a[36:39], a[116:119], v[68:71]
    ds_read_b64_tr_b16 a[4:5], v206 offset:16384
    v_mfma_f32_16x16x32_bf16 v[100:103], a[36:39], a[120:123], v[100:103]
    ds_read_b64_tr_b16 a[6:7], v206 offset:18432
    v_mfma_f32_16x16x32_bf16 v[132:135], a[36:39], a[124:127], v[132:135]
    buffer_load_dword v178, v6, s[52:55], s59 offen offset:1024 sc1
    v_mfma_f32_16x16x32_bf16 v[72:75], a[40:43], a[116:119], v[72:75]
    ds_read_b64_tr_b16 a[8:9], v210 offset:16384
    v_mfma_f32_16x16x32_bf16 v[104:107], a[40:43], a[120:123], v[104:107]
    ds_read_b64_tr_b16 a[10:11], v210 offset:18432
    v_mfma_f32_16x16x32_bf16 v[136:139], a[40:43], a[124:127], v[136:139]
    buffer_load_dwordx4 a[100:103], v217, s[8:11], s16 offen
    v_mfma_f32_16x16x32_bf16 v[76:79], a[44:47], a[116:119], v[76:79]
    ds_read_b64_tr_b16 a[12:13], v214 offset:16384
    v_mfma_f32_16x16x32_bf16 v[108:111], a[44:47], a[120:123], v[108:111]
    ds_read_b64_tr_b16 a[14:15], v214 offset:18432
    v_mfma_f32_16x16x32_bf16 v[140:143], a[44:47], a[124:127], v[140:143]
    ds_read_b64_tr_b16 a[16:17], v202 offset:20480
    v_mfma_f32_16x16x32_bf16 v[80:83], a[48:51], a[116:119], v[80:83]
    buffer_load_dword v179, v6, s[52:55], s59 offen offset:1536 sc1
    v_mfma_f32_16x16x32_bf16 v[112:115], a[48:51], a[120:123], v[112:115]
    ds_read_b64_tr_b16 a[18:19], v202 offset:22528
    v_mfma_f32_16x16x32_bf16 v[144:147], a[48:51], a[124:127], v[144:147]
    ds_read_b64_tr_b16 a[20:21], v206 offset:20480
    v_mfma_f32_16x16x32_bf16 v[84:87], a[52:55], a[116:119], v[84:87]
    buffer_load_dwordx4 a[104:107], v218, s[8:11], s16 offen
    v_mfma_f32_16x16x32_bf16 v[116:119], a[52:55], a[120:123], v[116:119]
    ds_read_b64_tr_b16 a[22:23], v206 offset:22528
    v_mfma_f32_16x16x32_bf16 v[148:151], a[52:55], a[124:127], v[148:151]
    ds_read_b64_tr_b16 a[24:25], v210 offset:20480
    v_mfma_f32_16x16x32_bf16 v[88:91], a[56:59], a[116:119], v[88:91]
    buffer_load_dwordx4 a[108:111], v219, s[8:11], s16 offen
    v_mfma_f32_16x16x32_bf16 v[120:123], a[56:59], a[120:123], v[120:123]
    ds_read_b64_tr_b16 a[26:27], v210 offset:22528
    v_mfma_f32_16x16x32_bf16 v[152:155], a[56:59], a[124:127], v[152:155]
    ds_read_b64_tr_b16 a[28:29], v214 offset:20480
    v_mfma_f32_16x16x32_bf16 v[92:95], a[60:63], a[116:119], v[92:95]
    ds_read_b64_tr_b16 a[30:31], v214 offset:22528
    v_mfma_f32_16x16x32_bf16 v[124:127], a[60:63], a[120:123], v[124:127]
    s_add_u32 s16, s16, 8192
    v_mfma_f32_16x16x32_bf16 v[156:159], a[60:63], a[124:127], v[156:159]
    s_waitcnt vmcnt(12) lgkmcnt(0)
    v_mfma_f32_16x16x32_bf16 v[64:67], a[0:3], a[68:71], v[64:67]
    ds_read_b64_tr_b16 a[32:33], v202 offset:24576
    v_mfma_f32_16x16x32_bf16 v[96:99], a[0:3], a[72:75], v[96:99]
    buffer_load_dwordx4 a[156:159], v216, s[8:11], s16 offen
    v_mfma_f32_16x16x32_bf16 v[128:131], a[0:3], a[76:79], v[128:131]
    ds_read_b64_tr_b16 a[34:35], v202 offset:26624
    v_mfma_f32_16x16x32_bf16 v[68:71], a[4:7], a[68:71], v[68:71]
    ds_read_b64_tr_b16 a[36:37], v206 offset:24576
    v_mfma_f32_16x16x32_bf16 v[100:103], a[4:7], a[72:75], v[100:103]
    ds_read_b64_tr_b16 a[38:39], v206 offset:26624
    v_mfma_f32_16x16x32_bf16 v[132:135], a[4:7], a[76:79], v[132:135]
    buffer_load_dword v180, v6, s[52:55], s60 offen offset:0 sc1
    v_mfma_f32_16x16x32_bf16 v[72:75], a[8:11], a[68:71], v[72:75]
    ds_read_b64_tr_b16 a[40:41], v210 offset:24576
    v_mfma_f32_16x16x32_bf16 v[104:107], a[8:11], a[72:75], v[104:107]
    ds_read_b64_tr_b16 a[42:43], v210 offset:26624
    v_mfma_f32_16x16x32_bf16 v[136:139], a[8:11], a[76:79], v[136:139]
    buffer_load_dwordx4 a[116:119], v217, s[8:11], s16 offen
    v_mfma_f32_16x16x32_bf16 v[76:79], a[12:15], a[68:71], v[76:79]
    ds_read_b64_tr_b16 a[44:45], v214 offset:24576
    v_mfma_f32_16x16x32_bf16 v[108:111], a[12:15], a[72:75], v[108:111]
    ds_read_b64_tr_b16 a[46:47], v214 offset:26624
    v_mfma_f32_16x16x32_bf16 v[140:143], a[12:15], a[76:79], v[140:143]
    ds_read_b64_tr_b16 a[48:49], v202 offset:28672
    v_mfma_f32_16x16x32_bf16 v[80:83], a[16:19], a[68:71], v[80:83]
    buffer_load_dword v181, v6, s[52:55], s60 offen offset:512 sc1
    v_mfma_f32_16x16x32_bf16 v[112:115], a[16:19], a[72:75], v[112:115]
    ds_read_b64_tr_b16 a[50:51], v202 offset:30720
    v_mfma_f32_16x16x32_bf16 v[144:147], a[16:19], a[76:79], v[144:147]
    ds_read_b64_tr_b16 a[52:53], v206 offset:28672
    v_mfma_f32_16x16x32_bf16 v[84:87], a[20:23], a[68:71], v[84:87]
    buffer_load_dwordx4 a[120:123], v218, s[8:11], s16 offen
    v_mfma_f32_16x16x32_bf16 v[116:119], a[20:23], a[72:75], v[116:119]
    ds_read_b64_tr_b16 a[54:55], v206 offset:30720
    v_mfma_f32_16x16x32_bf16 v[148:151], a[20:23], a[76:79], v[148:151]
    ds_read_b64_tr_b16 a[56:57], v210 offset:28672
    v_mfma_f32_16x16x32_bf16 v[88:91], a[24:27], a[68:71], v[88:91]
    buffer_load_dwordx4 a[124:127], v219, s[8:11], s16 offen
    v_mfma_f32_16x16x32_bf16 v[120:123], a[24:27], a[72:75], v[120:123]
    ds_read_b64_tr_b16 a[58:59], v210 offset:30720
    v_mfma_f32_16x16x32_bf16 v[152:155], a[24:27], a[76:79], v[152:155]
    ds_read_b64_tr_b16 a[60:61], v214 offset:28672
    v_mfma_f32_16x16x32_bf16 v[92:95], a[28:31], a[68:71], v[92:95]
    ds_read_b64_tr_b16 a[62:63], v214 offset:30720
    v_mfma_f32_16x16x32_bf16 v[124:127], a[28:31], a[72:75], v[124:127]
    s_add_u32 s16, s16, 8192
    v_mfma_f32_16x16x32_bf16 v[156:159], a[28:31], a[76:79], v[156:159]
    s_waitcnt vmcnt(12) lgkmcnt(0)
    v_mfma_f32_16x16x32_bf16 v[64:67], a[32:35], a[84:87], v[64:67]
    ds_read_b64_tr_b16 a[0:1], v202 offset:32768
    v_mfma_f32_16x16x32_bf16 v[96:99], a[32:35], a[88:91], v[96:99]
    buffer_load_dwordx4 a[160:163], v216, s[8:11], s16 offen
    v_mfma_f32_16x16x32_bf16 v[128:131], a[32:35], a[92:95], v[128:131]
    ds_read_b64_tr_b16 a[2:3], v202 offset:34816
    v_mfma_f32_16x16x32_bf16 v[68:71], a[36:39], a[84:87], v[68:71]
    ds_read_b64_tr_b16 a[4:5], v206 offset:32768
    v_mfma_f32_16x16x32_bf16 v[100:103], a[36:39], a[88:91], v[100:103]
    ds_read_b64_tr_b16 a[6:7], v206 offset:34816
    v_mfma_f32_16x16x32_bf16 v[132:135], a[36:39], a[92:95], v[132:135]
    buffer_load_dword v182, v6, s[52:55], s60 offen offset:1024 sc1
    v_mfma_f32_16x16x32_bf16 v[72:75], a[40:43], a[84:87], v[72:75]
    ds_read_b64_tr_b16 a[8:9], v210 offset:32768
    v_mfma_f32_16x16x32_bf16 v[104:107], a[40:43], a[88:91], v[104:107]
    ds_read_b64_tr_b16 a[10:11], v210 offset:34816
    v_mfma_f32_16x16x32_bf16 v[136:139], a[40:43], a[92:95], v[136:139]
    buffer_load_dwordx4 a[68:71], v217, s[8:11], s16 offen
    v_mfma_f32_16x16x32_bf16 v[76:79], a[44:47], a[84:87], v[76:79]
    ds_read_b64_tr_b16 a[12:13], v214 offset:32768
    v_mfma_f32_16x16x32_bf16 v[108:111], a[44:47], a[88:91], v[108:111]
    ds_read_b64_tr_b16 a[14:15], v214 offset:34816
    v_mfma_f32_16x16x32_bf16 v[140:143], a[44:47], a[92:95], v[140:143]
    ds_read_b64_tr_b16 a[16:17], v202 offset:36864
    v_mfma_f32_16x16x32_bf16 v[80:83], a[48:51], a[84:87], v[80:83]
    buffer_load_dword v183, v6, s[52:55], s60 offen offset:1536 sc1
    v_mfma_f32_16x16x32_bf16 v[112:115], a[48:51], a[88:91], v[112:115]
    ds_read_b64_tr_b16 a[18:19], v202 offset:38912
    v_mfma_f32_16x16x32_bf16 v[144:147], a[48:51], a[92:95], v[144:147]
    ds_read_b64_tr_b16 a[20:21], v206 offset:36864
    v_mfma_f32_16x16x32_bf16 v[84:87], a[52:55], a[84:87], v[84:87]
    buffer_load_dwordx4 a[72:75], v218, s[8:11], s16 offen
    v_mfma_f32_16x16x32_bf16 v[116:119], a[52:55], a[88:91], v[116:119]
    ds_read_b64_tr_b16 a[22:23], v206 offset:38912
    v_mfma_f32_16x16x32_bf16 v[148:151], a[52:55], a[92:95], v[148:151]
    ds_read_b64_tr_b16 a[24:25], v210 offset:36864
    v_mfma_f32_16x16x32_bf16 v[88:91], a[56:59], a[84:87], v[88:91]
    buffer_load_dwordx4 a[76:79], v219, s[8:11], s16 offen
    v_mfma_f32_16x16x32_bf16 v[120:123], a[56:59], a[88:91], v[120:123]
    ds_read_b64_tr_b16 a[26:27], v210 offset:38912
    v_mfma_f32_16x16x32_bf16 v[152:155], a[56:59], a[92:95], v[152:155]
    ds_read_b64_tr_b16 a[28:29], v214 offset:36864
    v_mfma_f32_16x16x32_bf16 v[92:95], a[60:63], a[84:87], v[92:95]
    ds_read_b64_tr_b16 a[30:31], v214 offset:38912
    v_mfma_f32_16x16x32_bf16 v[124:127], a[60:63], a[88:91], v[124:127]
    s_add_u32 s16, s16, 8192
    v_mfma_f32_16x16x32_bf16 v[156:159], a[60:63], a[92:95], v[156:159]
    s_waitcnt vmcnt(12) lgkmcnt(0)
    v_mfma_f32_16x16x32_bf16 v[64:67], a[0:3], a[100:103], v[64:67]
    ds_read_b64_tr_b16 a[32:33], v202 offset:40960
    v_mfma_f32_16x16x32_bf16 v[96:99], a[0:3], a[104:107], v[96:99]
    ds_read_b64_tr_b16 a[34:35], v202 offset:43008
    v_mfma_f32_16x16x32_bf16 v[128:131], a[0:3], a[108:111], v[128:131]
    buffer_load_dwordx4 a[164:167], v216, s[8:11], s16 offen
    v_mfma_f32_16x16x32_bf16 v[68:71], a[4:7], a[100:103], v[68:71]
    ds_read_b64_tr_b16 a[36:37], v206 offset:40960
    v_mfma_f32_16x16x32_bf16 v[100:103], a[4:7], a[104:107], v[100:103]
    ds_read_b64_tr_b16 a[38:39], v206 offset:43008
    v_mfma_f32_16x16x32_bf16 v[132:135], a[4:7], a[108:111], v[132:135]
    ds_read_b64_tr_b16 a[40:41], v210 offset:40960
    v_mfma_f32_16x16x32_bf16 v[72:75], a[8:11], a[100:103], v[72:75]
    ds_read_b64_tr_b16 a[42:43], v210 offset:43008
    v_mfma_f32_16x16x32_bf16 v[104:107], a[8:11], a[104:107], v[104:107]
    buffer_load_dwordx4 a[84:87], v217, s[8:11], s16 offen
    v_mfma_f32_16x16x32_bf16 v[136:139], a[8:11], a[108:111], v[136:139]
    ds_read_b64_tr_b16 a[44:45], v214 offset:40960
    v_mfma_f32_16x16x32_bf16 v[76:79], a[12:15], a[100:103], v[76:79]
    ds_read_b64_tr_b16 a[46:47], v214 offset:43008
    v_mfma_f32_16x16x32_bf16 v[108:111], a[12:15], a[104:107], v[108:111]
    ds_read_b64_tr_b16 a[48:49], v202 offset:45056
    v_mfma_f32_16x16x32_bf16 v[140:143], a[12:15], a[108:111], v[140:143]
    ds_read_b64_tr_b16 a[50:51], v202 offset:47104
    v_mfma_f32_16x16x32_bf16 v[80:83], a[16:19], a[100:103], v[80:83]
    buffer_load_dwordx4 a[88:91], v218, s[8:11], s16 offen
    v_mfma_f32_16x16x32_bf16 v[112:115], a[16:19], a[104:107], v[112:115]
    ds_read_b64_tr_b16 a[52:53], v206 offset:45056
    v_mfma_f32_16x16x32_bf16 v[144:147], a[16:19], a[108:111], v[144:147]
    ds_read_b64_tr_b16 a[54:55], v206 offset:47104
    v_mfma_f32_16x16x32_bf16 v[84:87], a[20:23], a[100:103], v[84:87]
    ds_read_b64_tr_b16 a[56:57], v210 offset:45056
    v_mfma_f32_16x16x32_bf16 v[116:119], a[20:23], a[104:107], v[116:119]
    buffer_load_dwordx4 a[92:95], v219, s[8:11], s16 offen
    v_mfma_f32_16x16x32_bf16 v[148:151], a[20:23], a[108:111], v[148:151]
    ds_read_b64_tr_b16 a[58:59], v210 offset:47104
    v_mfma_f32_16x16x32_bf16 v[88:91], a[24:27], a[100:103], v[88:91]
    ds_read_b64_tr_b16 a[60:61], v214 offset:45056
    v_mfma_f32_16x16x32_bf16 v[120:123], a[24:27], a[104:107], v[120:123]
    ds_read_b64_tr_b16 a[62:63], v214 offset:47104
    v_mfma_f32_16x16x32_bf16 v[152:155], a[24:27], a[108:111], v[152:155]
    v_mfma_f32_16x16x32_bf16 v[92:95], a[28:31], a[100:103], v[92:95]
    s_add_u32 s16, s16, 8192
    v_mfma_f32_16x16x32_bf16 v[124:127], a[28:31], a[104:107], v[124:127]
    v_mfma_f32_16x16x32_bf16 v[156:159], a[28:31], a[108:111], v[156:159]
    s_waitcnt vmcnt(10) lgkmcnt(0)
    v_mfma_f32_16x16x32_bf16 v[64:67], a[32:35], a[116:119], v[64:67]
    ds_read_b64_tr_b16 a[0:1], v203 offset:0
    v_mfma_f32_16x16x32_bf16 v[96:99], a[32:35], a[120:123], v[96:99]
    ds_read_b64_tr_b16 a[2:3], v203 offset:2048
    v_mfma_f32_16x16x32_bf16 v[128:131], a[32:35], a[124:127], v[128:131]
    buffer_load_dwordx4 a[168:171], v216, s[8:11], s16 offen
    v_mfma_f32_16x16x32_bf16 v[68:71], a[36:39], a[116:119], v[68:71]
    ds_read_b64_tr_b16 a[4:5], v207 offset:0
    v_mfma_f32_16x16x32_bf16 v[100:103], a[36:39], a[120:123], v[100:103]
    ds_read_b64_tr_b16 a[6:7], v207 offset:2048
    v_mfma_f32_16x16x32_bf16 v[132:135], a[36:39], a[124:127], v[132:135]
    ds_read_b64_tr_b16 a[8:9], v211 offset:0
    v_mfma_f32_16x16x32_bf16 v[72:75], a[40:43], a[116:119], v[72:75]
    ds_read_b64_tr_b16 a[10:11], v211 offset:2048
    v_mfma_f32_16x16x32_bf16 v[104:107], a[40:43], a[120:123], v[104:107]
    buffer_load_dwordx4 a[100:103], v217, s[8:11], s16 offen
    v_mfma_f32_16x16x32_bf16 v[136:139], a[40:43], a[124:127], v[136:139]
    ds_read_b64_tr_b16 a[12:13], v215 offset:0
    v_mfma_f32_16x16x32_bf16 v[76:79], a[44:47], a[116:119], v[76:79]
    ds_read_b64_tr_b16 a[14:15], v215 offset:2048
    v_mfma_f32_16x16x32_bf16 v[108:111], a[44:47], a[120:123], v[108:111]
    ds_read_b64_tr_b16 a[16:17], v203 offset:4096
    v_mfma_f32_16x16x32_bf16 v[140:143], a[44:47], a[124:127], v[140:143]
    ds_read_b64_tr_b16 a[18:19], v203 offset:6144
    v_mfma_f32_16x16x32_bf16 v[80:83], a[48:51], a[116:119], v[80:83]
    buffer_load_dwordx4 a[104:107], v218, s[8:11], s16 offen
    v_mfma_f32_16x16x32_bf16 v[112:115], a[48:51], a[120:123], v[112:115]
    ds_read_b64_tr_b16 a[20:21], v207 offset:4096
    v_mfma_f32_16x16x32_bf16 v[144:147], a[48:51], a[124:127], v[144:147]
    ds_read_b64_tr_b16 a[22:23], v207 offset:6144
    v_mfma_f32_16x16x32_bf16 v[84:87], a[52:55], a[116:119], v[84:87]
    ds_read_b64_tr_b16 a[24:25], v211 offset:4096
    v_mfma_f32_16x16x32_bf16 v[116:119], a[52:55], a[120:123], v[116:119]
    buffer_load_dwordx4 a[108:111], v219, s[8:11], s16 offen
    v_mfma_f32_16x16x32_bf16 v[148:151], a[52:55], a[124:127], v[148:151]
    ds_read_b64_tr_b16 a[26:27], v211 offset:6144
    v_mfma_f32_16x16x32_bf16 v[88:91], a[56:59], a[116:119], v[88:91]
    ds_read_b64_tr_b16 a[28:29], v215 offset:4096
    v_mfma_f32_16x16x32_bf16 v[120:123], a[56:59], a[120:123], v[120:123]
    ds_read_b64_tr_b16 a[30:31], v215 offset:6144
    v_mfma_f32_16x16x32_bf16 v[152:155], a[56:59], a[124:127], v[152:155]
    v_mfma_f32_16x16x32_bf16 v[92:95], a[60:63], a[116:119], v[92:95]
    s_add_u32 s16, s16, 8192
    v_mfma_f32_16x16x32_bf16 v[124:127], a[60:63], a[120:123], v[124:127]
    v_mfma_f32_16x16x32_bf16 v[156:159], a[60:63], a[124:127], v[156:159]
    s_waitcnt vmcnt(8) lgkmcnt(0)
    v_mfma_f32_16x16x32_bf16 v[64:67], a[0:3], a[68:71], v[64:67]
    ds_read_b64_tr_b16 a[32:33], v203 offset:8192
    v_mfma_f32_16x16x32_bf16 v[96:99], a[0:3], a[72:75], v[96:99]
    ds_read_b64_tr_b16 a[34:35], v203 offset:10240
    v_mfma_f32_16x16x32_bf16 v[128:131], a[0:3], a[76:79], v[128:131]
    buffer_load_dwordx4 a[172:175], v216, s[8:11], s16 offen
    v_mfma_f32_16x16x32_bf16 v[68:71], a[4:7], a[68:71], v[68:71]
    ds_read_b64_tr_b16 a[36:37], v207 offset:8192
    v_mfma_f32_16x16x32_bf16 v[100:103], a[4:7], a[72:75], v[100:103]
    ds_read_b64_tr_b16 a[38:39], v207 offset:10240
    v_mfma_f32_16x16x32_bf16 v[132:135], a[4:7], a[76:79], v[132:135]
    ds_read_b64_tr_b16 a[40:41], v211 offset:8192
    v_mfma_f32_16x16x32_bf16 v[72:75], a[8:11], a[68:71], v[72:75]
    ds_read_b64_tr_b16 a[42:43], v211 offset:10240
    v_mfma_f32_16x16x32_bf16 v[104:107], a[8:11], a[72:75], v[104:107]
    buffer_load_dwordx4 a[116:119], v217, s[8:11], s16 offen
    v_mfma_f32_16x16x32_bf16 v[136:139], a[8:11], a[76:79], v[136:139]
    ds_read_b64_tr_b16 a[44:45], v215 offset:8192
    v_mfma_f32_16x16x32_bf16 v[76:79], a[12:15], a[68:71], v[76:79]
    ds_read_b64_tr_b16 a[46:47], v215 offset:10240
    v_mfma_f32_16x16x32_bf16 v[108:111], a[12:15], a[72:75], v[108:111]
    ds_read_b64_tr_b16 a[48:49], v203 offset:12288
    v_mfma_f32_16x16x32_bf16 v[140:143], a[12:15], a[76:79], v[140:143]
    ds_read_b64_tr_b16 a[50:51], v203 offset:14336
    v_mfma_f32_16x16x32_bf16 v[80:83], a[16:19], a[68:71], v[80:83]
    buffer_load_dwordx4 a[120:123], v218, s[8:11], s16 offen
    v_mfma_f32_16x16x32_bf16 v[112:115], a[16:19], a[72:75], v[112:115]
    ds_read_b64_tr_b16 a[52:53], v207 offset:12288
    v_mfma_f32_16x16x32_bf16 v[144:147], a[16:19], a[76:79], v[144:147]
    ds_read_b64_tr_b16 a[54:55], v207 offset:14336
    v_mfma_f32_16x16x32_bf16 v[84:87], a[20:23], a[68:71], v[84:87]
    ds_read_b64_tr_b16 a[56:57], v211 offset:12288
    v_mfma_f32_16x16x32_bf16 v[116:119], a[20:23], a[72:75], v[116:119]
    buffer_load_dwordx4 a[124:127], v219, s[8:11], s16 offen
    v_mfma_f32_16x16x32_bf16 v[148:151], a[20:23], a[76:79], v[148:151]
    ds_read_b64_tr_b16 a[58:59], v211 offset:14336
    v_mfma_f32_16x16x32_bf16 v[88:91], a[24:27], a[68:71], v[88:91]
    ds_read_b64_tr_b16 a[60:61], v215 offset:12288
    v_mfma_f32_16x16x32_bf16 v[120:123], a[24:27], a[72:75], v[120:123]
    ds_read_b64_tr_b16 a[62:63], v215 offset:14336
    v_mfma_f32_16x16x32_bf16 v[152:155], a[24:27], a[76:79], v[152:155]
    v_mfma_f32_16x16x32_bf16 v[92:95], a[28:31], a[68:71], v[92:95]
    s_add_u32 s16, s16, 8192
    v_mfma_f32_16x16x32_bf16 v[124:127], a[28:31], a[72:75], v[124:127]
    v_mfma_f32_16x16x32_bf16 v[156:159], a[28:31], a[76:79], v[156:159]
    s_waitcnt vmcnt(8) lgkmcnt(0)
    v_mfma_f32_16x16x32_bf16 v[64:67], a[32:35], a[84:87], v[64:67]
    ds_read_b64_tr_b16 a[0:1], v200 offset:0
    v_mfma_f32_16x16x32_bf16 v[96:99], a[32:35], a[88:91], v[96:99]
    ds_read_b64_tr_b16 a[2:3], v200 offset:2048
    v_mfma_f32_16x16x32_bf16 v[128:131], a[32:35], a[92:95], v[128:131]
    ds_read_b64_tr_b16 a[4:5], v204 offset:0
    v_mfma_f32_16x16x32_bf16 v[68:71], a[36:39], a[84:87], v[68:71]
    ds_read_b64_tr_b16 a[6:7], v204 offset:2048
    v_mfma_f32_16x16x32_bf16 v[100:103], a[36:39], a[88:91], v[100:103]
    ds_read_b64_tr_b16 a[8:9], v208 offset:0
    v_mfma_f32_16x16x32_bf16 v[132:135], a[36:39], a[92:95], v[132:135]
    ds_read_b64_tr_b16 a[10:11], v208 offset:2048
    v_mfma_f32_16x16x32_bf16 v[72:75], a[40:43], a[84:87], v[72:75]
    v_mfma_f32_16x16x32_bf16 v[104:107], a[40:43], a[88:91], v[104:107]
    ds_read_b64_tr_b16 a[12:13], v212 offset:0
    v_mfma_f32_16x16x32_bf16 v[136:139], a[40:43], a[92:95], v[136:139]
    ds_read_b64_tr_b16 a[14:15], v212 offset:2048
    v_mfma_f32_16x16x32_bf16 v[76:79], a[44:47], a[84:87], v[76:79]
    ds_read_b64_tr_b16 a[16:17], v200 offset:4096
    v_mfma_f32_16x16x32_bf16 v[108:111], a[44:47], a[88:91], v[108:111]
    ds_read_b64_tr_b16 a[18:19], v200 offset:6144
    v_mfma_f32_16x16x32_bf16 v[140:143], a[44:47], a[92:95], v[140:143]
    ds_read_b64_tr_b16 a[20:21], v204 offset:4096
    v_mfma_f32_16x16x32_bf16 v[80:83], a[48:51], a[84:87], v[80:83]
    v_mfma_f32_16x16x32_bf16 v[112:115], a[48:51], a[88:91], v[112:115]
    ds_read_b64_tr_b16 a[22:23], v204 offset:6144
    v_mfma_f32_16x16x32_bf16 v[144:147], a[48:51], a[92:95], v[144:147]
    ds_read_b64_tr_b16 a[24:25], v208 offset:4096
    v_mfma_f32_16x16x32_bf16 v[84:87], a[52:55], a[84:87], v[84:87]
    ds_read_b64_tr_b16 a[26:27], v208 offset:6144
    v_mfma_f32_16x16x32_bf16 v[116:119], a[52:55], a[88:91], v[116:119]
    ds_read_b64_tr_b16 a[28:29], v212 offset:4096
    v_mfma_f32_16x16x32_bf16 v[148:151], a[52:55], a[92:95], v[148:151]
    ds_read_b64_tr_b16 a[30:31], v212 offset:6144
    v_mfma_f32_16x16x32_bf16 v[88:91], a[56:59], a[84:87], v[88:91]
    v_mfma_f32_16x16x32_bf16 v[120:123], a[56:59], a[88:91], v[120:123]
    v_mfma_f32_16x16x32_bf16 v[152:155], a[56:59], a[92:95], v[152:155]
    v_mfma_f32_16x16x32_bf16 v[92:95], a[60:63], a[84:87], v[92:95]
    v_mfma_f32_16x16x32_bf16 v[124:127], a[60:63], a[88:91], v[124:127]
    v_mfma_f32_16x16x32_bf16 v[156:159], a[60:63], a[92:95], v[156:159]
    s_waitcnt vmcnt(4) lgkmcnt(0)
    v_mfma_f32_16x16x32_bf16 v[64:67], a[0:3], a[100:103], v[64:67]
    ds_read_b64_tr_b16 a[32:33], v200 offset:8192
    v_mfma_f32_16x16x32_bf16 v[96:99], a[0:3], a[104:107], v[96:99]
    ds_read_b64_tr_b16 a[34:35], v200 offset:10240
    v_mfma_f32_16x16x32_bf16 v[128:131], a[0:3], a[108:111], v[128:131]
    ds_read_b64_tr_b16 a[36:37], v204 offset:8192
    v_mfma_f32_16x16x32_bf16 v[68:71], a[4:7], a[100:103], v[68:71]
    ds_read_b64_tr_b16 a[38:39], v204 offset:10240
    v_mfma_f32_16x16x32_bf16 v[100:103], a[4:7], a[104:107], v[100:103]
    ds_read_b64_tr_b16 a[40:41], v208 offset:8192
    v_mfma_f32_16x16x32_bf16 v[132:135], a[4:7], a[108:111], v[132:135]
    ds_read_b64_tr_b16 a[42:43], v208 offset:10240
    v_mfma_f32_16x16x32_bf16 v[72:75], a[8:11], a[100:103], v[72:75]
    v_mfma_f32_16x16x32_bf16 v[104:107], a[8:11], a[104:107], v[104:107]
    ds_read_b64_tr_b16 a[44:45], v212 offset:8192
    v_mfma_f32_16x16x32_bf16 v[136:139], a[8:11], a[108:111], v[136:139]
    ds_read_b64_tr_b16 a[46:47], v212 offset:10240
    v_mfma_f32_16x16x32_bf16 v[76:79], a[12:15], a[100:103], v[76:79]
    ds_read_b64_tr_b16 a[48:49], v200 offset:12288
    v_mfma_f32_16x16x32_bf16 v[108:111], a[12:15], a[104:107], v[108:111]
    ds_read_b64_tr_b16 a[50:51], v200 offset:14336
    v_mfma_f32_16x16x32_bf16 v[140:143], a[12:15], a[108:111], v[140:143]
    ds_read_b64_tr_b16 a[52:53], v204 offset:12288
    v_mfma_f32_16x16x32_bf16 v[80:83], a[16:19], a[100:103], v[80:83]
    v_mfma_f32_16x16x32_bf16 v[112:115], a[16:19], a[104:107], v[112:115]
    ds_read_b64_tr_b16 a[54:55], v204 offset:14336
    v_mfma_f32_16x16x32_bf16 v[144:147], a[16:19], a[108:111], v[144:147]
    ds_read_b64_tr_b16 a[56:57], v208 offset:12288
    v_mfma_f32_16x16x32_bf16 v[84:87], a[20:23], a[100:103], v[84:87]
    ds_read_b64_tr_b16 a[58:59], v208 offset:14336
    v_mfma_f32_16x16x32_bf16 v[116:119], a[20:23], a[104:107], v[116:119]
    ds_read_b64_tr_b16 a[60:61], v212 offset:12288
    v_mfma_f32_16x16x32_bf16 v[148:151], a[20:23], a[108:111], v[148:151]
    ds_read_b64_tr_b16 a[62:63], v212 offset:14336
    v_mfma_f32_16x16x32_bf16 v[88:91], a[24:27], a[100:103], v[88:91]
    v_mfma_f32_16x16x32_bf16 v[120:123], a[24:27], a[104:107], v[120:123]
    v_mfma_f32_16x16x32_bf16 v[152:155], a[24:27], a[108:111], v[152:155]
    v_mfma_f32_16x16x32_bf16 v[92:95], a[28:31], a[100:103], v[92:95]
    v_mfma_f32_16x16x32_bf16 v[124:127], a[28:31], a[104:107], v[124:127]
    v_mfma_f32_16x16x32_bf16 v[156:159], a[28:31], a[108:111], v[156:159]
    s_waitcnt vmcnt(0) lgkmcnt(0)
    ds_read_b64_tr_b16 a[0:1], v201 offset:32768
    ds_read_b64_tr_b16 a[2:3], v201 offset:34816
    ds_read_b64_tr_b16 a[4:5], v205 offset:32768
    ds_read_b64_tr_b16 a[6:7], v205 offset:34816
    ds_read_b64_tr_b16 a[8:9], v209 offset:32768
    ds_read_b64_tr_b16 a[10:11], v209 offset:34816
    ds_read_b64_tr_b16 a[12:13], v213 offset:32768
    ds_read_b64_tr_b16 a[14:15], v213 offset:34816
    ds_read_b64_tr_b16 a[16:17], v201 offset:36864
    ds_read_b64_tr_b16 a[18:19], v201 offset:38912
    ds_read_b64_tr_b16 a[20:21], v205 offset:36864
    ds_read_b64_tr_b16 a[22:23], v205 offset:38912
    ds_read_b64_tr_b16 a[24:25], v209 offset:36864
    ds_read_b64_tr_b16 a[26:27], v209 offset:38912
    ds_read_b64_tr_b16 a[28:29], v213 offset:36864
    ds_read_b64_tr_b16 a[30:31], v213 offset:38912
    v_mfma_f32_16x16x32_bf16 v[64:67], a[32:35], a[116:119], v[64:67]
    v_mfma_f32_16x16x32_bf16 v[68:71], a[36:39], a[116:119], v[68:71]
    v_mfma_f32_16x16x32_bf16 v[72:75], a[40:43], a[116:119], v[72:75]
    v_mfma_f32_16x16x32_bf16 v[76:79], a[44:47], a[116:119], v[76:79]
    v_mfma_f32_16x16x32_bf16 v[80:83], a[48:51], a[116:119], v[80:83]
    v_mfma_f32_16x16x32_bf16 v[84:87], a[52:55], a[116:119], v[84:87]
    v_mfma_f32_16x16x32_bf16 v[88:91], a[56:59], a[116:119], v[88:91]
    v_mfma_f32_16x16x32_bf16 v[92:95], a[60:63], a[116:119], v[92:95]
    v_mfma_f32_16x16x32_bf16 v[96:99], a[32:35], a[120:123], v[96:99]
    v_mfma_f32_16x16x32_bf16 v[100:103], a[36:39], a[120:123], v[100:103]
    s_add_u32 s4, s61, 4096
    v_cvt_pk_bf16_f32 v64, v64, v65
    v_cvt_pk_bf16_f32 v65, v66, v67
    v_mfma_f32_16x16x32_bf16 v[104:107], a[40:43], a[120:123], v[104:107]
    v_cvt_pk_bf16_f32 v66, v68, v69
    v_cvt_pk_bf16_f32 v67, v70, v71
    buffer_store_dwordx4 v[64:67], v24, s[24:27], s4 offen offset:0 sc1
    v_mfma_f32_16x16x32_bf16 v[108:111], a[44:47], a[120:123], v[108:111]
    v_cvt_pk_bf16_f32 v68, v72, v73
    v_cvt_pk_bf16_f32 v69, v74, v75
    v_cvt_pk_bf16_f32 v70, v76, v77
    v_mfma_f32_16x16x32_bf16 v[112:115], a[48:51], a[120:123], v[112:115]
    v_cvt_pk_bf16_f32 v71, v78, v79
    buffer_store_dwordx4 v[68:71], v24, s[24:27], s4 offen offset:1024 sc1
    v_cvt_pk_bf16_f32 v72, v80, v81
    v_mfma_f32_16x16x32_bf16 v[116:119], a[52:55], a[120:123], v[116:119]
    v_cvt_pk_bf16_f32 v73, v82, v83
    v_cvt_pk_bf16_f32 v74, v84, v85
    v_cvt_pk_bf16_f32 v75, v86, v87
    v_mfma_f32_16x16x32_bf16 v[120:123], a[56:59], a[120:123], v[120:123]
    buffer_store_dwordx4 v[72:75], v24, s[24:27], s4 offen offset:2048 sc1
    v_cvt_pk_bf16_f32 v76, v88, v89
    v_cvt_pk_bf16_f32 v77, v90, v91
    v_mfma_f32_16x16x32_bf16 v[124:127], a[60:63], a[120:123], v[124:127]
    v_cvt_pk_bf16_f32 v78, v92, v93
    v_cvt_pk_bf16_f32 v79, v94, v95
    buffer_store_dwordx4 v[76:79], v24, s[24:27], s4 offen offset:3072 sc1
    v_mfma_f32_16x16x32_bf16 v[128:131], a[32:35], a[124:127], v[128:131]
    v_mfma_f32_16x16x32_bf16 v[132:135], a[36:39], a[124:127], v[132:135]
    s_add_u32 s4, s61, 8192
    v_cvt_pk_bf16_f32 v96, v96, v97
    v_cvt_pk_bf16_f32 v97, v98, v99
    v_mfma_f32_16x16x32_bf16 v[136:139], a[40:43], a[124:127], v[136:139]
    v_cvt_pk_bf16_f32 v98, v100, v101
    v_cvt_pk_bf16_f32 v99, v102, v103
    buffer_store_dwordx4 v[96:99], v24, s[24:27], s4 offen offset:0 sc1
    v_mfma_f32_16x16x32_bf16 v[140:143], a[44:47], a[124:127], v[140:143]
    v_cvt_pk_bf16_f32 v100, v104, v105
    v_cvt_pk_bf16_f32 v101, v106, v107
    v_cvt_pk_bf16_f32 v102, v108, v109
    v_mfma_f32_16x16x32_bf16 v[144:147], a[48:51], a[124:127], v[144:147]
    v_cvt_pk_bf16_f32 v103, v110, v111
    buffer_store_dwordx4 v[100:103], v24, s[24:27], s4 offen offset:1024 sc1
    v_cvt_pk_bf16_f32 v104, v112, v113
    v_mfma_f32_16x16x32_bf16 v[148:151], a[52:55], a[124:127], v[148:151]
    v_cvt_pk_bf16_f32 v105, v114, v115
    v_cvt_pk_bf16_f32 v106, v116, v117
    v_cvt_pk_bf16_f32 v107, v118, v119
    v_mfma_f32_16x16x32_bf16 v[152:155], a[56:59], a[124:127], v[152:155]
    buffer_store_dwordx4 v[104:107], v24, s[24:27], s4 offen offset:2048 sc1
    v_cvt_pk_bf16_f32 v108, v120, v121
    v_cvt_pk_bf16_f32 v109, v122, v123
    v_mfma_f32_16x16x32_bf16 v[156:159], a[60:63], a[124:127], v[156:159]
    v_cvt_pk_bf16_f32 v110, v124, v125
    v_cvt_pk_bf16_f32 v111, v126, v127
    buffer_store_dwordx4 v[108:111], v24, s[24:27], s4 offen offset:3072 sc1
    s_nop 7
    s_add_u32 s4, s61, 12288
    v_cvt_pk_bf16_f32 v128, v128, v129
    v_cvt_pk_bf16_f32 v129, v130, v131
    v_cvt_pk_bf16_f32 v130, v132, v133
    v_cvt_pk_bf16_f32 v131, v134, v135
    buffer_store_dwordx4 v[128:131], v24, s[24:27], s4 offen offset:0 sc1
    v_cvt_pk_bf16_f32 v132, v136, v137
    v_cvt_pk_bf16_f32 v133, v138, v139
    v_cvt_pk_bf16_f32 v134, v140, v141
    v_cvt_pk_bf16_f32 v135, v142, v143
    buffer_store_dwordx4 v[132:135], v24, s[24:27], s4 offen offset:1024 sc1
    v_cvt_pk_bf16_f32 v136, v144, v145
    v_cvt_pk_bf16_f32 v137, v146, v147
    v_cvt_pk_bf16_f32 v138, v148, v149
    v_cvt_pk_bf16_f32 v139, v150, v151
    buffer_store_dwordx4 v[136:139], v24, s[24:27], s4 offen offset:2048 sc1
    v_cvt_pk_bf16_f32 v140, v152, v153
    v_cvt_pk_bf16_f32 v141, v154, v155
    v_cvt_pk_bf16_f32 v142, v156, v157
    v_cvt_pk_bf16_f32 v143, v158, v159
    buffer_store_dwordx4 v[140:143], v24, s[24:27], s4 offen offset:3072 sc1
    s_waitcnt lgkmcnt(0)
    v_mfma_f32_16x16x32_bf16 v[32:35], a[0:3], a[128:131], v[32:35]
    ds_read_b64_tr_b16 a[32:33], v201 offset:40960
    ds_read_b64_tr_b16 a[34:35], v201 offset:43008
    v_mfma_f32_16x16x32_bf16 v[36:39], a[4:7], a[128:131], v[36:39]
    ds_read_b64_tr_b16 a[36:37], v205 offset:40960
    ds_read_b64_tr_b16 a[38:39], v205 offset:43008
    v_mfma_f32_16x16x32_bf16 v[40:43], a[8:11], a[128:131], v[40:43]
    ds_read_b64_tr_b16 a[40:41], v209 offset:40960
    ds_read_b64_tr_b16 a[42:43], v209 offset:43008
    v_mfma_f32_16x16x32_bf16 v[44:47], a[12:15], a[128:131], v[44:47]
    ds_read_b64_tr_b16 a[44:45], v213 offset:40960
    ds_read_b64_tr_b16 a[46:47], v213 offset:43008
    v_mfma_f32_16x16x32_bf16 v[48:51], a[16:19], a[128:131], v[48:51]
    ds_read_b64_tr_b16 a[48:49], v201 offset:45056
    ds_read_b64_tr_b16 a[50:51], v201 offset:47104
    v_mfma_f32_16x16x32_bf16 v[52:55], a[20:23], a[128:131], v[52:55]
    ds_read_b64_tr_b16 a[52:53], v205 offset:45056
    ds_read_b64_tr_b16 a[54:55], v205 offset:47104
    v_mfma_f32_16x16x32_bf16 v[56:59], a[24:27], a[128:131], v[56:59]
    ds_read_b64_tr_b16 a[56:57], v209 offset:45056
    ds_read_b64_tr_b16 a[58:59], v209 offset:47104
    v_mfma_f32_16x16x32_bf16 v[60:63], a[28:31], a[128:131], v[60:63]
    ds_read_b64_tr_b16 a[60:61], v213 offset:45056
    ds_read_b64_tr_b16 a[62:63], v213 offset:47104
    s_waitcnt lgkmcnt(0)
    v_mfma_f32_16x16x32_bf16 v[32:35], a[32:35], a[132:135], v[32:35]
    ds_read_b64_tr_b16 a[0:1], v202 offset:0
    ds_read_b64_tr_b16 a[2:3], v202 offset:2048
    v_mfma_f32_16x16x32_bf16 v[36:39], a[36:39], a[132:135], v[36:39]
    ds_read_b64_tr_b16 a[4:5], v206 offset:0
    ds_read_b64_tr_b16 a[6:7], v206 offset:2048
    v_mfma_f32_16x16x32_bf16 v[40:43], a[40:43], a[132:135], v[40:43]
    ds_read_b64_tr_b16 a[8:9], v210 offset:0
    ds_read_b64_tr_b16 a[10:11], v210 offset:2048
    v_mfma_f32_16x16x32_bf16 v[44:47], a[44:47], a[132:135], v[44:47]
    ds_read_b64_tr_b16 a[12:13], v214 offset:0
    ds_read_b64_tr_b16 a[14:15], v214 offset:2048
    v_mfma_f32_16x16x32_bf16 v[48:51], a[48:51], a[132:135], v[48:51]
    ds_read_b64_tr_b16 a[16:17], v202 offset:4096
    ds_read_b64_tr_b16 a[18:19], v202 offset:6144
    v_mfma_f32_16x16x32_bf16 v[52:55], a[52:55], a[132:135], v[52:55]
    ds_read_b64_tr_b16 a[20:21], v206 offset:4096
    ds_read_b64_tr_b16 a[22:23], v206 offset:6144
    v_mfma_f32_16x16x32_bf16 v[56:59], a[56:59], a[132:135], v[56:59]
    ds_read_b64_tr_b16 a[24:25], v210 offset:4096
    ds_read_b64_tr_b16 a[26:27], v210 offset:6144
    v_mfma_f32_16x16x32_bf16 v[60:63], a[60:63], a[132:135], v[60:63]
    ds_read_b64_tr_b16 a[28:29], v214 offset:4096
    ds_read_b64_tr_b16 a[30:31], v214 offset:6144
    s_waitcnt lgkmcnt(0)
    v_mfma_f32_16x16x32_bf16 v[32:35], a[0:3], a[136:139], v[32:35]
    ds_read_b64_tr_b16 a[32:33], v202 offset:8192
    ds_read_b64_tr_b16 a[34:35], v202 offset:10240
    v_mfma_f32_16x16x32_bf16 v[36:39], a[4:7], a[136:139], v[36:39]
    ds_read_b64_tr_b16 a[36:37], v206 offset:8192
    ds_read_b64_tr_b16 a[38:39], v206 offset:10240
    v_mfma_f32_16x16x32_bf16 v[40:43], a[8:11], a[136:139], v[40:43]
    ds_read_b64_tr_b16 a[40:41], v210 offset:8192
    ds_read_b64_tr_b16 a[42:43], v210 offset:10240
    v_mfma_f32_16x16x32_bf16 v[44:47], a[12:15], a[136:139], v[44:47]
    ds_read_b64_tr_b16 a[44:45], v214 offset:8192
    ds_read_b64_tr_b16 a[46:47], v214 offset:10240
    v_mfma_f32_16x16x32_bf16 v[48:51], a[16:19], a[136:139], v[48:51]
    ds_read_b64_tr_b16 a[48:49], v202 offset:12288
    ds_read_b64_tr_b16 a[50:51], v202 offset:14336
    v_mfma_f32_16x16x32_bf16 v[52:55], a[20:23], a[136:139], v[52:55]
    ds_read_b64_tr_b16 a[52:53], v206 offset:12288
    ds_read_b64_tr_b16 a[54:55], v206 offset:14336
    v_mfma_f32_16x16x32_bf16 v[56:59], a[24:27], a[136:139], v[56:59]
    ds_read_b64_tr_b16 a[56:57], v210 offset:12288
    ds_read_b64_tr_b16 a[58:59], v210 offset:14336
    v_mfma_f32_16x16x32_bf16 v[60:63], a[28:31], a[136:139], v[60:63]
    ds_read_b64_tr_b16 a[60:61], v214 offset:12288
    ds_read_b64_tr_b16 a[62:63], v214 offset:14336
    s_waitcnt lgkmcnt(0)
    v_mfma_f32_16x16x32_bf16 v[32:35], a[32:35], a[140:143], v[32:35]
    ds_read_b64_tr_b16 a[0:1], v202 offset:16384
    ds_read_b64_tr_b16 a[2:3], v202 offset:18432
    v_mfma_f32_16x16x32_bf16 v[36:39], a[36:39], a[140:143], v[36:39]
    ds_read_b64_tr_b16 a[4:5], v206 offset:16384
    ds_read_b64_tr_b16 a[6:7], v206 offset:18432
    v_mfma_f32_16x16x32_bf16 v[40:43], a[40:43], a[140:143], v[40:43]
    ds_read_b64_tr_b16 a[8:9], v210 offset:16384
    ds_read_b64_tr_b16 a[10:11], v210 offset:18432
    v_mfma_f32_16x16x32_bf16 v[44:47], a[44:47], a[140:143], v[44:47]
    ds_read_b64_tr_b16 a[12:13], v214 offset:16384
    ds_read_b64_tr_b16 a[14:15], v214 offset:18432
    v_mfma_f32_16x16x32_bf16 v[48:51], a[48:51], a[140:143], v[48:51]
    ds_read_b64_tr_b16 a[16:17], v202 offset:20480
    ds_read_b64_tr_b16 a[18:19], v202 offset:22528
    v_mfma_f32_16x16x32_bf16 v[52:55], a[52:55], a[140:143], v[52:55]
    ds_read_b64_tr_b16 a[20:21], v206 offset:20480
    ds_read_b64_tr_b16 a[22:23], v206 offset:22528
    v_mfma_f32_16x16x32_bf16 v[56:59], a[56:59], a[140:143], v[56:59]
    ds_read_b64_tr_b16 a[24:25], v210 offset:20480
    ds_read_b64_tr_b16 a[26:27], v210 offset:22528
    v_mfma_f32_16x16x32_bf16 v[60:63], a[60:63], a[140:143], v[60:63]
    ds_read_b64_tr_b16 a[28:29], v214 offset:20480
    ds_read_b64_tr_b16 a[30:31], v214 offset:22528
    s_waitcnt lgkmcnt(0)
    v_mfma_f32_16x16x32_bf16 v[32:35], a[0:3], a[144:147], v[32:35]
    ds_read_b64_tr_b16 a[32:33], v202 offset:24576
    ds_read_b64_tr_b16 a[34:35], v202 offset:26624
    v_mfma_f32_16x16x32_bf16 v[36:39], a[4:7], a[144:147], v[36:39]
    ds_read_b64_tr_b16 a[36:37], v206 offset:24576
    ds_read_b64_tr_b16 a[38:39], v206 offset:26624
    v_mfma_f32_16x16x32_bf16 v[40:43], a[8:11], a[144:147], v[40:43]
    ds_read_b64_tr_b16 a[40:41], v210 offset:24576
    ds_read_b64_tr_b16 a[42:43], v210 offset:26624
    v_mfma_f32_16x16x32_bf16 v[44:47], a[12:15], a[144:147], v[44:47]
    ds_read_b64_tr_b16 a[44:45], v214 offset:24576
    ds_read_b64_tr_b16 a[46:47], v214 offset:26624
    v_mfma_f32_16x16x32_bf16 v[48:51], a[16:19], a[144:147], v[48:51]
    ds_read_b64_tr_b16 a[48:49], v202 offset:28672
    ds_read_b64_tr_b16 a[50:51], v202 offset:30720
    v_mfma_f32_16x16x32_bf16 v[52:55], a[20:23], a[144:147], v[52:55]
    ds_read_b64_tr_b16 a[52:53], v206 offset:28672
    ds_read_b64_tr_b16 a[54:55], v206 offset:30720
    v_mfma_f32_16x16x32_bf16 v[56:59], a[24:27], a[144:147], v[56:59]
    ds_read_b64_tr_b16 a[56:57], v210 offset:28672
    ds_read_b64_tr_b16 a[58:59], v210 offset:30720
    v_mfma_f32_16x16x32_bf16 v[60:63], a[28:31], a[144:147], v[60:63]
    ds_read_b64_tr_b16 a[60:61], v214 offset:28672
    ds_read_b64_tr_b16 a[62:63], v214 offset:30720
    s_lshl_b32 s4, s2, 2
    s_add_u32 s4, s4, s3
    v_lshlrev_b32 v2, 3, v1
    v_xor_b32 v2, s4, v2
    v_lshlrev_b32 v2, 7, v2
    v_mov_b32 v3, s88
    s_mov_b32 s5, 262144
    s_mov_b64 exec, 1
    s_waitcnt vmcnt(0)
    buffer_store_dword v3, v2, s[84:87], s5 offen sc1
    s_mov_b64 exec, -1
    s_waitcnt lgkmcnt(0)
    v_mfma_f32_16x16x32_bf16 v[32:35], a[32:35], a[148:151], v[32:35]
    ds_read_b64_tr_b16 a[0:1], v202 offset:32768
    ds_read_b64_tr_b16 a[2:3], v202 offset:34816
    v_mfma_f32_16x16x32_bf16 v[36:39], a[36:39], a[148:151], v[36:39]
    ds_read_b64_tr_b16 a[4:5], v206 offset:32768
    ds_read_b64_tr_b16 a[6:7], v206 offset:34816
    v_mfma_f32_16x16x32_bf16 v[40:43], a[40:43], a[148:151], v[40:43]
    ds_read_b64_tr_b16 a[8:9], v210 offset:32768
    ds_read_b64_tr_b16 a[10:11], v210 offset:34816
    v_mfma_f32_16x16x32_bf16 v[44:47], a[44:47], a[148:151], v[44:47]
    ds_read_b64_tr_b16 a[12:13], v214 offset:32768
    ds_read_b64_tr_b16 a[14:15], v214 offset:34816
    v_mfma_f32_16x16x32_bf16 v[48:51], a[48:51], a[148:151], v[48:51]
    ds_read_b64_tr_b16 a[16:17], v202 offset:36864
    ds_read_b64_tr_b16 a[18:19], v202 offset:38912
    v_mfma_f32_16x16x32_bf16 v[52:55], a[52:55], a[148:151], v[52:55]
    ds_read_b64_tr_b16 a[20:21], v206 offset:36864
    ds_read_b64_tr_b16 a[22:23], v206 offset:38912
    v_mfma_f32_16x16x32_bf16 v[56:59], a[56:59], a[148:151], v[56:59]
    ds_read_b64_tr_b16 a[24:25], v210 offset:36864
    ds_read_b64_tr_b16 a[26:27], v210 offset:38912
    v_mfma_f32_16x16x32_bf16 v[60:63], a[60:63], a[148:151], v[60:63]
    ds_read_b64_tr_b16 a[28:29], v214 offset:36864
    ds_read_b64_tr_b16 a[30:31], v214 offset:38912
    s_waitcnt lgkmcnt(0)
    v_mfma_f32_16x16x32_bf16 v[32:35], a[0:3], a[152:155], v[32:35]
    ds_read_b64_tr_b16 a[32:33], v202 offset:40960
    ds_read_b64_tr_b16 a[34:35], v202 offset:43008
    v_mfma_f32_16x16x32_bf16 v[36:39], a[4:7], a[152:155], v[36:39]
    ds_read_b64_tr_b16 a[36:37], v206 offset:40960
    ds_read_b64_tr_b16 a[38:39], v206 offset:43008
    v_mfma_f32_16x16x32_bf16 v[40:43], a[8:11], a[152:155], v[40:43]
    ds_read_b64_tr_b16 a[40:41], v210 offset:40960
    ds_read_b64_tr_b16 a[42:43], v210 offset:43008
    v_mfma_f32_16x16x32_bf16 v[44:47], a[12:15], a[152:155], v[44:47]
    ds_read_b64_tr_b16 a[44:45], v214 offset:40960
    ds_read_b64_tr_b16 a[46:47], v214 offset:43008
    v_mfma_f32_16x16x32_bf16 v[48:51], a[16:19], a[152:155], v[48:51]
    ds_read_b64_tr_b16 a[48:49], v202 offset:45056
    ds_read_b64_tr_b16 a[50:51], v202 offset:47104
    v_mfma_f32_16x16x32_bf16 v[52:55], a[20:23], a[152:155], v[52:55]
    ds_read_b64_tr_b16 a[52:53], v206 offset:45056
    ds_read_b64_tr_b16 a[54:55], v206 offset:47104
    v_mfma_f32_16x16x32_bf16 v[56:59], a[24:27], a[152:155], v[56:59]
    ds_read_b64_tr_b16 a[56:57], v210 offset:45056
    ds_read_b64_tr_b16 a[58:59], v210 offset:47104
    v_mfma_f32_16x16x32_bf16 v[60:63], a[28:31], a[152:155], v[60:63]
    ds_read_b64_tr_b16 a[60:61], v214 offset:45056
    ds_read_b64_tr_b16 a[62:63], v214 offset:47104
    s_waitcnt lgkmcnt(0)
    v_mfma_f32_16x16x32_bf16 v[32:35], a[32:35], a[156:159], v[32:35]
    ds_read_b64_tr_b16 a[0:1], v203 offset:0
    ds_read_b64_tr_b16 a[2:3], v203 offset:2048
    v_mfma_f32_16x16x32_bf16 v[36:39], a[36:39], a[156:159], v[36:39]
    ds_read_b64_tr_b16 a[4:5], v207 offset:0
    ds_read_b64_tr_b16 a[6:7], v207 offset:2048
    v_mfma_f32_16x16x32_bf16 v[40:43], a[40:43], a[156:159], v[40:43]
    ds_read_b64_tr_b16 a[8:9], v211 offset:0
    ds_read_b64_tr_b16 a[10:11], v211 offset:2048
    v_mfma_f32_16x16x32_bf16 v[44:47], a[44:47], a[156:159], v[44:47]
    ds_read_b64_tr_b16 a[12:13], v215 offset:0
    ds_read_b64_tr_b16 a[14:15], v215 offset:2048
    v_mfma_f32_16x16x32_bf16 v[48:51], a[48:51], a[156:159], v[48:51]
    ds_read_b64_tr_b16 a[16:17], v203 offset:4096
    ds_read_b64_tr_b16 a[18:19], v203 offset:6144
    v_mfma_f32_16x16x32_bf16 v[52:55], a[52:55], a[156:159], v[52:55]
    ds_read_b64_tr_b16 a[20:21], v207 offset:4096
    ds_read_b64_tr_b16 a[22:23], v207 offset:6144
    v_mfma_f32_16x16x32_bf16 v[56:59], a[56:59], a[156:159], v[56:59]
    ds_read_b64_tr_b16 a[24:25], v211 offset:4096
    ds_read_b64_tr_b16 a[26:27], v211 offset:6144
    v_mfma_f32_16x16x32_bf16 v[60:63], a[60:63], a[156:159], v[60:63]
    ds_read_b64_tr_b16 a[28:29], v215 offset:4096
    ds_read_b64_tr_b16 a[30:31], v215 offset:6144
    s_waitcnt lgkmcnt(0)
    v_mfma_f32_16x16x32_bf16 v[32:35], a[0:3], a[160:163], v[32:35]
    ds_read_b64_tr_b16 a[32:33], v203 offset:8192
    ds_read_b64_tr_b16 a[34:35], v203 offset:10240
    v_mfma_f32_16x16x32_bf16 v[36:39], a[4:7], a[160:163], v[36:39]
    ds_read_b64_tr_b16 a[36:37], v207 offset:8192
    ds_read_b64_tr_b16 a[38:39], v207 offset:10240
    v_mfma_f32_16x16x32_bf16 v[40:43], a[8:11], a[160:163], v[40:43]
    ds_read_b64_tr_b16 a[40:41], v211 offset:8192
    ds_read_b64_tr_b16 a[42:43], v211 offset:10240
    v_mfma_f32_16x16x32_bf16 v[44:47], a[12:15], a[160:163], v[44:47]
    ds_read_b64_tr_b16 a[44:45], v215 offset:8192
    ds_read_b64_tr_b16 a[46:47], v215 offset:10240
    v_mfma_f32_16x16x32_bf16 v[48:51], a[16:19], a[160:163], v[48:51]
    ds_read_b64_tr_b16 a[48:49], v203 offset:12288
    ds_read_b64_tr_b16 a[50:51], v203 offset:14336
    v_mfma_f32_16x16x32_bf16 v[52:55], a[20:23], a[160:163], v[52:55]
    ds_read_b64_tr_b16 a[52:53], v207 offset:12288
    ds_read_b64_tr_b16 a[54:55], v207 offset:14336
    v_mfma_f32_16x16x32_bf16 v[56:59], a[24:27], a[160:163], v[56:59]
    ds_read_b64_tr_b16 a[56:57], v211 offset:12288
    ds_read_b64_tr_b16 a[58:59], v211 offset:14336
    v_mfma_f32_16x16x32_bf16 v[60:63], a[28:31], a[160:163], v[60:63]
    ds_read_b64_tr_b16 a[60:61], v215 offset:12288
    ds_read_b64_tr_b16 a[62:63], v215 offset:14336
    s_waitcnt lgkmcnt(0)
    v_mfma_f32_16x16x32_bf16 v[32:35], a[32:35], a[164:167], v[32:35]
    ds_read_b64_tr_b16 a[0:1], v200 offset:0
    ds_read_b64_tr_b16 a[2:3], v200 offset:2048
    v_mfma_f32_16x16x32_bf16 v[36:39], a[36:39], a[164:167], v[36:39]
    ds_read_b64_tr_b16 a[4:5], v204 offset:0
    ds_read_b64_tr_b16 a[6:7], v204 offset:2048
    v_mfma_f32_16x16x32_bf16 v[40:43], a[40:43], a[164:167], v[40:43]
    ds_read_b64_tr_b16 a[8:9], v208 offset:0
    ds_read_b64_tr_b16 a[10:11], v208 offset:2048
    v_mfma_f32_16x16x32_bf16 v[44:47], a[44:47], a[164:167], v[44:47]
    ds_read_b64_tr_b16 a[12:13], v212 offset:0
    ds_read_b64_tr_b16 a[14:15], v212 offset:2048
    v_mfma_f32_16x16x32_bf16 v[48:51], a[48:51], a[164:167], v[48:51]
    ds_read_b64_tr_b16 a[16:17], v200 offset:4096
    ds_read_b64_tr_b16 a[18:19], v200 offset:6144
    v_mfma_f32_16x16x32_bf16 v[52:55], a[52:55], a[164:167], v[52:55]
    ds_read_b64_tr_b16 a[20:21], v204 offset:4096
    ds_read_b64_tr_b16 a[22:23], v204 offset:6144
    v_mfma_f32_16x16x32_bf16 v[56:59], a[56:59], a[164:167], v[56:59]
    ds_read_b64_tr_b16 a[24:25], v208 offset:4096
    ds_read_b64_tr_b16 a[26:27], v208 offset:6144
    v_mfma_f32_16x16x32_bf16 v[60:63], a[60:63], a[164:167], v[60:63]
    ds_read_b64_tr_b16 a[28:29], v212 offset:4096
    ds_read_b64_tr_b16 a[30:31], v212 offset:6144
    s_waitcnt lgkmcnt(0)
    v_mfma_f32_16x16x32_bf16 v[32:35], a[0:3], a[168:171], v[32:35]
    ds_read_b64_tr_b16 a[32:33], v200 offset:8192
    ds_read_b64_tr_b16 a[34:35], v200 offset:10240
    v_mfma_f32_16x16x32_bf16 v[36:39], a[4:7], a[168:171], v[36:39]
    ds_read_b64_tr_b16 a[36:37], v204 offset:8192
    ds_read_b64_tr_b16 a[38:39], v204 offset:10240
    v_mfma_f32_16x16x32_bf16 v[40:43], a[8:11], a[168:171], v[40:43]
    ds_read_b64_tr_b16 a[40:41], v208 offset:8192
    ds_read_b64_tr_b16 a[42:43], v208 offset:10240
    v_mfma_f32_16x16x32_bf16 v[44:47], a[12:15], a[168:171], v[44:47]
    ds_read_b64_tr_b16 a[44:45], v212 offset:8192
    ds_read_b64_tr_b16 a[46:47], v212 offset:10240
    v_mfma_f32_16x16x32_bf16 v[48:51], a[16:19], a[168:171], v[48:51]
    ds_read_b64_tr_b16 a[48:49], v200 offset:12288
    ds_read_b64_tr_b16 a[50:51], v200 offset:14336
    v_mfma_f32_16x16x32_bf16 v[52:55], a[20:23], a[168:171], v[52:55]
    ds_read_b64_tr_b16 a[52:53], v204 offset:12288
    ds_read_b64_tr_b16 a[54:55], v204 offset:14336
    v_mfma_f32_16x16x32_bf16 v[56:59], a[24:27], a[168:171], v[56:59]
    ds_read_b64_tr_b16 a[56:57], v208 offset:12288
    ds_read_b64_tr_b16 a[58:59], v208 offset:14336
    v_mfma_f32_16x16x32_bf16 v[60:63], a[28:31], a[168:171], v[60:63]
    ds_read_b64_tr_b16 a[60:61], v212 offset:12288
    ds_read_b64_tr_b16 a[62:63], v212 offset:14336
    s_waitcnt lgkmcnt(0)
    v_mfma_f32_16x16x32_bf16 v[32:35], a[32:35], a[172:175], v[32:35]
    v_mfma_f32_16x16x32_bf16 v[36:39], a[36:39], a[172:175], v[36:39]
    v_mfma_f32_16x16x32_bf16 v[40:43], a[40:43], a[172:175], v[40:43]
    v_mfma_f32_16x16x32_bf16 v[44:47], a[44:47], a[172:175], v[44:47]
    v_mfma_f32_16x16x32_bf16 v[48:51], a[48:51], a[172:175], v[48:51]
    v_mfma_f32_16x16x32_bf16 v[52:55], a[52:55], a[172:175], v[52:55]
    v_mfma_f32_16x16x32_bf16 v[56:59], a[56:59], a[172:175], v[56:59]
    v_mfma_f32_16x16x32_bf16 v[60:63], a[60:63], a[172:175], v[60:63]
    s_nop 7
    v_add_f32 v176, v176, v177
    v_add_f32 v178, v178, v179
    v_add_f32 v176, v176, v178
    v_mov_b32 v11, v176
    s_nop 1
    v_permlane16_swap_b32 v176, v11
    v_add_f32 v176, v176, v11
    v_mov_b32 v11, v176
    s_nop 1
    v_permlane32_swap_b32 v176, v11
    v_add_f32 v176, v176, v11
    v_add_f32 v180, v180, v181
    v_add_f32 v182, v182, v183
    v_add_f32 v180, v180, v182
    v_mov_b32 v11, v180
    s_nop 1
    v_permlane16_swap_b32 v180, v11
    v_add_f32 v180, v180, v11
    v_mov_b32 v11, v180
    s_nop 1
    v_permlane32_swap_b32 v180, v11
    v_add_f32 v180, v180, v11
    v_mul_f32 v176, 0x3a800000, v176
    v_mul_f32 v177, v176, v176
    v_mov_b32 v178, 0x3a800000
    v_fma_f32 v176, v180, v178, -v177
    v_max_f32 v176, 0, v176
    v_add_f32 v176, 0x3727c5ac, v176
    v_rcp_f32 v192, v176
    s_nop 0
    v_mov_b32 v193, v192
    v_lshlrev_b32 v112, 16, v160
    v_and_b32 v113, 0xffff0000, v160
    v_lshlrev_b32 v114, 16, v161
    v_and_b32 v115, 0xffff0000, v161
    v_lshlrev_b32 v116, 16, v162
    v_and_b32 v117, 0xffff0000, v162
    v_lshlrev_b32 v118, 16, v163
    v_and_b32 v119, 0xffff0000, v163
    v_lshlrev_b32 v120, 16, v164
    v_and_b32 v121, 0xffff0000, v164
    v_lshlrev_b32 v122, 16, v165
    v_and_b32 v123, 0xffff0000, v165
    v_lshlrev_b32 v124, 16, v166
    v_and_b32 v125, 0xffff0000, v166
    v_lshlrev_b32 v126, 16, v167
    v_and_b32 v127, 0xffff0000, v167
    v_lshlrev_b32 v128, 16, v168
    v_and_b32 v129, 0xffff0000, v168
    v_lshlrev_b32 v130, 16, v169
    v_and_b32 v131, 0xffff0000, v169
    v_lshlrev_b32 v132, 16, v170
    v_and_b32 v133, 0xffff0000, v170
    v_lshlrev_b32 v134, 16, v171
    v_and_b32 v135, 0xffff0000, v171
    v_lshlrev_b32 v136, 16, v172
    v_and_b32 v137, 0xffff0000, v172
    v_lshlrev_b32 v138, 16, v173
    v_and_b32 v139, 0xffff0000, v173
    v_lshlrev_b32 v140, 16, v174
    v_and_b32 v141, 0xffff0000, v174
    v_lshlrev_b32 v142, 16, v175
    v_and_b32 v143, 0xffff0000, v175
    v_bfe_u32 v8, v1, 2, 2
    v_lshrrev_b32 v9, 4, v1
    v_and_b32 v12, 1, v1
    v_lshlrev_b32 v12, 4, v12
    v_mov_b32 v13, 0x3f80
    v_cmp_eq_u32 vcc, v8, v9
    v_lshlrev_b32 v12, v12, v13
    v_and_b32 v13, 2, v1
    v_cndmask_b32 v12, 0, v12, vcc
    v_cmp_eq_u32 vcc, 0, v13
    v_mov_b32 v146, 0
    v_mov_b32 v147, 0
    v_cndmask_b32 v144, 0, v12, vcc
    v_cndmask_b32 v145, v12, 0, vcc
    v_mov_b32 v148, 0
    v_mov_b32 v149, 0
    v_mov_b32 v150, v144
    v_mov_b32 v151, v145
    v_and_b32 v11, 15, v1
    v_lshrrev_b32 v3, 4, v1
    v_lshlrev_b32 v10, 11, v11
    v_and_b32 v11, 1, v3
    v_lshl_add_u32 v10, v11, 5, v10
    v_lshrrev_b32 v11, 1, v3
    v_lshl_add_u32 v10, v11, 4, v10
    v_and_b32 v11, 8, v1
    v_mul_u32_u24 v11, 2040, v11
    v_sub_u32 v16, v10, v11
    v_add_u32 v17, 16384, v16
    s_mov_b64 exec, 0xe
    s_mov_b32 s4, 0x20000
L_x6_23:
    buffer_load_dword v4, v2, s[84:87], s5 offen sc1
    s_waitcnt vmcnt(0)
    v_cmp_ne_u32 vcc, s88, v4
    s_sub_u32 s4, s4, 1
    s_nop 3
    s_cbranch_vccz L_x6_23_ok
    s_cmp_eq_u32 s4, 0
    s_cbranch_scc0 L_x6_23
L_x6_23_ok:
    s_mov_b64 exec, -1
    s_xor_b32 s4, s61, 131072
    s_add_u32 s4, s4, 4096
    buffer_load_dwordx4 v[64:67], v24, s[24:27], s4 offen offset:0
    s_xor_b32 s4, s61, 262144
    s_add_u32 s4, s4, 8192
    buffer_load_dwordx4 v[68:71], v24, s[24:27], s4 offen offset:0
    s_xor_b32 s4, s61, 393216
    s_add_u32 s4, s4, 12288
    buffer_load_dwordx4 v[72:75], v24, s[24:27], s4 offen offset:0
    s_xor_b32 s4, s61, 131072
    s_add_u32 s4, s4, 4096
    buffer_load_dwordx4 v[76:79], v24, s[24:27], s4 offen offset:1024
    s_xor_b32 s4, s61, 262144
    s_add_u32 s4, s4, 8192
    buffer_load_dwordx4 v[80:83], v24, s[24:27], s4 offen offset:1024
    s_xor_b32 s4, s61, 393216
    s_add_u32 s4, s4, 12288
    buffer_load_dwordx4 v[84:87], v24, s[24:27], s4 offen offset:1024
    s_xor_b32 s4, s61, 131072
    s_add_u32 s4, s4, 4096
    buffer_load_dwordx4 v[88:91], v24, s[24:27], s4 offen offset:2048
    s_xor_b32 s4, s61, 262144
    s_add_u32 s4, s4, 8192
    buffer_load_dwordx4 v[92:95], v24, s[24:27], s4 offen offset:2048
    s_xor_b32 s4, s61, 393216
    s_add_u32 s4, s4, 12288
    buffer_load_dwordx4 v[96:99], v24, s[24:27], s4 offen offset:2048
    s_xor_b32 s4, s61, 131072
    s_add_u32 s4, s4, 4096
    buffer_load_dwordx4 v[100:103], v24, s[24:27], s4 offen offset:3072
    s_xor_b32 s4, s61, 262144
    s_add_u32 s4, s4, 8192
    buffer_load_dwordx4 v[104:107], v24, s[24:27], s4 offen offset:3072
    s_xor_b32 s4, s61, 393216
    s_add_u32 s4, s4, 12288
    buffer_load_dwordx4 v[108:111], v24, s[24:27], s4 offen offset:3072
    s_waitcnt vmcnt(9)
    v_mfma_f32_16x16x32_bf16 v[32:35], v[144:147], v[64:67], v[32:35]
    v_mfma_f32_16x16x32_bf16 v[36:39], v[148:151], v[64:67], v[36:39]
    v_mfma_f32_16x16x32_bf16 v[32:35], v[144:147], v[68:71], v[32:35]
    v_mfma_f32_16x16x32_bf16 v[36:39], v[148:151], v[68:71], v[36:39]
    v_mfma_f32_16x16x32_bf16 v[32:35], v[144:147], v[72:75], v[32:35]
    v_mfma_f32_16x16x32_bf16 v[36:39], v[148:151], v[72:75], v[36:39]
    s_waitcnt vmcnt(6)
    v_mfma_f32_16x16x32_bf16 v[40:43], v[144:147], v[76:79], v[40:43]
    v_mfma_f32_16x16x32_bf16 v[44:47], v[148:151], v[76:79], v[44:47]
    v_mfma_f32_16x16x32_bf16 v[40:43], v[144:147], v[80:83], v[40:43]
    v_mfma_f32_16x16x32_bf16 v[44:47], v[148:151], v[80:83], v[44:47]
    v_mfma_f32_16x16x32_bf16 v[40:43], v[144:147], v[84:87], v[40:43]
    v_mfma_f32_16x16x32_bf16 v[44:47], v[148:151], v[84:87], v[44:47]
    s_nop 1
    v_fma_f32 v32, v32, v192, v112
    v_fma_f32 v33, v33, v192, v113
    v_fma_f32 v34, v34, v192, v114
    v_fma_f32 v35, v35, v192, v115
    v_fma_f32 v36, v36, v192, v116
    v_fma_f32 v37, v37, v192, v117
    v_fma_f32 v38, v38, v192, v118
    v_fma_f32 v39, v39, v192, v119
    v_cvt_pk_bf16_f32 v160, v32, v33
    v_cvt_pk_bf16_f32 v161, v34, v35
    v_cvt_pk_bf16_f32 v162, v36, v37
    v_cvt_pk_bf16_f32 v163, v38, v39
    s_nop 1
    v_permlane16_swap_b32 v160, v162
    v_permlane16_swap_b32 v161, v163
    s_waitcnt vmcnt(3)
    v_mfma_f32_16x16x32_bf16 v[48:51], v[144:147], v[88:91], v[48:51]
    v_mfma_f32_16x16x32_bf16 v[52:55], v[148:151], v[88:91], v[52:55]
    v_mfma_f32_16x16x32_bf16 v[48:51], v[144:147], v[92:95], v[48:51]
    v_mfma_f32_16x16x32_bf16 v[52:55], v[148:151], v[92:95], v[52:55]
    v_mfma_f32_16x16x32_bf16 v[48:51], v[144:147], v[96:99], v[48:51]
    v_mfma_f32_16x16x32_bf16 v[52:55], v[148:151], v[96:99], v[52:55]
    s_nop 1
    v_fma_f32 v40, v40, v192, v120
    v_fma_f32 v41, v41, v192, v121
    v_fma_f32 v42, v42, v192, v122
    v_fma_f32 v43, v43, v192, v123
    v_fma_f32 v44, v44, v192, v124
    v_fma_f32 v45, v45, v192, v125
    v_fma_f32 v46, v46, v192, v126
    v_fma_f32 v47, v47, v192, v127
    v_cvt_pk_bf16_f32 v164, v40, v41
    v_cvt_pk_bf16_f32 v165, v42, v43
    v_cvt_pk_bf16_f32 v166, v44, v45
    v_cvt_pk_bf16_f32 v167, v46, v47
    s_nop 1
    v_permlane16_swap_b32 v164, v166
    v_permlane16_swap_b32 v165, v167
    v_mov_b32 v12, v160
    v_mov_b32 v13, v161
    v_mov_b32 v14, v162
    v_mov_b32 v15, v163
    v_mov_b32_dpp v160, v164 row_ror:8 row_mask:0xf bank_mask:0xc
    v_mov_b32_dpp v161, v165 row_ror:8 row_mask:0xf bank_mask:0xc
    v_mov_b32_dpp v162, v166 row_ror:8 row_mask:0xf bank_mask:0xc
    v_mov_b32_dpp v163, v167 row_ror:8 row_mask:0xf bank_mask:0xc
    v_mov_b32_dpp v164, v12 row_ror:8 row_mask:0xf bank_mask:0x3
    v_mov_b32_dpp v165, v13 row_ror:8 row_mask:0xf bank_mask:0x3
    v_mov_b32_dpp v166, v14 row_ror:8 row_mask:0xf bank_mask:0x3
    v_mov_b32_dpp v167, v15 row_ror:8 row_mask:0xf bank_mask:0x3
    buffer_store_dwordx4 v[160:163], v16, s[44:47], s42 offen offset:0 sc1
    buffer_store_dwordx4 v[164:167], v17, s[44:47], s42 offen offset:0 sc1
    s_waitcnt vmcnt(2)
    v_mfma_f32_16x16x32_bf16 v[56:59], v[144:147], v[100:103], v[56:59]
    v_mfma_f32_16x16x32_bf16 v[60:63], v[148:151], v[100:103], v[60:63]
    v_mfma_f32_16x16x32_bf16 v[56:59], v[144:147], v[104:107], v[56:59]
    v_mfma_f32_16x16x32_bf16 v[60:63], v[148:151], v[104:107], v[60:63]
    v_mfma_f32_16x16x32_bf16 v[56:59], v[144:147], v[108:111], v[56:59]
    v_mfma_f32_16x16x32_bf16 v[60:63], v[148:151], v[108:111], v[60:63]
    s_nop 1
    v_fma_f32 v48, v48, v193, v128
    v_fma_f32 v49, v49, v193, v129
    v_fma_f32 v50, v50, v193, v130
    v_fma_f32 v51, v51, v193, v131
    v_fma_f32 v52, v52, v193, v132
    v_fma_f32 v53, v53, v193, v133
    v_fma_f32 v54, v54, v193, v134
    v_fma_f32 v55, v55, v193, v135
    v_cvt_pk_bf16_f32 v168, v48, v49
    v_cvt_pk_bf16_f32 v169, v50, v51
    v_cvt_pk_bf16_f32 v170, v52, v53
    v_cvt_pk_bf16_f32 v171, v54, v55
    s_nop 1
    v_permlane16_swap_b32 v168, v170
    v_permlane16_swap_b32 v169, v171
    s_nop 7
    v_fma_f32 v56, v56, v193, v136
    v_fma_f32 v57, v57, v193, v137
    v_fma_f32 v58, v58, v193, v138
    v_fma_f32 v59, v59, v193, v139
    v_fma_f32 v60, v60, v193, v140
    v_fma_f32 v61, v61, v193, v141
    v_fma_f32 v62, v62, v193, v142
    v_fma_f32 v63, v63, v193, v143
    v_cvt_pk_bf16_f32 v172, v56, v57
    v_cvt_pk_bf16_f32 v173, v58, v59
    v_cvt_pk_bf16_f32 v174, v60, v61
    v_cvt_pk_bf16_f32 v175, v62, v63
    s_nop 1
    v_permlane16_swap_b32 v172, v174
    v_permlane16_swap_b32 v173, v175
    v_mov_b32 v12, v168
    v_mov_b32 v13, v169
    v_mov_b32 v14, v170
    v_mov_b32 v15, v171
    v_mov_b32_dpp v168, v172 row_ror:8 row_mask:0xf bank_mask:0xc
    v_mov_b32_dpp v169, v173 row_ror:8 row_mask:0xf bank_mask:0xc
    v_mov_b32_dpp v170, v174 row_ror:8 row_mask:0xf bank_mask:0xc
    v_mov_b32_dpp v171, v175 row_ror:8 row_mask:0xf bank_mask:0xc
    v_mov_b32_dpp v172, v12 row_ror:8 row_mask:0xf bank_mask:0x3
    v_mov_b32_dpp v173, v13 row_ror:8 row_mask:0xf bank_mask:0x3
    v_mov_b32_dpp v174, v14 row_ror:8 row_mask:0xf bank_mask:0x3
    v_mov_b32_dpp v175, v15 row_ror:8 row_mask:0xf bank_mask:0x3
    buffer_store_dwordx4 v[168:171], v16, s[44:47], s42 offen offset:128 sc1
    buffer_store_dwordx4 v[172:175], v17, s[44:47], s42 offen offset:128 sc1
L_sequential_preLN__mha_block__glu_gated_reglu__prompt_kernel_end:
    s_endpgm

.section .rodata,"a"
.p2align 6
.amdhsa_kernel sequential_preLN__mha_block__glu_gated_reglu__prompt_kernel
  .amdhsa_next_free_vgpr 512
  .amdhsa_next_free_sgpr 102
  .amdhsa_accum_offset 256
  .amdhsa_group_segment_fixed_size 0
  .amdhsa_kernarg_size 80
  .amdhsa_user_sgpr_count 2
  .amdhsa_user_sgpr_kernarg_segment_ptr 1
  .amdhsa_system_sgpr_workgroup_id_x 1
  .amdhsa_float_denorm_mode_32 3
.end_amdhsa_kernel
```
